```python
import torch

def _softmax(x, axis=-1):
    return torch.softmax(x, dim=axis)

def _gelu(x):
    return torch.nn.functional.gelu(x, approximate='tanh')

def _silu(x):
    return torch.nn.functional.silu(x)

def _sigmoid(x):
    return torch.sigmoid(x)

def _layernorm(x, axis=-1, eps=1e-05):
    m = x.mean(dim=axis, keepdim=True)
    v = x.var(dim=axis, keepdim=True, unbiased=False)
    return (x - m) / torch.sqrt(v + eps)

def _scatter_add(tgt, idx, src, axis=0):
    return tgt.clone().index_add_(axis, idx, src)

def _segment_sum(src, seg, n):
    out = torch.zeros((n,) + src.shape[1:], dtype=src.dtype)
    return out.index_add_(0, seg, src)

def _pad(x, pw):
    flat = tuple((v for pair in reversed(pw) for v in pair))
    return torch.nn.functional.pad(x, flat)
kernel_name = 'gated_mix__memory_aug_recurrent_mem_tr__moe_arch_mod__prompt'

def setup_inputs():

    _w = lambda a: (lambda t: t.to(torch.bfloat16) if t.is_floating_point() else t)(torch.as_tensor(a))

    def _A_setup():
        B, S, Dm = (1, 2048, 1024)
        H, Dh = (32, 128)
        M, seg = (8, 32)
        seg = min(seg, S)
        S = S // seg * seg
        return {'x': _w((lambda *s: torch.randn(*s, dtype=torch.bfloat16) * 0.05)(B, S, Dm)), 'mem0': _w((lambda *s: torch.randn(*s, dtype=torch.bfloat16) * 0.8)(B, M, Dm)), 'Wq': _w((lambda *s: torch.randn(*s, dtype=torch.bfloat16) * 3.2)(Dm, H, Dh) * Dm ** (-0.5)), 'Wk': _w((lambda *s: torch.randn(*s, dtype=torch.bfloat16) * 3.2)(Dm, H, Dh) * Dm ** (-0.5)), 'Wv': _w((lambda *s: torch.randn(*s, dtype=torch.bfloat16) * 0.8)(Dm, H, Dh) * Dm ** (-0.5)), 'Wo': _w((lambda *s: torch.randn(*s, dtype=torch.bfloat16) * 0.8)(H, Dh, Dm) * (H * Dh) ** (-0.5)), 'seg_len': seg}
    _A_in = _A_setup()

    def _B_setup():
        B, S, D, F, C = (1, 2048, 1024, 3584, 1)
        return {'x': _w((lambda *s: torch.randn(*s, dtype=torch.bfloat16) * 0.05)(B, S, D)), 'w_r': _w((lambda *s: torch.randn(*s, dtype=torch.bfloat16) * 1.6)(D)), 'w_gate': _w((lambda *s: torch.randn(*s, dtype=torch.bfloat16) * 0.2)(D, F)), 'w_up': _w((lambda *s: torch.randn(*s, dtype=torch.bfloat16) * 0.2)(D, F)), 'w_down': _w((lambda *s: torch.randn(*s, dtype=torch.bfloat16) * 0.2)(F, D))}
    _B_in = _B_setup()
    return {'A_x': _A_in['x'], 'A_mem0': _A_in['mem0'], 'A_Wq': _A_in['Wq'], 'A_Wk': _A_in['Wk'], 'A_Wv': _A_in['Wv'], 'A_Wo': _A_in['Wo'], 'A_seg_len': _A_in['seg_len'], 'B_x': _B_in['x'], 'B_w_r': _B_in['w_r'], 'B_w_gate': _B_in['w_gate'], 'B_w_up': _B_in['w_up'], 'B_w_down': _B_in['w_down'], 'gate_w': _w((lambda *s: torch.randn(*s, dtype=torch.bfloat16) * 0.05)(1024) * 16.0)}

def reference(A_x, A_mem0, A_Wq, A_Wk, A_Wv, A_Wo, A_seg_len, B_x, B_w_r, B_w_gate, B_w_up, B_w_down, gate_w):

    def _A_ref(x, mem0, Wq, Wk, Wv, Wo, seg_len):
        B, S, Dm = x.shape
        H, Dh = (Wq.shape[1], Wq.shape[2])
        M = mem0.shape[1]
        scale = Dh ** (-0.5)
        n_seg = S // seg_len
        L = M + seg_len
        idx = torch.arange(L)
        mask = (idx[:, None] < M) | (idx[:, None] >= idx[None, :])
        mem = mem0
        outs = []
        for s in range(n_seg):
            xs = x[:, s * seg_len:(s + 1) * seg_len, :].clone()
            h = torch.concatenate([mem, xs], axis=1)
            q = torch.einsum('btd,dhe->bhte', h, Wq)
            k = torch.einsum('btd,dhe->bhte', h, Wk)
            v = torch.einsum('btd,dhe->bhte', h, Wv)
            scores = torch.einsum('bhqe,bhke->bhqk', q, k) * scale
            scores = torch.where(mask[None, None], scores, -1000000000.0)
            p = _softmax(scores, axis=-1)
            o = torch.einsum('bhqk,bhke->bhqe', p, v)
            o = torch.einsum('bhte,hed->btd', o, Wo)
            mem = o[:, :M, :].clone()
            outs.append(o[:, M:, :])
        return torch.concatenate(outs, axis=1)

    def _B_ref(x, w_r, w_gate, w_up, w_down):
        B, S, D = x.shape
        C = 1
        r = x @ w_r
        idx = torch.argsort(-r, axis=-1)[:, :C]
        idx_e = (lambda x, n, axis: torch.repeat_interleave(x, n, dim=axis))(idx.reshape(B, C, 1), D, axis=2)
        x_sel = (lambda x, i, axis: torch.take_along_dim(x, i, dim=axis))(x, idx_e, axis=1)
        g = _silu(x_sel @ w_gate)
        u = x_sel @ w_up
        y = g * u @ w_down
        r_sel = _sigmoid((lambda x, i, axis: torch.take_along_dim(x, i, dim=axis))(r, idx, axis=1))
        y = y * r_sel.reshape(B, C, 1)
        b_off = (torch.arange(B) * S).reshape(B, 1)
        flat_idx = (idx + b_off).reshape(B * C)
        zero = (x * 0.0).reshape(B * S, D)
        upd = _scatter_add(zero, flat_idx, y.reshape(B * C, D), axis=0)
        return x + upd.reshape(B, S, D)
    x = A_x
    g = _sigmoid((x * gate_w).sum(-1, keepdims=True))
    a = _A_ref(x, A_mem0, A_Wq, A_Wk, A_Wv, A_Wo, A_seg_len)
    b = _B_ref(x, B_w_r, B_w_gate, B_w_up, B_w_down)
    return g * a + (1 - g) * b
```

```asm
; @launch grid=(256,1,1) block=(256,1,1) lds=163840
.amdgcn_target "amdgcn-amd-amdhsa--gfx950"
.text
.globl gated_mix__memory_aug_recurrent_mem_tr__moe_arch_mod__prompt_kernel
.p2align 8
.type gated_mix__memory_aug_recurrent_mem_tr__moe_arch_mod__prompt_kernel,@function
gated_mix__memory_aug_recurrent_mem_tr__moe_arch_mod__prompt_kernel:
    s_cmp_ge_u32 s2, 256
    s_cbranch_scc1 L_exit
    s_load_dwordx16 s[4:19], s[0:1], 0
    s_load_dwordx16 s[20:35], s[0:1], 64
    s_getreg_b32 s52, hwreg(HW_REG_XCC_ID, 0, 4)
    v_lshrrev_b32 v1, 6, v0
    v_lshlrev_b32 v2, 4, v0
    v_readfirstlane_b32 s54, v1
    v_and_b32 v0, 63, v0
    s_mov_b32 s55, 0
    s_mov_b32 s56, 0
    s_mov_b32 s57, 65536
    s_and_b32 s98, s52, 7
    s_lshl_b32 s98, s98, 5
    v_mov_b32 v4, 0
    v_mov_b32 v5, 0
    v_mov_b32 v6, 0
    v_mov_b32 v7, 0
    v_mov_b32 v8, s98
    v_mov_b32 v9, 1
    s_waitcnt lgkmcnt(0)
    s_mov_b32 s36, s34
    s_and_b32 s37, s35, 0xffff
    s_mov_b32 s38, 0x10000000
    s_mov_b32 s39, 0x20000
    s_lshl_b32 s96, s2, 12
    s_add_u32 s97, s96, 0x100000
    s_cmp_lg_u32 s54, 0
    s_cbranch_scc1 L_noticket
    s_mov_b64 exec, 1
    global_atomic_add v3, v8, v9, s[32:33] sc0
    s_mov_b64 exec, -1
    buffer_store_dwordx4 v[4:7], v2, s[36:39], s96 offen sc1
    buffer_store_dwordx4 v[4:7], v2, s[36:39], s97 offen sc1
    s_waitcnt vmcnt(2)
    v_and_b32 v3, 0xffff, v3
    s_mov_b64 exec, 1
    ds_write_b32 v4, v3
    s_mov_b64 exec, -1
    s_branch L_ticket2
    s_nop 0
L_noticket:
    buffer_store_dwordx4 v[4:7], v2, s[36:39], s96 offen sc1
    buffer_store_dwordx4 v[4:7], v2, s[36:39], s97 offen sc1
L_ticket2:
    s_waitcnt vmcnt(0) lgkmcnt(0)
    s_barrier
    ds_read_b32 v3, v4
    s_cmp_lg_u32 s54, 0
    s_cbranch_scc1 L_ticket3
    v_mov_b32 v9, 0x10000
    s_mov_b64 exec, 1
    global_atomic_add v8, v9, s[32:33]
    s_mov_b64 exec, -1
L_ticket3:
    s_waitcnt lgkmcnt(0)
    v_readfirstlane_b32 s53, v3
    s_barrier
    s_cmp_ge_u32 s53, 32
    s_cbranch_scc1 L_census_first
    s_cmp_ge_u32 s52, 8
    s_cbranch_scc0 L_dispatch
L_census_first:
    s_cmp_eq_u32 s56, 1
    s_cbranch_scc1 L_cenok_2
    v_and_b32 v238, 7, v0
    v_lshlrev_b32 v238, 5, v238
L_cen_1:
    global_load_dword v239, v238, s[32:33] sc1
    s_waitcnt vmcnt(0)
L_cen_1_w:
    v_lshrrev_b32 v30, 16, v239
    s_mov_b32 s96, 0
    v_readlane_b32 s97, v30, 0
    s_add_u32 s96, s96, s97
    v_readlane_b32 s97, v30, 1
    s_add_u32 s96, s96, s97
    v_readlane_b32 s97, v30, 2
    s_add_u32 s96, s96, s97
    v_readlane_b32 s97, v30, 3
    s_add_u32 s96, s96, s97
    v_readlane_b32 s97, v30, 4
    s_add_u32 s96, s96, s97
    v_readlane_b32 s97, v30, 5
    s_add_u32 s96, s96, s97
    v_readlane_b32 s97, v30, 6
    s_add_u32 s96, s96, s97
    v_readlane_b32 s97, v30, 7
    s_add_u32 s96, s96, s97
    s_cmp_eq_u32 s96, 256
    s_cbranch_scc1 L_cen_1_done
    s_sub_u32 s57, s57, 1
    s_cbranch_scc1 L_exit
    s_branch L_cen_1
L_cen_1_done:
    s_mov_b32 s56, 1
    v_cmp_ne_u32 vcc, 0x200020, v239
    s_cbranch_vccz L_cenok_2
    s_lshr_b32 s52, s2, 5
    s_and_b32 s53, s2, 31
    s_mov_b32 s55, 1
    s_waitcnt vmcnt(0)
    s_barrier
    s_branch L_dispatch
L_cenok_2:
    s_branch L_exit
    s_nop 0
L_dispatch:
    s_cmp_lt_u32 s52, 4
    s_cbranch_scc1 L_chain
    s_cmp_eq_u32 s52, 7
    s_cbranch_scc1 L_mod
L_qkv:
    s_cmp_eq_u32 s52, 4
    s_cselect_b32 s40, s10, s12
    s_cselect_b32 s41, s11, s13
    s_cmp_eq_u32 s52, 6
    s_cselect_b32 s40, s8, s40
    s_cselect_b32 s41, s9, s41
    s_and_b32 s41, s41, 0xffff
    s_mov_b32 s42, 0x800000
    s_mov_b32 s43, 0x20000
    s_mov_b32 s44, s4
    s_and_b32 s45, s5, 0xffff
    s_mov_b32 s46, 0x400000
    s_mov_b32 s47, 0x20000
    s_lshl_b32 s96, s54, 3
    s_add_u32 s97, s96, 0
    s_and_b32 s98, s97, 15
    v_xor_b32 v29, s98, v0
    v_lshlrev_b32 v29, 4, v29
    s_lshl_b32 s97, s97, 11
    v_add_u32 v2, s97, v29
    s_add_u32 s97, s96, 1
    s_and_b32 s98, s97, 15
    v_xor_b32 v29, s98, v0
    v_lshlrev_b32 v29, 4, v29
    s_lshl_b32 s97, s97, 11
    v_add_u32 v3, s97, v29
    s_add_u32 s97, s96, 2
    s_and_b32 s98, s97, 15
    v_xor_b32 v29, s98, v0
    v_lshlrev_b32 v29, 4, v29
    s_lshl_b32 s97, s97, 11
    v_add_u32 v4, s97, v29
    s_add_u32 s97, s96, 3
    s_and_b32 s98, s97, 15
    v_xor_b32 v29, s98, v0
    v_lshlrev_b32 v29, 4, v29
    s_lshl_b32 s97, s97, 11
    v_add_u32 v5, s97, v29
    s_add_u32 s97, s96, 4
    s_and_b32 s98, s97, 15
    v_xor_b32 v29, s98, v0
    v_lshlrev_b32 v29, 4, v29
    s_lshl_b32 s97, s97, 11
    v_add_u32 v6, s97, v29
    s_add_u32 s97, s96, 5
    s_and_b32 s98, s97, 15
    v_xor_b32 v29, s98, v0
    v_lshlrev_b32 v29, 4, v29
    s_lshl_b32 s97, s97, 11
    v_add_u32 v7, s97, v29
    s_add_u32 s97, s96, 6
    s_and_b32 s98, s97, 15
    v_xor_b32_e64 v29, s98, v0
    v_lshlrev_b32 v29, 4, v29
    s_lshl_b32 s97, s97, 11
    v_add_u32_e64 v8, s97, v29
    s_add_u32 s97, s96, 7
    s_and_b32 s98, s97, 15
    v_xor_b32_e64 v29, s98, v0
    v_lshlrev_b32 v29, 4, v29
    s_lshl_b32 s97, s97, 11
    v_add_u32_e64 v9, s97, v29
    s_lshl_b32 s67, s54, 14
    s_mov_b32 s63, 0
    s_add_u32 m0, s67, 0
    s_nop 0
    buffer_load_dwordx4 v2, s[44:47], s63 offen offset:0 lds
    s_add_u32 m0, s67, 0
    s_nop 0
    buffer_load_dwordx4 v2, s[44:47], s63 offen offset:1024 lds
    s_add_u32 m0, s67, 2048
    s_nop 0
    buffer_load_dwordx4 v3, s[44:47], s63 offen offset:0 lds
    s_add_u32 m0, s67, 2048
    s_nop 0
    buffer_load_dwordx4 v3, s[44:47], s63 offen offset:1024 lds
    s_add_u32 m0, s67, 4096
    s_nop 0
    buffer_load_dwordx4 v4, s[44:47], s63 offen offset:0 lds
    s_add_u32 m0, s67, 4096
    s_nop 0
    buffer_load_dwordx4 v4, s[44:47], s63 offen offset:1024 lds
    s_add_u32 m0, s67, 6144
    s_nop 0
    buffer_load_dwordx4 v5, s[44:47], s63 offen offset:0 lds
    s_add_u32 m0, s67, 6144
    s_nop 0
    buffer_load_dwordx4 v5, s[44:47], s63 offen offset:1024 lds
    s_add_u32 m0, s67, 8192
    s_nop 0
    buffer_load_dwordx4 v6, s[44:47], s63 offen offset:0 lds
    s_add_u32 m0, s67, 8192
    s_nop 0
    buffer_load_dwordx4 v6, s[44:47], s63 offen offset:1024 lds
    s_add_u32 m0, s67, 10240
    s_nop 0
    buffer_load_dwordx4 v7, s[44:47], s63 offen offset:0 lds
    s_add_u32 m0, s67, 10240
    s_nop 0
    buffer_load_dwordx4 v7, s[44:47], s63 offen offset:1024 lds
    s_add_u32 m0, s67, 12288
    s_nop 0
    buffer_load_dwordx4 v8, s[44:47], s63 offen offset:0 lds
    s_add_u32 m0, s67, 12288
    s_nop 0
    buffer_load_dwordx4 v8, s[44:47], s63 offen offset:1024 lds
    s_add_u32 m0, s67, 14336
    s_nop 0
    buffer_load_dwordx4 v9, s[44:47], s63 offen offset:0 lds
    s_add_u32 m0, s67, 14336
    s_nop 0
    buffer_load_dwordx4 v9, s[44:47], s63 offen offset:1024 lds
    s_mul_i32 s61, s54, 24576
    s_add_u32 s61, s61, 65536
    s_lshl_b32 s62, s53, 8
    s_lshl_b32 s96, s54, 6
    s_add_u32 s62, s62, s96
    v_lshrrev_b32 v29, 2, v0
    v_lshlrev_b32 v29, 13, v29
    v_and_b32 v30, 3, v0
    v_lshrrev_b32 v31, 5, v0
    v_lshlrev_b32 v31, 1, v31
    v_xor_b32 v31, v31, v30
    v_lshl_add_u32 v32, v31, 4, v29
    v_lshrrev_b32 v29, 5, v0
    v_lshlrev_b32_e64 v29, 10, v29
    v_lshl_add_u32 v29, v30, 3, v29
    v_bfe_u32 v30, v0, 2, 2
    v_lshl_add_u32 v29, v30, 6, v29
    v_bfe_u32 v30, v0, 4, 1
    v_mul_u32_u24 v30, 544, v30
    v_add_u32 v29, v29, v30
    v_add_u32 v33, s61, v29
    v_xor_b32 v34, 32, v33
    v_and_b32 v31, 15, v0
    v_lshlrev_b32 v29, 11, v31
    v_lshrrev_b32 v30, 4, v0
    v_add_u32 v35, 0, v30
    v_xor_b32 v35, v35, v31
    v_lshl_add_u32 v10, v35, 4, v29
    v_add_u32 v14, 0x10000, v10
    v_add_u32 v35, 4, v30
    v_xor_b32 v35, v35, v31
    v_lshl_add_u32 v11, v35, 4, v29
    v_add_u32 v15, 0x10000, v11
    v_add_u32 v35, 8, v30
    v_xor_b32 v35, v35, v31
    v_lshl_add_u32 v12, v35, 4, v29
    v_add_u32 v16, 0x10000, v12
    v_add_u32 v35, 12, v30
    v_xor_b32 v35, v35, v31
    v_lshl_add_u32 v13, v35, 4, v29
    v_add_u32 v17, 0x10000, v13
    v_lshlrev_b32 v26, 4, v0
    s_cmp_eq_u32 s52, 5
    s_cselect_b32 s96, 11, 10
    s_cselect_b32 s97, 8192, 0
    s_lshl_b32 s96, s54, s96
    s_add_u32 s96, s96, s97
    s_cmp_eq_u32 s52, 6
    s_cselect_b32 s97, 13, 14
    s_lshl_b32 s97, s53, s97
    s_add_u32 s96, s96, s97
    s_mov_b32 s97, 16777216
    s_mov_b32 s65, 0x80000
    s_cmp_eq_u32 s52, 6
    s_cselect_b32 s97, 50331648, s97
    s_cselect_b32 s65, 0x40000, s65
    s_add_u32 s64, s96, s97
    s_sub_u32 s96, s52, 4
    s_lshl_b32 s96, s96, 2
    s_add_u32 s96, s96, s54
    s_lshl_b32 s96, s96, 2
    s_lshl_b32 s97, s53, 7
    s_add_u32 s66, s96, s97
    s_add_u32 s66, s66, 0
    v_mov_b32 v29, 0x40000000
    v_cmp_eq_u32 vcc, 0, v0
    s_nop 1
    v_cndmask_b32 v106, v29, 0, vcc
    v_mov_b32 v27, 1
    s_lshl_b32 s96, s53, 11
    s_lshl_b32 s97, s54, 9
    s_add_u32 s96, s96, s97
    s_add_u32 s96, s96, 65536
    v_lshl_add_u32 v104, v0, 6, s96
    v_cmp_gt_u32 vcc, 8, v0
    s_nop 1
    v_cndmask_b32_e64 v104, v29, v104, vcc
    s_mov_b32 s58, 0
    s_mov_b32 s68, 0
    s_mov_b32 s69, 0
    s_mov_b32 s70, 0
    s_waitcnt lgkmcnt(0)
    s_cmp_eq_u32 s52, 5
    s_cbranch_scc1 L_qkv_v
L_qkv_k:
    s_add_u32 m0, s61, 0
    s_add_u32 s97, s62, 0
    buffer_load_dwordx4 v32, s[40:43], s97 offen lds
    s_add_u32 m0, s61, 1024
    s_add_u32 s97, s62, 131072
    buffer_load_dwordx4 v32, s[40:43], s97 offen lds
    s_add_u32 m0, s61, 2048
    s_add_u32 s97, s62, 262144
    buffer_load_dwordx4 v32, s[40:43], s97 offen lds
    s_add_u32 m0, s61, 3072
    s_add_u32 s97, s62, 393216
    buffer_load_dwordx4 v32, s[40:43], s97 offen lds
    s_add_u32 m0, s61, 4096
    s_add_u32 s97, s62, 524288
    buffer_load_dwordx4 v32, s[40:43], s97 offen lds
    s_add_u32 m0, s61, 5120
    s_add_u32 s97, s62, 655360
    buffer_load_dwordx4 v32, s[40:43], s97 offen lds
    s_add_u32 m0, s61, 6144
    s_add_u32 s97, s62, 786432
    buffer_load_dwordx4 v32, s[40:43], s97 offen lds
    s_add_u32 m0, s61, 7168
    s_add_u32 s97, s62, 917504
    buffer_load_dwordx4 v32, s[40:43], s97 offen lds
    s_add_u32 m0, s61, 8192
    s_add_u32 s97, s62, 1048576
    buffer_load_dwordx4 v32, s[40:43], s97 offen lds
    s_add_u32 m0, s61, 9216
    s_add_u32 s97, s62, 1179648
    buffer_load_dwordx4 v32, s[40:43], s97 offen lds
    s_add_u32 m0, s61, 10240
    s_add_u32 s97, s62, 1310720
    buffer_load_dwordx4 v32, s[40:43], s97 offen lds
    s_add_u32 m0, s61, 11264
    s_add_u32 s97, s62, 1441792
    buffer_load_dwordx4 v32, s[40:43], s97 offen lds
    s_add_u32 m0, s61, 12288
    s_add_u32 s97, s62, 1572864
    buffer_load_dwordx4 v32, s[40:43], s97 offen lds
    s_add_u32 m0, s61, 13312
    s_add_u32 s97, s62, 1703936
    buffer_load_dwordx4 v32, s[40:43], s97 offen lds
    s_add_u32 m0, s61, 14336
    s_add_u32 s97, s62, 1835008
    buffer_load_dwordx4 v32, s[40:43], s97 offen lds
    s_add_u32 m0, s61, 15360
    s_add_u32 s97, s62, 1966080
    buffer_load_dwordx4 v32, s[40:43], s97 offen lds
    s_add_u32 m0, s61, 16384
    s_add_u32 s97, s62, 2097152
    buffer_load_dwordx4 v32, s[40:43], s97 offen lds
    s_add_u32 m0, s61, 17408
    s_add_u32 s97, s62, 2228224
    buffer_load_dwordx4 v32, s[40:43], s97 offen lds
    s_add_u32 m0, s61, 18432
    s_add_u32 s97, s62, 2359296
    buffer_load_dwordx4 v32, s[40:43], s97 offen lds
    s_add_u32 m0, s61, 19456
    s_add_u32 s97, s62, 2490368
    buffer_load_dwordx4 v32, s[40:43], s97 offen lds
    s_add_u32 m0, s61, 20480
    s_add_u32 s97, s62, 2621440
    buffer_load_dwordx4 v32, s[40:43], s97 offen lds
    s_add_u32 m0, s61, 21504
    s_add_u32 s97, s62, 2752512
    buffer_load_dwordx4 v32, s[40:43], s97 offen lds
    s_add_u32 m0, s61, 22528
    s_add_u32 s97, s62, 2883584
    buffer_load_dwordx4 v32, s[40:43], s97 offen lds
    s_add_u32 m0, s61, 23552
    s_add_u32 s97, s62, 3014656
    buffer_load_dwordx4 v32, s[40:43], s97 offen lds
    s_waitcnt vmcnt(16)
    ds_read_b64_tr_b16 a[0:1], v33 offset:0
    ds_read_b64_tr_b16 a[2:3], v33 offset:256
    ds_read_b64_tr_b16 a[4:5], v34 offset:0
    ds_read_b64_tr_b16 a[6:7], v34 offset:256
    ds_read_b64_tr_b16 a[8:9], v33 offset:2048
    ds_read_b64_tr_b16 a[10:11], v33 offset:2304
    ds_read_b64_tr_b16 a[12:13], v34 offset:2048
    ds_read_b64_tr_b16 a[14:15], v34 offset:2304
    ds_read_b64_tr_b16 a[16:17], v33 offset:4096
    ds_read_b64_tr_b16 a[18:19], v33 offset:4352
    ds_read_b64_tr_b16 a[20:21], v34 offset:4096
    ds_read_b64_tr_b16 a[22:23], v34 offset:4352
    ds_read_b64_tr_b16 a[24:25], v33 offset:6144
    ds_read_b64_tr_b16 a[26:27], v33 offset:6400
    ds_read_b64_tr_b16 a[28:29], v34 offset:6144
    ds_read_b64_tr_b16 a[30:31], v34 offset:6400
    s_waitcnt lgkmcnt(0)
    s_add_u32 m0, s61, 0
    s_add_u32 s97, s62, 3145728
    buffer_load_dwordx4 v32, s[40:43], s97 offen lds
    s_add_u32 m0, s61, 1024
    s_add_u32 s97, s62, 3276800
    buffer_load_dwordx4 v32, s[40:43], s97 offen lds
    s_add_u32 m0, s61, 2048
    s_add_u32 s97, s62, 3407872
    buffer_load_dwordx4 v32, s[40:43], s97 offen lds
    s_add_u32 m0, s61, 3072
    s_add_u32 s97, s62, 3538944
    buffer_load_dwordx4 v32, s[40:43], s97 offen lds
    s_add_u32 m0, s61, 4096
    s_add_u32 s97, s62, 3670016
    buffer_load_dwordx4 v32, s[40:43], s97 offen lds
    s_add_u32 m0, s61, 5120
    s_add_u32 s97, s62, 3801088
    buffer_load_dwordx4 v32, s[40:43], s97 offen lds
    s_add_u32 m0, s61, 6144
    s_add_u32 s97, s62, 3932160
    buffer_load_dwordx4 v32, s[40:43], s97 offen lds
    s_add_u32 m0, s61, 7168
    s_add_u32 s97, s62, 4063232
    buffer_load_dwordx4 v32, s[40:43], s97 offen lds
    s_barrier
    ds_read_b128 v[72:75], v10 offset:0
    ds_read_b128 v[76:79], v10 offset:32768
    ds_read_b128 v[80:83], v11 offset:0
    ds_read_b128 v[84:87], v11 offset:32768
    ds_read_b128 v[88:91], v12 offset:0
    ds_read_b128 v[92:95], v12 offset:32768
    ds_read_b128 v[96:99], v13 offset:0
    ds_read_b128 v[100:103], v13 offset:32768
    s_waitcnt lgkmcnt(7)
    v_mfma_f32_16x16x32_bf16 v[40:43], a[0:3], v[72:75], 0
    v_mfma_f32_16x16x32_bf16 v[44:47], a[4:7], v[72:75], 0
    s_waitcnt lgkmcnt(6)
    v_mfma_f32_16x16x32_bf16 v[48:51], a[0:3], v[76:79], 0
    v_mfma_f32_16x16x32_bf16 v[52:55], a[4:7], v[76:79], 0
    s_waitcnt lgkmcnt(5)
    v_mfma_f32_16x16x32_bf16 v[40:43], a[8:11], v[80:83], v[40:43]
    v_mfma_f32_16x16x32_bf16 v[44:47], a[12:15], v[80:83], v[44:47]
    s_waitcnt lgkmcnt(4)
    v_mfma_f32_16x16x32_bf16 v[48:51], a[8:11], v[84:87], v[48:51]
    v_mfma_f32_16x16x32_bf16 v[52:55], a[12:15], v[84:87], v[52:55]
    s_waitcnt lgkmcnt(3)
    v_mfma_f32_16x16x32_bf16 v[40:43], a[16:19], v[88:91], v[40:43]
    v_mfma_f32_16x16x32_bf16 v[44:47], a[20:23], v[88:91], v[44:47]
    s_waitcnt lgkmcnt(2)
    v_mfma_f32_16x16x32_bf16 v[48:51], a[16:19], v[92:95], v[48:51]
    v_mfma_f32_16x16x32_bf16 v[52:55], a[20:23], v[92:95], v[52:55]
    s_waitcnt lgkmcnt(1)
    v_mfma_f32_16x16x32_bf16 v[40:43], a[24:27], v[96:99], v[40:43]
    v_mfma_f32_16x16x32_bf16 v[44:47], a[28:31], v[96:99], v[44:47]
    s_waitcnt lgkmcnt(0)
    v_mfma_f32_16x16x32_bf16 v[48:51], a[24:27], v[100:103], v[48:51]
    v_mfma_f32_16x16x32_bf16 v[52:55], a[28:31], v[100:103], v[52:55]
    s_waitcnt vmcnt(16)
    ds_read_b64_tr_b16 a[32:33], v33 offset:8192
    ds_read_b64_tr_b16 a[34:35], v33 offset:8448
    ds_read_b64_tr_b16 a[36:37], v34 offset:8192
    ds_read_b64_tr_b16 a[38:39], v34 offset:8448
    ds_read_b64_tr_b16 a[40:41], v33 offset:10240
    ds_read_b64_tr_b16 a[42:43], v33 offset:10496
    ds_read_b64_tr_b16 a[44:45], v34 offset:10240
    ds_read_b64_tr_b16 a[46:47], v34 offset:10496
    ds_read_b64_tr_b16 a[48:49], v33 offset:12288
    ds_read_b64_tr_b16 a[50:51], v33 offset:12544
    ds_read_b64_tr_b16 a[52:53], v34 offset:12288
    ds_read_b64_tr_b16 a[54:55], v34 offset:12544
    ds_read_b64_tr_b16 a[56:57], v33 offset:14336
    ds_read_b64_tr_b16 a[58:59], v33 offset:14592
    ds_read_b64_tr_b16 a[60:61], v34 offset:14336
    ds_read_b64_tr_b16 a[62:63], v34 offset:14592
    s_waitcnt lgkmcnt(0)
    s_add_u32 m0, s61, 8192
    s_add_u32 s97, s62, 4194304
    buffer_load_dwordx4 v32, s[40:43], s97 offen lds
    s_add_u32 m0, s61, 9216
    s_add_u32 s97, s62, 4325376
    buffer_load_dwordx4 v32, s[40:43], s97 offen lds
    s_add_u32 m0, s61, 10240
    s_add_u32 s97, s62, 4456448
    buffer_load_dwordx4 v32, s[40:43], s97 offen lds
    s_add_u32 m0, s61, 11264
    s_add_u32 s97, s62, 4587520
    buffer_load_dwordx4 v32, s[40:43], s97 offen lds
    s_add_u32 m0, s61, 12288
    s_add_u32 s97, s62, 4718592
    buffer_load_dwordx4 v32, s[40:43], s97 offen lds
    s_add_u32 m0, s61, 13312
    s_add_u32 s97, s62, 4849664
    buffer_load_dwordx4 v32, s[40:43], s97 offen lds
    s_add_u32 m0, s61, 14336
    s_add_u32 s97, s62, 4980736
    buffer_load_dwordx4 v32, s[40:43], s97 offen lds
    s_add_u32 m0, s61, 15360
    s_add_u32 s97, s62, 5111808
    buffer_load_dwordx4 v32, s[40:43], s97 offen lds
    ds_read_b128 v[72:75], v10 offset:256
    ds_read_b128 v[76:79], v10 offset:33024
    ds_read_b128 v[80:83], v11 offset:256
    ds_read_b128 v[84:87], v11 offset:33024
    ds_read_b128 v[88:91], v12 offset:256
    ds_read_b128 v[92:95], v12 offset:33024
    ds_read_b128 v[96:99], v13 offset:256
    ds_read_b128 v[100:103], v13 offset:33024
    s_waitcnt lgkmcnt(7)
    v_mfma_f32_16x16x32_bf16 v[40:43], a[32:35], v[72:75], v[40:43]
    v_mfma_f32_16x16x32_bf16 v[44:47], a[36:39], v[72:75], v[44:47]
    s_waitcnt lgkmcnt(6)
    v_mfma_f32_16x16x32_bf16 v[48:51], a[32:35], v[76:79], v[48:51]
    v_mfma_f32_16x16x32_bf16 v[52:55], a[36:39], v[76:79], v[52:55]
    s_waitcnt lgkmcnt(5)
    v_mfma_f32_16x16x32_bf16 v[40:43], a[40:43], v[80:83], v[40:43]
    v_mfma_f32_16x16x32_bf16 v[44:47], a[44:47], v[80:83], v[44:47]
    s_waitcnt lgkmcnt(4)
    v_mfma_f32_16x16x32_bf16 v[48:51], a[40:43], v[84:87], v[48:51]
    v_mfma_f32_16x16x32_bf16 v[52:55], a[44:47], v[84:87], v[52:55]
    s_waitcnt lgkmcnt(3)
    v_mfma_f32_16x16x32_bf16 v[40:43], a[48:51], v[88:91], v[40:43]
    v_mfma_f32_16x16x32_bf16 v[44:47], a[52:55], v[88:91], v[44:47]
    s_waitcnt lgkmcnt(2)
    v_mfma_f32_16x16x32_bf16 v[48:51], a[48:51], v[92:95], v[48:51]
    v_mfma_f32_16x16x32_bf16 v[52:55], a[52:55], v[92:95], v[52:55]
    s_waitcnt lgkmcnt(1)
    v_mfma_f32_16x16x32_bf16 v[40:43], a[56:59], v[96:99], v[40:43]
    v_mfma_f32_16x16x32_bf16 v[44:47], a[60:63], v[96:99], v[44:47]
    s_waitcnt lgkmcnt(0)
    v_mfma_f32_16x16x32_bf16 v[48:51], a[56:59], v[100:103], v[48:51]
    v_mfma_f32_16x16x32_bf16 v[52:55], a[60:63], v[100:103], v[52:55]
    s_waitcnt vmcnt(16)
    ds_read_b64_tr_b16 a[64:65], v33 offset:16384
    ds_read_b64_tr_b16 a[66:67], v33 offset:16640
    ds_read_b64_tr_b16 a[68:69], v34 offset:16384
    ds_read_b64_tr_b16 a[70:71], v34 offset:16640
    ds_read_b64_tr_b16 a[72:73], v33 offset:18432
    ds_read_b64_tr_b16 a[74:75], v33 offset:18688
    ds_read_b64_tr_b16 a[76:77], v34 offset:18432
    ds_read_b64_tr_b16 a[78:79], v34 offset:18688
    ds_read_b64_tr_b16 a[80:81], v33 offset:20480
    ds_read_b64_tr_b16 a[82:83], v33 offset:20736
    ds_read_b64_tr_b16 a[84:85], v34 offset:20480
    ds_read_b64_tr_b16 a[86:87], v34 offset:20736
    ds_read_b64_tr_b16 a[88:89], v33 offset:22528
    ds_read_b64_tr_b16 a[90:91], v33 offset:22784
    ds_read_b64_tr_b16 a[92:93], v34 offset:22528
    ds_read_b64_tr_b16 a[94:95], v34 offset:22784
    s_waitcnt lgkmcnt(0)
    s_add_u32 m0, s61, 16384
    s_add_u32 s97, s62, 5242880
    buffer_load_dwordx4 v32, s[40:43], s97 offen lds
    s_add_u32 m0, s61, 17408
    s_add_u32 s97, s62, 5373952
    buffer_load_dwordx4 v32, s[40:43], s97 offen lds
    s_add_u32 m0, s61, 18432
    s_add_u32 s97, s62, 5505024
    buffer_load_dwordx4 v32, s[40:43], s97 offen lds
    s_add_u32 m0, s61, 19456
    s_add_u32 s97, s62, 5636096
    buffer_load_dwordx4 v32, s[40:43], s97 offen lds
    s_add_u32 m0, s61, 20480
    s_add_u32 s97, s62, 5767168
    buffer_load_dwordx4 v32, s[40:43], s97 offen lds
    s_add_u32 m0, s61, 21504
    s_add_u32 s97, s62, 5898240
    buffer_load_dwordx4 v32, s[40:43], s97 offen lds
    s_add_u32 m0, s61, 22528
    s_add_u32 s97, s62, 6029312
    buffer_load_dwordx4 v32, s[40:43], s97 offen lds
    s_add_u32 m0, s61, 23552
    s_add_u32 s97, s62, 6160384
    buffer_load_dwordx4 v32, s[40:43], s97 offen lds
    ds_read_b128 v[72:75], v10 offset:512
    ds_read_b128 v[76:79], v10 offset:33280
    ds_read_b128 v[80:83], v11 offset:512
    ds_read_b128 v[84:87], v11 offset:33280
    ds_read_b128 v[88:91], v12 offset:512
    ds_read_b128 v[92:95], v12 offset:33280
    ds_read_b128 v[96:99], v13 offset:512
    ds_read_b128 v[100:103], v13 offset:33280
    s_waitcnt lgkmcnt(7)
    v_mfma_f32_16x16x32_bf16 v[40:43], a[64:67], v[72:75], v[40:43]
    v_mfma_f32_16x16x32_bf16 v[44:47], a[68:71], v[72:75], v[44:47]
    s_waitcnt lgkmcnt(6)
    v_mfma_f32_16x16x32_bf16 v[48:51], a[64:67], v[76:79], v[48:51]
    v_mfma_f32_16x16x32_bf16 v[52:55], a[68:71], v[76:79], v[52:55]
    s_waitcnt lgkmcnt(5)
    v_mfma_f32_16x16x32_bf16 v[40:43], a[72:75], v[80:83], v[40:43]
    v_mfma_f32_16x16x32_bf16 v[44:47], a[76:79], v[80:83], v[44:47]
    s_waitcnt lgkmcnt(4)
    v_mfma_f32_16x16x32_bf16 v[48:51], a[72:75], v[84:87], v[48:51]
    v_mfma_f32_16x16x32_bf16 v[52:55], a[76:79], v[84:87], v[52:55]
    s_waitcnt lgkmcnt(3)
    v_mfma_f32_16x16x32_bf16 v[40:43], a[80:83], v[88:91], v[40:43]
    v_mfma_f32_16x16x32_bf16 v[44:47], a[84:87], v[88:91], v[44:47]
    s_waitcnt lgkmcnt(2)
    v_mfma_f32_16x16x32_bf16 v[48:51], a[80:83], v[92:95], v[48:51]
    v_mfma_f32_16x16x32_bf16 v[52:55], a[84:87], v[92:95], v[52:55]
    s_waitcnt lgkmcnt(1)
    v_mfma_f32_16x16x32_bf16 v[40:43], a[88:91], v[96:99], v[40:43]
    v_mfma_f32_16x16x32_bf16 v[44:47], a[92:95], v[96:99], v[44:47]
    s_waitcnt lgkmcnt(0)
    v_mfma_f32_16x16x32_bf16 v[48:51], a[88:91], v[100:103], v[48:51]
    v_mfma_f32_16x16x32_bf16 v[52:55], a[92:95], v[100:103], v[52:55]
    s_waitcnt vmcnt(16)
    ds_read_b64_tr_b16 a[96:97], v33 offset:0
    ds_read_b64_tr_b16 a[98:99], v33 offset:256
    ds_read_b64_tr_b16 a[100:101], v34 offset:0
    ds_read_b64_tr_b16 a[102:103], v34 offset:256
    ds_read_b64_tr_b16 a[104:105], v33 offset:2048
    ds_read_b64_tr_b16 a[106:107], v33 offset:2304
    ds_read_b64_tr_b16 a[108:109], v34 offset:2048
    ds_read_b64_tr_b16 a[110:111], v34 offset:2304
    ds_read_b64_tr_b16 a[112:113], v33 offset:4096
    ds_read_b64_tr_b16 a[114:115], v33 offset:4352
    ds_read_b64_tr_b16 a[116:117], v34 offset:4096
    ds_read_b64_tr_b16 a[118:119], v34 offset:4352
    ds_read_b64_tr_b16 a[120:121], v33 offset:6144
    ds_read_b64_tr_b16 a[122:123], v33 offset:6400
    ds_read_b64_tr_b16 a[124:125], v34 offset:6144
    ds_read_b64_tr_b16 a[126:127], v34 offset:6400
    s_waitcnt lgkmcnt(0)
    s_add_u32 m0, s61, 0
    s_add_u32 s97, s62, 6291456
    buffer_load_dwordx4 v32, s[40:43], s97 offen lds
    s_add_u32 m0, s61, 1024
    s_add_u32 s97, s62, 6422528
    buffer_load_dwordx4 v32, s[40:43], s97 offen lds
    s_add_u32 m0, s61, 2048
    s_add_u32 s97, s62, 6553600
    buffer_load_dwordx4 v32, s[40:43], s97 offen lds
    s_add_u32 m0, s61, 3072
    s_add_u32 s97, s62, 6684672
    buffer_load_dwordx4 v32, s[40:43], s97 offen lds
    s_add_u32 m0, s61, 4096
    s_add_u32 s97, s62, 6815744
    buffer_load_dwordx4 v32, s[40:43], s97 offen lds
    s_add_u32 m0, s61, 5120
    s_add_u32 s97, s62, 6946816
    buffer_load_dwordx4 v32, s[40:43], s97 offen lds
    s_add_u32 m0, s61, 6144
    s_add_u32 s97, s62, 7077888
    buffer_load_dwordx4 v32, s[40:43], s97 offen lds
    s_add_u32 m0, s61, 7168
    s_add_u32 s97, s62, 7208960
    buffer_load_dwordx4 v32, s[40:43], s97 offen lds
    ds_read_b128 v[72:75], v10 offset:768
    ds_read_b128 v[76:79], v10 offset:33536
    ds_read_b128 v[80:83], v11 offset:768
    ds_read_b128 v[84:87], v11 offset:33536
    ds_read_b128 v[88:91], v12 offset:768
    ds_read_b128 v[92:95], v12 offset:33536
    ds_read_b128 v[96:99], v13 offset:768
    ds_read_b128 v[100:103], v13 offset:33536
    s_waitcnt lgkmcnt(7)
    v_mfma_f32_16x16x32_bf16 v[40:43], a[96:99], v[72:75], v[40:43]
    v_mfma_f32_16x16x32_bf16 v[44:47], a[100:103], v[72:75], v[44:47]
    s_waitcnt lgkmcnt(6)
    v_mfma_f32_16x16x32_bf16 v[48:51], a[96:99], v[76:79], v[48:51]
    v_mfma_f32_16x16x32_bf16 v[52:55], a[100:103], v[76:79], v[52:55]
    s_waitcnt lgkmcnt(5)
    v_mfma_f32_16x16x32_bf16 v[40:43], a[104:107], v[80:83], v[40:43]
    v_mfma_f32_16x16x32_bf16 v[44:47], a[108:111], v[80:83], v[44:47]
    s_waitcnt lgkmcnt(4)
    v_mfma_f32_16x16x32_bf16 v[48:51], a[104:107], v[84:87], v[48:51]
    v_mfma_f32_16x16x32_bf16 v[52:55], a[108:111], v[84:87], v[52:55]
    s_waitcnt lgkmcnt(3)
    v_mfma_f32_16x16x32_bf16 v[40:43], a[112:115], v[88:91], v[40:43]
    v_mfma_f32_16x16x32_bf16 v[44:47], a[116:119], v[88:91], v[44:47]
    s_waitcnt lgkmcnt(2)
    v_mfma_f32_16x16x32_bf16 v[48:51], a[112:115], v[92:95], v[48:51]
    v_mfma_f32_16x16x32_bf16 v[52:55], a[116:119], v[92:95], v[52:55]
    s_waitcnt lgkmcnt(1)
    v_mfma_f32_16x16x32_bf16 v[40:43], a[120:123], v[96:99], v[40:43]
    v_mfma_f32_16x16x32_bf16 v[44:47], a[124:127], v[96:99], v[44:47]
    s_waitcnt lgkmcnt(0)
    v_mfma_f32_16x16x32_bf16 v[48:51], a[120:123], v[100:103], v[48:51]
    v_mfma_f32_16x16x32_bf16 v[52:55], a[124:127], v[100:103], v[52:55]
    s_waitcnt vmcnt(16)
    ds_read_b64_tr_b16 a[128:129], v33 offset:8192
    ds_read_b64_tr_b16 a[130:131], v33 offset:8448
    ds_read_b64_tr_b16 a[132:133], v34 offset:8192
    ds_read_b64_tr_b16 a[134:135], v34 offset:8448
    ds_read_b64_tr_b16 a[136:137], v33 offset:10240
    ds_read_b64_tr_b16 a[138:139], v33 offset:10496
    ds_read_b64_tr_b16 a[140:141], v34 offset:10240
    ds_read_b64_tr_b16 a[142:143], v34 offset:10496
    ds_read_b64_tr_b16 a[144:145], v33 offset:12288
    ds_read_b64_tr_b16 a[146:147], v33 offset:12544
    ds_read_b64_tr_b16 a[148:149], v34 offset:12288
    ds_read_b64_tr_b16 a[150:151], v34 offset:12544
    ds_read_b64_tr_b16 a[152:153], v33 offset:14336
    ds_read_b64_tr_b16 a[154:155], v33 offset:14592
    ds_read_b64_tr_b16 a[156:157], v34 offset:14336
    ds_read_b64_tr_b16 a[158:159], v34 offset:14592
    s_waitcnt lgkmcnt(0)
    s_add_u32 m0, s61, 8192
    s_add_u32 s97, s62, 7340032
    buffer_load_dwordx4 v32, s[40:43], s97 offen lds
    s_add_u32 m0, s61, 9216
    s_add_u32 s97, s62, 7471104
    buffer_load_dwordx4 v32, s[40:43], s97 offen lds
    s_add_u32 m0, s61, 10240
    s_add_u32 s97, s62, 7602176
    buffer_load_dwordx4 v32, s[40:43], s97 offen lds
    s_add_u32 m0, s61, 11264
    s_add_u32 s97, s62, 7733248
    buffer_load_dwordx4 v32, s[40:43], s97 offen lds
    s_add_u32 m0, s61, 12288
    s_add_u32 s97, s62, 7864320
    buffer_load_dwordx4 v32, s[40:43], s97 offen lds
    s_add_u32 m0, s61, 13312
    s_add_u32 s97, s62, 7995392
    buffer_load_dwordx4 v32, s[40:43], s97 offen lds
    s_add_u32 m0, s61, 14336
    s_add_u32 s97, s62, 8126464
    buffer_load_dwordx4 v32, s[40:43], s97 offen lds
    s_add_u32 m0, s61, 15360
    s_add_u32 s97, s62, 8257536
    buffer_load_dwordx4 v32, s[40:43], s97 offen lds
    v_and_b32 v238, 7, v0
    v_lshlrev_b32 v238, 5, v238
    global_load_dword v239, v238, s[32:33] sc1
    ds_read_b128 v[72:75], v10 offset:1024
    ds_read_b128 v[76:79], v10 offset:33792
    ds_read_b128 v[80:83], v11 offset:1024
    ds_read_b128 v[84:87], v11 offset:33792
    ds_read_b128 v[88:91], v12 offset:1024
    ds_read_b128 v[92:95], v12 offset:33792
    ds_read_b128 v[96:99], v13 offset:1024
    ds_read_b128 v[100:103], v13 offset:33792
    s_waitcnt lgkmcnt(7)
    v_mfma_f32_16x16x32_bf16 v[40:43], a[128:131], v[72:75], v[40:43]
    v_mfma_f32_16x16x32_bf16 v[44:47], a[132:135], v[72:75], v[44:47]
    s_waitcnt lgkmcnt(6)
    v_mfma_f32_16x16x32_bf16 v[48:51], a[128:131], v[76:79], v[48:51]
    v_mfma_f32_16x16x32_bf16 v[52:55], a[132:135], v[76:79], v[52:55]
    s_waitcnt lgkmcnt(5)
    v_mfma_f32_16x16x32_bf16 v[40:43], a[136:139], v[80:83], v[40:43]
    v_mfma_f32_16x16x32_bf16 v[44:47], a[140:143], v[80:83], v[44:47]
    s_waitcnt lgkmcnt(4)
    v_mfma_f32_16x16x32_bf16 v[48:51], a[136:139], v[84:87], v[48:51]
    v_mfma_f32_16x16x32_bf16 v[52:55], a[140:143], v[84:87], v[52:55]
    s_waitcnt lgkmcnt(3)
    v_mfma_f32_16x16x32_bf16 v[40:43], a[144:147], v[88:91], v[40:43]
    v_mfma_f32_16x16x32_bf16 v[44:47], a[148:151], v[88:91], v[44:47]
    s_waitcnt lgkmcnt(2)
    v_mfma_f32_16x16x32_bf16 v[48:51], a[144:147], v[92:95], v[48:51]
    v_mfma_f32_16x16x32_bf16 v[52:55], a[148:151], v[92:95], v[52:55]
    s_waitcnt lgkmcnt(1)
    v_mfma_f32_16x16x32_bf16 v[40:43], a[152:155], v[96:99], v[40:43]
    v_mfma_f32_16x16x32_bf16 v[44:47], a[156:159], v[96:99], v[44:47]
    s_waitcnt lgkmcnt(0)
    v_mfma_f32_16x16x32_bf16 v[48:51], a[152:155], v[100:103], v[48:51]
    v_mfma_f32_16x16x32_bf16 v[52:55], a[156:159], v[100:103], v[52:55]
    s_waitcnt vmcnt(17)
    ds_read_b64_tr_b16 a[160:161], v33 offset:16384
    ds_read_b64_tr_b16 a[162:163], v33 offset:16640
    ds_read_b64_tr_b16 a[164:165], v34 offset:16384
    ds_read_b64_tr_b16 a[166:167], v34 offset:16640
    ds_read_b64_tr_b16 a[168:169], v33 offset:18432
    ds_read_b64_tr_b16 a[170:171], v33 offset:18688
    ds_read_b64_tr_b16 a[172:173], v34 offset:18432
    ds_read_b64_tr_b16 a[174:175], v34 offset:18688
    ds_read_b64_tr_b16 a[176:177], v33 offset:20480
    ds_read_b64_tr_b16 a[178:179], v33 offset:20736
    ds_read_b64_tr_b16 a[180:181], v34 offset:20480
    ds_read_b64_tr_b16 a[182:183], v34 offset:20736
    ds_read_b64_tr_b16 a[184:185], v33 offset:22528
    ds_read_b64_tr_b16 a[186:187], v33 offset:22784
    ds_read_b64_tr_b16 a[188:189], v34 offset:22528
    ds_read_b64_tr_b16 a[190:191], v34 offset:22784
    s_waitcnt lgkmcnt(0)
    ds_read_b128 v[72:75], v10 offset:1280
    ds_read_b128 v[76:79], v10 offset:34048
    ds_read_b128 v[80:83], v11 offset:1280
    ds_read_b128 v[84:87], v11 offset:34048
    ds_read_b128 v[88:91], v12 offset:1280
    ds_read_b128 v[92:95], v12 offset:34048
    ds_read_b128 v[96:99], v13 offset:1280
    ds_read_b128 v[100:103], v13 offset:34048
    s_waitcnt lgkmcnt(7)
    v_mfma_f32_16x16x32_bf16 v[40:43], a[160:163], v[72:75], v[40:43]
    v_mfma_f32_16x16x32_bf16 v[44:47], a[164:167], v[72:75], v[44:47]
    s_waitcnt lgkmcnt(6)
    v_mfma_f32_16x16x32_bf16 v[48:51], a[160:163], v[76:79], v[48:51]
    v_mfma_f32_16x16x32_bf16 v[52:55], a[164:167], v[76:79], v[52:55]
    s_waitcnt lgkmcnt(5)
    v_mfma_f32_16x16x32_bf16 v[40:43], a[168:171], v[80:83], v[40:43]
    v_mfma_f32_16x16x32_bf16 v[44:47], a[172:175], v[80:83], v[44:47]
    s_waitcnt lgkmcnt(4)
    v_mfma_f32_16x16x32_bf16 v[48:51], a[168:171], v[84:87], v[48:51]
    v_mfma_f32_16x16x32_bf16 v[52:55], a[172:175], v[84:87], v[52:55]
    s_waitcnt lgkmcnt(3)
    v_mfma_f32_16x16x32_bf16 v[40:43], a[176:179], v[88:91], v[40:43]
    v_mfma_f32_16x16x32_bf16 v[44:47], a[180:183], v[88:91], v[44:47]
    s_waitcnt lgkmcnt(2)
    v_mfma_f32_16x16x32_bf16 v[48:51], a[176:179], v[92:95], v[48:51]
    v_mfma_f32_16x16x32_bf16 v[52:55], a[180:183], v[92:95], v[52:55]
    s_waitcnt lgkmcnt(1)
    v_mfma_f32_16x16x32_bf16 v[40:43], a[184:187], v[96:99], v[40:43]
    v_mfma_f32_16x16x32_bf16 v[44:47], a[188:191], v[96:99], v[44:47]
    s_waitcnt lgkmcnt(0)
    v_mfma_f32_16x16x32_bf16 v[48:51], a[184:187], v[100:103], v[48:51]
    v_mfma_f32_16x16x32_bf16 v[52:55], a[188:191], v[100:103], v[52:55]
    s_waitcnt vmcnt(9)
    ds_read_b64_tr_b16 a[192:193], v33 offset:0
    ds_read_b64_tr_b16 a[194:195], v33 offset:256
    ds_read_b64_tr_b16 a[196:197], v34 offset:0
    ds_read_b64_tr_b16 a[198:199], v34 offset:256
    ds_read_b64_tr_b16 a[200:201], v33 offset:2048
    ds_read_b64_tr_b16 a[202:203], v33 offset:2304
    ds_read_b64_tr_b16 a[204:205], v34 offset:2048
    ds_read_b64_tr_b16 a[206:207], v34 offset:2304
    ds_read_b64_tr_b16 a[208:209], v33 offset:4096
    ds_read_b64_tr_b16 a[210:211], v33 offset:4352
    ds_read_b64_tr_b16 a[212:213], v34 offset:4096
    ds_read_b64_tr_b16 a[214:215], v34 offset:4352
    ds_read_b64_tr_b16 a[216:217], v33 offset:6144
    ds_read_b64_tr_b16 a[218:219], v33 offset:6400
    ds_read_b64_tr_b16 a[220:221], v34 offset:6144
    ds_read_b64_tr_b16 a[222:223], v34 offset:6400
    s_waitcnt lgkmcnt(0)
    ds_read_b128 v[72:75], v10 offset:1536
    ds_read_b128 v[76:79], v10 offset:34304
    ds_read_b128 v[80:83], v11 offset:1536
    ds_read_b128 v[84:87], v11 offset:34304
    ds_read_b128 v[88:91], v12 offset:1536
    ds_read_b128 v[92:95], v12 offset:34304
    ds_read_b128 v[96:99], v13 offset:1536
    ds_read_b128 v[100:103], v13 offset:34304
    s_waitcnt lgkmcnt(7)
    v_mfma_f32_16x16x32_bf16 v[40:43], a[192:195], v[72:75], v[40:43]
    v_mfma_f32_16x16x32_bf16 v[44:47], a[196:199], v[72:75], v[44:47]
    s_waitcnt lgkmcnt(6)
    v_mfma_f32_16x16x32_bf16 v[48:51], a[192:195], v[76:79], v[48:51]
    v_mfma_f32_16x16x32_bf16 v[52:55], a[196:199], v[76:79], v[52:55]
    s_waitcnt lgkmcnt(5)
    v_mfma_f32_16x16x32_bf16 v[40:43], a[200:203], v[80:83], v[40:43]
    v_mfma_f32_16x16x32_bf16 v[44:47], a[204:207], v[80:83], v[44:47]
    s_waitcnt lgkmcnt(4)
    v_mfma_f32_16x16x32_bf16 v[48:51], a[200:203], v[84:87], v[48:51]
    v_mfma_f32_16x16x32_bf16 v[52:55], a[204:207], v[84:87], v[52:55]
    s_waitcnt lgkmcnt(3)
    v_mfma_f32_16x16x32_bf16 v[40:43], a[208:211], v[88:91], v[40:43]
    v_mfma_f32_16x16x32_bf16 v[44:47], a[212:215], v[88:91], v[44:47]
    s_waitcnt lgkmcnt(2)
    v_mfma_f32_16x16x32_bf16 v[48:51], a[208:211], v[92:95], v[48:51]
    v_mfma_f32_16x16x32_bf16 v[52:55], a[212:215], v[92:95], v[52:55]
    s_waitcnt lgkmcnt(1)
    v_mfma_f32_16x16x32_bf16 v[40:43], a[216:219], v[96:99], v[40:43]
    v_mfma_f32_16x16x32_bf16 v[44:47], a[220:223], v[96:99], v[44:47]
    s_waitcnt lgkmcnt(0)
    v_mfma_f32_16x16x32_bf16 v[48:51], a[216:219], v[100:103], v[48:51]
    v_mfma_f32_16x16x32_bf16 v[52:55], a[220:223], v[100:103], v[52:55]
    s_waitcnt vmcnt(1)
    ds_read_b64_tr_b16 a[224:225], v33 offset:8192
    ds_read_b64_tr_b16 a[226:227], v33 offset:8448
    ds_read_b64_tr_b16 a[228:229], v34 offset:8192
    ds_read_b64_tr_b16 a[230:231], v34 offset:8448
    ds_read_b64_tr_b16 a[232:233], v33 offset:10240
    ds_read_b64_tr_b16 a[234:235], v33 offset:10496
    ds_read_b64_tr_b16 a[236:237], v34 offset:10240
    ds_read_b64_tr_b16 a[238:239], v34 offset:10496
    ds_read_b64_tr_b16 a[240:241], v33 offset:12288
    ds_read_b64_tr_b16 a[242:243], v33 offset:12544
    ds_read_b64_tr_b16 a[244:245], v34 offset:12288
    ds_read_b64_tr_b16 a[246:247], v34 offset:12544
    ds_read_b64_tr_b16 a[248:249], v33 offset:14336
    ds_read_b64_tr_b16 a[250:251], v33 offset:14592
    ds_read_b64_tr_b16 a[252:253], v34 offset:14336
    ds_read_b64_tr_b16 a[254:255], v34 offset:14592
    s_waitcnt lgkmcnt(0)
    ds_read_b128 v[72:75], v10 offset:1792
    ds_read_b128 v[76:79], v10 offset:34560
    ds_read_b128 v[80:83], v11 offset:1792
    ds_read_b128 v[84:87], v11 offset:34560
    ds_read_b128 v[88:91], v12 offset:1792
    ds_read_b128 v[92:95], v12 offset:34560
    ds_read_b128 v[96:99], v13 offset:1792
    ds_read_b128 v[100:103], v13 offset:34560
    s_waitcnt lgkmcnt(7)
    v_mfma_f32_16x16x32_bf16 v[40:43], a[224:227], v[72:75], v[40:43]
    v_mfma_f32_16x16x32_bf16 v[44:47], a[228:231], v[72:75], v[44:47]
    s_waitcnt lgkmcnt(6)
    v_mfma_f32_16x16x32_bf16 v[48:51], a[224:227], v[76:79], v[48:51]
    v_mfma_f32_16x16x32_bf16 v[52:55], a[228:231], v[76:79], v[52:55]
    s_waitcnt lgkmcnt(5)
    v_mfma_f32_16x16x32_bf16 v[40:43], a[232:235], v[80:83], v[40:43]
    v_mfma_f32_16x16x32_bf16 v[44:47], a[236:239], v[80:83], v[44:47]
    s_waitcnt lgkmcnt(4)
    v_mfma_f32_16x16x32_bf16 v[48:51], a[232:235], v[84:87], v[48:51]
    v_mfma_f32_16x16x32_bf16 v[52:55], a[236:239], v[84:87], v[52:55]
    s_waitcnt lgkmcnt(3)
    v_mfma_f32_16x16x32_bf16 v[40:43], a[240:243], v[88:91], v[40:43]
    v_mfma_f32_16x16x32_bf16 v[44:47], a[244:247], v[88:91], v[44:47]
    s_waitcnt lgkmcnt(2)
    v_mfma_f32_16x16x32_bf16 v[48:51], a[240:243], v[92:95], v[48:51]
    v_mfma_f32_16x16x32_bf16 v[52:55], a[244:247], v[92:95], v[52:55]
    s_waitcnt lgkmcnt(1)
    v_mfma_f32_16x16x32_bf16 v[40:43], a[248:251], v[96:99], v[40:43]
    v_mfma_f32_16x16x32_bf16 v[44:47], a[252:255], v[96:99], v[44:47]
    s_waitcnt lgkmcnt(0)
    v_mfma_f32_16x16x32_bf16 v[48:51], a[248:251], v[100:103], v[48:51]
    v_mfma_f32_16x16x32_bf16 v[52:55], a[252:255], v[100:103], v[52:55]
    s_barrier
    s_cmp_eq_u32 s56, 1
    s_cbranch_scc1 L_cenok_4
    s_waitcnt vmcnt(0)
    s_branch L_cen_3_w
    s_nop 0
    v_and_b32 v238, 7, v0
    v_lshlrev_b32 v238, 5, v238
L_cen_3:
    global_load_dword v239, v238, s[32:33] sc1
    s_waitcnt vmcnt(0)
L_cen_3_w:
    v_lshrrev_b32 v30, 16, v239
    s_mov_b32 s96, 0
    v_readlane_b32 s97, v30, 0
    s_add_u32 s96, s96, s97
    v_readlane_b32 s97, v30, 1
    s_add_u32 s96, s96, s97
    v_readlane_b32 s97, v30, 2
    s_add_u32 s96, s96, s97
    v_readlane_b32 s97, v30, 3
    s_add_u32 s96, s96, s97
    v_readlane_b32 s97, v30, 4
    s_add_u32 s96, s96, s97
    v_readlane_b32 s97, v30, 5
    s_add_u32 s96, s96, s97
    v_readlane_b32 s97, v30, 6
    s_add_u32 s96, s96, s97
    v_readlane_b32 s97, v30, 7
    s_add_u32 s96, s96, s97
    s_cmp_eq_u32 s96, 256
    s_cbranch_scc1 L_cen_3_done
    s_sub_u32 s57, s57, 1
    s_cbranch_scc1 L_exit
    s_branch L_cen_3
    s_nop 0
L_cen_3_done:
    s_mov_b32 s56, 1
    v_cmp_ne_u32 vcc, 0x200020, v239
    s_cbranch_vccz L_cenok_4
    s_lshr_b32 s52, s2, 5
    s_and_b32 s53, s2, 31
    s_mov_b32 s55, 1
    s_waitcnt vmcnt(0)
    s_barrier
    s_branch L_dispatch
    s_nop 0
    s_nop 0
    s_nop 0
L_cenok_4:
    s_add_u32 s59, s64, 4096
    v_cvt_pk_bf16_f32 v32, v40, v41
    v_cvt_pk_bf16_f32 v33, v42, v43
    v_cvt_pk_bf16_f32 v34, v44, v45
    v_cvt_pk_bf16_f32 v35, v46, v47
    buffer_store_dwordx4 v[32:35], v26, s[36:39], s64 offen sc1
    v_cvt_pk_bf16_f32 v36, v48, v49
    v_cvt_pk_bf16_f32 v37, v50, v51
    v_cvt_pk_bf16_f32 v38, v52, v53
    v_cvt_pk_bf16_f32 v39, v54, v55
    buffer_store_dwordx4 v[36:39], v26, s[36:39], s59 offen sc1
    s_add_u32 s63, s63, 0x10000
    s_add_u32 m0, s67, 65536
    s_nop 0
    buffer_load_dwordx4 v2, s[44:47], s63 offen offset:0 lds
    s_add_u32 m0, s67, 65536
    s_nop 0
    buffer_load_dwordx4 v2, s[44:47], s63 offen offset:1024 lds
    s_add_u32 m0, s67, 67584
    s_nop 0
    buffer_load_dwordx4 v3, s[44:47], s63 offen offset:0 lds
    s_add_u32 m0, s67, 67584
    s_nop 0
    buffer_load_dwordx4 v3, s[44:47], s63 offen offset:1024 lds
    s_add_u32 m0, s67, 69632
    s_nop 0
    buffer_load_dwordx4 v4, s[44:47], s63 offen offset:0 lds
    s_add_u32 m0, s67, 69632
    s_nop 0
    buffer_load_dwordx4 v4, s[44:47], s63 offen offset:1024 lds
    s_add_u32 m0, s67, 71680
    s_nop 0
    buffer_load_dwordx4 v5, s[44:47], s63 offen offset:0 lds
    s_add_u32 m0, s67, 71680
    s_nop 0
    buffer_load_dwordx4 v5, s[44:47], s63 offen offset:1024 lds
    s_add_u32 m0, s67, 73728
    s_nop 0
    buffer_load_dwordx4 v6, s[44:47], s63 offen offset:0 lds
    s_add_u32 m0, s67, 73728
    s_nop 0
    buffer_load_dwordx4 v6, s[44:47], s63 offen offset:1024 lds
    s_add_u32 m0, s67, 75776
    s_nop 0
    buffer_load_dwordx4 v7, s[44:47], s63 offen offset:0 lds
    s_add_u32 m0, s67, 75776
    s_nop 0
    buffer_load_dwordx4 v7, s[44:47], s63 offen offset:1024 lds
    s_add_u32 m0, s67, 77824
    s_nop 0
    buffer_load_dwordx4 v8, s[44:47], s63 offen offset:0 lds
    s_add_u32 m0, s67, 77824
    s_nop 0
    buffer_load_dwordx4 v8, s[44:47], s63 offen offset:1024 lds
    s_add_u32 m0, s67, 79872
    s_nop 0
    buffer_load_dwordx4 v9, s[44:47], s63 offen offset:0 lds
    s_add_u32 m0, s67, 79872
    s_nop 0
    buffer_load_dwordx4 v9, s[44:47], s63 offen offset:1024 lds
    s_waitcnt vmcnt(16)
    buffer_store_dword v27, v106, s[36:39], s66 offen sc1
    s_waitcnt vmcnt(1)
    s_barrier
L_qkv_loop_k:
    ds_read_b128 v[72:75], v14 offset:0
    ds_read_b128 v[76:79], v14 offset:32768
    ds_read_b128 v[80:83], v15 offset:0
    ds_read_b128 v[84:87], v15 offset:32768
    ds_read_b128 v[88:91], v16 offset:0
    ds_read_b128 v[92:95], v16 offset:32768
    ds_read_b128 v[96:99], v17 offset:0
    ds_read_b128 v[100:103], v17 offset:32768
    s_add_u32 s63, s63, 0x10000
    s_waitcnt lgkmcnt(7)
    v_mfma_f32_16x16x32_bf16 v[56:59], a[0:3], v[72:75], 0
    v_mfma_f32_16x16x32_bf16 v[60:63], a[4:7], v[72:75], 0
    ds_read_b128 v[72:75], v14 offset:256
    s_waitcnt lgkmcnt(7)
    v_mfma_f32_16x16x32_bf16 v[64:67], a[0:3], v[76:79], 0
    v_mfma_f32_16x16x32_bf16 v[68:71], a[4:7], v[76:79], 0
    ds_read_b128 v[76:79], v14 offset:33024
    s_add_u32 s59, s64, 4096
    s_waitcnt lgkmcnt(7)
    v_mfma_f32_16x16x32_bf16 v[56:59], a[8:11], v[80:83], v[56:59]
    v_cvt_pk_bf16_f32 v32, v40, v41
    v_mfma_f32_16x16x32_bf16 v[60:63], a[12:15], v[80:83], v[60:63]
    ds_read_b128 v[80:83], v15 offset:256
    v_cvt_pk_bf16_f32 v33, v42, v43
    s_waitcnt lgkmcnt(7)
    v_mfma_f32_16x16x32_bf16 v[64:67], a[8:11], v[84:87], v[64:67]
    v_cvt_pk_bf16_f32 v34, v44, v45
    v_mfma_f32_16x16x32_bf16 v[68:71], a[12:15], v[84:87], v[68:71]
    ds_read_b128 v[84:87], v15 offset:33024
    v_cvt_pk_bf16_f32 v35, v46, v47
    s_waitcnt lgkmcnt(7)
    v_mfma_f32_16x16x32_bf16 v[56:59], a[16:19], v[88:91], v[56:59]
    buffer_store_dwordx4 v[32:35], v26, s[36:39], s64 offen sc1
    v_mfma_f32_16x16x32_bf16 v[60:63], a[20:23], v[88:91], v[60:63]
    ds_read_b128 v[88:91], v16 offset:256
    v_cvt_pk_bf16_f32 v36, v48, v49
    s_waitcnt lgkmcnt(7)
    v_mfma_f32_16x16x32_bf16 v[64:67], a[16:19], v[92:95], v[64:67]
    v_cvt_pk_bf16_f32 v37, v50, v51
    v_mfma_f32_16x16x32_bf16 v[68:71], a[20:23], v[92:95], v[68:71]
    ds_read_b128 v[92:95], v16 offset:33024
    v_cvt_pk_bf16_f32 v38, v52, v53
    s_waitcnt lgkmcnt(7)
    v_mfma_f32_16x16x32_bf16 v[56:59], a[24:27], v[96:99], v[56:59]
    v_cvt_pk_bf16_f32 v39, v54, v55
    v_mfma_f32_16x16x32_bf16 v[60:63], a[28:31], v[96:99], v[60:63]
    ds_read_b128 v[96:99], v17 offset:256
    buffer_store_dwordx4 v[36:39], v26, s[36:39], s59 offen sc1
    s_waitcnt lgkmcnt(7)
    v_mfma_f32_16x16x32_bf16 v[64:67], a[24:27], v[100:103], v[64:67]
    s_add_u32 s64, s64, s65
    v_mfma_f32_16x16x32_bf16 v[68:71], a[28:31], v[100:103], v[68:71]
    ds_read_b128 v[100:103], v17 offset:33024
    s_waitcnt lgkmcnt(7)
    v_mfma_f32_16x16x32_bf16 v[56:59], a[32:35], v[72:75], v[56:59]
    s_add_u32 m0, s67, 0
    v_mfma_f32_16x16x32_bf16 v[60:63], a[36:39], v[72:75], v[60:63]
    ds_read_b128 v[72:75], v14 offset:512
    buffer_load_dwordx4 v2, s[44:47], s63 offen offset:0 lds
    s_waitcnt lgkmcnt(7)
    v_mfma_f32_16x16x32_bf16 v[64:67], a[32:35], v[76:79], v[64:67]
    v_mfma_f32_16x16x32_bf16 v[68:71], a[36:39], v[76:79], v[68:71]
    ds_read_b128 v[76:79], v14 offset:33280
    s_add_u32 m0, s67, 0
    s_waitcnt lgkmcnt(7)
    v_mfma_f32_16x16x32_bf16 v[56:59], a[40:43], v[80:83], v[56:59]
    buffer_load_dwordx4 v2, s[44:47], s63 offen offset:1024 lds
    v_mfma_f32_16x16x32_bf16 v[60:63], a[44:47], v[80:83], v[60:63]
    ds_read_b128 v[80:83], v15 offset:512
    s_waitcnt lgkmcnt(7)
    v_mfma_f32_16x16x32_bf16 v[64:67], a[40:43], v[84:87], v[64:67]
    s_add_u32 m0, s67, 2048
    v_mfma_f32_16x16x32_bf16 v[68:71], a[44:47], v[84:87], v[68:71]
    ds_read_b128 v[84:87], v15 offset:33280
    buffer_load_dwordx4 v3, s[44:47], s63 offen offset:0 lds
    s_waitcnt lgkmcnt(7)
    v_mfma_f32_16x16x32_bf16 v[56:59], a[48:51], v[88:91], v[56:59]
    v_mfma_f32_16x16x32_bf16 v[60:63], a[52:55], v[88:91], v[60:63]
    ds_read_b128 v[88:91], v16 offset:512
    s_add_u32 m0, s67, 2048
    s_waitcnt lgkmcnt(7)
    v_mfma_f32_16x16x32_bf16 v[64:67], a[48:51], v[92:95], v[64:67]
    buffer_load_dwordx4 v3, s[44:47], s63 offen offset:1024 lds
    v_mfma_f32_16x16x32_bf16 v[68:71], a[52:55], v[92:95], v[68:71]
    ds_read_b128 v[92:95], v16 offset:33280
    s_waitcnt lgkmcnt(7)
    v_mfma_f32_16x16x32_bf16 v[56:59], a[56:59], v[96:99], v[56:59]
    s_add_u32 m0, s67, 4096
    v_mfma_f32_16x16x32_bf16 v[60:63], a[60:63], v[96:99], v[60:63]
    ds_read_b128 v[96:99], v17 offset:512
    buffer_load_dwordx4 v4, s[44:47], s63 offen offset:0 lds
    s_waitcnt lgkmcnt(7)
    v_mfma_f32_16x16x32_bf16 v[64:67], a[56:59], v[100:103], v[64:67]
    v_mfma_f32_16x16x32_bf16 v[68:71], a[60:63], v[100:103], v[68:71]
    ds_read_b128 v[100:103], v17 offset:33280
    s_add_u32 m0, s67, 4096
    s_waitcnt lgkmcnt(7)
    v_mfma_f32_16x16x32_bf16 v[56:59], a[64:67], v[72:75], v[56:59]
    buffer_load_dwordx4 v4, s[44:47], s63 offen offset:1024 lds
    v_mfma_f32_16x16x32_bf16 v[60:63], a[68:71], v[72:75], v[60:63]
    ds_read_b128 v[72:75], v14 offset:768
    s_waitcnt lgkmcnt(7)
    v_mfma_f32_16x16x32_bf16 v[64:67], a[64:67], v[76:79], v[64:67]
    s_add_u32 m0, s67, 6144
    v_mfma_f32_16x16x32_bf16 v[68:71], a[68:71], v[76:79], v[68:71]
    ds_read_b128 v[76:79], v14 offset:33536
    buffer_load_dwordx4 v5, s[44:47], s63 offen offset:0 lds
    s_waitcnt lgkmcnt(7)
    v_mfma_f32_16x16x32_bf16 v[56:59], a[72:75], v[80:83], v[56:59]
    v_mfma_f32_16x16x32_bf16 v[60:63], a[76:79], v[80:83], v[60:63]
    ds_read_b128 v[80:83], v15 offset:768
    s_add_u32 m0, s67, 6144
    s_waitcnt lgkmcnt(7)
    v_mfma_f32_16x16x32_bf16 v[64:67], a[72:75], v[84:87], v[64:67]
    buffer_load_dwordx4 v5, s[44:47], s63 offen offset:1024 lds
    v_mfma_f32_16x16x32_bf16 v[68:71], a[76:79], v[84:87], v[68:71]
    ds_read_b128 v[84:87], v15 offset:33536
    s_waitcnt lgkmcnt(7)
    v_mfma_f32_16x16x32_bf16 v[56:59], a[80:83], v[88:91], v[56:59]
    s_add_u32 m0, s67, 8192
    v_mfma_f32_16x16x32_bf16 v[60:63], a[84:87], v[88:91], v[60:63]
    ds_read_b128 v[88:91], v16 offset:768
    buffer_load_dwordx4 v6, s[44:47], s63 offen offset:0 lds
    s_waitcnt lgkmcnt(7)
    v_mfma_f32_16x16x32_bf16 v[64:67], a[80:83], v[92:95], v[64:67]
    v_mfma_f32_16x16x32_bf16 v[68:71], a[84:87], v[92:95], v[68:71]
    ds_read_b128 v[92:95], v16 offset:33536
    s_add_u32 m0, s67, 8192
    s_waitcnt lgkmcnt(7)
    v_mfma_f32_16x16x32_bf16 v[56:59], a[88:91], v[96:99], v[56:59]
    buffer_load_dwordx4 v6, s[44:47], s63 offen offset:1024 lds
    v_mfma_f32_16x16x32_bf16 v[60:63], a[92:95], v[96:99], v[60:63]
    ds_read_b128 v[96:99], v17 offset:768
    s_waitcnt lgkmcnt(7)
    v_mfma_f32_16x16x32_bf16 v[64:67], a[88:91], v[100:103], v[64:67]
    s_add_u32 m0, s67, 10240
    v_mfma_f32_16x16x32_bf16 v[68:71], a[92:95], v[100:103], v[68:71]
    ds_read_b128 v[100:103], v17 offset:33536
    buffer_load_dwordx4 v7, s[44:47], s63 offen offset:0 lds
    s_waitcnt lgkmcnt(7)
    v_mfma_f32_16x16x32_bf16 v[56:59], a[96:99], v[72:75], v[56:59]
    v_mfma_f32_16x16x32_bf16 v[60:63], a[100:103], v[72:75], v[60:63]
    ds_read_b128 v[72:75], v14 offset:1024
    s_add_u32 m0, s67, 10240
    s_waitcnt lgkmcnt(7)
    v_mfma_f32_16x16x32_bf16 v[64:67], a[96:99], v[76:79], v[64:67]
    buffer_load_dwordx4 v7, s[44:47], s63 offen offset:1024 lds
    v_mfma_f32_16x16x32_bf16 v[68:71], a[100:103], v[76:79], v[68:71]
    ds_read_b128 v[76:79], v14 offset:33792
    s_waitcnt lgkmcnt(7)
    v_mfma_f32_16x16x32_bf16 v[56:59], a[104:107], v[80:83], v[56:59]
    s_add_u32 m0, s67, 12288
    v_mfma_f32_16x16x32_bf16 v[60:63], a[108:111], v[80:83], v[60:63]
    ds_read_b128 v[80:83], v15 offset:1024
    buffer_load_dwordx4 v8, s[44:47], s63 offen offset:0 lds
    s_waitcnt lgkmcnt(7)
    v_mfma_f32_16x16x32_bf16 v[64:67], a[104:107], v[84:87], v[64:67]
    v_mfma_f32_16x16x32_bf16 v[68:71], a[108:111], v[84:87], v[68:71]
    ds_read_b128 v[84:87], v15 offset:33792
    s_add_u32 m0, s67, 12288
    s_waitcnt lgkmcnt(7)
    v_mfma_f32_16x16x32_bf16 v[56:59], a[112:115], v[88:91], v[56:59]
    buffer_load_dwordx4 v8, s[44:47], s63 offen offset:1024 lds
    v_mfma_f32_16x16x32_bf16 v[60:63], a[116:119], v[88:91], v[60:63]
    ds_read_b128 v[88:91], v16 offset:1024
    s_waitcnt lgkmcnt(7)
    v_mfma_f32_16x16x32_bf16 v[64:67], a[112:115], v[92:95], v[64:67]
    s_add_u32 m0, s67, 14336
    v_mfma_f32_16x16x32_bf16 v[68:71], a[116:119], v[92:95], v[68:71]
    ds_read_b128 v[92:95], v16 offset:33792
    buffer_load_dwordx4 v9, s[44:47], s63 offen offset:0 lds
    s_waitcnt lgkmcnt(7)
    v_mfma_f32_16x16x32_bf16 v[56:59], a[120:123], v[96:99], v[56:59]
    v_mfma_f32_16x16x32_bf16 v[60:63], a[124:127], v[96:99], v[60:63]
    ds_read_b128 v[96:99], v17 offset:1024
    s_add_u32 m0, s67, 14336
    s_waitcnt lgkmcnt(7)
    v_mfma_f32_16x16x32_bf16 v[64:67], a[120:123], v[100:103], v[64:67]
    buffer_load_dwordx4 v9, s[44:47], s63 offen offset:1024 lds
    v_mfma_f32_16x16x32_bf16 v[68:71], a[124:127], v[100:103], v[68:71]
    ds_read_b128 v[100:103], v17 offset:33792
    s_waitcnt lgkmcnt(7)
    v_mfma_f32_16x16x32_bf16 v[56:59], a[128:131], v[72:75], v[56:59]
    buffer_load_dword v105, v104, s[44:47], s63 offen
    v_mfma_f32_16x16x32_bf16 v[60:63], a[132:135], v[72:75], v[60:63]
    ds_read_b128 v[72:75], v14 offset:1280
    s_waitcnt lgkmcnt(7)
    v_mfma_f32_16x16x32_bf16 v[64:67], a[128:131], v[76:79], v[64:67]
    v_mfma_f32_16x16x32_bf16 v[68:71], a[132:135], v[76:79], v[68:71]
    ds_read_b128 v[76:79], v14 offset:34048
    s_waitcnt lgkmcnt(7)
    v_mfma_f32_16x16x32_bf16 v[56:59], a[136:139], v[80:83], v[56:59]
    v_mfma_f32_16x16x32_bf16 v[60:63], a[140:143], v[80:83], v[60:63]
    ds_read_b128 v[80:83], v15 offset:1280
    s_waitcnt lgkmcnt(7)
    v_mfma_f32_16x16x32_bf16 v[64:67], a[136:139], v[84:87], v[64:67]
    s_waitcnt vmcnt(17)
    buffer_store_dword v27, v106, s[36:39], s66 offen sc1
    v_add_u32_e64 v27, 1, v27
    v_mfma_f32_16x16x32_bf16 v[68:71], a[140:143], v[84:87], v[68:71]
    ds_read_b128 v[84:87], v15 offset:34048
    s_waitcnt lgkmcnt(7)
    v_mfma_f32_16x16x32_bf16 v[56:59], a[144:147], v[88:91], v[56:59]
    v_mfma_f32_16x16x32_bf16 v[60:63], a[148:151], v[88:91], v[60:63]
    ds_read_b128 v[88:91], v16 offset:1280
    s_waitcnt lgkmcnt(7)
    v_mfma_f32_16x16x32_bf16 v[64:67], a[144:147], v[92:95], v[64:67]
    v_mfma_f32_16x16x32_bf16 v[68:71], a[148:151], v[92:95], v[68:71]
    ds_read_b128 v[92:95], v16 offset:34048
    s_waitcnt lgkmcnt(7)
    v_mfma_f32_16x16x32_bf16 v[56:59], a[152:155], v[96:99], v[56:59]
    v_mfma_f32_16x16x32_bf16 v[60:63], a[156:159], v[96:99], v[60:63]
    ds_read_b128 v[96:99], v17 offset:1280
    s_waitcnt lgkmcnt(7)
    v_mfma_f32_16x16x32_bf16 v[64:67], a[152:155], v[100:103], v[64:67]
    v_mfma_f32_16x16x32_bf16 v[68:71], a[156:159], v[100:103], v[68:71]
    ds_read_b128 v[100:103], v17 offset:34048
    s_waitcnt lgkmcnt(7)
    v_mfma_f32_16x16x32_bf16 v[56:59], a[160:163], v[72:75], v[56:59]
    v_mfma_f32_16x16x32_bf16 v[60:63], a[164:167], v[72:75], v[60:63]
    ds_read_b128 v[72:75], v14 offset:1536
    s_waitcnt lgkmcnt(7)
    v_mfma_f32_16x16x32_bf16 v[64:67], a[160:163], v[76:79], v[64:67]
    v_mfma_f32_16x16x32_bf16 v[68:71], a[164:167], v[76:79], v[68:71]
    ds_read_b128 v[76:79], v14 offset:34304
    s_waitcnt lgkmcnt(7)
    v_mfma_f32_16x16x32_bf16 v[56:59], a[168:171], v[80:83], v[56:59]
    v_mfma_f32_16x16x32_bf16 v[60:63], a[172:175], v[80:83], v[60:63]
    ds_read_b128 v[80:83], v15 offset:1536
    s_waitcnt lgkmcnt(7)
    v_mfma_f32_16x16x32_bf16 v[64:67], a[168:171], v[84:87], v[64:67]
    v_mfma_f32_16x16x32_bf16 v[68:71], a[172:175], v[84:87], v[68:71]
    ds_read_b128 v[84:87], v15 offset:34304
    s_waitcnt lgkmcnt(7)
    v_mfma_f32_16x16x32_bf16 v[56:59], a[176:179], v[88:91], v[56:59]
    v_mfma_f32_16x16x32_bf16 v[60:63], a[180:183], v[88:91], v[60:63]
    ds_read_b128 v[88:91], v16 offset:1536
    s_waitcnt lgkmcnt(7)
    v_mfma_f32_16x16x32_bf16 v[64:67], a[176:179], v[92:95], v[64:67]
    v_mfma_f32_16x16x32_bf16 v[68:71], a[180:183], v[92:95], v[68:71]
    ds_read_b128 v[92:95], v16 offset:34304
    s_waitcnt lgkmcnt(7)
    v_mfma_f32_16x16x32_bf16 v[56:59], a[184:187], v[96:99], v[56:59]
    v_mfma_f32_16x16x32_bf16 v[60:63], a[188:191], v[96:99], v[60:63]
    ds_read_b128 v[96:99], v17 offset:1536
    s_waitcnt lgkmcnt(7)
    v_mfma_f32_16x16x32_bf16 v[64:67], a[184:187], v[100:103], v[64:67]
    v_mfma_f32_16x16x32_bf16 v[68:71], a[188:191], v[100:103], v[68:71]
    ds_read_b128 v[100:103], v17 offset:34304
    s_waitcnt lgkmcnt(7)
    v_mfma_f32_16x16x32_bf16 v[56:59], a[192:195], v[72:75], v[56:59]
    v_mfma_f32_16x16x32_bf16 v[60:63], a[196:199], v[72:75], v[60:63]
    ds_read_b128 v[72:75], v14 offset:1792
    s_waitcnt lgkmcnt(7)
    v_mfma_f32_16x16x32_bf16 v[64:67], a[192:195], v[76:79], v[64:67]
    v_mfma_f32_16x16x32_bf16 v[68:71], a[196:199], v[76:79], v[68:71]
    ds_read_b128 v[76:79], v14 offset:34560
    s_waitcnt lgkmcnt(7)
    v_mfma_f32_16x16x32_bf16 v[56:59], a[200:203], v[80:83], v[56:59]
    v_mfma_f32_16x16x32_bf16 v[60:63], a[204:207], v[80:83], v[60:63]
    ds_read_b128 v[80:83], v15 offset:1792
    s_waitcnt lgkmcnt(7)
    v_mfma_f32_16x16x32_bf16 v[64:67], a[200:203], v[84:87], v[64:67]
    v_mfma_f32_16x16x32_bf16 v[68:71], a[204:207], v[84:87], v[68:71]
    ds_read_b128 v[84:87], v15 offset:34560
    s_waitcnt lgkmcnt(7)
    v_mfma_f32_16x16x32_bf16 v[56:59], a[208:211], v[88:91], v[56:59]
    v_mfma_f32_16x16x32_bf16 v[60:63], a[212:215], v[88:91], v[60:63]
    ds_read_b128 v[88:91], v16 offset:1792
    s_waitcnt lgkmcnt(7)
    v_mfma_f32_16x16x32_bf16 v[64:67], a[208:211], v[92:95], v[64:67]
    v_mfma_f32_16x16x32_bf16 v[68:71], a[212:215], v[92:95], v[68:71]
    ds_read_b128 v[92:95], v16 offset:34560
    s_waitcnt lgkmcnt(7)
    v_mfma_f32_16x16x32_bf16 v[56:59], a[216:219], v[96:99], v[56:59]
    v_mfma_f32_16x16x32_bf16 v[60:63], a[220:223], v[96:99], v[60:63]
    ds_read_b128 v[96:99], v17 offset:1792
    s_waitcnt lgkmcnt(7)
    v_mfma_f32_16x16x32_bf16 v[64:67], a[216:219], v[100:103], v[64:67]
    v_mfma_f32_16x16x32_bf16 v[68:71], a[220:223], v[100:103], v[68:71]
    ds_read_b128 v[100:103], v17 offset:34560
    s_waitcnt lgkmcnt(7)
    v_mfma_f32_16x16x32_bf16 v[56:59], a[224:227], v[72:75], v[56:59]
    v_mfma_f32_16x16x32_bf16 v[60:63], a[228:231], v[72:75], v[60:63]
    s_waitcnt lgkmcnt(6)
    v_mfma_f32_16x16x32_bf16 v[64:67], a[224:227], v[76:79], v[64:67]
    v_mfma_f32_16x16x32_bf16 v[68:71], a[228:231], v[76:79], v[68:71]
    s_waitcnt lgkmcnt(5)
    v_mfma_f32_16x16x32_bf16 v[56:59], a[232:235], v[80:83], v[56:59]
    v_mfma_f32_16x16x32_bf16 v[60:63], a[236:239], v[80:83], v[60:63]
    s_waitcnt lgkmcnt(4)
    v_mfma_f32_16x16x32_bf16 v[64:67], a[232:235], v[84:87], v[64:67]
    v_mfma_f32_16x16x32_bf16 v[68:71], a[236:239], v[84:87], v[68:71]
    s_waitcnt lgkmcnt(3)
    v_mfma_f32_16x16x32_bf16 v[56:59], a[240:243], v[88:91], v[56:59]
    v_mfma_f32_16x16x32_bf16 v[60:63], a[244:247], v[88:91], v[60:63]
    s_waitcnt lgkmcnt(2)
    v_mfma_f32_16x16x32_bf16 v[64:67], a[240:243], v[92:95], v[64:67]
    v_mfma_f32_16x16x32_bf16 v[68:71], a[244:247], v[92:95], v[68:71]
    s_waitcnt lgkmcnt(1)
    v_mfma_f32_16x16x32_bf16 v[56:59], a[248:251], v[96:99], v[56:59]
    v_mfma_f32_16x16x32_bf16 v[60:63], a[252:255], v[96:99], v[60:63]
    s_waitcnt lgkmcnt(0)
    v_mfma_f32_16x16x32_bf16 v[64:67], a[248:251], v[100:103], v[64:67]
    v_mfma_f32_16x16x32_bf16 v[68:71], a[252:255], v[100:103], v[68:71]
    s_waitcnt vmcnt(2)
    s_barrier
    s_add_u32 s58, s58, 2
    s_cmp_eq_u32 s58, 64
    s_cbranch_scc1 L_qkv_fin_k
    ds_read_b128 v[72:75], v10 offset:0
    ds_read_b128 v[76:79], v10 offset:32768
    ds_read_b128 v[80:83], v11 offset:0
    ds_read_b128 v[84:87], v11 offset:32768
    ds_read_b128 v[88:91], v12 offset:0
    ds_read_b128 v[92:95], v12 offset:32768
    ds_read_b128 v[96:99], v13 offset:0
    ds_read_b128 v[100:103], v13 offset:32768
    s_add_u32 s63, s63, 0x10000
    s_waitcnt lgkmcnt(7)
    v_mfma_f32_16x16x32_bf16 v[40:43], a[0:3], v[72:75], 0
    v_mfma_f32_16x16x32_bf16 v[44:47], a[4:7], v[72:75], 0
    ds_read_b128 v[72:75], v10 offset:256
    s_waitcnt lgkmcnt(7)
    v_mfma_f32_16x16x32_bf16 v[48:51], a[0:3], v[76:79], 0
    v_mfma_f32_16x16x32_bf16 v[52:55], a[4:7], v[76:79], 0
    ds_read_b128 v[76:79], v10 offset:33024
    s_add_u32 s59, s64, 4096
    s_waitcnt lgkmcnt(7)
    v_mfma_f32_16x16x32_bf16 v[40:43], a[8:11], v[80:83], v[40:43]
    v_cvt_pk_bf16_f32 v32, v56, v57
    v_mfma_f32_16x16x32_bf16 v[44:47], a[12:15], v[80:83], v[44:47]
    ds_read_b128 v[80:83], v11 offset:256
    v_cvt_pk_bf16_f32 v33, v58, v59
    s_waitcnt lgkmcnt(7)
    v_mfma_f32_16x16x32_bf16 v[48:51], a[8:11], v[84:87], v[48:51]
    v_cvt_pk_bf16_f32 v34, v60, v61
    v_mfma_f32_16x16x32_bf16 v[52:55], a[12:15], v[84:87], v[52:55]
    ds_read_b128 v[84:87], v11 offset:33024
    v_cvt_pk_bf16_f32 v35, v62, v63
    s_waitcnt lgkmcnt(7)
    v_mfma_f32_16x16x32_bf16 v[40:43], a[16:19], v[88:91], v[40:43]
    buffer_store_dwordx4 v[32:35], v26, s[36:39], s64 offen sc1
    v_mfma_f32_16x16x32_bf16 v[44:47], a[20:23], v[88:91], v[44:47]
    ds_read_b128 v[88:91], v12 offset:256
    v_cvt_pk_bf16_f32 v36, v64, v65
    s_waitcnt lgkmcnt(7)
    v_mfma_f32_16x16x32_bf16 v[48:51], a[16:19], v[92:95], v[48:51]
    v_cvt_pk_bf16_f32 v37, v66, v67
    v_mfma_f32_16x16x32_bf16 v[52:55], a[20:23], v[92:95], v[52:55]
    ds_read_b128 v[92:95], v12 offset:33024
    v_cvt_pk_bf16_f32 v38, v68, v69
    s_waitcnt lgkmcnt(7)
    v_mfma_f32_16x16x32_bf16 v[40:43], a[24:27], v[96:99], v[40:43]
    v_cvt_pk_bf16_f32 v39, v70, v71
    v_mfma_f32_16x16x32_bf16 v[44:47], a[28:31], v[96:99], v[44:47]
    ds_read_b128 v[96:99], v13 offset:256
    buffer_store_dwordx4 v[36:39], v26, s[36:39], s59 offen sc1
    s_waitcnt lgkmcnt(7)
    v_mfma_f32_16x16x32_bf16 v[48:51], a[24:27], v[100:103], v[48:51]
    s_add_u32 s64, s64, s65
    v_mfma_f32_16x16x32_bf16 v[52:55], a[28:31], v[100:103], v[52:55]
    ds_read_b128 v[100:103], v13 offset:33024
    s_waitcnt lgkmcnt(7)
    v_mfma_f32_16x16x32_bf16 v[40:43], a[32:35], v[72:75], v[40:43]
    s_add_u32 m0, s67, 65536
    v_mfma_f32_16x16x32_bf16 v[44:47], a[36:39], v[72:75], v[44:47]
    ds_read_b128 v[72:75], v10 offset:512
    buffer_load_dwordx4 v2, s[44:47], s63 offen offset:0 lds
    s_waitcnt lgkmcnt(7)
    v_mfma_f32_16x16x32_bf16 v[48:51], a[32:35], v[76:79], v[48:51]
    v_mfma_f32_16x16x32_bf16 v[52:55], a[36:39], v[76:79], v[52:55]
    ds_read_b128 v[76:79], v10 offset:33280
    s_add_u32 m0, s67, 65536
    s_waitcnt lgkmcnt(7)
    v_mfma_f32_16x16x32_bf16 v[40:43], a[40:43], v[80:83], v[40:43]
    buffer_load_dwordx4 v2, s[44:47], s63 offen offset:1024 lds
    v_mfma_f32_16x16x32_bf16 v[44:47], a[44:47], v[80:83], v[44:47]
    ds_read_b128 v[80:83], v11 offset:512
    s_waitcnt lgkmcnt(7)
    v_mfma_f32_16x16x32_bf16 v[48:51], a[40:43], v[84:87], v[48:51]
    s_add_u32 m0, s67, 67584
    v_mfma_f32_16x16x32_bf16 v[52:55], a[44:47], v[84:87], v[52:55]
    ds_read_b128 v[84:87], v11 offset:33280
    buffer_load_dwordx4 v3, s[44:47], s63 offen offset:0 lds
    s_waitcnt lgkmcnt(7)
    v_mfma_f32_16x16x32_bf16 v[40:43], a[48:51], v[88:91], v[40:43]
    v_mfma_f32_16x16x32_bf16 v[44:47], a[52:55], v[88:91], v[44:47]
    ds_read_b128 v[88:91], v12 offset:512
    s_add_u32 m0, s67, 67584
    s_waitcnt lgkmcnt(7)
    v_mfma_f32_16x16x32_bf16 v[48:51], a[48:51], v[92:95], v[48:51]
    buffer_load_dwordx4 v3, s[44:47], s63 offen offset:1024 lds
    v_mfma_f32_16x16x32_bf16 v[52:55], a[52:55], v[92:95], v[52:55]
    ds_read_b128 v[92:95], v12 offset:33280
    s_waitcnt lgkmcnt(7)
    v_mfma_f32_16x16x32_bf16 v[40:43], a[56:59], v[96:99], v[40:43]
    s_add_u32 m0, s67, 69632
    v_mfma_f32_16x16x32_bf16 v[44:47], a[60:63], v[96:99], v[44:47]
    ds_read_b128 v[96:99], v13 offset:512
    buffer_load_dwordx4 v4, s[44:47], s63 offen offset:0 lds
    s_waitcnt lgkmcnt(7)
    v_mfma_f32_16x16x32_bf16 v[48:51], a[56:59], v[100:103], v[48:51]
    v_mfma_f32_16x16x32_bf16 v[52:55], a[60:63], v[100:103], v[52:55]
    ds_read_b128 v[100:103], v13 offset:33280
    s_add_u32 m0, s67, 69632
    s_waitcnt lgkmcnt(7)
    v_mfma_f32_16x16x32_bf16 v[40:43], a[64:67], v[72:75], v[40:43]
    buffer_load_dwordx4 v4, s[44:47], s63 offen offset:1024 lds
    v_mfma_f32_16x16x32_bf16 v[44:47], a[68:71], v[72:75], v[44:47]
    ds_read_b128 v[72:75], v10 offset:768
    s_waitcnt lgkmcnt(7)
    v_mfma_f32_16x16x32_bf16 v[48:51], a[64:67], v[76:79], v[48:51]
    s_add_u32 m0, s67, 71680
    v_mfma_f32_16x16x32_bf16 v[52:55], a[68:71], v[76:79], v[52:55]
    ds_read_b128 v[76:79], v10 offset:33536
    buffer_load_dwordx4 v5, s[44:47], s63 offen offset:0 lds
    s_waitcnt lgkmcnt(7)
    v_mfma_f32_16x16x32_bf16 v[40:43], a[72:75], v[80:83], v[40:43]
    v_mfma_f32_16x16x32_bf16 v[44:47], a[76:79], v[80:83], v[44:47]
    ds_read_b128 v[80:83], v11 offset:768
    s_add_u32 m0, s67, 71680
    s_waitcnt lgkmcnt(7)
    v_mfma_f32_16x16x32_bf16 v[48:51], a[72:75], v[84:87], v[48:51]
    buffer_load_dwordx4 v5, s[44:47], s63 offen offset:1024 lds
    v_mfma_f32_16x16x32_bf16 v[52:55], a[76:79], v[84:87], v[52:55]
    ds_read_b128 v[84:87], v11 offset:33536
    s_waitcnt lgkmcnt(7)
    v_mfma_f32_16x16x32_bf16 v[40:43], a[80:83], v[88:91], v[40:43]
    s_add_u32 m0, s67, 73728
    v_mfma_f32_16x16x32_bf16 v[44:47], a[84:87], v[88:91], v[44:47]
    ds_read_b128 v[88:91], v12 offset:768
    buffer_load_dwordx4 v6, s[44:47], s63 offen offset:0 lds
    s_waitcnt lgkmcnt(7)
    v_mfma_f32_16x16x32_bf16 v[48:51], a[80:83], v[92:95], v[48:51]
    v_mfma_f32_16x16x32_bf16 v[52:55], a[84:87], v[92:95], v[52:55]
    ds_read_b128 v[92:95], v12 offset:33536
    s_add_u32 m0, s67, 73728
    s_waitcnt lgkmcnt(7)
    v_mfma_f32_16x16x32_bf16 v[40:43], a[88:91], v[96:99], v[40:43]
    buffer_load_dwordx4 v6, s[44:47], s63 offen offset:1024 lds
    v_mfma_f32_16x16x32_bf16 v[44:47], a[92:95], v[96:99], v[44:47]
    ds_read_b128 v[96:99], v13 offset:768
    s_waitcnt lgkmcnt(7)
    v_mfma_f32_16x16x32_bf16 v[48:51], a[88:91], v[100:103], v[48:51]
    s_add_u32 m0, s67, 75776
    v_mfma_f32_16x16x32_bf16 v[52:55], a[92:95], v[100:103], v[52:55]
    ds_read_b128 v[100:103], v13 offset:33536
    buffer_load_dwordx4 v7, s[44:47], s63 offen offset:0 lds
    s_waitcnt lgkmcnt(7)
    v_mfma_f32_16x16x32_bf16 v[40:43], a[96:99], v[72:75], v[40:43]
    v_mfma_f32_16x16x32_bf16 v[44:47], a[100:103], v[72:75], v[44:47]
    ds_read_b128 v[72:75], v10 offset:1024
    s_add_u32 m0, s67, 75776
    s_waitcnt lgkmcnt(7)
    v_mfma_f32_16x16x32_bf16 v[48:51], a[96:99], v[76:79], v[48:51]
    buffer_load_dwordx4 v7, s[44:47], s63 offen offset:1024 lds
    v_mfma_f32_16x16x32_bf16 v[52:55], a[100:103], v[76:79], v[52:55]
    ds_read_b128 v[76:79], v10 offset:33792
    s_waitcnt lgkmcnt(7)
    v_mfma_f32_16x16x32_bf16 v[40:43], a[104:107], v[80:83], v[40:43]
    s_add_u32 m0, s67, 77824
    v_mfma_f32_16x16x32_bf16 v[44:47], a[108:111], v[80:83], v[44:47]
    ds_read_b128 v[80:83], v11 offset:1024
    buffer_load_dwordx4 v8, s[44:47], s63 offen offset:0 lds
    s_waitcnt lgkmcnt(7)
    v_mfma_f32_16x16x32_bf16 v[48:51], a[104:107], v[84:87], v[48:51]
    v_mfma_f32_16x16x32_bf16 v[52:55], a[108:111], v[84:87], v[52:55]
    ds_read_b128 v[84:87], v11 offset:33792
    s_add_u32 m0, s67, 77824
    s_waitcnt lgkmcnt(7)
    v_mfma_f32_16x16x32_bf16 v[40:43], a[112:115], v[88:91], v[40:43]
    buffer_load_dwordx4 v8, s[44:47], s63 offen offset:1024 lds
    v_mfma_f32_16x16x32_bf16 v[44:47], a[116:119], v[88:91], v[44:47]
    ds_read_b128 v[88:91], v12 offset:1024
    s_waitcnt lgkmcnt(7)
    v_mfma_f32_16x16x32_bf16 v[48:51], a[112:115], v[92:95], v[48:51]
    s_add_u32 m0, s67, 79872
    v_mfma_f32_16x16x32_bf16 v[52:55], a[116:119], v[92:95], v[52:55]
    ds_read_b128 v[92:95], v12 offset:33792
    buffer_load_dwordx4 v9, s[44:47], s63 offen offset:0 lds
    s_waitcnt lgkmcnt(7)
    v_mfma_f32_16x16x32_bf16 v[40:43], a[120:123], v[96:99], v[40:43]
    v_mfma_f32_16x16x32_bf16 v[44:47], a[124:127], v[96:99], v[44:47]
    ds_read_b128 v[96:99], v13 offset:1024
    s_add_u32 m0, s67, 79872
    s_waitcnt lgkmcnt(7)
    v_mfma_f32_16x16x32_bf16 v[48:51], a[120:123], v[100:103], v[48:51]
    buffer_load_dwordx4 v9, s[44:47], s63 offen offset:1024 lds
    v_mfma_f32_16x16x32_bf16 v[52:55], a[124:127], v[100:103], v[52:55]
    ds_read_b128 v[100:103], v13 offset:33792
    s_waitcnt lgkmcnt(7)
    v_mfma_f32_16x16x32_bf16 v[40:43], a[128:131], v[72:75], v[40:43]
    buffer_load_dword v105, v104, s[44:47], s63 offen
    v_mfma_f32_16x16x32_bf16 v[44:47], a[132:135], v[72:75], v[44:47]
    ds_read_b128 v[72:75], v10 offset:1280
    s_waitcnt lgkmcnt(7)
    v_mfma_f32_16x16x32_bf16 v[48:51], a[128:131], v[76:79], v[48:51]
    v_mfma_f32_16x16x32_bf16 v[52:55], a[132:135], v[76:79], v[52:55]
    ds_read_b128 v[76:79], v10 offset:34048
    s_waitcnt lgkmcnt(7)
    v_mfma_f32_16x16x32_bf16 v[40:43], a[136:139], v[80:83], v[40:43]
    v_mfma_f32_16x16x32_bf16 v[44:47], a[140:143], v[80:83], v[44:47]
    ds_read_b128 v[80:83], v11 offset:1280
    s_waitcnt lgkmcnt(7)
    v_mfma_f32_16x16x32_bf16 v[48:51], a[136:139], v[84:87], v[48:51]
    s_waitcnt vmcnt(17)
    buffer_store_dword v27, v106, s[36:39], s66 offen sc1
    v_add_u32_e64 v27, 1, v27
    v_mfma_f32_16x16x32_bf16 v[52:55], a[140:143], v[84:87], v[52:55]
    ds_read_b128 v[84:87], v11 offset:34048
    s_waitcnt lgkmcnt(7)
    v_mfma_f32_16x16x32_bf16 v[40:43], a[144:147], v[88:91], v[40:43]
    v_mfma_f32_16x16x32_bf16 v[44:47], a[148:151], v[88:91], v[44:47]
    ds_read_b128 v[88:91], v12 offset:1280
    s_waitcnt lgkmcnt(7)
    v_mfma_f32_16x16x32_bf16 v[48:51], a[144:147], v[92:95], v[48:51]
    v_mfma_f32_16x16x32_bf16 v[52:55], a[148:151], v[92:95], v[52:55]
    ds_read_b128 v[92:95], v12 offset:34048
    s_waitcnt lgkmcnt(7)
    v_mfma_f32_16x16x32_bf16 v[40:43], a[152:155], v[96:99], v[40:43]
    v_mfma_f32_16x16x32_bf16 v[44:47], a[156:159], v[96:99], v[44:47]
    ds_read_b128 v[96:99], v13 offset:1280
    s_waitcnt lgkmcnt(7)
    v_mfma_f32_16x16x32_bf16 v[48:51], a[152:155], v[100:103], v[48:51]
    v_mfma_f32_16x16x32_bf16 v[52:55], a[156:159], v[100:103], v[52:55]
    ds_read_b128 v[100:103], v13 offset:34048
    s_waitcnt lgkmcnt(7)
    v_mfma_f32_16x16x32_bf16 v[40:43], a[160:163], v[72:75], v[40:43]
    v_mfma_f32_16x16x32_bf16 v[44:47], a[164:167], v[72:75], v[44:47]
    ds_read_b128 v[72:75], v10 offset:1536
    s_waitcnt lgkmcnt(7)
    v_mfma_f32_16x16x32_bf16 v[48:51], a[160:163], v[76:79], v[48:51]
    v_mfma_f32_16x16x32_bf16 v[52:55], a[164:167], v[76:79], v[52:55]
    ds_read_b128 v[76:79], v10 offset:34304
    s_waitcnt lgkmcnt(7)
    v_mfma_f32_16x16x32_bf16 v[40:43], a[168:171], v[80:83], v[40:43]
    v_mfma_f32_16x16x32_bf16 v[44:47], a[172:175], v[80:83], v[44:47]
    ds_read_b128 v[80:83], v11 offset:1536
    s_waitcnt lgkmcnt(7)
    v_mfma_f32_16x16x32_bf16 v[48:51], a[168:171], v[84:87], v[48:51]
    v_mfma_f32_16x16x32_bf16 v[52:55], a[172:175], v[84:87], v[52:55]
    ds_read_b128 v[84:87], v11 offset:34304
    s_waitcnt lgkmcnt(7)
    v_mfma_f32_16x16x32_bf16 v[40:43], a[176:179], v[88:91], v[40:43]
    v_mfma_f32_16x16x32_bf16 v[44:47], a[180:183], v[88:91], v[44:47]
    ds_read_b128 v[88:91], v12 offset:1536
    s_waitcnt lgkmcnt(7)
    v_mfma_f32_16x16x32_bf16 v[48:51], a[176:179], v[92:95], v[48:51]
    v_mfma_f32_16x16x32_bf16 v[52:55], a[180:183], v[92:95], v[52:55]
    ds_read_b128 v[92:95], v12 offset:34304
    s_waitcnt lgkmcnt(7)
    v_mfma_f32_16x16x32_bf16 v[40:43], a[184:187], v[96:99], v[40:43]
    v_mfma_f32_16x16x32_bf16 v[44:47], a[188:191], v[96:99], v[44:47]
    ds_read_b128 v[96:99], v13 offset:1536
    s_waitcnt lgkmcnt(7)
    v_mfma_f32_16x16x32_bf16 v[48:51], a[184:187], v[100:103], v[48:51]
    v_mfma_f32_16x16x32_bf16 v[52:55], a[188:191], v[100:103], v[52:55]
    ds_read_b128 v[100:103], v13 offset:34304
    s_waitcnt lgkmcnt(7)
    v_mfma_f32_16x16x32_bf16 v[40:43], a[192:195], v[72:75], v[40:43]
    v_mfma_f32_16x16x32_bf16 v[44:47], a[196:199], v[72:75], v[44:47]
    ds_read_b128 v[72:75], v10 offset:1792
    s_waitcnt lgkmcnt(7)
    v_mfma_f32_16x16x32_bf16 v[48:51], a[192:195], v[76:79], v[48:51]
    v_mfma_f32_16x16x32_bf16 v[52:55], a[196:199], v[76:79], v[52:55]
    ds_read_b128 v[76:79], v10 offset:34560
    s_waitcnt lgkmcnt(7)
    v_mfma_f32_16x16x32_bf16 v[40:43], a[200:203], v[80:83], v[40:43]
    v_mfma_f32_16x16x32_bf16 v[44:47], a[204:207], v[80:83], v[44:47]
    ds_read_b128 v[80:83], v11 offset:1792
    s_waitcnt lgkmcnt(7)
    v_mfma_f32_16x16x32_bf16 v[48:51], a[200:203], v[84:87], v[48:51]
    v_mfma_f32_16x16x32_bf16 v[52:55], a[204:207], v[84:87], v[52:55]
    ds_read_b128 v[84:87], v11 offset:34560
    s_waitcnt lgkmcnt(7)
    v_mfma_f32_16x16x32_bf16 v[40:43], a[208:211], v[88:91], v[40:43]
    v_mfma_f32_16x16x32_bf16 v[44:47], a[212:215], v[88:91], v[44:47]
    ds_read_b128 v[88:91], v12 offset:1792
    s_waitcnt lgkmcnt(7)
    v_mfma_f32_16x16x32_bf16 v[48:51], a[208:211], v[92:95], v[48:51]
    v_mfma_f32_16x16x32_bf16 v[52:55], a[212:215], v[92:95], v[52:55]
    ds_read_b128 v[92:95], v12 offset:34560
    s_waitcnt lgkmcnt(7)
    v_mfma_f32_16x16x32_bf16 v[40:43], a[216:219], v[96:99], v[40:43]
    v_mfma_f32_16x16x32_bf16 v[44:47], a[220:223], v[96:99], v[44:47]
    ds_read_b128 v[96:99], v13 offset:1792
    s_waitcnt lgkmcnt(7)
    v_mfma_f32_16x16x32_bf16 v[48:51], a[216:219], v[100:103], v[48:51]
    v_mfma_f32_16x16x32_bf16 v[52:55], a[220:223], v[100:103], v[52:55]
    ds_read_b128 v[100:103], v13 offset:34560
    s_waitcnt lgkmcnt(7)
    v_mfma_f32_16x16x32_bf16 v[40:43], a[224:227], v[72:75], v[40:43]
    v_mfma_f32_16x16x32_bf16 v[44:47], a[228:231], v[72:75], v[44:47]
    s_waitcnt lgkmcnt(6)
    v_mfma_f32_16x16x32_bf16 v[48:51], a[224:227], v[76:79], v[48:51]
    v_mfma_f32_16x16x32_bf16 v[52:55], a[228:231], v[76:79], v[52:55]
    s_waitcnt lgkmcnt(5)
    v_mfma_f32_16x16x32_bf16 v[40:43], a[232:235], v[80:83], v[40:43]
    v_mfma_f32_16x16x32_bf16 v[44:47], a[236:239], v[80:83], v[44:47]
    s_waitcnt lgkmcnt(4)
    v_mfma_f32_16x16x32_bf16 v[48:51], a[232:235], v[84:87], v[48:51]
    v_mfma_f32_16x16x32_bf16 v[52:55], a[236:239], v[84:87], v[52:55]
    s_waitcnt lgkmcnt(3)
    v_mfma_f32_16x16x32_bf16 v[40:43], a[240:243], v[88:91], v[40:43]
    v_mfma_f32_16x16x32_bf16 v[44:47], a[244:247], v[88:91], v[44:47]
    s_waitcnt lgkmcnt(2)
    v_mfma_f32_16x16x32_bf16 v[48:51], a[240:243], v[92:95], v[48:51]
    v_mfma_f32_16x16x32_bf16 v[52:55], a[244:247], v[92:95], v[52:55]
    s_waitcnt lgkmcnt(1)
    v_mfma_f32_16x16x32_bf16 v[40:43], a[248:251], v[96:99], v[40:43]
    v_mfma_f32_16x16x32_bf16 v[44:47], a[252:255], v[96:99], v[44:47]
    s_waitcnt lgkmcnt(0)
    v_mfma_f32_16x16x32_bf16 v[48:51], a[248:251], v[100:103], v[48:51]
    v_mfma_f32_16x16x32_bf16 v[52:55], a[252:255], v[100:103], v[52:55]
    s_waitcnt vmcnt(2)
    s_barrier
    s_branch L_qkv_loop_k
    s_nop 0
L_qkv_v:
    s_add_u32 m0, s61, 0
    s_add_u32 s97, s62, 0
    buffer_load_dwordx4 v32, s[40:43], s97 offen lds
    s_add_u32 m0, s61, 1024
    s_add_u32 s97, s62, 131072
    buffer_load_dwordx4 v32, s[40:43], s97 offen lds
    s_add_u32 m0, s61, 2048
    s_add_u32 s97, s62, 262144
    buffer_load_dwordx4 v32, s[40:43], s97 offen lds
    s_add_u32 m0, s61, 3072
    s_add_u32 s97, s62, 393216
    buffer_load_dwordx4 v32, s[40:43], s97 offen lds
    s_add_u32 m0, s61, 4096
    s_add_u32 s97, s62, 524288
    buffer_load_dwordx4 v32, s[40:43], s97 offen lds
    s_add_u32 m0, s61, 5120
    s_add_u32 s97, s62, 655360
    buffer_load_dwordx4 v32, s[40:43], s97 offen lds
    s_add_u32 m0, s61, 6144
    s_add_u32 s97, s62, 786432
    buffer_load_dwordx4 v32, s[40:43], s97 offen lds
    s_add_u32 m0, s61, 7168
    s_add_u32 s97, s62, 917504
    buffer_load_dwordx4 v32, s[40:43], s97 offen lds
    s_add_u32 m0, s61, 8192
    s_add_u32 s97, s62, 1048576
    buffer_load_dwordx4 v32, s[40:43], s97 offen lds
    s_add_u32 m0, s61, 9216
    s_add_u32 s97, s62, 1179648
    buffer_load_dwordx4 v32, s[40:43], s97 offen lds
    s_add_u32 m0, s61, 10240
    s_add_u32 s97, s62, 1310720
    buffer_load_dwordx4 v32, s[40:43], s97 offen lds
    s_add_u32 m0, s61, 11264
    s_add_u32 s97, s62, 1441792
    buffer_load_dwordx4 v32, s[40:43], s97 offen lds
    s_add_u32 m0, s61, 12288
    s_add_u32 s97, s62, 1572864
    buffer_load_dwordx4 v32, s[40:43], s97 offen lds
    s_add_u32 m0, s61, 13312
    s_add_u32 s97, s62, 1703936
    buffer_load_dwordx4 v32, s[40:43], s97 offen lds
    s_add_u32 m0, s61, 14336
    s_add_u32 s97, s62, 1835008
    buffer_load_dwordx4 v32, s[40:43], s97 offen lds
    s_add_u32 m0, s61, 15360
    s_add_u32 s97, s62, 1966080
    buffer_load_dwordx4 v32, s[40:43], s97 offen lds
    s_add_u32 m0, s61, 16384
    s_add_u32 s97, s62, 2097152
    buffer_load_dwordx4 v32, s[40:43], s97 offen lds
    s_add_u32 m0, s61, 17408
    s_add_u32 s97, s62, 2228224
    buffer_load_dwordx4 v32, s[40:43], s97 offen lds
    s_add_u32 m0, s61, 18432
    s_add_u32 s97, s62, 2359296
    buffer_load_dwordx4 v32, s[40:43], s97 offen lds
    s_add_u32 m0, s61, 19456
    s_add_u32 s97, s62, 2490368
    buffer_load_dwordx4 v32, s[40:43], s97 offen lds
    s_add_u32 m0, s61, 20480
    s_add_u32 s97, s62, 2621440
    buffer_load_dwordx4 v32, s[40:43], s97 offen lds
    s_add_u32 m0, s61, 21504
    s_add_u32 s97, s62, 2752512
    buffer_load_dwordx4 v32, s[40:43], s97 offen lds
    s_add_u32 m0, s61, 22528
    s_add_u32 s97, s62, 2883584
    buffer_load_dwordx4 v32, s[40:43], s97 offen lds
    s_add_u32 m0, s61, 23552
    s_add_u32 s97, s62, 3014656
    buffer_load_dwordx4 v32, s[40:43], s97 offen lds
    s_waitcnt vmcnt(16)
    ds_read_b64_tr_b16 a[0:1], v33 offset:0
    ds_read_b64_tr_b16 a[2:3], v33 offset:256
    ds_read_b64_tr_b16 a[4:5], v34 offset:0
    ds_read_b64_tr_b16 a[6:7], v34 offset:256
    ds_read_b64_tr_b16 a[8:9], v33 offset:2048
    ds_read_b64_tr_b16 a[10:11], v33 offset:2304
    ds_read_b64_tr_b16 a[12:13], v34 offset:2048
    ds_read_b64_tr_b16 a[14:15], v34 offset:2304
    ds_read_b64_tr_b16 a[16:17], v33 offset:4096
    ds_read_b64_tr_b16 a[18:19], v33 offset:4352
    ds_read_b64_tr_b16 a[20:21], v34 offset:4096
    ds_read_b64_tr_b16 a[22:23], v34 offset:4352
    ds_read_b64_tr_b16 a[24:25], v33 offset:6144
    ds_read_b64_tr_b16 a[26:27], v33 offset:6400
    ds_read_b64_tr_b16 a[28:29], v34 offset:6144
    ds_read_b64_tr_b16 a[30:31], v34 offset:6400
    s_waitcnt lgkmcnt(0)
    s_add_u32 m0, s61, 0
    s_add_u32 s97, s62, 3145728
    buffer_load_dwordx4 v32, s[40:43], s97 offen lds
    s_add_u32 m0, s61, 1024
    s_add_u32 s97, s62, 3276800
    buffer_load_dwordx4 v32, s[40:43], s97 offen lds
    s_add_u32 m0, s61, 2048
    s_add_u32 s97, s62, 3407872
    buffer_load_dwordx4 v32, s[40:43], s97 offen lds
    s_add_u32 m0, s61, 3072
    s_add_u32 s97, s62, 3538944
    buffer_load_dwordx4 v32, s[40:43], s97 offen lds
    s_add_u32 m0, s61, 4096
    s_add_u32 s97, s62, 3670016
    buffer_load_dwordx4 v32, s[40:43], s97 offen lds
    s_add_u32 m0, s61, 5120
    s_add_u32 s97, s62, 3801088
    buffer_load_dwordx4 v32, s[40:43], s97 offen lds
    s_add_u32 m0, s61, 6144
    s_add_u32 s97, s62, 3932160
    buffer_load_dwordx4 v32, s[40:43], s97 offen lds
    s_add_u32 m0, s61, 7168
    s_add_u32 s97, s62, 4063232
    buffer_load_dwordx4 v32, s[40:43], s97 offen lds
    s_barrier
    ds_read_b128 v[72:75], v10 offset:0
    ds_read_b128 v[76:79], v10 offset:32768
    ds_read_b128 v[80:83], v11 offset:0
    ds_read_b128 v[84:87], v11 offset:32768
    ds_read_b128 v[88:91], v12 offset:0
    ds_read_b128 v[92:95], v12 offset:32768
    ds_read_b128 v[96:99], v13 offset:0
    ds_read_b128 v[100:103], v13 offset:32768
    s_waitcnt lgkmcnt(7)
    v_mfma_f32_16x16x32_bf16 v[40:43], v[72:75], a[0:3], 0
    v_mfma_f32_16x16x32_bf16 v[48:51], v[72:75], a[4:7], 0
    s_waitcnt lgkmcnt(6)
    v_mfma_f32_16x16x32_bf16 v[44:47], v[76:79], a[0:3], 0
    v_mfma_f32_16x16x32_bf16 v[52:55], v[76:79], a[4:7], 0
    s_waitcnt lgkmcnt(5)
    v_mfma_f32_16x16x32_bf16 v[40:43], v[80:83], a[8:11], v[40:43]
    v_mfma_f32_16x16x32_bf16 v[48:51], v[80:83], a[12:15], v[48:51]
    s_waitcnt lgkmcnt(4)
    v_mfma_f32_16x16x32_bf16 v[44:47], v[84:87], a[8:11], v[44:47]
    v_mfma_f32_16x16x32_bf16 v[52:55], v[84:87], a[12:15], v[52:55]
    s_waitcnt lgkmcnt(3)
    v_mfma_f32_16x16x32_bf16 v[40:43], v[88:91], a[16:19], v[40:43]
    v_mfma_f32_16x16x32_bf16 v[48:51], v[88:91], a[20:23], v[48:51]
    s_waitcnt lgkmcnt(2)
    v_mfma_f32_16x16x32_bf16 v[44:47], v[92:95], a[16:19], v[44:47]
    v_mfma_f32_16x16x32_bf16 v[52:55], v[92:95], a[20:23], v[52:55]
    s_waitcnt lgkmcnt(1)
    v_mfma_f32_16x16x32_bf16 v[40:43], v[96:99], a[24:27], v[40:43]
    v_mfma_f32_16x16x32_bf16 v[48:51], v[96:99], a[28:31], v[48:51]
    s_waitcnt lgkmcnt(0)
    v_mfma_f32_16x16x32_bf16 v[44:47], v[100:103], a[24:27], v[44:47]
    v_mfma_f32_16x16x32_bf16 v[52:55], v[100:103], a[28:31], v[52:55]
    s_waitcnt vmcnt(16)
    ds_read_b64_tr_b16 a[32:33], v33 offset:8192
    ds_read_b64_tr_b16 a[34:35], v33 offset:8448
    ds_read_b64_tr_b16 a[36:37], v34 offset:8192
    ds_read_b64_tr_b16 a[38:39], v34 offset:8448
    ds_read_b64_tr_b16 a[40:41], v33 offset:10240
    ds_read_b64_tr_b16 a[42:43], v33 offset:10496
    ds_read_b64_tr_b16 a[44:45], v34 offset:10240
    ds_read_b64_tr_b16 a[46:47], v34 offset:10496
    ds_read_b64_tr_b16 a[48:49], v33 offset:12288
    ds_read_b64_tr_b16 a[50:51], v33 offset:12544
    ds_read_b64_tr_b16 a[52:53], v34 offset:12288
    ds_read_b64_tr_b16 a[54:55], v34 offset:12544
    ds_read_b64_tr_b16 a[56:57], v33 offset:14336
    ds_read_b64_tr_b16 a[58:59], v33 offset:14592
    ds_read_b64_tr_b16 a[60:61], v34 offset:14336
    ds_read_b64_tr_b16 a[62:63], v34 offset:14592
    s_waitcnt lgkmcnt(0)
    s_add_u32 m0, s61, 8192
    s_add_u32 s97, s62, 4194304
    buffer_load_dwordx4 v32, s[40:43], s97 offen lds
    s_add_u32 m0, s61, 9216
    s_add_u32 s97, s62, 4325376
    buffer_load_dwordx4 v32, s[40:43], s97 offen lds
    s_add_u32 m0, s61, 10240
    s_add_u32 s97, s62, 4456448
    buffer_load_dwordx4 v32, s[40:43], s97 offen lds
    s_add_u32 m0, s61, 11264
    s_add_u32 s97, s62, 4587520
    buffer_load_dwordx4 v32, s[40:43], s97 offen lds
    s_add_u32 m0, s61, 12288
    s_add_u32 s97, s62, 4718592
    buffer_load_dwordx4 v32, s[40:43], s97 offen lds
    s_add_u32 m0, s61, 13312
    s_add_u32 s97, s62, 4849664
    buffer_load_dwordx4 v32, s[40:43], s97 offen lds
    s_add_u32 m0, s61, 14336
    s_add_u32 s97, s62, 4980736
    buffer_load_dwordx4 v32, s[40:43], s97 offen lds
    s_add_u32 m0, s61, 15360
    s_add_u32 s97, s62, 5111808
    buffer_load_dwordx4 v32, s[40:43], s97 offen lds
    ds_read_b128 v[72:75], v10 offset:256
    ds_read_b128 v[76:79], v10 offset:33024
    ds_read_b128 v[80:83], v11 offset:256
    ds_read_b128 v[84:87], v11 offset:33024
    ds_read_b128 v[88:91], v12 offset:256
    ds_read_b128 v[92:95], v12 offset:33024
    ds_read_b128 v[96:99], v13 offset:256
    ds_read_b128 v[100:103], v13 offset:33024
    s_waitcnt lgkmcnt(7)
    v_mfma_f32_16x16x32_bf16 v[40:43], v[72:75], a[32:35], v[40:43]
    v_mfma_f32_16x16x32_bf16 v[48:51], v[72:75], a[36:39], v[48:51]
    s_waitcnt lgkmcnt(6)
    v_mfma_f32_16x16x32_bf16 v[44:47], v[76:79], a[32:35], v[44:47]
    v_mfma_f32_16x16x32_bf16 v[52:55], v[76:79], a[36:39], v[52:55]
    s_waitcnt lgkmcnt(5)
    v_mfma_f32_16x16x32_bf16 v[40:43], v[80:83], a[40:43], v[40:43]
    v_mfma_f32_16x16x32_bf16 v[48:51], v[80:83], a[44:47], v[48:51]
    s_waitcnt lgkmcnt(4)
    v_mfma_f32_16x16x32_bf16 v[44:47], v[84:87], a[40:43], v[44:47]
    v_mfma_f32_16x16x32_bf16 v[52:55], v[84:87], a[44:47], v[52:55]
    s_waitcnt lgkmcnt(3)
    v_mfma_f32_16x16x32_bf16 v[40:43], v[88:91], a[48:51], v[40:43]
    v_mfma_f32_16x16x32_bf16 v[48:51], v[88:91], a[52:55], v[48:51]
    s_waitcnt lgkmcnt(2)
    v_mfma_f32_16x16x32_bf16 v[44:47], v[92:95], a[48:51], v[44:47]
    v_mfma_f32_16x16x32_bf16 v[52:55], v[92:95], a[52:55], v[52:55]
    s_waitcnt lgkmcnt(1)
    v_mfma_f32_16x16x32_bf16 v[40:43], v[96:99], a[56:59], v[40:43]
    v_mfma_f32_16x16x32_bf16 v[48:51], v[96:99], a[60:63], v[48:51]
    s_waitcnt lgkmcnt(0)
    v_mfma_f32_16x16x32_bf16 v[44:47], v[100:103], a[56:59], v[44:47]
    v_mfma_f32_16x16x32_bf16 v[52:55], v[100:103], a[60:63], v[52:55]
    s_waitcnt vmcnt(16)
    ds_read_b64_tr_b16 a[64:65], v33 offset:16384
    ds_read_b64_tr_b16 a[66:67], v33 offset:16640
    ds_read_b64_tr_b16 a[68:69], v34 offset:16384
    ds_read_b64_tr_b16 a[70:71], v34 offset:16640
    ds_read_b64_tr_b16 a[72:73], v33 offset:18432
    ds_read_b64_tr_b16 a[74:75], v33 offset:18688
    ds_read_b64_tr_b16 a[76:77], v34 offset:18432
    ds_read_b64_tr_b16 a[78:79], v34 offset:18688
    ds_read_b64_tr_b16 a[80:81], v33 offset:20480
    ds_read_b64_tr_b16 a[82:83], v33 offset:20736
    ds_read_b64_tr_b16 a[84:85], v34 offset:20480
    ds_read_b64_tr_b16 a[86:87], v34 offset:20736
    ds_read_b64_tr_b16 a[88:89], v33 offset:22528
    ds_read_b64_tr_b16 a[90:91], v33 offset:22784
    ds_read_b64_tr_b16 a[92:93], v34 offset:22528
    ds_read_b64_tr_b16 a[94:95], v34 offset:22784
    s_waitcnt lgkmcnt(0)
    s_add_u32 m0, s61, 16384
    s_add_u32 s97, s62, 5242880
    buffer_load_dwordx4 v32, s[40:43], s97 offen lds
    s_add_u32 m0, s61, 17408
    s_add_u32 s97, s62, 5373952
    buffer_load_dwordx4 v32, s[40:43], s97 offen lds
    s_add_u32 m0, s61, 18432
    s_add_u32 s97, s62, 5505024
    buffer_load_dwordx4 v32, s[40:43], s97 offen lds
    s_add_u32 m0, s61, 19456
    s_add_u32 s97, s62, 5636096
    buffer_load_dwordx4 v32, s[40:43], s97 offen lds
    s_add_u32 m0, s61, 20480
    s_add_u32 s97, s62, 5767168
    buffer_load_dwordx4 v32, s[40:43], s97 offen lds
    s_add_u32 m0, s61, 21504
    s_add_u32 s97, s62, 5898240
    buffer_load_dwordx4 v32, s[40:43], s97 offen lds
    s_add_u32 m0, s61, 22528
    s_add_u32 s97, s62, 6029312
    buffer_load_dwordx4 v32, s[40:43], s97 offen lds
    s_add_u32 m0, s61, 23552
    s_add_u32 s97, s62, 6160384
    buffer_load_dwordx4 v32, s[40:43], s97 offen lds
    ds_read_b128 v[72:75], v10 offset:512
    ds_read_b128 v[76:79], v10 offset:33280
    ds_read_b128 v[80:83], v11 offset:512
    ds_read_b128 v[84:87], v11 offset:33280
    ds_read_b128 v[88:91], v12 offset:512
    ds_read_b128 v[92:95], v12 offset:33280
    ds_read_b128 v[96:99], v13 offset:512
    ds_read_b128 v[100:103], v13 offset:33280
    s_waitcnt lgkmcnt(7)
    v_mfma_f32_16x16x32_bf16 v[40:43], v[72:75], a[64:67], v[40:43]
    v_mfma_f32_16x16x32_bf16 v[48:51], v[72:75], a[68:71], v[48:51]
    s_waitcnt lgkmcnt(6)
    v_mfma_f32_16x16x32_bf16 v[44:47], v[76:79], a[64:67], v[44:47]
    v_mfma_f32_16x16x32_bf16 v[52:55], v[76:79], a[68:71], v[52:55]
    s_waitcnt lgkmcnt(5)
    v_mfma_f32_16x16x32_bf16 v[40:43], v[80:83], a[72:75], v[40:43]
    v_mfma_f32_16x16x32_bf16 v[48:51], v[80:83], a[76:79], v[48:51]
    s_waitcnt lgkmcnt(4)
    v_mfma_f32_16x16x32_bf16 v[44:47], v[84:87], a[72:75], v[44:47]
    v_mfma_f32_16x16x32_bf16 v[52:55], v[84:87], a[76:79], v[52:55]
    s_waitcnt lgkmcnt(3)
    v_mfma_f32_16x16x32_bf16 v[40:43], v[88:91], a[80:83], v[40:43]
    v_mfma_f32_16x16x32_bf16 v[48:51], v[88:91], a[84:87], v[48:51]
    s_waitcnt lgkmcnt(2)
    v_mfma_f32_16x16x32_bf16 v[44:47], v[92:95], a[80:83], v[44:47]
    v_mfma_f32_16x16x32_bf16 v[52:55], v[92:95], a[84:87], v[52:55]
    s_waitcnt lgkmcnt(1)
    v_mfma_f32_16x16x32_bf16 v[40:43], v[96:99], a[88:91], v[40:43]
    v_mfma_f32_16x16x32_bf16 v[48:51], v[96:99], a[92:95], v[48:51]
    s_waitcnt lgkmcnt(0)
    v_mfma_f32_16x16x32_bf16 v[44:47], v[100:103], a[88:91], v[44:47]
    v_mfma_f32_16x16x32_bf16 v[52:55], v[100:103], a[92:95], v[52:55]
    s_waitcnt vmcnt(16)
    ds_read_b64_tr_b16 a[96:97], v33 offset:0
    ds_read_b64_tr_b16 a[98:99], v33 offset:256
    ds_read_b64_tr_b16 a[100:101], v34 offset:0
    ds_read_b64_tr_b16 a[102:103], v34 offset:256
    ds_read_b64_tr_b16 a[104:105], v33 offset:2048
    ds_read_b64_tr_b16 a[106:107], v33 offset:2304
    ds_read_b64_tr_b16 a[108:109], v34 offset:2048
    ds_read_b64_tr_b16 a[110:111], v34 offset:2304
    ds_read_b64_tr_b16 a[112:113], v33 offset:4096
    ds_read_b64_tr_b16 a[114:115], v33 offset:4352
    ds_read_b64_tr_b16 a[116:117], v34 offset:4096
    ds_read_b64_tr_b16 a[118:119], v34 offset:4352
    ds_read_b64_tr_b16 a[120:121], v33 offset:6144
    ds_read_b64_tr_b16 a[122:123], v33 offset:6400
    ds_read_b64_tr_b16 a[124:125], v34 offset:6144
    ds_read_b64_tr_b16 a[126:127], v34 offset:6400
    s_waitcnt lgkmcnt(0)
    s_add_u32 m0, s61, 0
    s_add_u32 s97, s62, 6291456
    buffer_load_dwordx4 v32, s[40:43], s97 offen lds
    s_add_u32 m0, s61, 1024
    s_add_u32 s97, s62, 6422528
    buffer_load_dwordx4 v32, s[40:43], s97 offen lds
    s_add_u32 m0, s61, 2048
    s_add_u32 s97, s62, 6553600
    buffer_load_dwordx4 v32, s[40:43], s97 offen lds
    s_add_u32 m0, s61, 3072
    s_add_u32 s97, s62, 6684672
    buffer_load_dwordx4 v32, s[40:43], s97 offen lds
    s_add_u32 m0, s61, 4096
    s_add_u32 s97, s62, 6815744
    buffer_load_dwordx4 v32, s[40:43], s97 offen lds
    s_add_u32 m0, s61, 5120
    s_add_u32 s97, s62, 6946816
    buffer_load_dwordx4 v32, s[40:43], s97 offen lds
    s_add_u32 m0, s61, 6144
    s_add_u32 s97, s62, 7077888
    buffer_load_dwordx4 v32, s[40:43], s97 offen lds
    s_add_u32 m0, s61, 7168
    s_add_u32 s97, s62, 7208960
    buffer_load_dwordx4 v32, s[40:43], s97 offen lds
    ds_read_b128 v[72:75], v10 offset:768
    ds_read_b128 v[76:79], v10 offset:33536
    ds_read_b128 v[80:83], v11 offset:768
    ds_read_b128 v[84:87], v11 offset:33536
    ds_read_b128 v[88:91], v12 offset:768
    ds_read_b128 v[92:95], v12 offset:33536
    ds_read_b128 v[96:99], v13 offset:768
    ds_read_b128 v[100:103], v13 offset:33536
    s_waitcnt lgkmcnt(7)
    v_mfma_f32_16x16x32_bf16 v[40:43], v[72:75], a[96:99], v[40:43]
    v_mfma_f32_16x16x32_bf16 v[48:51], v[72:75], a[100:103], v[48:51]
    s_waitcnt lgkmcnt(6)
    v_mfma_f32_16x16x32_bf16 v[44:47], v[76:79], a[96:99], v[44:47]
    v_mfma_f32_16x16x32_bf16 v[52:55], v[76:79], a[100:103], v[52:55]
    s_waitcnt lgkmcnt(5)
    v_mfma_f32_16x16x32_bf16 v[40:43], v[80:83], a[104:107], v[40:43]
    v_mfma_f32_16x16x32_bf16 v[48:51], v[80:83], a[108:111], v[48:51]
    s_waitcnt lgkmcnt(4)
    v_mfma_f32_16x16x32_bf16 v[44:47], v[84:87], a[104:107], v[44:47]
    v_mfma_f32_16x16x32_bf16 v[52:55], v[84:87], a[108:111], v[52:55]
    s_waitcnt lgkmcnt(3)
    v_mfma_f32_16x16x32_bf16 v[40:43], v[88:91], a[112:115], v[40:43]
    v_mfma_f32_16x16x32_bf16 v[48:51], v[88:91], a[116:119], v[48:51]
    s_waitcnt lgkmcnt(2)
    v_mfma_f32_16x16x32_bf16 v[44:47], v[92:95], a[112:115], v[44:47]
    v_mfma_f32_16x16x32_bf16 v[52:55], v[92:95], a[116:119], v[52:55]
    s_waitcnt lgkmcnt(1)
    v_mfma_f32_16x16x32_bf16 v[40:43], v[96:99], a[120:123], v[40:43]
    v_mfma_f32_16x16x32_bf16 v[48:51], v[96:99], a[124:127], v[48:51]
    s_waitcnt lgkmcnt(0)
    v_mfma_f32_16x16x32_bf16 v[44:47], v[100:103], a[120:123], v[44:47]
    v_mfma_f32_16x16x32_bf16 v[52:55], v[100:103], a[124:127], v[52:55]
    s_waitcnt vmcnt(16)
    ds_read_b64_tr_b16 a[128:129], v33 offset:8192
    ds_read_b64_tr_b16 a[130:131], v33 offset:8448
    ds_read_b64_tr_b16 a[132:133], v34 offset:8192
    ds_read_b64_tr_b16 a[134:135], v34 offset:8448
    ds_read_b64_tr_b16 a[136:137], v33 offset:10240
    ds_read_b64_tr_b16 a[138:139], v33 offset:10496
    ds_read_b64_tr_b16 a[140:141], v34 offset:10240
    ds_read_b64_tr_b16 a[142:143], v34 offset:10496
    ds_read_b64_tr_b16 a[144:145], v33 offset:12288
    ds_read_b64_tr_b16 a[146:147], v33 offset:12544
    ds_read_b64_tr_b16 a[148:149], v34 offset:12288
    ds_read_b64_tr_b16 a[150:151], v34 offset:12544
    ds_read_b64_tr_b16 a[152:153], v33 offset:14336
    ds_read_b64_tr_b16 a[154:155], v33 offset:14592
    ds_read_b64_tr_b16 a[156:157], v34 offset:14336
    ds_read_b64_tr_b16 a[158:159], v34 offset:14592
    s_waitcnt lgkmcnt(0)
    s_add_u32 m0, s61, 8192
    s_add_u32 s97, s62, 7340032
    buffer_load_dwordx4 v32, s[40:43], s97 offen lds
    s_add_u32 m0, s61, 9216
    s_add_u32 s97, s62, 7471104
    buffer_load_dwordx4 v32, s[40:43], s97 offen lds
    s_add_u32 m0, s61, 10240
    s_add_u32 s97, s62, 7602176
    buffer_load_dwordx4 v32, s[40:43], s97 offen lds
    s_add_u32 m0, s61, 11264
    s_add_u32 s97, s62, 7733248
    buffer_load_dwordx4 v32, s[40:43], s97 offen lds
    s_add_u32 m0, s61, 12288
    s_add_u32 s97, s62, 7864320
    buffer_load_dwordx4 v32, s[40:43], s97 offen lds
    s_add_u32 m0, s61, 13312
    s_add_u32 s97, s62, 7995392
    buffer_load_dwordx4 v32, s[40:43], s97 offen lds
    s_add_u32 m0, s61, 14336
    s_add_u32 s97, s62, 8126464
    buffer_load_dwordx4 v32, s[40:43], s97 offen lds
    s_add_u32 m0, s61, 15360
    s_add_u32 s97, s62, 8257536
    buffer_load_dwordx4 v32, s[40:43], s97 offen lds
    v_and_b32 v238, 7, v0
    v_lshlrev_b32 v238, 5, v238
    global_load_dword v239, v238, s[32:33] sc1
    ds_read_b128 v[72:75], v10 offset:1024
    ds_read_b128 v[76:79], v10 offset:33792
    ds_read_b128 v[80:83], v11 offset:1024
    ds_read_b128 v[84:87], v11 offset:33792
    ds_read_b128 v[88:91], v12 offset:1024
    ds_read_b128 v[92:95], v12 offset:33792
    ds_read_b128 v[96:99], v13 offset:1024
    ds_read_b128 v[100:103], v13 offset:33792
    s_waitcnt lgkmcnt(7)
    v_mfma_f32_16x16x32_bf16 v[40:43], v[72:75], a[128:131], v[40:43]
    v_mfma_f32_16x16x32_bf16 v[48:51], v[72:75], a[132:135], v[48:51]
    s_waitcnt lgkmcnt(6)
    v_mfma_f32_16x16x32_bf16 v[44:47], v[76:79], a[128:131], v[44:47]
    v_mfma_f32_16x16x32_bf16 v[52:55], v[76:79], a[132:135], v[52:55]
    s_waitcnt lgkmcnt(5)
    v_mfma_f32_16x16x32_bf16 v[40:43], v[80:83], a[136:139], v[40:43]
    v_mfma_f32_16x16x32_bf16 v[48:51], v[80:83], a[140:143], v[48:51]
    s_waitcnt lgkmcnt(4)
    v_mfma_f32_16x16x32_bf16 v[44:47], v[84:87], a[136:139], v[44:47]
    v_mfma_f32_16x16x32_bf16 v[52:55], v[84:87], a[140:143], v[52:55]
    s_waitcnt lgkmcnt(3)
    v_mfma_f32_16x16x32_bf16 v[40:43], v[88:91], a[144:147], v[40:43]
    v_mfma_f32_16x16x32_bf16 v[48:51], v[88:91], a[148:151], v[48:51]
    s_waitcnt lgkmcnt(2)
    v_mfma_f32_16x16x32_bf16 v[44:47], v[92:95], a[144:147], v[44:47]
    v_mfma_f32_16x16x32_bf16 v[52:55], v[92:95], a[148:151], v[52:55]
    s_waitcnt lgkmcnt(1)
    v_mfma_f32_16x16x32_bf16 v[40:43], v[96:99], a[152:155], v[40:43]
    v_mfma_f32_16x16x32_bf16 v[48:51], v[96:99], a[156:159], v[48:51]
    s_waitcnt lgkmcnt(0)
    v_mfma_f32_16x16x32_bf16 v[44:47], v[100:103], a[152:155], v[44:47]
    v_mfma_f32_16x16x32_bf16 v[52:55], v[100:103], a[156:159], v[52:55]
    s_waitcnt vmcnt(17)
    ds_read_b64_tr_b16 a[160:161], v33 offset:16384
    ds_read_b64_tr_b16 a[162:163], v33 offset:16640
    ds_read_b64_tr_b16 a[164:165], v34 offset:16384
    ds_read_b64_tr_b16 a[166:167], v34 offset:16640
    ds_read_b64_tr_b16 a[168:169], v33 offset:18432
    ds_read_b64_tr_b16 a[170:171], v33 offset:18688
    ds_read_b64_tr_b16 a[172:173], v34 offset:18432
    ds_read_b64_tr_b16 a[174:175], v34 offset:18688
    ds_read_b64_tr_b16 a[176:177], v33 offset:20480
    ds_read_b64_tr_b16 a[178:179], v33 offset:20736
    ds_read_b64_tr_b16 a[180:181], v34 offset:20480
    ds_read_b64_tr_b16 a[182:183], v34 offset:20736
    ds_read_b64_tr_b16 a[184:185], v33 offset:22528
    ds_read_b64_tr_b16 a[186:187], v33 offset:22784
    ds_read_b64_tr_b16 a[188:189], v34 offset:22528
    ds_read_b64_tr_b16 a[190:191], v34 offset:22784
    s_waitcnt lgkmcnt(0)
    ds_read_b128 v[72:75], v10 offset:1280
    ds_read_b128 v[76:79], v10 offset:34048
    ds_read_b128 v[80:83], v11 offset:1280
    ds_read_b128 v[84:87], v11 offset:34048
    ds_read_b128 v[88:91], v12 offset:1280
    ds_read_b128 v[92:95], v12 offset:34048
    ds_read_b128 v[96:99], v13 offset:1280
    ds_read_b128 v[100:103], v13 offset:34048
    s_waitcnt lgkmcnt(7)
    v_mfma_f32_16x16x32_bf16 v[40:43], v[72:75], a[160:163], v[40:43]
    v_mfma_f32_16x16x32_bf16 v[48:51], v[72:75], a[164:167], v[48:51]
    s_waitcnt lgkmcnt(6)
    v_mfma_f32_16x16x32_bf16 v[44:47], v[76:79], a[160:163], v[44:47]
    v_mfma_f32_16x16x32_bf16 v[52:55], v[76:79], a[164:167], v[52:55]
    s_waitcnt lgkmcnt(5)
    v_mfma_f32_16x16x32_bf16 v[40:43], v[80:83], a[168:171], v[40:43]
    v_mfma_f32_16x16x32_bf16 v[48:51], v[80:83], a[172:175], v[48:51]
    s_waitcnt lgkmcnt(4)
    v_mfma_f32_16x16x32_bf16 v[44:47], v[84:87], a[168:171], v[44:47]
    v_mfma_f32_16x16x32_bf16 v[52:55], v[84:87], a[172:175], v[52:55]
    s_waitcnt lgkmcnt(3)
    v_mfma_f32_16x16x32_bf16 v[40:43], v[88:91], a[176:179], v[40:43]
    v_mfma_f32_16x16x32_bf16 v[48:51], v[88:91], a[180:183], v[48:51]
    s_waitcnt lgkmcnt(2)
    v_mfma_f32_16x16x32_bf16 v[44:47], v[92:95], a[176:179], v[44:47]
    v_mfma_f32_16x16x32_bf16 v[52:55], v[92:95], a[180:183], v[52:55]
    s_waitcnt lgkmcnt(1)
    v_mfma_f32_16x16x32_bf16 v[40:43], v[96:99], a[184:187], v[40:43]
    v_mfma_f32_16x16x32_bf16 v[48:51], v[96:99], a[188:191], v[48:51]
    s_waitcnt lgkmcnt(0)
    v_mfma_f32_16x16x32_bf16 v[44:47], v[100:103], a[184:187], v[44:47]
    v_mfma_f32_16x16x32_bf16 v[52:55], v[100:103], a[188:191], v[52:55]
    s_waitcnt vmcnt(9)
    ds_read_b64_tr_b16 a[192:193], v33 offset:0
    ds_read_b64_tr_b16 a[194:195], v33 offset:256
    ds_read_b64_tr_b16 a[196:197], v34 offset:0
    ds_read_b64_tr_b16 a[198:199], v34 offset:256
    ds_read_b64_tr_b16 a[200:201], v33 offset:2048
    ds_read_b64_tr_b16 a[202:203], v33 offset:2304
    ds_read_b64_tr_b16 a[204:205], v34 offset:2048
    ds_read_b64_tr_b16 a[206:207], v34 offset:2304
    ds_read_b64_tr_b16 a[208:209], v33 offset:4096
    ds_read_b64_tr_b16 a[210:211], v33 offset:4352
    ds_read_b64_tr_b16 a[212:213], v34 offset:4096
    ds_read_b64_tr_b16 a[214:215], v34 offset:4352
    ds_read_b64_tr_b16 a[216:217], v33 offset:6144
    ds_read_b64_tr_b16 a[218:219], v33 offset:6400
    ds_read_b64_tr_b16 a[220:221], v34 offset:6144
    ds_read_b64_tr_b16 a[222:223], v34 offset:6400
    s_waitcnt lgkmcnt(0)
    ds_read_b128 v[72:75], v10 offset:1536
    ds_read_b128 v[76:79], v10 offset:34304
    ds_read_b128 v[80:83], v11 offset:1536
    ds_read_b128 v[84:87], v11 offset:34304
    ds_read_b128 v[88:91], v12 offset:1536
    ds_read_b128 v[92:95], v12 offset:34304
    ds_read_b128 v[96:99], v13 offset:1536
    ds_read_b128 v[100:103], v13 offset:34304
    s_waitcnt lgkmcnt(7)
    v_mfma_f32_16x16x32_bf16 v[40:43], v[72:75], a[192:195], v[40:43]
    v_mfma_f32_16x16x32_bf16 v[48:51], v[72:75], a[196:199], v[48:51]
    s_waitcnt lgkmcnt(6)
    v_mfma_f32_16x16x32_bf16 v[44:47], v[76:79], a[192:195], v[44:47]
    v_mfma_f32_16x16x32_bf16 v[52:55], v[76:79], a[196:199], v[52:55]
    s_waitcnt lgkmcnt(5)
    v_mfma_f32_16x16x32_bf16 v[40:43], v[80:83], a[200:203], v[40:43]
    v_mfma_f32_16x16x32_bf16 v[48:51], v[80:83], a[204:207], v[48:51]
    s_waitcnt lgkmcnt(4)
    v_mfma_f32_16x16x32_bf16 v[44:47], v[84:87], a[200:203], v[44:47]
    v_mfma_f32_16x16x32_bf16 v[52:55], v[84:87], a[204:207], v[52:55]
    s_waitcnt lgkmcnt(3)
    v_mfma_f32_16x16x32_bf16 v[40:43], v[88:91], a[208:211], v[40:43]
    v_mfma_f32_16x16x32_bf16 v[48:51], v[88:91], a[212:215], v[48:51]
    s_waitcnt lgkmcnt(2)
    v_mfma_f32_16x16x32_bf16 v[44:47], v[92:95], a[208:211], v[44:47]
    v_mfma_f32_16x16x32_bf16 v[52:55], v[92:95], a[212:215], v[52:55]
    s_waitcnt lgkmcnt(1)
    v_mfma_f32_16x16x32_bf16 v[40:43], v[96:99], a[216:219], v[40:43]
    v_mfma_f32_16x16x32_bf16 v[48:51], v[96:99], a[220:223], v[48:51]
    s_waitcnt lgkmcnt(0)
    v_mfma_f32_16x16x32_bf16 v[44:47], v[100:103], a[216:219], v[44:47]
    v_mfma_f32_16x16x32_bf16 v[52:55], v[100:103], a[220:223], v[52:55]
    s_waitcnt vmcnt(1)
    ds_read_b64_tr_b16 a[224:225], v33 offset:8192
    ds_read_b64_tr_b16 a[226:227], v33 offset:8448
    ds_read_b64_tr_b16 a[228:229], v34 offset:8192
    ds_read_b64_tr_b16 a[230:231], v34 offset:8448
    ds_read_b64_tr_b16 a[232:233], v33 offset:10240
    ds_read_b64_tr_b16 a[234:235], v33 offset:10496
    ds_read_b64_tr_b16 a[236:237], v34 offset:10240
    ds_read_b64_tr_b16 a[238:239], v34 offset:10496
    ds_read_b64_tr_b16 a[240:241], v33 offset:12288
    ds_read_b64_tr_b16 a[242:243], v33 offset:12544
    ds_read_b64_tr_b16 a[244:245], v34 offset:12288
    ds_read_b64_tr_b16 a[246:247], v34 offset:12544
    ds_read_b64_tr_b16 a[248:249], v33 offset:14336
    ds_read_b64_tr_b16 a[250:251], v33 offset:14592
    ds_read_b64_tr_b16 a[252:253], v34 offset:14336
    ds_read_b64_tr_b16 a[254:255], v34 offset:14592
    s_waitcnt lgkmcnt(0)
    ds_read_b128 v[72:75], v10 offset:1792
    ds_read_b128 v[76:79], v10 offset:34560
    ds_read_b128 v[80:83], v11 offset:1792
    ds_read_b128 v[84:87], v11 offset:34560
    ds_read_b128 v[88:91], v12 offset:1792
    ds_read_b128 v[92:95], v12 offset:34560
    ds_read_b128 v[96:99], v13 offset:1792
    ds_read_b128 v[100:103], v13 offset:34560
    s_waitcnt lgkmcnt(7)
    v_mfma_f32_16x16x32_bf16 v[40:43], v[72:75], a[224:227], v[40:43]
    v_mfma_f32_16x16x32_bf16 v[48:51], v[72:75], a[228:231], v[48:51]
    s_waitcnt lgkmcnt(6)
    v_mfma_f32_16x16x32_bf16 v[44:47], v[76:79], a[224:227], v[44:47]
    v_mfma_f32_16x16x32_bf16 v[52:55], v[76:79], a[228:231], v[52:55]
    s_waitcnt lgkmcnt(5)
    v_mfma_f32_16x16x32_bf16 v[40:43], v[80:83], a[232:235], v[40:43]
    v_mfma_f32_16x16x32_bf16 v[48:51], v[80:83], a[236:239], v[48:51]
    s_waitcnt lgkmcnt(4)
    v_mfma_f32_16x16x32_bf16 v[44:47], v[84:87], a[232:235], v[44:47]
    v_mfma_f32_16x16x32_bf16 v[52:55], v[84:87], a[236:239], v[52:55]
    s_waitcnt lgkmcnt(3)
    v_mfma_f32_16x16x32_bf16 v[40:43], v[88:91], a[240:243], v[40:43]
    v_mfma_f32_16x16x32_bf16 v[48:51], v[88:91], a[244:247], v[48:51]
    s_waitcnt lgkmcnt(2)
    v_mfma_f32_16x16x32_bf16 v[44:47], v[92:95], a[240:243], v[44:47]
    v_mfma_f32_16x16x32_bf16 v[52:55], v[92:95], a[244:247], v[52:55]
    s_waitcnt lgkmcnt(1)
    v_mfma_f32_16x16x32_bf16 v[40:43], v[96:99], a[248:251], v[40:43]
    v_mfma_f32_16x16x32_bf16 v[48:51], v[96:99], a[252:255], v[48:51]
    s_waitcnt lgkmcnt(0)
    v_mfma_f32_16x16x32_bf16 v[44:47], v[100:103], a[248:251], v[44:47]
    v_mfma_f32_16x16x32_bf16 v[52:55], v[100:103], a[252:255], v[52:55]
    s_barrier
    s_cmp_eq_u32 s56, 1
    s_cbranch_scc1 L_cenok_6
    s_waitcnt vmcnt(0)
    s_branch L_cen_5_w
    v_and_b32 v238, 7, v0
    v_lshlrev_b32 v238, 5, v238
L_cen_5:
    global_load_dword v239, v238, s[32:33] sc1
    s_waitcnt vmcnt(0)
L_cen_5_w:
    v_lshrrev_b32 v30, 16, v239
    s_mov_b32 s96, 0
    v_readlane_b32 s97, v30, 0
    s_add_u32 s96, s96, s97
    v_readlane_b32 s97, v30, 1
    s_add_u32 s96, s96, s97
    v_readlane_b32 s97, v30, 2
    s_add_u32 s96, s96, s97
    v_readlane_b32 s97, v30, 3
    s_add_u32 s96, s96, s97
    v_readlane_b32 s97, v30, 4
    s_add_u32 s96, s96, s97
    v_readlane_b32 s97, v30, 5
    s_add_u32 s96, s96, s97
    v_readlane_b32 s97, v30, 6
    s_add_u32 s96, s96, s97
    v_readlane_b32 s97, v30, 7
    s_add_u32 s96, s96, s97
    s_cmp_eq_u32 s96, 256
    s_cbranch_scc1 L_cen_5_done
    s_sub_u32 s57, s57, 1
    s_cbranch_scc1 L_exit
    s_branch L_cen_5
L_cen_5_done:
    s_mov_b32 s56, 1
    v_cmp_ne_u32 vcc, 0x200020, v239
    s_cbranch_vccz L_cenok_6
    s_lshr_b32 s52, s2, 5
    s_and_b32 s53, s2, 31
    s_mov_b32 s55, 1
    s_waitcnt vmcnt(0)
    s_barrier
    s_branch L_dispatch
    s_nop 0
L_cenok_6:
    s_add_u32 s59, s64, 4096
    v_cvt_pk_bf16_f32 v32, v40, v41
    v_cvt_pk_bf16_f32 v33, v42, v43
    s_nop 0
    v_cvt_pk_bf16_f32 v34, v44, v45
    v_cvt_pk_bf16_f32 v35, v46, v47
    buffer_store_dwordx4 v[32:35], v26, s[36:39], s64 offen offset:0 sc1
    v_cvt_pk_bf16_f32 v36, v48, v49
    v_cvt_pk_bf16_f32 v37, v50, v51
    v_cvt_pk_bf16_f32 v38, v52, v53
    v_cvt_pk_bf16_f32 v39, v54, v55
    buffer_store_dwordx4 v[36:39], v26, s[36:39], s64 offen offset:1024 sc1
    s_add_u32 s63, s63, 0x10000
    s_add_u32 m0, s67, 65536
    s_nop 0
    buffer_load_dwordx4 v2, s[44:47], s63 offen offset:0 lds
    s_add_u32 m0, s67, 65536
    s_nop 0
    buffer_load_dwordx4 v2, s[44:47], s63 offen offset:1024 lds
    s_add_u32 m0, s67, 67584
    s_nop 0
    buffer_load_dwordx4 v3, s[44:47], s63 offen offset:0 lds
    s_add_u32 m0, s67, 67584
    s_nop 0
    buffer_load_dwordx4 v3, s[44:47], s63 offen offset:1024 lds
    s_add_u32 m0, s67, 69632
    s_nop 0
    buffer_load_dwordx4 v4, s[44:47], s63 offen offset:0 lds
    s_add_u32 m0, s67, 69632
    s_nop 0
    buffer_load_dwordx4 v4, s[44:47], s63 offen offset:1024 lds
    s_add_u32 m0, s67, 71680
    s_nop 0
    buffer_load_dwordx4 v5, s[44:47], s63 offen offset:0 lds
    s_add_u32 m0, s67, 71680
    s_nop 0
    buffer_load_dwordx4 v5, s[44:47], s63 offen offset:1024 lds
    s_add_u32 m0, s67, 73728
    s_nop 0
    buffer_load_dwordx4 v6, s[44:47], s63 offen offset:0 lds
    s_add_u32 m0, s67, 73728
    s_nop 0
    buffer_load_dwordx4 v6, s[44:47], s63 offen offset:1024 lds
    s_add_u32 m0, s67, 75776
    s_nop 0
    buffer_load_dwordx4 v7, s[44:47], s63 offen offset:0 lds
    s_add_u32 m0, s67, 75776
    s_nop 0
    buffer_load_dwordx4 v7, s[44:47], s63 offen offset:1024 lds
    s_add_u32 m0, s67, 77824
    s_nop 0
    buffer_load_dwordx4 v8, s[44:47], s63 offen offset:0 lds
    s_add_u32 m0, s67, 77824
    s_nop 0
    buffer_load_dwordx4 v8, s[44:47], s63 offen offset:1024 lds
    s_add_u32 m0, s67, 79872
    s_nop 0
    buffer_load_dwordx4 v9, s[44:47], s63 offen offset:0 lds
    s_add_u32 m0, s67, 79872
    s_nop 0
    buffer_load_dwordx4 v9, s[44:47], s63 offen offset:1024 lds
    s_waitcnt vmcnt(16)
    buffer_store_dword v27, v106, s[36:39], s66 offen sc1
    s_waitcnt vmcnt(1)
    s_barrier
L_qkv_loop_v:
    ds_read_b128 v[72:75], v14 offset:0
    ds_read_b128 v[76:79], v14 offset:32768
    ds_read_b128 v[80:83], v15 offset:0
    ds_read_b128 v[84:87], v15 offset:32768
    ds_read_b128 v[88:91], v16 offset:0
    ds_read_b128 v[92:95], v16 offset:32768
    ds_read_b128 v[96:99], v17 offset:0
    ds_read_b128 v[100:103], v17 offset:32768
    s_add_u32 s63, s63, 0x10000
    s_waitcnt lgkmcnt(7)
    v_mfma_f32_16x16x32_bf16 v[56:59], v[72:75], a[0:3], 0
    v_mfma_f32_16x16x32_bf16 v[64:67], v[72:75], a[4:7], 0
    ds_read_b128 v[72:75], v14 offset:256
    s_waitcnt lgkmcnt(7)
    v_mfma_f32_16x16x32_bf16 v[60:63], v[76:79], a[0:3], 0
    v_mfma_f32_16x16x32_bf16 v[68:71], v[76:79], a[4:7], 0
    ds_read_b128 v[76:79], v14 offset:33024
    s_add_u32 s59, s64, 4096
    s_waitcnt lgkmcnt(7)
    v_mfma_f32_16x16x32_bf16 v[56:59], v[80:83], a[8:11], v[56:59]
    v_cvt_pk_bf16_f32 v32, v40, v41
    v_mfma_f32_16x16x32_bf16 v[64:67], v[80:83], a[12:15], v[64:67]
    ds_read_b128 v[80:83], v15 offset:256
    v_cvt_pk_bf16_f32 v33, v42, v43
    s_waitcnt lgkmcnt(7)
    v_mfma_f32_16x16x32_bf16 v[60:63], v[84:87], a[8:11], v[60:63]
    v_cvt_pk_bf16_f32 v34, v44, v45
    v_mfma_f32_16x16x32_bf16 v[68:71], v[84:87], a[12:15], v[68:71]
    ds_read_b128 v[84:87], v15 offset:33024
    v_cvt_pk_bf16_f32 v35, v46, v47
    s_waitcnt lgkmcnt(7)
    v_mfma_f32_16x16x32_bf16 v[56:59], v[88:91], a[16:19], v[56:59]
    buffer_store_dwordx4 v[32:35], v26, s[36:39], s64 offen offset:0 sc1
    v_mfma_f32_16x16x32_bf16 v[64:67], v[88:91], a[20:23], v[64:67]
    ds_read_b128 v[88:91], v16 offset:256
    v_cvt_pk_bf16_f32 v36, v48, v49
    s_waitcnt lgkmcnt(7)
    v_mfma_f32_16x16x32_bf16 v[60:63], v[92:95], a[16:19], v[60:63]
    v_cvt_pk_bf16_f32 v37, v50, v51
    v_mfma_f32_16x16x32_bf16 v[68:71], v[92:95], a[20:23], v[68:71]
    ds_read_b128 v[92:95], v16 offset:33024
    v_cvt_pk_bf16_f32 v38, v52, v53
    s_waitcnt lgkmcnt(7)
    v_mfma_f32_16x16x32_bf16 v[56:59], v[96:99], a[24:27], v[56:59]
    v_cvt_pk_bf16_f32 v39, v54, v55
    v_mfma_f32_16x16x32_bf16 v[64:67], v[96:99], a[28:31], v[64:67]
    ds_read_b128 v[96:99], v17 offset:256
    buffer_store_dwordx4 v[36:39], v26, s[36:39], s64 offen offset:1024 sc1
    s_waitcnt lgkmcnt(7)
    v_mfma_f32_16x16x32_bf16 v[60:63], v[100:103], a[24:27], v[60:63]
    s_add_u32 s64, s64, s65
    v_mfma_f32_16x16x32_bf16 v[68:71], v[100:103], a[28:31], v[68:71]
    ds_read_b128 v[100:103], v17 offset:33024
    s_waitcnt lgkmcnt(7)
    v_mfma_f32_16x16x32_bf16 v[56:59], v[72:75], a[32:35], v[56:59]
    s_add_u32 m0, s67, 0
    v_mfma_f32_16x16x32_bf16 v[64:67], v[72:75], a[36:39], v[64:67]
    ds_read_b128 v[72:75], v14 offset:512
    buffer_load_dwordx4 v2, s[44:47], s63 offen offset:0 lds
    s_waitcnt lgkmcnt(7)
    v_mfma_f32_16x16x32_bf16 v[60:63], v[76:79], a[32:35], v[60:63]
    v_mfma_f32_16x16x32_bf16 v[68:71], v[76:79], a[36:39], v[68:71]
    ds_read_b128 v[76:79], v14 offset:33280
    s_add_u32 m0, s67, 0
    s_waitcnt lgkmcnt(7)
    v_mfma_f32_16x16x32_bf16 v[56:59], v[80:83], a[40:43], v[56:59]
    buffer_load_dwordx4 v2, s[44:47], s63 offen offset:1024 lds
    v_mfma_f32_16x16x32_bf16 v[64:67], v[80:83], a[44:47], v[64:67]
    ds_read_b128 v[80:83], v15 offset:512
    s_waitcnt lgkmcnt(7)
    v_mfma_f32_16x16x32_bf16 v[60:63], v[84:87], a[40:43], v[60:63]
    s_add_u32 m0, s67, 2048
    v_mfma_f32_16x16x32_bf16 v[68:71], v[84:87], a[44:47], v[68:71]
    ds_read_b128 v[84:87], v15 offset:33280
    buffer_load_dwordx4 v3, s[44:47], s63 offen offset:0 lds
    s_waitcnt lgkmcnt(7)
    v_mfma_f32_16x16x32_bf16 v[56:59], v[88:91], a[48:51], v[56:59]
    v_mfma_f32_16x16x32_bf16 v[64:67], v[88:91], a[52:55], v[64:67]
    ds_read_b128 v[88:91], v16 offset:512
    s_add_u32 m0, s67, 2048
    s_waitcnt lgkmcnt(7)
    v_mfma_f32_16x16x32_bf16 v[60:63], v[92:95], a[48:51], v[60:63]
    buffer_load_dwordx4 v3, s[44:47], s63 offen offset:1024 lds
    v_mfma_f32_16x16x32_bf16 v[68:71], v[92:95], a[52:55], v[68:71]
    ds_read_b128 v[92:95], v16 offset:33280
    s_waitcnt lgkmcnt(7)
    v_mfma_f32_16x16x32_bf16 v[56:59], v[96:99], a[56:59], v[56:59]
    s_add_u32 m0, s67, 4096
    v_mfma_f32_16x16x32_bf16 v[64:67], v[96:99], a[60:63], v[64:67]
    ds_read_b128 v[96:99], v17 offset:512
    buffer_load_dwordx4 v4, s[44:47], s63 offen offset:0 lds
    s_waitcnt lgkmcnt(7)
    v_mfma_f32_16x16x32_bf16 v[60:63], v[100:103], a[56:59], v[60:63]
    v_mfma_f32_16x16x32_bf16 v[68:71], v[100:103], a[60:63], v[68:71]
    ds_read_b128 v[100:103], v17 offset:33280
    s_add_u32 m0, s67, 4096
    s_waitcnt lgkmcnt(7)
    v_mfma_f32_16x16x32_bf16 v[56:59], v[72:75], a[64:67], v[56:59]
    buffer_load_dwordx4 v4, s[44:47], s63 offen offset:1024 lds
    v_mfma_f32_16x16x32_bf16 v[64:67], v[72:75], a[68:71], v[64:67]
    ds_read_b128 v[72:75], v14 offset:768
    s_waitcnt lgkmcnt(7)
    v_mfma_f32_16x16x32_bf16 v[60:63], v[76:79], a[64:67], v[60:63]
    s_add_u32 m0, s67, 6144
    v_mfma_f32_16x16x32_bf16 v[68:71], v[76:79], a[68:71], v[68:71]
    ds_read_b128 v[76:79], v14 offset:33536
    buffer_load_dwordx4 v5, s[44:47], s63 offen offset:0 lds
    s_waitcnt lgkmcnt(7)
    v_mfma_f32_16x16x32_bf16 v[56:59], v[80:83], a[72:75], v[56:59]
    v_mfma_f32_16x16x32_bf16 v[64:67], v[80:83], a[76:79], v[64:67]
    ds_read_b128 v[80:83], v15 offset:768
    s_add_u32 m0, s67, 6144
    s_waitcnt lgkmcnt(7)
    v_mfma_f32_16x16x32_bf16 v[60:63], v[84:87], a[72:75], v[60:63]
    buffer_load_dwordx4 v5, s[44:47], s63 offen offset:1024 lds
    v_mfma_f32_16x16x32_bf16 v[68:71], v[84:87], a[76:79], v[68:71]
    ds_read_b128 v[84:87], v15 offset:33536
    s_waitcnt lgkmcnt(7)
    v_mfma_f32_16x16x32_bf16 v[56:59], v[88:91], a[80:83], v[56:59]
    s_add_u32 m0, s67, 8192
    v_mfma_f32_16x16x32_bf16 v[64:67], v[88:91], a[84:87], v[64:67]
    ds_read_b128 v[88:91], v16 offset:768
    buffer_load_dwordx4 v6, s[44:47], s63 offen offset:0 lds
    s_waitcnt lgkmcnt(7)
    v_mfma_f32_16x16x32_bf16 v[60:63], v[92:95], a[80:83], v[60:63]
    v_mfma_f32_16x16x32_bf16 v[68:71], v[92:95], a[84:87], v[68:71]
    ds_read_b128 v[92:95], v16 offset:33536
    s_add_u32 m0, s67, 8192
    s_waitcnt lgkmcnt(7)
    v_mfma_f32_16x16x32_bf16 v[56:59], v[96:99], a[88:91], v[56:59]
    buffer_load_dwordx4 v6, s[44:47], s63 offen offset:1024 lds
    v_mfma_f32_16x16x32_bf16 v[64:67], v[96:99], a[92:95], v[64:67]
    ds_read_b128 v[96:99], v17 offset:768
    s_waitcnt lgkmcnt(7)
    v_mfma_f32_16x16x32_bf16 v[60:63], v[100:103], a[88:91], v[60:63]
    s_add_u32 m0, s67, 10240
    v_mfma_f32_16x16x32_bf16 v[68:71], v[100:103], a[92:95], v[68:71]
    ds_read_b128 v[100:103], v17 offset:33536
    buffer_load_dwordx4 v7, s[44:47], s63 offen offset:0 lds
    s_waitcnt lgkmcnt(7)
    v_mfma_f32_16x16x32_bf16 v[56:59], v[72:75], a[96:99], v[56:59]
    v_mfma_f32_16x16x32_bf16 v[64:67], v[72:75], a[100:103], v[64:67]
    ds_read_b128 v[72:75], v14 offset:1024
    s_add_u32 m0, s67, 10240
    s_waitcnt lgkmcnt(7)
    v_mfma_f32_16x16x32_bf16 v[60:63], v[76:79], a[96:99], v[60:63]
    buffer_load_dwordx4 v7, s[44:47], s63 offen offset:1024 lds
    v_mfma_f32_16x16x32_bf16 v[68:71], v[76:79], a[100:103], v[68:71]
    ds_read_b128 v[76:79], v14 offset:33792
    s_waitcnt lgkmcnt(7)
    v_mfma_f32_16x16x32_bf16 v[56:59], v[80:83], a[104:107], v[56:59]
    s_add_u32 m0, s67, 12288
    v_mfma_f32_16x16x32_bf16 v[64:67], v[80:83], a[108:111], v[64:67]
    ds_read_b128 v[80:83], v15 offset:1024
    buffer_load_dwordx4 v8, s[44:47], s63 offen offset:0 lds
    s_waitcnt lgkmcnt(7)
    v_mfma_f32_16x16x32_bf16 v[60:63], v[84:87], a[104:107], v[60:63]
    v_mfma_f32_16x16x32_bf16 v[68:71], v[84:87], a[108:111], v[68:71]
    ds_read_b128 v[84:87], v15 offset:33792
    s_add_u32 m0, s67, 12288
    s_waitcnt lgkmcnt(7)
    v_mfma_f32_16x16x32_bf16 v[56:59], v[88:91], a[112:115], v[56:59]
    buffer_load_dwordx4 v8, s[44:47], s63 offen offset:1024 lds
    v_mfma_f32_16x16x32_bf16 v[64:67], v[88:91], a[116:119], v[64:67]
    ds_read_b128 v[88:91], v16 offset:1024
    s_waitcnt lgkmcnt(7)
    v_mfma_f32_16x16x32_bf16 v[60:63], v[92:95], a[112:115], v[60:63]
    s_add_u32 m0, s67, 14336
    v_mfma_f32_16x16x32_bf16 v[68:71], v[92:95], a[116:119], v[68:71]
    ds_read_b128 v[92:95], v16 offset:33792
    buffer_load_dwordx4 v9, s[44:47], s63 offen offset:0 lds
    s_waitcnt lgkmcnt(7)
    v_mfma_f32_16x16x32_bf16 v[56:59], v[96:99], a[120:123], v[56:59]
    v_mfma_f32_16x16x32_bf16 v[64:67], v[96:99], a[124:127], v[64:67]
    ds_read_b128 v[96:99], v17 offset:1024
    s_add_u32 m0, s67, 14336
    s_waitcnt lgkmcnt(7)
    v_mfma_f32_16x16x32_bf16 v[60:63], v[100:103], a[120:123], v[60:63]
    buffer_load_dwordx4 v9, s[44:47], s63 offen offset:1024 lds
    v_mfma_f32_16x16x32_bf16 v[68:71], v[100:103], a[124:127], v[68:71]
    ds_read_b128 v[100:103], v17 offset:33792
    s_waitcnt lgkmcnt(7)
    v_mfma_f32_16x16x32_bf16 v[56:59], v[72:75], a[128:131], v[56:59]
    buffer_load_dword v105, v104, s[44:47], s63 offen
    v_mfma_f32_16x16x32_bf16 v[64:67], v[72:75], a[132:135], v[64:67]
    ds_read_b128 v[72:75], v14 offset:1280
    s_waitcnt lgkmcnt(7)
    v_mfma_f32_16x16x32_bf16 v[60:63], v[76:79], a[128:131], v[60:63]
    v_mfma_f32_16x16x32_bf16 v[68:71], v[76:79], a[132:135], v[68:71]
    ds_read_b128 v[76:79], v14 offset:34048
    s_waitcnt lgkmcnt(7)
    v_mfma_f32_16x16x32_bf16 v[56:59], v[80:83], a[136:139], v[56:59]
    v_mfma_f32_16x16x32_bf16 v[64:67], v[80:83], a[140:143], v[64:67]
    ds_read_b128 v[80:83], v15 offset:1280
    s_waitcnt lgkmcnt(7)
    v_mfma_f32_16x16x32_bf16 v[60:63], v[84:87], a[136:139], v[60:63]
    s_waitcnt vmcnt(17)
    buffer_store_dword v27, v106, s[36:39], s66 offen sc1
    v_add_u32 v27, 1, v27
    v_mfma_f32_16x16x32_bf16 v[68:71], v[84:87], a[140:143], v[68:71]
    ds_read_b128 v[84:87], v15 offset:34048
    s_waitcnt lgkmcnt(7)
    v_mfma_f32_16x16x32_bf16 v[56:59], v[88:91], a[144:147], v[56:59]
    v_mfma_f32_16x16x32_bf16 v[64:67], v[88:91], a[148:151], v[64:67]
    ds_read_b128 v[88:91], v16 offset:1280
    s_waitcnt lgkmcnt(7)
    v_mfma_f32_16x16x32_bf16 v[60:63], v[92:95], a[144:147], v[60:63]
    v_mfma_f32_16x16x32_bf16 v[68:71], v[92:95], a[148:151], v[68:71]
    ds_read_b128 v[92:95], v16 offset:34048
    s_waitcnt lgkmcnt(7)
    v_mfma_f32_16x16x32_bf16 v[56:59], v[96:99], a[152:155], v[56:59]
    v_mfma_f32_16x16x32_bf16 v[64:67], v[96:99], a[156:159], v[64:67]
    ds_read_b128 v[96:99], v17 offset:1280
    s_waitcnt lgkmcnt(7)
    v_mfma_f32_16x16x32_bf16 v[60:63], v[100:103], a[152:155], v[60:63]
    v_mfma_f32_16x16x32_bf16 v[68:71], v[100:103], a[156:159], v[68:71]
    ds_read_b128 v[100:103], v17 offset:34048
    s_waitcnt lgkmcnt(7)
    v_mfma_f32_16x16x32_bf16 v[56:59], v[72:75], a[160:163], v[56:59]
    v_mfma_f32_16x16x32_bf16 v[64:67], v[72:75], a[164:167], v[64:67]
    ds_read_b128 v[72:75], v14 offset:1536
    s_waitcnt lgkmcnt(7)
    v_mfma_f32_16x16x32_bf16 v[60:63], v[76:79], a[160:163], v[60:63]
    v_mfma_f32_16x16x32_bf16 v[68:71], v[76:79], a[164:167], v[68:71]
    ds_read_b128 v[76:79], v14 offset:34304
    s_waitcnt lgkmcnt(7)
    v_mfma_f32_16x16x32_bf16 v[56:59], v[80:83], a[168:171], v[56:59]
    v_mfma_f32_16x16x32_bf16 v[64:67], v[80:83], a[172:175], v[64:67]
    ds_read_b128 v[80:83], v15 offset:1536
    s_waitcnt lgkmcnt(7)
    v_mfma_f32_16x16x32_bf16 v[60:63], v[84:87], a[168:171], v[60:63]
    v_mfma_f32_16x16x32_bf16 v[68:71], v[84:87], a[172:175], v[68:71]
    ds_read_b128 v[84:87], v15 offset:34304
    s_waitcnt lgkmcnt(7)
    v_mfma_f32_16x16x32_bf16 v[56:59], v[88:91], a[176:179], v[56:59]
    v_mfma_f32_16x16x32_bf16 v[64:67], v[88:91], a[180:183], v[64:67]
    ds_read_b128 v[88:91], v16 offset:1536
    s_waitcnt lgkmcnt(7)
    v_mfma_f32_16x16x32_bf16 v[60:63], v[92:95], a[176:179], v[60:63]
    v_mfma_f32_16x16x32_bf16 v[68:71], v[92:95], a[180:183], v[68:71]
    ds_read_b128 v[92:95], v16 offset:34304
    s_waitcnt lgkmcnt(7)
    v_mfma_f32_16x16x32_bf16 v[56:59], v[96:99], a[184:187], v[56:59]
    v_mfma_f32_16x16x32_bf16 v[64:67], v[96:99], a[188:191], v[64:67]
    ds_read_b128 v[96:99], v17 offset:1536
    s_waitcnt lgkmcnt(7)
    v_mfma_f32_16x16x32_bf16 v[60:63], v[100:103], a[184:187], v[60:63]
    v_mfma_f32_16x16x32_bf16 v[68:71], v[100:103], a[188:191], v[68:71]
    ds_read_b128 v[100:103], v17 offset:34304
    s_waitcnt lgkmcnt(7)
    v_mfma_f32_16x16x32_bf16 v[56:59], v[72:75], a[192:195], v[56:59]
    v_mfma_f32_16x16x32_bf16 v[64:67], v[72:75], a[196:199], v[64:67]
    ds_read_b128 v[72:75], v14 offset:1792
    s_waitcnt lgkmcnt(7)
    v_mfma_f32_16x16x32_bf16 v[60:63], v[76:79], a[192:195], v[60:63]
    v_mfma_f32_16x16x32_bf16 v[68:71], v[76:79], a[196:199], v[68:71]
    ds_read_b128 v[76:79], v14 offset:34560
    s_waitcnt lgkmcnt(7)
    v_mfma_f32_16x16x32_bf16 v[56:59], v[80:83], a[200:203], v[56:59]
    v_mfma_f32_16x16x32_bf16 v[64:67], v[80:83], a[204:207], v[64:67]
    ds_read_b128 v[80:83], v15 offset:1792
    s_waitcnt lgkmcnt(7)
    v_mfma_f32_16x16x32_bf16 v[60:63], v[84:87], a[200:203], v[60:63]
    v_mfma_f32_16x16x32_bf16 v[68:71], v[84:87], a[204:207], v[68:71]
    ds_read_b128 v[84:87], v15 offset:34560
    s_waitcnt lgkmcnt(7)
    v_mfma_f32_16x16x32_bf16 v[56:59], v[88:91], a[208:211], v[56:59]
    v_mfma_f32_16x16x32_bf16 v[64:67], v[88:91], a[212:215], v[64:67]
    ds_read_b128 v[88:91], v16 offset:1792
    s_waitcnt lgkmcnt(7)
    v_mfma_f32_16x16x32_bf16 v[60:63], v[92:95], a[208:211], v[60:63]
    v_mfma_f32_16x16x32_bf16 v[68:71], v[92:95], a[212:215], v[68:71]
    ds_read_b128 v[92:95], v16 offset:34560
    s_waitcnt lgkmcnt(7)
    v_mfma_f32_16x16x32_bf16 v[56:59], v[96:99], a[216:219], v[56:59]
    v_mfma_f32_16x16x32_bf16 v[64:67], v[96:99], a[220:223], v[64:67]
    ds_read_b128 v[96:99], v17 offset:1792
    s_waitcnt lgkmcnt(7)
    v_mfma_f32_16x16x32_bf16 v[60:63], v[100:103], a[216:219], v[60:63]
    v_mfma_f32_16x16x32_bf16 v[68:71], v[100:103], a[220:223], v[68:71]
    ds_read_b128 v[100:103], v17 offset:34560
    s_waitcnt lgkmcnt(7)
    v_mfma_f32_16x16x32_bf16 v[56:59], v[72:75], a[224:227], v[56:59]
    v_mfma_f32_16x16x32_bf16 v[64:67], v[72:75], a[228:231], v[64:67]
    s_waitcnt lgkmcnt(6)
    v_mfma_f32_16x16x32_bf16 v[60:63], v[76:79], a[224:227], v[60:63]
    v_mfma_f32_16x16x32_bf16 v[68:71], v[76:79], a[228:231], v[68:71]
    s_waitcnt lgkmcnt(5)
    v_mfma_f32_16x16x32_bf16 v[56:59], v[80:83], a[232:235], v[56:59]
    v_mfma_f32_16x16x32_bf16 v[64:67], v[80:83], a[236:239], v[64:67]
    s_waitcnt lgkmcnt(4)
    v_mfma_f32_16x16x32_bf16 v[60:63], v[84:87], a[232:235], v[60:63]
    v_mfma_f32_16x16x32_bf16 v[68:71], v[84:87], a[236:239], v[68:71]
    s_waitcnt lgkmcnt(3)
    v_mfma_f32_16x16x32_bf16 v[56:59], v[88:91], a[240:243], v[56:59]
    v_mfma_f32_16x16x32_bf16 v[64:67], v[88:91], a[244:247], v[64:67]
    s_waitcnt lgkmcnt(2)
    v_mfma_f32_16x16x32_bf16 v[60:63], v[92:95], a[240:243], v[60:63]
    v_mfma_f32_16x16x32_bf16 v[68:71], v[92:95], a[244:247], v[68:71]
    s_waitcnt lgkmcnt(1)
    v_mfma_f32_16x16x32_bf16 v[56:59], v[96:99], a[248:251], v[56:59]
    v_mfma_f32_16x16x32_bf16 v[64:67], v[96:99], a[252:255], v[64:67]
    s_waitcnt lgkmcnt(0)
    v_mfma_f32_16x16x32_bf16 v[60:63], v[100:103], a[248:251], v[60:63]
    v_mfma_f32_16x16x32_bf16 v[68:71], v[100:103], a[252:255], v[68:71]
    s_waitcnt vmcnt(2)
    s_barrier
    s_add_u32 s58, s58, 2
    s_cmp_eq_u32 s58, 64
    s_cbranch_scc1 L_qkv_fin_v
    ds_read_b128 v[72:75], v10 offset:0
    ds_read_b128 v[76:79], v10 offset:32768
    ds_read_b128 v[80:83], v11 offset:0
    ds_read_b128 v[84:87], v11 offset:32768
    ds_read_b128 v[88:91], v12 offset:0
    ds_read_b128 v[92:95], v12 offset:32768
    ds_read_b128 v[96:99], v13 offset:0
    ds_read_b128 v[100:103], v13 offset:32768
    s_add_u32 s63, s63, 0x10000
    s_waitcnt lgkmcnt(7)
    v_mfma_f32_16x16x32_bf16 v[40:43], v[72:75], a[0:3], 0
    v_mfma_f32_16x16x32_bf16 v[48:51], v[72:75], a[4:7], 0
    ds_read_b128 v[72:75], v10 offset:256
    s_waitcnt lgkmcnt(7)
    v_mfma_f32_16x16x32_bf16 v[44:47], v[76:79], a[0:3], 0
    v_mfma_f32_16x16x32_bf16 v[52:55], v[76:79], a[4:7], 0
    ds_read_b128 v[76:79], v10 offset:33024
    s_add_u32 s59, s64, 4096
    s_waitcnt lgkmcnt(7)
    v_mfma_f32_16x16x32_bf16 v[40:43], v[80:83], a[8:11], v[40:43]
    v_cvt_pk_bf16_f32 v32, v56, v57
    v_mfma_f32_16x16x32_bf16 v[48:51], v[80:83], a[12:15], v[48:51]
    ds_read_b128 v[80:83], v11 offset:256
    v_cvt_pk_bf16_f32 v33, v58, v59
    s_waitcnt lgkmcnt(7)
    v_mfma_f32_16x16x32_bf16 v[44:47], v[84:87], a[8:11], v[44:47]
    v_cvt_pk_bf16_f32 v34, v60, v61
    v_mfma_f32_16x16x32_bf16 v[52:55], v[84:87], a[12:15], v[52:55]
    ds_read_b128 v[84:87], v11 offset:33024
    v_cvt_pk_bf16_f32 v35, v62, v63
    s_waitcnt lgkmcnt(7)
    v_mfma_f32_16x16x32_bf16 v[40:43], v[88:91], a[16:19], v[40:43]
    buffer_store_dwordx4 v[32:35], v26, s[36:39], s64 offen offset:0 sc1
    v_mfma_f32_16x16x32_bf16 v[48:51], v[88:91], a[20:23], v[48:51]
    ds_read_b128 v[88:91], v12 offset:256
    v_cvt_pk_bf16_f32 v36, v64, v65
    s_waitcnt lgkmcnt(7)
    v_mfma_f32_16x16x32_bf16 v[44:47], v[92:95], a[16:19], v[44:47]
    v_cvt_pk_bf16_f32 v37, v66, v67
    v_mfma_f32_16x16x32_bf16 v[52:55], v[92:95], a[20:23], v[52:55]
    ds_read_b128 v[92:95], v12 offset:33024
    v_cvt_pk_bf16_f32 v38, v68, v69
    s_waitcnt lgkmcnt(7)
    v_mfma_f32_16x16x32_bf16 v[40:43], v[96:99], a[24:27], v[40:43]
    v_cvt_pk_bf16_f32 v39, v70, v71
    v_mfma_f32_16x16x32_bf16 v[48:51], v[96:99], a[28:31], v[48:51]
    ds_read_b128 v[96:99], v13 offset:256
    buffer_store_dwordx4 v[36:39], v26, s[36:39], s64 offen offset:1024 sc1
    s_waitcnt lgkmcnt(7)
    v_mfma_f32_16x16x32_bf16 v[44:47], v[100:103], a[24:27], v[44:47]
    s_add_u32 s64, s64, s65
    v_mfma_f32_16x16x32_bf16 v[52:55], v[100:103], a[28:31], v[52:55]
    ds_read_b128 v[100:103], v13 offset:33024
    s_waitcnt lgkmcnt(7)
    v_mfma_f32_16x16x32_bf16 v[40:43], v[72:75], a[32:35], v[40:43]
    s_add_u32 m0, s67, 65536
    v_mfma_f32_16x16x32_bf16 v[48:51], v[72:75], a[36:39], v[48:51]
    ds_read_b128 v[72:75], v10 offset:512
    buffer_load_dwordx4 v2, s[44:47], s63 offen offset:0 lds
    s_waitcnt lgkmcnt(7)
    v_mfma_f32_16x16x32_bf16 v[44:47], v[76:79], a[32:35], v[44:47]
    v_mfma_f32_16x16x32_bf16 v[52:55], v[76:79], a[36:39], v[52:55]
    ds_read_b128 v[76:79], v10 offset:33280
    s_add_u32 m0, s67, 65536
    s_waitcnt lgkmcnt(7)
    v_mfma_f32_16x16x32_bf16 v[40:43], v[80:83], a[40:43], v[40:43]
    buffer_load_dwordx4 v2, s[44:47], s63 offen offset:1024 lds
    v_mfma_f32_16x16x32_bf16 v[48:51], v[80:83], a[44:47], v[48:51]
    ds_read_b128 v[80:83], v11 offset:512
    s_waitcnt lgkmcnt(7)
    v_mfma_f32_16x16x32_bf16 v[44:47], v[84:87], a[40:43], v[44:47]
    s_add_u32 m0, s67, 67584
    v_mfma_f32_16x16x32_bf16 v[52:55], v[84:87], a[44:47], v[52:55]
    ds_read_b128 v[84:87], v11 offset:33280
    buffer_load_dwordx4 v3, s[44:47], s63 offen offset:0 lds
    s_waitcnt lgkmcnt(7)
    v_mfma_f32_16x16x32_bf16 v[40:43], v[88:91], a[48:51], v[40:43]
    v_mfma_f32_16x16x32_bf16 v[48:51], v[88:91], a[52:55], v[48:51]
    ds_read_b128 v[88:91], v12 offset:512
    s_add_u32 m0, s67, 67584
    s_waitcnt lgkmcnt(7)
    v_mfma_f32_16x16x32_bf16 v[44:47], v[92:95], a[48:51], v[44:47]
    buffer_load_dwordx4 v3, s[44:47], s63 offen offset:1024 lds
    v_mfma_f32_16x16x32_bf16 v[52:55], v[92:95], a[52:55], v[52:55]
    ds_read_b128 v[92:95], v12 offset:33280
    s_waitcnt lgkmcnt(7)
    v_mfma_f32_16x16x32_bf16 v[40:43], v[96:99], a[56:59], v[40:43]
    s_add_u32 m0, s67, 69632
    v_mfma_f32_16x16x32_bf16 v[48:51], v[96:99], a[60:63], v[48:51]
    ds_read_b128 v[96:99], v13 offset:512
    buffer_load_dwordx4 v4, s[44:47], s63 offen offset:0 lds
    s_waitcnt lgkmcnt(7)
    v_mfma_f32_16x16x32_bf16 v[44:47], v[100:103], a[56:59], v[44:47]
    v_mfma_f32_16x16x32_bf16 v[52:55], v[100:103], a[60:63], v[52:55]
    ds_read_b128 v[100:103], v13 offset:33280
    s_add_u32 m0, s67, 69632
    s_waitcnt lgkmcnt(7)
    v_mfma_f32_16x16x32_bf16 v[40:43], v[72:75], a[64:67], v[40:43]
    buffer_load_dwordx4 v4, s[44:47], s63 offen offset:1024 lds
    v_mfma_f32_16x16x32_bf16 v[48:51], v[72:75], a[68:71], v[48:51]
    ds_read_b128 v[72:75], v10 offset:768
    s_waitcnt lgkmcnt(7)
    v_mfma_f32_16x16x32_bf16 v[44:47], v[76:79], a[64:67], v[44:47]
    s_add_u32 m0, s67, 71680
    v_mfma_f32_16x16x32_bf16 v[52:55], v[76:79], a[68:71], v[52:55]
    ds_read_b128 v[76:79], v10 offset:33536
    buffer_load_dwordx4 v5, s[44:47], s63 offen offset:0 lds
    s_waitcnt lgkmcnt(7)
    v_mfma_f32_16x16x32_bf16 v[40:43], v[80:83], a[72:75], v[40:43]
    v_mfma_f32_16x16x32_bf16 v[48:51], v[80:83], a[76:79], v[48:51]
    ds_read_b128 v[80:83], v11 offset:768
    s_add_u32 m0, s67, 71680
    s_waitcnt lgkmcnt(7)
    v_mfma_f32_16x16x32_bf16 v[44:47], v[84:87], a[72:75], v[44:47]
    buffer_load_dwordx4 v5, s[44:47], s63 offen offset:1024 lds
    v_mfma_f32_16x16x32_bf16 v[52:55], v[84:87], a[76:79], v[52:55]
    ds_read_b128 v[84:87], v11 offset:33536
    s_waitcnt lgkmcnt(7)
    v_mfma_f32_16x16x32_bf16 v[40:43], v[88:91], a[80:83], v[40:43]
    s_add_u32 m0, s67, 73728
    v_mfma_f32_16x16x32_bf16 v[48:51], v[88:91], a[84:87], v[48:51]
    ds_read_b128 v[88:91], v12 offset:768
    buffer_load_dwordx4 v6, s[44:47], s63 offen offset:0 lds
    s_waitcnt lgkmcnt(7)
    v_mfma_f32_16x16x32_bf16 v[44:47], v[92:95], a[80:83], v[44:47]
    v_mfma_f32_16x16x32_bf16 v[52:55], v[92:95], a[84:87], v[52:55]
    ds_read_b128 v[92:95], v12 offset:33536
    s_add_u32 m0, s67, 73728
    s_waitcnt lgkmcnt(7)
    v_mfma_f32_16x16x32_bf16 v[40:43], v[96:99], a[88:91], v[40:43]
    buffer_load_dwordx4 v6, s[44:47], s63 offen offset:1024 lds
    v_mfma_f32_16x16x32_bf16 v[48:51], v[96:99], a[92:95], v[48:51]
    ds_read_b128 v[96:99], v13 offset:768
    s_waitcnt lgkmcnt(7)
    v_mfma_f32_16x16x32_bf16 v[44:47], v[100:103], a[88:91], v[44:47]
    s_add_u32 m0, s67, 75776
    v_mfma_f32_16x16x32_bf16 v[52:55], v[100:103], a[92:95], v[52:55]
    ds_read_b128 v[100:103], v13 offset:33536
    buffer_load_dwordx4 v7, s[44:47], s63 offen offset:0 lds
    s_waitcnt lgkmcnt(7)
    v_mfma_f32_16x16x32_bf16 v[40:43], v[72:75], a[96:99], v[40:43]
    v_mfma_f32_16x16x32_bf16 v[48:51], v[72:75], a[100:103], v[48:51]
    ds_read_b128 v[72:75], v10 offset:1024
    s_add_u32 m0, s67, 75776
    s_waitcnt lgkmcnt(7)
    v_mfma_f32_16x16x32_bf16 v[44:47], v[76:79], a[96:99], v[44:47]
    buffer_load_dwordx4 v7, s[44:47], s63 offen offset:1024 lds
    v_mfma_f32_16x16x32_bf16 v[52:55], v[76:79], a[100:103], v[52:55]
    ds_read_b128 v[76:79], v10 offset:33792
    s_waitcnt lgkmcnt(7)
    v_mfma_f32_16x16x32_bf16 v[40:43], v[80:83], a[104:107], v[40:43]
    s_add_u32 m0, s67, 77824
    v_mfma_f32_16x16x32_bf16 v[48:51], v[80:83], a[108:111], v[48:51]
    ds_read_b128 v[80:83], v11 offset:1024
    buffer_load_dwordx4 v8, s[44:47], s63 offen offset:0 lds
    s_waitcnt lgkmcnt(7)
    v_mfma_f32_16x16x32_bf16 v[44:47], v[84:87], a[104:107], v[44:47]
    v_mfma_f32_16x16x32_bf16 v[52:55], v[84:87], a[108:111], v[52:55]
    ds_read_b128 v[84:87], v11 offset:33792
    s_add_u32 m0, s67, 77824
    s_waitcnt lgkmcnt(7)
    v_mfma_f32_16x16x32_bf16 v[40:43], v[88:91], a[112:115], v[40:43]
    buffer_load_dwordx4 v8, s[44:47], s63 offen offset:1024 lds
    v_mfma_f32_16x16x32_bf16 v[48:51], v[88:91], a[116:119], v[48:51]
    ds_read_b128 v[88:91], v12 offset:1024
    s_waitcnt lgkmcnt(7)
    v_mfma_f32_16x16x32_bf16 v[44:47], v[92:95], a[112:115], v[44:47]
    s_add_u32 m0, s67, 79872
    v_mfma_f32_16x16x32_bf16 v[52:55], v[92:95], a[116:119], v[52:55]
    ds_read_b128 v[92:95], v12 offset:33792
    buffer_load_dwordx4 v9, s[44:47], s63 offen offset:0 lds
    s_waitcnt lgkmcnt(7)
    v_mfma_f32_16x16x32_bf16 v[40:43], v[96:99], a[120:123], v[40:43]
    v_mfma_f32_16x16x32_bf16 v[48:51], v[96:99], a[124:127], v[48:51]
    ds_read_b128 v[96:99], v13 offset:1024
    s_add_u32 m0, s67, 79872
    s_waitcnt lgkmcnt(7)
    v_mfma_f32_16x16x32_bf16 v[44:47], v[100:103], a[120:123], v[44:47]
    buffer_load_dwordx4 v9, s[44:47], s63 offen offset:1024 lds
    v_mfma_f32_16x16x32_bf16 v[52:55], v[100:103], a[124:127], v[52:55]
    ds_read_b128 v[100:103], v13 offset:33792
    s_waitcnt lgkmcnt(7)
    v_mfma_f32_16x16x32_bf16 v[40:43], v[72:75], a[128:131], v[40:43]
    buffer_load_dword v105, v104, s[44:47], s63 offen
    v_mfma_f32_16x16x32_bf16 v[48:51], v[72:75], a[132:135], v[48:51]
    ds_read_b128 v[72:75], v10 offset:1280
    s_waitcnt lgkmcnt(7)
    v_mfma_f32_16x16x32_bf16 v[44:47], v[76:79], a[128:131], v[44:47]
    v_mfma_f32_16x16x32_bf16 v[52:55], v[76:79], a[132:135], v[52:55]
    ds_read_b128 v[76:79], v10 offset:34048
    s_waitcnt lgkmcnt(7)
    v_mfma_f32_16x16x32_bf16 v[40:43], v[80:83], a[136:139], v[40:43]
    v_mfma_f32_16x16x32_bf16 v[48:51], v[80:83], a[140:143], v[48:51]
    ds_read_b128 v[80:83], v11 offset:1280
    s_waitcnt lgkmcnt(7)
    v_mfma_f32_16x16x32_bf16 v[44:47], v[84:87], a[136:139], v[44:47]
    s_waitcnt vmcnt(17)
    buffer_store_dword v27, v106, s[36:39], s66 offen sc1
    v_add_u32_e64 v27, 1, v27
    v_mfma_f32_16x16x32_bf16 v[52:55], v[84:87], a[140:143], v[52:55]
    ds_read_b128 v[84:87], v11 offset:34048
    s_waitcnt lgkmcnt(7)
    v_mfma_f32_16x16x32_bf16 v[40:43], v[88:91], a[144:147], v[40:43]
    v_mfma_f32_16x16x32_bf16 v[48:51], v[88:91], a[148:151], v[48:51]
    ds_read_b128 v[88:91], v12 offset:1280
    s_waitcnt lgkmcnt(7)
    v_mfma_f32_16x16x32_bf16 v[44:47], v[92:95], a[144:147], v[44:47]
    v_mfma_f32_16x16x32_bf16 v[52:55], v[92:95], a[148:151], v[52:55]
    ds_read_b128 v[92:95], v12 offset:34048
    s_waitcnt lgkmcnt(7)
    v_mfma_f32_16x16x32_bf16 v[40:43], v[96:99], a[152:155], v[40:43]
    v_mfma_f32_16x16x32_bf16 v[48:51], v[96:99], a[156:159], v[48:51]
    ds_read_b128 v[96:99], v13 offset:1280
    s_waitcnt lgkmcnt(7)
    v_mfma_f32_16x16x32_bf16 v[44:47], v[100:103], a[152:155], v[44:47]
    v_mfma_f32_16x16x32_bf16 v[52:55], v[100:103], a[156:159], v[52:55]
    ds_read_b128 v[100:103], v13 offset:34048
    s_waitcnt lgkmcnt(7)
    v_mfma_f32_16x16x32_bf16 v[40:43], v[72:75], a[160:163], v[40:43]
    v_mfma_f32_16x16x32_bf16 v[48:51], v[72:75], a[164:167], v[48:51]
    ds_read_b128 v[72:75], v10 offset:1536
    s_waitcnt lgkmcnt(7)
    v_mfma_f32_16x16x32_bf16 v[44:47], v[76:79], a[160:163], v[44:47]
    v_mfma_f32_16x16x32_bf16 v[52:55], v[76:79], a[164:167], v[52:55]
    ds_read_b128 v[76:79], v10 offset:34304
    s_waitcnt lgkmcnt(7)
    v_mfma_f32_16x16x32_bf16 v[40:43], v[80:83], a[168:171], v[40:43]
    v_mfma_f32_16x16x32_bf16 v[48:51], v[80:83], a[172:175], v[48:51]
    ds_read_b128 v[80:83], v11 offset:1536
    s_waitcnt lgkmcnt(7)
    v_mfma_f32_16x16x32_bf16 v[44:47], v[84:87], a[168:171], v[44:47]
    v_mfma_f32_16x16x32_bf16 v[52:55], v[84:87], a[172:175], v[52:55]
    ds_read_b128 v[84:87], v11 offset:34304
    s_waitcnt lgkmcnt(7)
    v_mfma_f32_16x16x32_bf16 v[40:43], v[88:91], a[176:179], v[40:43]
    v_mfma_f32_16x16x32_bf16 v[48:51], v[88:91], a[180:183], v[48:51]
    ds_read_b128 v[88:91], v12 offset:1536
    s_waitcnt lgkmcnt(7)
    v_mfma_f32_16x16x32_bf16 v[44:47], v[92:95], a[176:179], v[44:47]
    v_mfma_f32_16x16x32_bf16 v[52:55], v[92:95], a[180:183], v[52:55]
    ds_read_b128 v[92:95], v12 offset:34304
    s_waitcnt lgkmcnt(7)
    v_mfma_f32_16x16x32_bf16 v[40:43], v[96:99], a[184:187], v[40:43]
    v_mfma_f32_16x16x32_bf16 v[48:51], v[96:99], a[188:191], v[48:51]
    ds_read_b128 v[96:99], v13 offset:1536
    s_waitcnt lgkmcnt(7)
    v_mfma_f32_16x16x32_bf16 v[44:47], v[100:103], a[184:187], v[44:47]
    v_mfma_f32_16x16x32_bf16 v[52:55], v[100:103], a[188:191], v[52:55]
    ds_read_b128 v[100:103], v13 offset:34304
    s_waitcnt lgkmcnt(7)
    v_mfma_f32_16x16x32_bf16 v[40:43], v[72:75], a[192:195], v[40:43]
    v_mfma_f32_16x16x32_bf16 v[48:51], v[72:75], a[196:199], v[48:51]
    ds_read_b128 v[72:75], v10 offset:1792
    s_waitcnt lgkmcnt(7)
    v_mfma_f32_16x16x32_bf16 v[44:47], v[76:79], a[192:195], v[44:47]
    v_mfma_f32_16x16x32_bf16 v[52:55], v[76:79], a[196:199], v[52:55]
    ds_read_b128 v[76:79], v10 offset:34560
    s_waitcnt lgkmcnt(7)
    v_mfma_f32_16x16x32_bf16 v[40:43], v[80:83], a[200:203], v[40:43]
    v_mfma_f32_16x16x32_bf16 v[48:51], v[80:83], a[204:207], v[48:51]
    ds_read_b128 v[80:83], v11 offset:1792
    s_waitcnt lgkmcnt(7)
    v_mfma_f32_16x16x32_bf16 v[44:47], v[84:87], a[200:203], v[44:47]
    v_mfma_f32_16x16x32_bf16 v[52:55], v[84:87], a[204:207], v[52:55]
    ds_read_b128 v[84:87], v11 offset:34560
    s_waitcnt lgkmcnt(7)
    v_mfma_f32_16x16x32_bf16 v[40:43], v[88:91], a[208:211], v[40:43]
    v_mfma_f32_16x16x32_bf16 v[48:51], v[88:91], a[212:215], v[48:51]
    ds_read_b128 v[88:91], v12 offset:1792
    s_waitcnt lgkmcnt(7)
    v_mfma_f32_16x16x32_bf16 v[44:47], v[92:95], a[208:211], v[44:47]
    v_mfma_f32_16x16x32_bf16 v[52:55], v[92:95], a[212:215], v[52:55]
    ds_read_b128 v[92:95], v12 offset:34560
    s_waitcnt lgkmcnt(7)
    v_mfma_f32_16x16x32_bf16 v[40:43], v[96:99], a[216:219], v[40:43]
    v_mfma_f32_16x16x32_bf16 v[48:51], v[96:99], a[220:223], v[48:51]
    ds_read_b128 v[96:99], v13 offset:1792
    s_waitcnt lgkmcnt(7)
    v_mfma_f32_16x16x32_bf16 v[44:47], v[100:103], a[216:219], v[44:47]
    v_mfma_f32_16x16x32_bf16 v[52:55], v[100:103], a[220:223], v[52:55]
    ds_read_b128 v[100:103], v13 offset:34560
    s_waitcnt lgkmcnt(7)
    v_mfma_f32_16x16x32_bf16 v[40:43], v[72:75], a[224:227], v[40:43]
    v_mfma_f32_16x16x32_bf16 v[48:51], v[72:75], a[228:231], v[48:51]
    s_waitcnt lgkmcnt(6)
    v_mfma_f32_16x16x32_bf16 v[44:47], v[76:79], a[224:227], v[44:47]
    v_mfma_f32_16x16x32_bf16 v[52:55], v[76:79], a[228:231], v[52:55]
    s_waitcnt lgkmcnt(5)
    v_mfma_f32_16x16x32_bf16 v[40:43], v[80:83], a[232:235], v[40:43]
    v_mfma_f32_16x16x32_bf16 v[48:51], v[80:83], a[236:239], v[48:51]
    s_waitcnt lgkmcnt(4)
    v_mfma_f32_16x16x32_bf16 v[44:47], v[84:87], a[232:235], v[44:47]
    v_mfma_f32_16x16x32_bf16 v[52:55], v[84:87], a[236:239], v[52:55]
    s_waitcnt lgkmcnt(3)
    v_mfma_f32_16x16x32_bf16 v[40:43], v[88:91], a[240:243], v[40:43]
    v_mfma_f32_16x16x32_bf16 v[48:51], v[88:91], a[244:247], v[48:51]
    s_waitcnt lgkmcnt(2)
    v_mfma_f32_16x16x32_bf16 v[44:47], v[92:95], a[240:243], v[44:47]
    v_mfma_f32_16x16x32_bf16 v[52:55], v[92:95], a[244:247], v[52:55]
    s_waitcnt lgkmcnt(1)
    v_mfma_f32_16x16x32_bf16 v[40:43], v[96:99], a[248:251], v[40:43]
    v_mfma_f32_16x16x32_bf16 v[48:51], v[96:99], a[252:255], v[48:51]
    s_waitcnt lgkmcnt(0)
    v_mfma_f32_16x16x32_bf16 v[44:47], v[100:103], a[248:251], v[44:47]
    v_mfma_f32_16x16x32_bf16 v[52:55], v[100:103], a[252:255], v[52:55]
    s_waitcnt vmcnt(2)
    s_barrier
    s_branch L_qkv_loop_v
    s_nop 0
L_qkv_fin_k:
    s_add_u32 s59, s64, 4096
    v_cvt_pk_bf16_f32 v32, v56, v57
    v_cvt_pk_bf16_f32 v33, v58, v59
    v_cvt_pk_bf16_f32 v34, v60, v61
    v_cvt_pk_bf16_f32 v35, v62, v63
    buffer_store_dwordx4 v[32:35], v26, s[36:39], s64 offen sc1
    v_cvt_pk_bf16_f32 v36, v64, v65
    v_cvt_pk_bf16_f32 v37, v66, v67
    v_cvt_pk_bf16_f32 v38, v68, v69
    v_cvt_pk_bf16_f32 v39, v70, v71
    buffer_store_dwordx4 v[36:39], v26, s[36:39], s59 offen sc1
    s_branch L_qkv_fin
    s_nop 0
L_qkv_fin_v:
    s_add_u32 s59, s64, 4096
    v_cvt_pk_bf16_f32 v32, v56, v57
    v_cvt_pk_bf16_f32 v33, v58, v59
    v_cvt_pk_bf16_f32 v34, v60, v61
    v_cvt_pk_bf16_f32 v35, v62, v63
    buffer_store_dwordx4 v[32:35], v26, s[36:39], s64 offen offset:0 sc1
    v_cvt_pk_bf16_f32 v36, v64, v65
    v_cvt_pk_bf16_f32 v37, v66, v67
    v_cvt_pk_bf16_f32 v38, v68, v69
    v_cvt_pk_bf16_f32 v39, v70, v71
    buffer_store_dwordx4 v[36:39], v26, s[36:39], s64 offen offset:1024 sc1
L_qkv_fin:
    s_waitcnt vmcnt(0)
    buffer_store_dword v27, v106, s[36:39], s66 offen sc1
    s_branch L_p2
    s_nop 0
    s_nop 0
L_mod:
    s_mov_b32 s60, 0
    s_cmp_lg_u32 s52, 7
    s_cbranch_scc1 L_noprobe
    s_or_b32 s96, s53, s54
    s_cmp_lg_u32 s96, 0
    s_cbranch_scc1 L_noprobe
    v_lshlrev_b32 v28, 7, v0
    v_and_b32 v28, 0x780, v28
    v_and_b32 v29, 16, v0
    v_lshl_add_u32 v28, v29, 9, v28
    s_mov_b32 s96, 32768
    buffer_store_dword v28, v28, s[36:39], s96 offen sc1
    s_mov_b32 s61, -1
    s_mov_b32 s62, -1
    s_mov_b32 s69, 6
    s_waitcnt vmcnt(0)
L_probe:
    s_add_u32 s97, s96, 0
    s_memtime s[64:65]
    s_waitcnt lgkmcnt(0)
    buffer_load_dword v29, off, s[36:39], s97 sc1
    s_waitcnt vmcnt(0)
    s_memtime s[66:67]
    s_waitcnt lgkmcnt(0)
    s_sub_u32 s70, s66, s64
    s_min_u32 s61, s61, s70
    s_add_u32 s97, s96, 8192
    s_memtime s[64:65]
    s_waitcnt lgkmcnt(0)
    buffer_load_dword v29, off, s[36:39], s97 sc1
    s_waitcnt vmcnt(0)
    s_memtime s[66:67]
    s_waitcnt lgkmcnt(0)
    s_sub_u32 s71, s66, s64
    s_min_u32 s62, s62, s71
    s_add_u32 s96, s96, 128
    s_sub_u32 s69, s69, 1
    s_cmp_lg_u32 s69, 0
    s_cbranch_scc1 L_probe
    s_cmp_gt_u32 s61, s62
    s_cselect_b32 s60, 1, 8193
L_noprobe:
    s_cmp_eq_u32 s60, 0
    s_cbranch_scc1 L_mod_np
    s_cmp_eq_u32 s56, 1
    s_cbranch_scc1 L_cenok_8
    v_and_b32 v238, 7, v0
    v_lshlrev_b32 v238, 5, v238
L_cen_7:
    global_load_dword v239, v238, s[32:33] sc1
    s_waitcnt vmcnt(0)
L_cen_7_w:
    v_lshrrev_b32 v30, 16, v239
    s_mov_b32 s96, 0
    v_readlane_b32 s97, v30, 0
    s_add_u32 s96, s96, s97
    v_readlane_b32 s97, v30, 1
    s_add_u32 s96, s96, s97
    v_readlane_b32 s97, v30, 2
    s_add_u32 s96, s96, s97
    v_readlane_b32 s97, v30, 3
    s_add_u32 s96, s96, s97
    v_readlane_b32 s97, v30, 4
    s_add_u32 s96, s96, s97
    v_readlane_b32 s97, v30, 5
    s_add_u32 s96, s96, s97
    v_readlane_b32 s97, v30, 6
    s_add_u32 s96, s96, s97
    v_readlane_b32 s97, v30, 7
    s_add_u32 s96, s96, s97
    s_cmp_eq_u32 s96, 256
    s_cbranch_scc1 L_cen_7_done
    s_sub_u32 s57, s57, 1
    s_cbranch_scc1 L_exit
    s_branch L_cen_7
L_cen_7_done:
    s_mov_b32 s56, 1
    v_cmp_ne_u32 vcc, 0x200020, v239
    s_cbranch_vccz L_cenok_8
    s_lshr_b32 s52, s2, 5
    s_and_b32 s53, s2, 31
    s_mov_b32 s55, 1
    s_waitcnt vmcnt(0)
    s_barrier
    s_branch L_dispatch
L_cenok_8:
    s_cmp_eq_u32 s60, 0
    s_cbranch_scc1 L_nopub
    v_mov_b32 v28, s60
    s_mov_b32 s96, 16896
    buffer_store_dword v28, off, s[36:39], s96 sc1
L_nopub:
L_mod_np:
    s_mov_b32 s44, s4
    s_and_b32 s45, s5, 0xffff
    s_mov_b32 s46, 0x400000
    s_mov_b32 s47, 0x20000
    s_mov_b32 s40, s20
    s_and_b32 s41, s21, 0xffff
    s_mov_b32 s42, 0x800
    s_mov_b32 s43, 0x20000
    s_mov_b32 s48, s28
    s_and_b32 s49, s29, 0xffff
    s_mov_b32 s50, 0x800
    s_mov_b32 s51, 0x20000
    v_lshlrev_b32 v1, 4, v0
    s_lshl_b32 s96, s53, 17
    s_lshl_b32 s97, s54, 15
    s_add_u32 s96, s96, s97
    buffer_load_dwordx4 v[2:5], v1, s[40:43], 0 offen
    buffer_load_dwordx4 v[6:9], v1, s[40:43], 0 offen offset:1024
    buffer_load_dwordx4 v[32:35], v1, s[48:51], 0 offen
    buffer_load_dwordx4 v[36:39], v1, s[48:51], 0 offen offset:1024
    buffer_load_dwordx4 v[64:67], v1, s[44:47], s96 offen offset:0
    buffer_load_dwordx4 v[68:71], v1, s[44:47], s96 offen offset:1024
    buffer_load_dwordx4 v[72:75], v1, s[44:47], s96 offen offset:2048
    buffer_load_dwordx4 v[76:79], v1, s[44:47], s96 offen offset:3072
    s_add_u32 s96, s96, 4096
    buffer_load_dwordx4 v[80:83], v1, s[44:47], s96 offen offset:0
    buffer_load_dwordx4 v[84:87], v1, s[44:47], s96 offen offset:1024
    buffer_load_dwordx4 v[88:91], v1, s[44:47], s96 offen offset:2048
    buffer_load_dwordx4 v[92:95], v1, s[44:47], s96 offen offset:3072
    s_add_u32 s96, s96, 4096
    buffer_load_dwordx4 v[96:99], v1, s[44:47], s96 offen offset:0
    buffer_load_dwordx4 v[100:103], v1, s[44:47], s96 offen offset:1024
    buffer_load_dwordx4 v[104:107], v1, s[44:47], s96 offen offset:2048
    buffer_load_dwordx4 v[108:111], v1, s[44:47], s96 offen offset:3072
    s_add_u32 s96, s96, 4096
    buffer_load_dwordx4 v[112:115], v1, s[44:47], s96 offen offset:0
    buffer_load_dwordx4 v[116:119], v1, s[44:47], s96 offen offset:1024
    buffer_load_dwordx4 v[120:123], v1, s[44:47], s96 offen offset:2048
    buffer_load_dwordx4 v[124:127], v1, s[44:47], s96 offen offset:3072
    s_add_u32 s96, s96, 4096
    buffer_load_dwordx4 v[128:131], v1, s[44:47], s96 offen offset:0
    buffer_load_dwordx4 v[132:135], v1, s[44:47], s96 offen offset:1024
    buffer_load_dwordx4 v[136:139], v1, s[44:47], s96 offen offset:2048
    buffer_load_dwordx4 v[140:143], v1, s[44:47], s96 offen offset:3072
    s_add_u32 s96, s96, 4096
    buffer_load_dwordx4 v[144:147], v1, s[44:47], s96 offen offset:0
    buffer_load_dwordx4 v[148:151], v1, s[44:47], s96 offen offset:1024
    buffer_load_dwordx4 v[152:155], v1, s[44:47], s96 offen offset:2048
    buffer_load_dwordx4 v[156:159], v1, s[44:47], s96 offen offset:3072
    s_add_u32 s96, s96, 4096
    buffer_load_dwordx4 v[160:163], v1, s[44:47], s96 offen offset:0
    buffer_load_dwordx4 v[164:167], v1, s[44:47], s96 offen offset:1024
    buffer_load_dwordx4 v[168:171], v1, s[44:47], s96 offen offset:2048
    buffer_load_dwordx4 v[172:175], v1, s[44:47], s96 offen offset:3072
    s_add_u32 s96, s96, 4096
    buffer_load_dwordx4 v[176:179], v1, s[44:47], s96 offen offset:0
    buffer_load_dwordx4 v[180:183], v1, s[44:47], s96 offen offset:1024
    buffer_load_dwordx4 v[184:187], v1, s[44:47], s96 offen offset:2048
    buffer_load_dwordx4 v[188:191], v1, s[44:47], s96 offen offset:3072
    s_add_u32 s96, s96, 4096
    s_waitcnt vmcnt(32)
    v_lshlrev_b32 v10, 16, v32
    v_and_b32 v11, 0xffff0000, v32
    v_lshlrev_b32 v12, 16, v33
    v_and_b32 v13, 0xffff0000, v33
    v_lshlrev_b32 v14, 16, v34
    v_and_b32 v15, 0xffff0000, v34
    v_lshlrev_b32 v16, 16, v35
    v_and_b32 v17, 0xffff0000, v35
    v_lshlrev_b32 v18, 16, v36
    v_and_b32 v19, 0xffff0000, v36
    v_lshlrev_b32_e64 v20, 16, v37
    v_and_b32 v21, 0xffff0000, v37
    v_lshlrev_b32 v22, 16, v38
    v_and_b32 v23, 0xffff0000, v38
    v_lshlrev_b32 v24, 16, v39
    v_and_b32 v25, 0xffff0000, v39
    v_mov_b32 v26, 0x3f803f80
    s_waitcnt vmcnt(30)
    v_dot2_f32_bf16 v192, v64, v2, 0
    v_lshlrev_b32 v28, 16, v64
    v_and_b32 v29, 0xffff0000, v64
    v_mul_f32 v28, v28, v10
    v_mul_f32 v29, v29, v11
    v_cvt_pk_bf16_f32 v28, v28, v29
    v_dot2_f32_bf16 v208, v28, v26, 0
    v_dot2_f32_bf16 v192, v65, v3, v192
    v_lshlrev_b32 v28, 16, v65
    v_and_b32 v29, 0xffff0000, v65
    v_mul_f32 v28, v28, v12
    v_mul_f32_e64 v29, v29, v13
    v_cvt_pk_bf16_f32 v28, v28, v29
    v_dot2_f32_bf16 v208, v28, v26, v208
    v_dot2_f32_bf16 v192, v66, v4, v192
    v_lshlrev_b32 v28, 16, v66
    v_and_b32 v29, 0xffff0000, v66
    v_mul_f32 v28, v28, v14
    v_mul_f32 v29, v29, v15
    v_cvt_pk_bf16_f32 v28, v28, v29
    v_dot2_f32_bf16 v208, v28, v26, v208
    v_dot2_f32_bf16 v192, v67, v5, v192
    v_lshlrev_b32 v28, 16, v67
    v_and_b32 v29, 0xffff0000, v67
    v_mul_f32 v28, v28, v16
    v_mul_f32 v29, v29, v17
    v_cvt_pk_bf16_f32 v28, v28, v29
    v_dot2_f32_bf16 v208, v28, v26, v208
    v_dot2_f32_bf16 v192, v68, v6, v192
    v_lshlrev_b32 v28, 16, v68
    v_and_b32 v29, 0xffff0000, v68
    v_mul_f32 v28, v28, v18
    v_mul_f32_e64 v29, v29, v19
    v_cvt_pk_bf16_f32 v28, v28, v29
    v_dot2_f32_bf16 v208, v28, v26, v208
    v_dot2_f32_bf16 v192, v69, v7, v192
    v_lshlrev_b32_e64 v28, 16, v69
    v_and_b32 v29, 0xffff0000, v69
    v_mul_f32 v28, v28, v20
    v_mul_f32 v29, v29, v21
    v_cvt_pk_bf16_f32 v28, v28, v29
    v_dot2_f32_bf16 v208, v28, v26, v208
    v_dot2_f32_bf16 v192, v70, v8, v192
    v_lshlrev_b32 v28, 16, v70
    v_and_b32 v29, 0xffff0000, v70
    v_mul_f32 v28, v28, v22
    v_mul_f32_e64 v29, v29, v23
    v_cvt_pk_bf16_f32 v28, v28, v29
    v_dot2_f32_bf16 v208, v28, v26, v208
    v_dot2_f32_bf16 v192, v71, v9, v192
    v_lshlrev_b32_e64 v28, 16, v71
    v_and_b32 v29, 0xffff0000, v71
    v_mul_f32 v28, v28, v24
    v_mul_f32 v29, v29, v25
    v_cvt_pk_bf16_f32 v28, v28, v29
    v_dot2_f32_bf16 v208, v28, v26, v208
    s_waitcnt vmcnt(28)
    v_dot2_f32_bf16 v193, v72, v2, 0
    v_lshlrev_b32 v28, 16, v72
    v_and_b32 v29, 0xffff0000, v72
    v_mul_f32 v28, v28, v10
    v_mul_f32 v29, v29, v11
    v_cvt_pk_bf16_f32 v28, v28, v29
    v_dot2_f32_bf16 v209, v28, v26, 0
    v_dot2_f32_bf16 v193, v73, v3, v193
    v_lshlrev_b32_e64 v28, 16, v73
    v_and_b32 v29, 0xffff0000, v73
    v_mul_f32 v28, v28, v12
    v_mul_f32 v29, v29, v13
    v_cvt_pk_bf16_f32 v28, v28, v29
    v_dot2_f32_bf16 v209, v28, v26, v209
    v_dot2_f32_bf16 v193, v74, v4, v193
    v_lshlrev_b32 v28, 16, v74
    v_and_b32 v29, 0xffff0000, v74
    v_mul_f32 v28, v28, v14
    v_mul_f32_e64 v29, v29, v15
    v_cvt_pk_bf16_f32 v28, v28, v29
    v_dot2_f32_bf16 v209, v28, v26, v209
    v_dot2_f32_bf16 v193, v75, v5, v193
    v_lshlrev_b32_e64 v28, 16, v75
    v_and_b32 v29, 0xffff0000, v75
    v_mul_f32 v28, v28, v16
    v_mul_f32 v29, v29, v17
    v_cvt_pk_bf16_f32 v28, v28, v29
    v_dot2_f32_bf16 v209, v28, v26, v209
    v_dot2_f32_bf16 v193, v76, v6, v193
    v_lshlrev_b32 v28, 16, v76
    v_and_b32 v29, 0xffff0000, v76
    v_mul_f32 v28, v28, v18
    v_mul_f32_e64 v29, v29, v19
    v_cvt_pk_bf16_f32 v28, v28, v29
    v_dot2_f32_bf16 v209, v28, v26, v209
    v_dot2_f32_bf16 v193, v77, v7, v193
    v_lshlrev_b32_e64 v28, 16, v77
    v_and_b32 v29, 0xffff0000, v77
    v_mul_f32 v28, v28, v20
    v_mul_f32 v29, v29, v21
    v_cvt_pk_bf16_f32 v28, v28, v29
    v_dot2_f32_bf16 v209, v28, v26, v209
    v_dot2_f32_bf16 v193, v78, v8, v193
    v_lshlrev_b32 v28, 16, v78
    v_and_b32 v29, 0xffff0000, v78
    v_mul_f32 v28, v28, v22
    v_mul_f32_e64 v29, v29, v23
    v_cvt_pk_bf16_f32 v28, v28, v29
    v_dot2_f32_bf16 v209, v28, v26, v209
    v_dot2_f32_bf16 v193, v79, v9, v193
    v_lshlrev_b32_e64 v28, 16, v79
    v_and_b32 v29, 0xffff0000, v79
    v_mul_f32 v28, v28, v24
    v_mul_f32 v29, v29, v25
    v_cvt_pk_bf16_f32 v28, v28, v29
    v_dot2_f32_bf16 v209, v28, v26, v209
    s_waitcnt vmcnt(26)
    v_dot2_f32_bf16 v194, v80, v2, 0
    v_lshlrev_b32 v28, 16, v80
    v_and_b32 v29, 0xffff0000, v80
    v_mul_f32 v28, v28, v10
    v_mul_f32 v29, v29, v11
    v_cvt_pk_bf16_f32 v28, v28, v29
    v_dot2_f32_bf16 v210, v28, v26, 0
    v_dot2_f32_bf16 v194, v81, v3, v194
    v_lshlrev_b32_e64 v28, 16, v81
    v_and_b32 v29, 0xffff0000, v81
    v_mul_f32 v28, v28, v12
    v_mul_f32 v29, v29, v13
    v_cvt_pk_bf16_f32 v28, v28, v29
    v_dot2_f32_bf16 v210, v28, v26, v210
    v_dot2_f32_bf16 v194, v82, v4, v194
    v_lshlrev_b32 v28, 16, v82
    v_and_b32 v29, 0xffff0000, v82
    v_mul_f32 v28, v28, v14
    v_mul_f32_e64 v29, v29, v15
    v_cvt_pk_bf16_f32 v28, v28, v29
    v_dot2_f32_bf16 v210, v28, v26, v210
    v_dot2_f32_bf16 v194, v83, v5, v194
    v_lshlrev_b32_e64 v28, 16, v83
    v_and_b32 v29, 0xffff0000, v83
    v_mul_f32 v28, v28, v16
    v_mul_f32 v29, v29, v17
    v_cvt_pk_bf16_f32 v28, v28, v29
    v_dot2_f32_bf16 v210, v28, v26, v210
    v_dot2_f32_bf16 v194, v84, v6, v194
    v_lshlrev_b32 v28, 16, v84
    v_and_b32 v29, 0xffff0000, v84
    v_mul_f32 v28, v28, v18
    v_mul_f32_e64 v29, v29, v19
    v_cvt_pk_bf16_f32 v28, v28, v29
    v_dot2_f32_bf16 v210, v28, v26, v210
    v_dot2_f32_bf16 v194, v85, v7, v194
    v_lshlrev_b32_e64 v28, 16, v85
    v_and_b32 v29, 0xffff0000, v85
    v_mul_f32 v28, v28, v20
    v_mul_f32 v29, v29, v21
    v_cvt_pk_bf16_f32 v28, v28, v29
    v_dot2_f32_bf16 v210, v28, v26, v210
    v_dot2_f32_bf16 v194, v86, v8, v194
    v_lshlrev_b32 v28, 16, v86
    v_and_b32 v29, 0xffff0000, v86
    v_mul_f32 v28, v28, v22
    v_mul_f32_e64 v29, v29, v23
    v_cvt_pk_bf16_f32 v28, v28, v29
    v_dot2_f32_bf16 v210, v28, v26, v210
    v_dot2_f32_bf16 v194, v87, v9, v194
    v_lshlrev_b32_e64 v28, 16, v87
    v_and_b32 v29, 0xffff0000, v87
    v_mul_f32 v28, v28, v24
    v_mul_f32 v29, v29, v25
    v_cvt_pk_bf16_f32 v28, v28, v29
    v_dot2_f32_bf16 v210, v28, v26, v210
    s_waitcnt vmcnt(24)
    v_dot2_f32_bf16 v195, v88, v2, 0
    v_lshlrev_b32 v28, 16, v88
    v_and_b32 v29, 0xffff0000, v88
    v_mul_f32 v28, v28, v10
    v_mul_f32 v29, v29, v11
    v_cvt_pk_bf16_f32 v28, v28, v29
    v_dot2_f32_bf16 v211, v28, v26, 0
    v_dot2_f32_bf16 v195, v89, v3, v195
    v_lshlrev_b32_e64 v28, 16, v89
    v_and_b32 v29, 0xffff0000, v89
    v_mul_f32 v28, v28, v12
    v_mul_f32 v29, v29, v13
    v_cvt_pk_bf16_f32 v28, v28, v29
    v_dot2_f32_bf16 v211, v28, v26, v211
    v_dot2_f32_bf16 v195, v90, v4, v195
    v_lshlrev_b32 v28, 16, v90
    v_and_b32 v29, 0xffff0000, v90
    v_mul_f32 v28, v28, v14
    v_mul_f32_e64 v29, v29, v15
    v_cvt_pk_bf16_f32 v28, v28, v29
    v_dot2_f32_bf16 v211, v28, v26, v211
    v_dot2_f32_bf16 v195, v91, v5, v195
    v_lshlrev_b32_e64 v28, 16, v91
    v_and_b32 v29, 0xffff0000, v91
    v_mul_f32 v28, v28, v16
    v_mul_f32 v29, v29, v17
    v_cvt_pk_bf16_f32 v28, v28, v29
    v_dot2_f32_bf16 v211, v28, v26, v211
    v_dot2_f32_bf16 v195, v92, v6, v195
    v_lshlrev_b32 v28, 16, v92
    v_and_b32 v29, 0xffff0000, v92
    v_mul_f32 v28, v28, v18
    v_mul_f32_e64 v29, v29, v19
    v_cvt_pk_bf16_f32 v28, v28, v29
    v_dot2_f32_bf16 v211, v28, v26, v211
    v_dot2_f32_bf16 v195, v93, v7, v195
    v_lshlrev_b32_e64 v28, 16, v93
    v_and_b32 v29, 0xffff0000, v93
    v_mul_f32 v28, v28, v20
    v_mul_f32 v29, v29, v21
    v_cvt_pk_bf16_f32 v28, v28, v29
    v_dot2_f32_bf16 v211, v28, v26, v211
    v_dot2_f32_bf16 v195, v94, v8, v195
    v_lshlrev_b32 v28, 16, v94
    v_and_b32 v29, 0xffff0000, v94
    v_mul_f32 v28, v28, v22
    v_mul_f32_e64 v29, v29, v23
    v_cvt_pk_bf16_f32 v28, v28, v29
    v_dot2_f32_bf16 v211, v28, v26, v211
    v_dot2_f32_bf16 v195, v95, v9, v195
    v_lshlrev_b32_e64 v28, 16, v95
    v_and_b32 v29, 0xffff0000, v95
    v_mul_f32 v28, v28, v24
    v_mul_f32 v29, v29, v25
    v_cvt_pk_bf16_f32 v28, v28, v29
    v_dot2_f32_bf16 v211, v28, v26, v211
    s_waitcnt vmcnt(22)
    v_dot2_f32_bf16 v196, v96, v2, 0
    v_lshlrev_b32 v28, 16, v96
    v_and_b32 v29, 0xffff0000, v96
    v_mul_f32 v28, v28, v10
    v_mul_f32 v29, v29, v11
    v_cvt_pk_bf16_f32 v28, v28, v29
    v_dot2_f32_bf16 v212, v28, v26, 0
    v_dot2_f32_bf16 v196, v97, v3, v196
    v_lshlrev_b32_e64 v28, 16, v97
    v_and_b32 v29, 0xffff0000, v97
    v_mul_f32 v28, v28, v12
    v_mul_f32 v29, v29, v13
    v_cvt_pk_bf16_f32 v28, v28, v29
    v_dot2_f32_bf16 v212, v28, v26, v212
    v_dot2_f32_bf16 v196, v98, v4, v196
    v_lshlrev_b32 v28, 16, v98
    v_and_b32 v29, 0xffff0000, v98
    v_mul_f32 v28, v28, v14
    v_mul_f32_e64 v29, v29, v15
    v_cvt_pk_bf16_f32 v28, v28, v29
    v_dot2_f32_bf16 v212, v28, v26, v212
    v_dot2_f32_bf16 v196, v99, v5, v196
    v_lshlrev_b32_e64 v28, 16, v99
    v_and_b32 v29, 0xffff0000, v99
    v_mul_f32 v28, v28, v16
    v_mul_f32 v29, v29, v17
    v_cvt_pk_bf16_f32 v28, v28, v29
    v_dot2_f32_bf16 v212, v28, v26, v212
    v_dot2_f32_bf16 v196, v100, v6, v196
    v_lshlrev_b32 v28, 16, v100
    v_and_b32 v29, 0xffff0000, v100
    v_mul_f32 v28, v28, v18
    v_mul_f32_e64 v29, v29, v19
    v_cvt_pk_bf16_f32 v28, v28, v29
    v_dot2_f32_bf16 v212, v28, v26, v212
    v_dot2_f32_bf16 v196, v101, v7, v196
    v_lshlrev_b32_e64 v28, 16, v101
    v_and_b32 v29, 0xffff0000, v101
    v_mul_f32 v28, v28, v20
    v_mul_f32 v29, v29, v21
    v_cvt_pk_bf16_f32 v28, v28, v29
    v_dot2_f32_bf16 v212, v28, v26, v212
    v_dot2_f32_bf16 v196, v102, v8, v196
    v_lshlrev_b32 v28, 16, v102
    v_and_b32 v29, 0xffff0000, v102
    v_mul_f32 v28, v28, v22
    v_mul_f32_e64 v29, v29, v23
    v_cvt_pk_bf16_f32 v28, v28, v29
    v_dot2_f32_bf16 v212, v28, v26, v212
    v_dot2_f32_bf16 v196, v103, v9, v196
    v_lshlrev_b32_e64 v28, 16, v103
    v_and_b32 v29, 0xffff0000, v103
    v_mul_f32 v28, v28, v24
    v_mul_f32 v29, v29, v25
    v_cvt_pk_bf16_f32 v28, v28, v29
    v_dot2_f32_bf16 v212, v28, v26, v212
    s_waitcnt vmcnt(20)
    v_dot2_f32_bf16 v197, v104, v2, 0
    v_lshlrev_b32 v28, 16, v104
    v_and_b32 v29, 0xffff0000, v104
    v_mul_f32 v28, v28, v10
    v_mul_f32 v29, v29, v11
    v_cvt_pk_bf16_f32 v28, v28, v29
    v_dot2_f32_bf16 v213, v28, v26, 0
    v_dot2_f32_bf16 v197, v105, v3, v197
    v_lshlrev_b32_e64 v28, 16, v105
    v_and_b32 v29, 0xffff0000, v105
    v_mul_f32 v28, v28, v12
    v_mul_f32 v29, v29, v13
    v_cvt_pk_bf16_f32 v28, v28, v29
    v_dot2_f32_bf16 v213, v28, v26, v213
    v_dot2_f32_bf16 v197, v106, v4, v197
    v_lshlrev_b32 v28, 16, v106
    v_and_b32 v29, 0xffff0000, v106
    v_mul_f32 v28, v28, v14
    v_mul_f32_e64 v29, v29, v15
    v_cvt_pk_bf16_f32 v28, v28, v29
    v_dot2_f32_bf16 v213, v28, v26, v213
    v_dot2_f32_bf16 v197, v107, v5, v197
    v_lshlrev_b32_e64 v28, 16, v107
    v_and_b32 v29, 0xffff0000, v107
    v_mul_f32 v28, v28, v16
    v_mul_f32 v29, v29, v17
    v_cvt_pk_bf16_f32 v28, v28, v29
    v_dot2_f32_bf16 v213, v28, v26, v213
    v_dot2_f32_bf16 v197, v108, v6, v197
    v_lshlrev_b32 v28, 16, v108
    v_and_b32 v29, 0xffff0000, v108
    v_mul_f32 v28, v28, v18
    v_mul_f32_e64 v29, v29, v19
    v_cvt_pk_bf16_f32 v28, v28, v29
    v_dot2_f32_bf16 v213, v28, v26, v213
    v_dot2_f32_bf16 v197, v109, v7, v197
    v_lshlrev_b32_e64 v28, 16, v109
    v_and_b32 v29, 0xffff0000, v109
    v_mul_f32 v28, v28, v20
    v_mul_f32 v29, v29, v21
    v_cvt_pk_bf16_f32 v28, v28, v29
    v_dot2_f32_bf16 v213, v28, v26, v213
    v_dot2_f32_bf16 v197, v110, v8, v197
    v_lshlrev_b32 v28, 16, v110
    v_and_b32 v29, 0xffff0000, v110
    v_mul_f32 v28, v28, v22
    v_mul_f32_e64 v29, v29, v23
    v_cvt_pk_bf16_f32 v28, v28, v29
    v_dot2_f32_bf16 v213, v28, v26, v213
    v_dot2_f32_bf16 v197, v111, v9, v197
    v_lshlrev_b32_e64 v28, 16, v111
    v_and_b32 v29, 0xffff0000, v111
    v_mul_f32 v28, v28, v24
    v_mul_f32 v29, v29, v25
    v_cvt_pk_bf16_f32 v28, v28, v29
    v_dot2_f32_bf16 v213, v28, v26, v213
    s_waitcnt vmcnt(18)
    v_dot2_f32_bf16 v198, v112, v2, 0
    v_lshlrev_b32 v28, 16, v112
    v_and_b32 v29, 0xffff0000, v112
    v_mul_f32 v28, v28, v10
    v_mul_f32 v29, v29, v11
    v_cvt_pk_bf16_f32 v28, v28, v29
    v_dot2_f32_bf16 v214, v28, v26, 0
    v_dot2_f32_bf16 v198, v113, v3, v198
    v_lshlrev_b32_e64 v28, 16, v113
    v_and_b32 v29, 0xffff0000, v113
    v_mul_f32 v28, v28, v12
    v_mul_f32 v29, v29, v13
    v_cvt_pk_bf16_f32 v28, v28, v29
    v_dot2_f32_bf16 v214, v28, v26, v214
    v_dot2_f32_bf16 v198, v114, v4, v198
    v_lshlrev_b32 v28, 16, v114
    v_and_b32 v29, 0xffff0000, v114
    v_mul_f32 v28, v28, v14
    v_mul_f32_e64 v29, v29, v15
    v_cvt_pk_bf16_f32 v28, v28, v29
    v_dot2_f32_bf16 v214, v28, v26, v214
    v_dot2_f32_bf16 v198, v115, v5, v198
    v_lshlrev_b32_e64 v28, 16, v115
    v_and_b32 v29, 0xffff0000, v115
    v_mul_f32 v28, v28, v16
    v_mul_f32 v29, v29, v17
    v_cvt_pk_bf16_f32 v28, v28, v29
    v_dot2_f32_bf16 v214, v28, v26, v214
    v_dot2_f32_bf16 v198, v116, v6, v198
    v_lshlrev_b32 v28, 16, v116
    v_and_b32 v29, 0xffff0000, v116
    v_mul_f32 v28, v28, v18
    v_mul_f32_e64 v29, v29, v19
    v_cvt_pk_bf16_f32 v28, v28, v29
    v_dot2_f32_bf16 v214, v28, v26, v214
    v_dot2_f32_bf16 v198, v117, v7, v198
    v_lshlrev_b32_e64 v28, 16, v117
    v_and_b32 v29, 0xffff0000, v117
    v_mul_f32 v28, v28, v20
    v_mul_f32 v29, v29, v21
    v_cvt_pk_bf16_f32 v28, v28, v29
    v_dot2_f32_bf16 v214, v28, v26, v214
    v_dot2_f32_bf16 v198, v118, v8, v198
    v_lshlrev_b32 v28, 16, v118
    v_and_b32 v29, 0xffff0000, v118
    v_mul_f32 v28, v28, v22
    v_mul_f32_e64 v29, v29, v23
    v_cvt_pk_bf16_f32 v28, v28, v29
    v_dot2_f32_bf16 v214, v28, v26, v214
    v_dot2_f32_bf16 v198, v119, v9, v198
    v_lshlrev_b32_e64 v28, 16, v119
    v_and_b32 v29, 0xffff0000, v119
    v_mul_f32 v28, v28, v24
    v_mul_f32 v29, v29, v25
    v_cvt_pk_bf16_f32 v28, v28, v29
    v_dot2_f32_bf16 v214, v28, v26, v214
    s_waitcnt vmcnt(16)
    v_dot2_f32_bf16 v199, v120, v2, 0
    v_lshlrev_b32 v28, 16, v120
    v_and_b32 v29, 0xffff0000, v120
    v_mul_f32 v28, v28, v10
    v_mul_f32 v29, v29, v11
    v_cvt_pk_bf16_f32 v28, v28, v29
    v_dot2_f32_bf16 v215, v28, v26, 0
    v_dot2_f32_bf16 v199, v121, v3, v199
    v_lshlrev_b32_e64 v28, 16, v121
    v_and_b32 v29, 0xffff0000, v121
    v_mul_f32 v28, v28, v12
    v_mul_f32 v29, v29, v13
    v_cvt_pk_bf16_f32 v28, v28, v29
    v_dot2_f32_bf16 v215, v28, v26, v215
    v_dot2_f32_bf16 v199, v122, v4, v199
    v_lshlrev_b32 v28, 16, v122
    v_and_b32 v29, 0xffff0000, v122
    v_mul_f32 v28, v28, v14
    v_mul_f32_e64 v29, v29, v15
    v_cvt_pk_bf16_f32 v28, v28, v29
    v_dot2_f32_bf16 v215, v28, v26, v215
    v_dot2_f32_bf16 v199, v123, v5, v199
    v_lshlrev_b32_e64 v28, 16, v123
    v_and_b32 v29, 0xffff0000, v123
    v_mul_f32 v28, v28, v16
    v_mul_f32 v29, v29, v17
    v_cvt_pk_bf16_f32 v28, v28, v29
    v_dot2_f32_bf16 v215, v28, v26, v215
    v_dot2_f32_bf16 v199, v124, v6, v199
    v_lshlrev_b32 v28, 16, v124
    v_and_b32 v29, 0xffff0000, v124
    v_mul_f32 v28, v28, v18
    v_mul_f32_e64 v29, v29, v19
    v_cvt_pk_bf16_f32 v28, v28, v29
    v_dot2_f32_bf16 v215, v28, v26, v215
    v_dot2_f32_bf16 v199, v125, v7, v199
    v_lshlrev_b32_e64 v28, 16, v125
    v_and_b32 v29, 0xffff0000, v125
    v_mul_f32 v28, v28, v20
    v_mul_f32 v29, v29, v21
    v_cvt_pk_bf16_f32 v28, v28, v29
    v_dot2_f32_bf16 v215, v28, v26, v215
    v_dot2_f32_bf16 v199, v126, v8, v199
    v_lshlrev_b32 v28, 16, v126
    v_and_b32 v29, 0xffff0000, v126
    v_mul_f32 v28, v28, v22
    v_mul_f32_e64 v29, v29, v23
    v_cvt_pk_bf16_f32 v28, v28, v29
    v_dot2_f32_bf16 v215, v28, v26, v215
    v_dot2_f32_bf16 v199, v127, v9, v199
    v_lshlrev_b32_e64 v28, 16, v127
    v_and_b32 v29, 0xffff0000, v127
    v_mul_f32 v28, v28, v24
    v_mul_f32 v29, v29, v25
    v_cvt_pk_bf16_f32 v28, v28, v29
    v_dot2_f32_bf16 v215, v28, v26, v215
    s_waitcnt vmcnt(14)
    v_dot2_f32_bf16 v200, v128, v2, 0
    v_lshlrev_b32 v28, 16, v128
    v_and_b32 v29, 0xffff0000, v128
    v_mul_f32 v28, v28, v10
    v_mul_f32 v29, v29, v11
    v_cvt_pk_bf16_f32 v28, v28, v29
    v_dot2_f32_bf16 v216, v28, v26, 0
    v_dot2_f32_bf16 v200, v129, v3, v200
    v_lshlrev_b32_e64 v28, 16, v129
    v_and_b32 v29, 0xffff0000, v129
    v_mul_f32 v28, v28, v12
    v_mul_f32 v29, v29, v13
    v_cvt_pk_bf16_f32 v28, v28, v29
    v_dot2_f32_bf16 v216, v28, v26, v216
    v_dot2_f32_bf16 v200, v130, v4, v200
    v_lshlrev_b32 v28, 16, v130
    v_and_b32 v29, 0xffff0000, v130
    v_mul_f32 v28, v28, v14
    v_mul_f32_e64 v29, v29, v15
    v_cvt_pk_bf16_f32 v28, v28, v29
    v_dot2_f32_bf16 v216, v28, v26, v216
    v_dot2_f32_bf16 v200, v131, v5, v200
    v_lshlrev_b32_e64 v28, 16, v131
    v_and_b32 v29, 0xffff0000, v131
    v_mul_f32 v28, v28, v16
    v_mul_f32 v29, v29, v17
    v_cvt_pk_bf16_f32 v28, v28, v29
    v_dot2_f32_bf16 v216, v28, v26, v216
    v_dot2_f32_bf16 v200, v132, v6, v200
    v_lshlrev_b32 v28, 16, v132
    v_and_b32 v29, 0xffff0000, v132
    v_mul_f32 v28, v28, v18
    v_mul_f32_e64 v29, v29, v19
    v_cvt_pk_bf16_f32 v28, v28, v29
    v_dot2_f32_bf16 v216, v28, v26, v216
    v_dot2_f32_bf16 v200, v133, v7, v200
    v_lshlrev_b32_e64 v28, 16, v133
    v_and_b32 v29, 0xffff0000, v133
    v_mul_f32 v28, v28, v20
    v_mul_f32 v29, v29, v21
    v_cvt_pk_bf16_f32 v28, v28, v29
    v_dot2_f32_bf16 v216, v28, v26, v216
    v_dot2_f32_bf16 v200, v134, v8, v200
    v_lshlrev_b32 v28, 16, v134
    v_and_b32 v29, 0xffff0000, v134
    v_mul_f32 v28, v28, v22
    v_mul_f32_e64 v29, v29, v23
    v_cvt_pk_bf16_f32 v28, v28, v29
    v_dot2_f32_bf16 v216, v28, v26, v216
    v_dot2_f32_bf16 v200, v135, v9, v200
    v_lshlrev_b32_e64 v28, 16, v135
    v_and_b32 v29, 0xffff0000, v135
    v_mul_f32 v28, v28, v24
    v_mul_f32 v29, v29, v25
    v_cvt_pk_bf16_f32 v28, v28, v29
    v_dot2_f32_bf16 v216, v28, v26, v216
    s_waitcnt vmcnt(12)
    v_dot2_f32_bf16 v201, v136, v2, 0
    v_lshlrev_b32 v28, 16, v136
    v_and_b32 v29, 0xffff0000, v136
    v_mul_f32 v28, v28, v10
    v_mul_f32 v29, v29, v11
    v_cvt_pk_bf16_f32 v28, v28, v29
    v_dot2_f32_bf16 v217, v28, v26, 0
    v_dot2_f32_bf16 v201, v137, v3, v201
    v_lshlrev_b32_e64 v28, 16, v137
    v_and_b32 v29, 0xffff0000, v137
    v_mul_f32 v28, v28, v12
    v_mul_f32 v29, v29, v13
    v_cvt_pk_bf16_f32 v28, v28, v29
    v_dot2_f32_bf16 v217, v28, v26, v217
    v_dot2_f32_bf16 v201, v138, v4, v201
    v_lshlrev_b32 v28, 16, v138
    v_and_b32 v29, 0xffff0000, v138
    v_mul_f32 v28, v28, v14
    v_mul_f32_e64 v29, v29, v15
    v_cvt_pk_bf16_f32 v28, v28, v29
    v_dot2_f32_bf16 v217, v28, v26, v217
    v_dot2_f32_bf16 v201, v139, v5, v201
    v_lshlrev_b32_e64 v28, 16, v139
    v_and_b32 v29, 0xffff0000, v139
    v_mul_f32 v28, v28, v16
    v_mul_f32 v29, v29, v17
    v_cvt_pk_bf16_f32 v28, v28, v29
    v_dot2_f32_bf16 v217, v28, v26, v217
    v_dot2_f32_bf16 v201, v140, v6, v201
    v_lshlrev_b32 v28, 16, v140
    v_and_b32 v29, 0xffff0000, v140
    v_mul_f32 v28, v28, v18
    v_mul_f32_e64 v29, v29, v19
    v_cvt_pk_bf16_f32 v28, v28, v29
    v_dot2_f32_bf16 v217, v28, v26, v217
    v_dot2_f32_bf16 v201, v141, v7, v201
    v_lshlrev_b32_e64 v28, 16, v141
    v_and_b32 v29, 0xffff0000, v141
    v_mul_f32 v28, v28, v20
    v_mul_f32 v29, v29, v21
    v_cvt_pk_bf16_f32 v28, v28, v29
    v_dot2_f32_bf16 v217, v28, v26, v217
    v_dot2_f32_bf16 v201, v142, v8, v201
    v_lshlrev_b32 v28, 16, v142
    v_and_b32 v29, 0xffff0000, v142
    v_mul_f32 v28, v28, v22
    v_mul_f32_e64 v29, v29, v23
    v_cvt_pk_bf16_f32 v28, v28, v29
    v_dot2_f32_bf16 v217, v28, v26, v217
    v_dot2_f32_bf16 v201, v143, v9, v201
    v_lshlrev_b32_e64 v28, 16, v143
    v_and_b32 v29, 0xffff0000, v143
    v_mul_f32 v28, v28, v24
    v_mul_f32 v29, v29, v25
    v_cvt_pk_bf16_f32 v28, v28, v29
    v_dot2_f32_bf16 v217, v28, v26, v217
    s_waitcnt vmcnt(10)
    v_dot2_f32_bf16 v202, v144, v2, 0
    v_lshlrev_b32 v28, 16, v144
    v_and_b32 v29, 0xffff0000, v144
    v_mul_f32 v28, v28, v10
    v_mul_f32 v29, v29, v11
    v_cvt_pk_bf16_f32 v28, v28, v29
    v_dot2_f32_bf16 v218, v28, v26, 0
    v_dot2_f32_bf16 v202, v145, v3, v202
    v_lshlrev_b32_e64 v28, 16, v145
    v_and_b32 v29, 0xffff0000, v145
    v_mul_f32 v28, v28, v12
    v_mul_f32 v29, v29, v13
    v_cvt_pk_bf16_f32 v28, v28, v29
    v_dot2_f32_bf16 v218, v28, v26, v218
    v_dot2_f32_bf16 v202, v146, v4, v202
    v_lshlrev_b32 v28, 16, v146
    v_and_b32 v29, 0xffff0000, v146
    v_mul_f32 v28, v28, v14
    v_mul_f32_e64 v29, v29, v15
    v_cvt_pk_bf16_f32 v28, v28, v29
    v_dot2_f32_bf16 v218, v28, v26, v218
    v_dot2_f32_bf16 v202, v147, v5, v202
    v_lshlrev_b32_e64 v28, 16, v147
    v_and_b32 v29, 0xffff0000, v147
    v_mul_f32 v28, v28, v16
    v_mul_f32 v29, v29, v17
    v_cvt_pk_bf16_f32 v28, v28, v29
    v_dot2_f32_bf16 v218, v28, v26, v218
    v_dot2_f32_bf16 v202, v148, v6, v202
    v_lshlrev_b32 v28, 16, v148
    v_and_b32 v29, 0xffff0000, v148
    v_mul_f32 v28, v28, v18
    v_mul_f32_e64 v29, v29, v19
    v_cvt_pk_bf16_f32 v28, v28, v29
    v_dot2_f32_bf16 v218, v28, v26, v218
    v_dot2_f32_bf16 v202, v149, v7, v202
    v_lshlrev_b32_e64 v28, 16, v149
    v_and_b32 v29, 0xffff0000, v149
    v_mul_f32 v28, v28, v20
    v_mul_f32 v29, v29, v21
    v_cvt_pk_bf16_f32 v28, v28, v29
    v_dot2_f32_bf16 v218, v28, v26, v218
    v_dot2_f32_bf16 v202, v150, v8, v202
    v_lshlrev_b32 v28, 16, v150
    v_and_b32 v29, 0xffff0000, v150
    v_mul_f32 v28, v28, v22
    v_mul_f32_e64 v29, v29, v23
    v_cvt_pk_bf16_f32 v28, v28, v29
    v_dot2_f32_bf16 v218, v28, v26, v218
    v_dot2_f32_bf16 v202, v151, v9, v202
    v_lshlrev_b32_e64 v28, 16, v151
    v_and_b32 v29, 0xffff0000, v151
    v_mul_f32 v28, v28, v24
    v_mul_f32 v29, v29, v25
    v_cvt_pk_bf16_f32 v28, v28, v29
    v_dot2_f32_bf16 v218, v28, v26, v218
    s_waitcnt vmcnt(8)
    v_dot2_f32_bf16 v203, v152, v2, 0
    v_lshlrev_b32 v28, 16, v152
    v_and_b32 v29, 0xffff0000, v152
    v_mul_f32 v28, v28, v10
    v_mul_f32 v29, v29, v11
    v_cvt_pk_bf16_f32 v28, v28, v29
    v_dot2_f32_bf16 v219, v28, v26, 0
    v_dot2_f32_bf16 v203, v153, v3, v203
    v_lshlrev_b32_e64 v28, 16, v153
    v_and_b32 v29, 0xffff0000, v153
    v_mul_f32 v28, v28, v12
    v_mul_f32 v29, v29, v13
    v_cvt_pk_bf16_f32 v28, v28, v29
    v_dot2_f32_bf16 v219, v28, v26, v219
    v_dot2_f32_bf16 v203, v154, v4, v203
    v_lshlrev_b32 v28, 16, v154
    v_and_b32 v29, 0xffff0000, v154
    v_mul_f32 v28, v28, v14
    v_mul_f32_e64 v29, v29, v15
    v_cvt_pk_bf16_f32 v28, v28, v29
    v_dot2_f32_bf16 v219, v28, v26, v219
    v_dot2_f32_bf16 v203, v155, v5, v203
    v_lshlrev_b32_e64 v28, 16, v155
    v_and_b32 v29, 0xffff0000, v155
    v_mul_f32 v28, v28, v16
    v_mul_f32 v29, v29, v17
    v_cvt_pk_bf16_f32 v28, v28, v29
    v_dot2_f32_bf16 v219, v28, v26, v219
    v_dot2_f32_bf16 v203, v156, v6, v203
    v_lshlrev_b32 v28, 16, v156
    v_and_b32 v29, 0xffff0000, v156
    v_mul_f32 v28, v28, v18
    v_mul_f32_e64 v29, v29, v19
    v_cvt_pk_bf16_f32 v28, v28, v29
    v_dot2_f32_bf16 v219, v28, v26, v219
    v_dot2_f32_bf16 v203, v157, v7, v203
    v_lshlrev_b32_e64 v28, 16, v157
    v_and_b32 v29, 0xffff0000, v157
    v_mul_f32 v28, v28, v20
    v_mul_f32 v29, v29, v21
    v_cvt_pk_bf16_f32 v28, v28, v29
    v_dot2_f32_bf16 v219, v28, v26, v219
    v_dot2_f32_bf16 v203, v158, v8, v203
    v_lshlrev_b32 v28, 16, v158
    v_and_b32 v29, 0xffff0000, v158
    v_mul_f32 v28, v28, v22
    v_mul_f32_e64 v29, v29, v23
    v_cvt_pk_bf16_f32 v28, v28, v29
    v_dot2_f32_bf16 v219, v28, v26, v219
    v_dot2_f32_bf16 v203, v159, v9, v203
    v_lshlrev_b32_e64 v28, 16, v159
    v_and_b32 v29, 0xffff0000, v159
    v_mul_f32 v28, v28, v24
    v_mul_f32 v29, v29, v25
    v_cvt_pk_bf16_f32 v28, v28, v29
    v_dot2_f32_bf16 v219, v28, v26, v219
    s_waitcnt vmcnt(6)
    v_dot2_f32_bf16 v204, v160, v2, 0
    v_lshlrev_b32 v28, 16, v160
    v_and_b32 v29, 0xffff0000, v160
    v_mul_f32 v28, v28, v10
    v_mul_f32 v29, v29, v11
    v_cvt_pk_bf16_f32 v28, v28, v29
    v_dot2_f32_bf16 v220, v28, v26, 0
    v_dot2_f32_bf16 v204, v161, v3, v204
    v_lshlrev_b32_e64 v28, 16, v161
    v_and_b32 v29, 0xffff0000, v161
    v_mul_f32 v28, v28, v12
    v_mul_f32 v29, v29, v13
    v_cvt_pk_bf16_f32 v28, v28, v29
    v_dot2_f32_bf16 v220, v28, v26, v220
    v_dot2_f32_bf16 v204, v162, v4, v204
    v_lshlrev_b32 v28, 16, v162
    v_and_b32 v29, 0xffff0000, v162
    v_mul_f32 v28, v28, v14
    v_mul_f32_e64 v29, v29, v15
    v_cvt_pk_bf16_f32 v28, v28, v29
    v_dot2_f32_bf16 v220, v28, v26, v220
    v_dot2_f32_bf16 v204, v163, v5, v204
    v_lshlrev_b32_e64 v28, 16, v163
    v_and_b32 v29, 0xffff0000, v163
    v_mul_f32 v28, v28, v16
    v_mul_f32 v29, v29, v17
    v_cvt_pk_bf16_f32 v28, v28, v29
    v_dot2_f32_bf16 v220, v28, v26, v220
    v_dot2_f32_bf16 v204, v164, v6, v204
    v_lshlrev_b32 v28, 16, v164
    v_and_b32 v29, 0xffff0000, v164
    v_mul_f32 v28, v28, v18
    v_mul_f32_e64 v29, v29, v19
    v_cvt_pk_bf16_f32 v28, v28, v29
    v_dot2_f32_bf16 v220, v28, v26, v220
    v_dot2_f32_bf16 v204, v165, v7, v204
    v_lshlrev_b32_e64 v28, 16, v165
    v_and_b32 v29, 0xffff0000, v165
    v_mul_f32 v28, v28, v20
    v_mul_f32 v29, v29, v21
    v_cvt_pk_bf16_f32 v28, v28, v29
    v_dot2_f32_bf16 v220, v28, v26, v220
    v_dot2_f32_bf16 v204, v166, v8, v204
    v_lshlrev_b32 v28, 16, v166
    v_and_b32 v29, 0xffff0000, v166
    v_mul_f32 v28, v28, v22
    v_mul_f32_e64 v29, v29, v23
    v_cvt_pk_bf16_f32 v28, v28, v29
    v_dot2_f32_bf16 v220, v28, v26, v220
    v_dot2_f32_bf16 v204, v167, v9, v204
    v_lshlrev_b32_e64 v28, 16, v167
    v_and_b32 v29, 0xffff0000, v167
    v_mul_f32 v28, v28, v24
    v_mul_f32 v29, v29, v25
    v_cvt_pk_bf16_f32 v28, v28, v29
    v_dot2_f32_bf16 v220, v28, v26, v220
    s_waitcnt vmcnt(4)
    v_dot2_f32_bf16 v205, v168, v2, 0
    v_lshlrev_b32 v28, 16, v168
    v_and_b32 v29, 0xffff0000, v168
    v_mul_f32 v28, v28, v10
    v_mul_f32 v29, v29, v11
    v_cvt_pk_bf16_f32 v28, v28, v29
    v_dot2_f32_bf16 v221, v28, v26, 0
    v_dot2_f32_bf16 v205, v169, v3, v205
    v_lshlrev_b32_e64 v28, 16, v169
    v_and_b32 v29, 0xffff0000, v169
    v_mul_f32 v28, v28, v12
    v_mul_f32 v29, v29, v13
    v_cvt_pk_bf16_f32 v28, v28, v29
    v_dot2_f32_bf16 v221, v28, v26, v221
    v_dot2_f32_bf16 v205, v170, v4, v205
    v_lshlrev_b32 v28, 16, v170
    v_and_b32 v29, 0xffff0000, v170
    v_mul_f32 v28, v28, v14
    v_mul_f32_e64 v29, v29, v15
    v_cvt_pk_bf16_f32 v28, v28, v29
    v_dot2_f32_bf16 v221, v28, v26, v221
    v_dot2_f32_bf16 v205, v171, v5, v205
    v_lshlrev_b32_e64 v28, 16, v171
    v_and_b32 v29, 0xffff0000, v171
    v_mul_f32 v28, v28, v16
    v_mul_f32 v29, v29, v17
    v_cvt_pk_bf16_f32 v28, v28, v29
    v_dot2_f32_bf16 v221, v28, v26, v221
    v_dot2_f32_bf16 v205, v172, v6, v205
    v_lshlrev_b32 v28, 16, v172
    v_and_b32 v29, 0xffff0000, v172
    v_mul_f32 v28, v28, v18
    v_mul_f32_e64 v29, v29, v19
    v_cvt_pk_bf16_f32 v28, v28, v29
    v_dot2_f32_bf16 v221, v28, v26, v221
    v_dot2_f32_bf16 v205, v173, v7, v205
    v_lshlrev_b32_e64 v28, 16, v173
    v_and_b32 v29, 0xffff0000, v173
    v_mul_f32 v28, v28, v20
    v_mul_f32 v29, v29, v21
    v_cvt_pk_bf16_f32 v28, v28, v29
    v_dot2_f32_bf16 v221, v28, v26, v221
    v_dot2_f32_bf16 v205, v174, v8, v205
    v_lshlrev_b32 v28, 16, v174
    v_and_b32 v29, 0xffff0000, v174
    v_mul_f32 v28, v28, v22
    v_mul_f32_e64 v29, v29, v23
    v_cvt_pk_bf16_f32 v28, v28, v29
    v_dot2_f32_bf16 v221, v28, v26, v221
    v_dot2_f32_bf16 v205, v175, v9, v205
    v_lshlrev_b32_e64 v28, 16, v175
    v_and_b32 v29, 0xffff0000, v175
    v_mul_f32 v28, v28, v24
    v_mul_f32 v29, v29, v25
    v_cvt_pk_bf16_f32 v28, v28, v29
    v_dot2_f32_bf16 v221, v28, v26, v221
    s_waitcnt vmcnt(2)
    v_dot2_f32_bf16 v206, v176, v2, 0
    v_lshlrev_b32 v28, 16, v176
    v_and_b32 v29, 0xffff0000, v176
    v_mul_f32 v28, v28, v10
    v_mul_f32 v29, v29, v11
    v_cvt_pk_bf16_f32 v28, v28, v29
    v_dot2_f32_bf16 v222, v28, v26, 0
    v_dot2_f32_bf16 v206, v177, v3, v206
    v_lshlrev_b32_e64 v28, 16, v177
    v_and_b32 v29, 0xffff0000, v177
    v_mul_f32 v28, v28, v12
    v_mul_f32 v29, v29, v13
    v_cvt_pk_bf16_f32 v28, v28, v29
    v_dot2_f32_bf16 v222, v28, v26, v222
    v_dot2_f32_bf16 v206, v178, v4, v206
    v_lshlrev_b32 v28, 16, v178
    v_and_b32 v29, 0xffff0000, v178
    v_mul_f32 v28, v28, v14
    v_mul_f32_e64 v29, v29, v15
    v_cvt_pk_bf16_f32 v28, v28, v29
    v_dot2_f32_bf16 v222, v28, v26, v222
    v_dot2_f32_bf16 v206, v179, v5, v206
    v_lshlrev_b32_e64 v28, 16, v179
    v_and_b32 v29, 0xffff0000, v179
    v_mul_f32 v28, v28, v16
    v_mul_f32 v29, v29, v17
    v_cvt_pk_bf16_f32 v28, v28, v29
    v_dot2_f32_bf16 v222, v28, v26, v222
    v_dot2_f32_bf16 v206, v180, v6, v206
    v_lshlrev_b32 v28, 16, v180
    v_and_b32 v29, 0xffff0000, v180
    v_mul_f32 v28, v28, v18
    v_mul_f32_e64 v29, v29, v19
    v_cvt_pk_bf16_f32 v28, v28, v29
    v_dot2_f32_bf16 v222, v28, v26, v222
    v_dot2_f32_bf16 v206, v181, v7, v206
    v_lshlrev_b32_e64 v28, 16, v181
    v_and_b32 v29, 0xffff0000, v181
    v_mul_f32 v28, v28, v20
    v_mul_f32 v29, v29, v21
    v_cvt_pk_bf16_f32 v28, v28, v29
    v_dot2_f32_bf16 v222, v28, v26, v222
    v_dot2_f32_bf16 v206, v182, v8, v206
    v_lshlrev_b32 v28, 16, v182
    v_and_b32 v29, 0xffff0000, v182
    v_mul_f32 v28, v28, v22
    v_mul_f32_e64 v29, v29, v23
    v_cvt_pk_bf16_f32 v28, v28, v29
    v_dot2_f32_bf16 v222, v28, v26, v222
    v_dot2_f32_bf16 v206, v183, v9, v206
    v_lshlrev_b32_e64 v28, 16, v183
    v_and_b32 v29, 0xffff0000, v183
    v_mul_f32 v28, v28, v24
    v_mul_f32 v29, v29, v25
    v_cvt_pk_bf16_f32 v28, v28, v29
    v_dot2_f32_bf16 v222, v28, v26, v222
    s_waitcnt vmcnt(0)
    v_dot2_f32_bf16 v207, v184, v2, 0
    v_lshlrev_b32 v28, 16, v184
    v_and_b32 v29, 0xffff0000, v184
    v_mul_f32 v28, v28, v10
    v_mul_f32 v29, v29, v11
    v_cvt_pk_bf16_f32 v28, v28, v29
    v_dot2_f32_bf16 v223, v28, v26, 0
    v_dot2_f32_bf16 v207, v185, v3, v207
    v_lshlrev_b32_e64 v28, 16, v185
    v_and_b32 v29, 0xffff0000, v185
    v_mul_f32 v28, v28, v12
    v_mul_f32 v29, v29, v13
    v_cvt_pk_bf16_f32 v28, v28, v29
    v_dot2_f32_bf16 v223, v28, v26, v223
    v_dot2_f32_bf16 v207, v186, v4, v207
    v_lshlrev_b32 v28, 16, v186
    v_and_b32 v29, 0xffff0000, v186
    v_mul_f32 v28, v28, v14
    v_mul_f32_e64 v29, v29, v15
    v_cvt_pk_bf16_f32 v28, v28, v29
    v_dot2_f32_bf16 v223, v28, v26, v223
    v_dot2_f32_bf16 v207, v187, v5, v207
    v_lshlrev_b32_e64 v28, 16, v187
    v_and_b32 v29, 0xffff0000, v187
    v_mul_f32 v28, v28, v16
    v_mul_f32 v29, v29, v17
    v_cvt_pk_bf16_f32 v28, v28, v29
    v_dot2_f32_bf16 v223, v28, v26, v223
    v_dot2_f32_bf16 v207, v188, v6, v207
    v_lshlrev_b32 v28, 16, v188
    v_and_b32 v29, 0xffff0000, v188
    v_mul_f32 v28, v28, v18
    v_mul_f32_e64 v29, v29, v19
    v_cvt_pk_bf16_f32 v28, v28, v29
    v_dot2_f32_bf16 v223, v28, v26, v223
    v_dot2_f32_bf16 v207, v189, v7, v207
    v_lshlrev_b32_e64 v28, 16, v189
    v_and_b32 v29, 0xffff0000, v189
    v_mul_f32 v28, v28, v20
    v_mul_f32 v29, v29, v21
    v_cvt_pk_bf16_f32 v28, v28, v29
    v_dot2_f32_bf16 v223, v28, v26, v223
    v_dot2_f32_bf16 v207, v190, v8, v207
    v_lshlrev_b32 v28, 16, v190
    v_and_b32 v29, 0xffff0000, v190
    v_mul_f32 v28, v28, v22
    v_mul_f32_e64 v29, v29, v23
    v_cvt_pk_bf16_f32 v28, v28, v29
    v_dot2_f32_bf16 v223, v28, v26, v223
    v_dot2_f32_bf16 v207, v191, v9, v207
    v_lshlrev_b32_e64 v28, 16, v191
    v_and_b32 v29, 0xffff0000, v191
    v_mul_f32 v28, v28, v24
    v_mul_f32 v29, v29, v25
    v_cvt_pk_bf16_f32 v28, v28, v29
    v_dot2_f32_bf16 v223, v28, v26, v223
    v_permlane32_swap_b32 v192, v200
    v_add_f32 v192, v192, v200
    v_permlane32_swap_b32 v193, v201
    v_add_f32 v193, v193, v201
    v_permlane32_swap_b32 v194, v202
    v_add_f32 v194, v194, v202
    v_permlane32_swap_b32 v195, v203
    v_add_f32 v195, v195, v203
    v_permlane32_swap_b32 v196, v204
    v_add_f32 v196, v196, v204
    v_permlane32_swap_b32 v197, v205
    v_add_f32 v197, v197, v205
    v_permlane32_swap_b32 v198, v206
    v_add_f32 v198, v198, v206
    v_permlane32_swap_b32 v199, v207
    v_add_f32 v199, v199, v207
    v_permlane16_swap_b32 v192, v196
    v_add_f32 v192, v192, v196
    v_permlane16_swap_b32 v193, v197
    v_add_f32 v193, v193, v197
    v_permlane16_swap_b32 v194, v198
    v_add_f32 v194, v194, v198
    v_permlane16_swap_b32 v195, v199
    v_add_f32 v195, v195, v199
    v_add_f32_dpp v192, v192, v192 row_ror:8 row_mask:0xf bank_mask:0xf
    v_add_f32_dpp v193, v193, v193 row_ror:8 row_mask:0xf bank_mask:0xf
    v_add_f32_dpp v194, v194, v194 row_ror:8 row_mask:0xf bank_mask:0xf
    v_add_f32_dpp v195, v195, v195 row_ror:8 row_mask:0xf bank_mask:0xf
    v_add_f32_dpp v192, v192, v192 row_ror:4 row_mask:0xf bank_mask:0xf
    v_add_f32_dpp v193, v193, v193 row_ror:4 row_mask:0xf bank_mask:0xf
    v_add_f32_dpp v194, v194, v194 row_ror:4 row_mask:0xf bank_mask:0xf
    v_add_f32_dpp v195, v195, v195 row_ror:4 row_mask:0xf bank_mask:0xf
    v_add_f32_dpp v192, v192, v192 row_ror:2 row_mask:0xf bank_mask:0xf
    v_add_f32_dpp v193, v193, v193 row_ror:2 row_mask:0xf bank_mask:0xf
    v_add_f32_dpp v194, v194, v194 row_ror:2 row_mask:0xf bank_mask:0xf
    v_add_f32_dpp v195, v195, v195 row_ror:2 row_mask:0xf bank_mask:0xf
    v_add_f32_dpp v192, v192, v192 row_ror:1 row_mask:0xf bank_mask:0xf
    v_add_f32_dpp v193, v193, v193 row_ror:1 row_mask:0xf bank_mask:0xf
    v_add_f32_dpp v194, v194, v194 row_ror:1 row_mask:0xf bank_mask:0xf
    v_add_f32_dpp v195, v195, v195 row_ror:1 row_mask:0xf bank_mask:0xf
    v_permlane32_swap_b32 v208, v216
    v_add_f32 v208, v208, v216
    v_permlane32_swap_b32 v209, v217
    v_add_f32 v209, v209, v217
    v_permlane32_swap_b32 v210, v218
    v_add_f32 v210, v210, v218
    v_permlane32_swap_b32 v211, v219
    v_add_f32 v211, v211, v219
    v_permlane32_swap_b32 v212, v220
    v_add_f32 v212, v212, v220
    v_permlane32_swap_b32 v213, v221
    v_add_f32 v213, v213, v221
    v_permlane32_swap_b32 v214, v222
    v_add_f32 v214, v214, v222
    v_permlane32_swap_b32 v215, v223
    v_add_f32 v215, v215, v223
    v_permlane16_swap_b32 v208, v212
    v_add_f32 v208, v208, v212
    v_permlane16_swap_b32 v209, v213
    v_add_f32 v209, v209, v213
    v_permlane16_swap_b32 v210, v214
    v_add_f32 v210, v210, v214
    v_permlane16_swap_b32 v211, v215
    v_add_f32 v211, v211, v215
    v_add_f32_dpp v208, v208, v208 row_ror:8 row_mask:0xf bank_mask:0xf
    v_add_f32_dpp v209, v209, v209 row_ror:8 row_mask:0xf bank_mask:0xf
    v_add_f32_dpp v210, v210, v210 row_ror:8 row_mask:0xf bank_mask:0xf
    v_add_f32_dpp v211, v211, v211 row_ror:8 row_mask:0xf bank_mask:0xf
    v_add_f32_dpp v208, v208, v208 row_ror:4 row_mask:0xf bank_mask:0xf
    v_add_f32_dpp v209, v209, v209 row_ror:4 row_mask:0xf bank_mask:0xf
    v_add_f32_dpp v210, v210, v210 row_ror:4 row_mask:0xf bank_mask:0xf
    v_add_f32_dpp v211, v211, v211 row_ror:4 row_mask:0xf bank_mask:0xf
    v_add_f32_dpp v208, v208, v208 row_ror:2 row_mask:0xf bank_mask:0xf
    v_add_f32_dpp v209, v209, v209 row_ror:2 row_mask:0xf bank_mask:0xf
    v_add_f32_dpp v210, v210, v210 row_ror:2 row_mask:0xf bank_mask:0xf
    v_add_f32_dpp v211, v211, v211 row_ror:2 row_mask:0xf bank_mask:0xf
    v_add_f32_dpp v208, v208, v208 row_ror:1 row_mask:0xf bank_mask:0xf
    v_add_f32_dpp v209, v209, v209 row_ror:1 row_mask:0xf bank_mask:0xf
    v_add_f32_dpp v210, v210, v210 row_ror:1 row_mask:0xf bank_mask:0xf
    v_add_f32_dpp v211, v211, v211 row_ror:1 row_mask:0xf bank_mask:0xf
    v_and_b32 v28, 3, v0
    v_cmp_eq_u32 vcc, 1, v28
    s_nop 1
    v_cndmask_b32 v192, v192, v193, vcc
    v_cndmask_b32 v208, v208, v209, vcc
    v_cmp_eq_u32 vcc, 2, v28
    s_nop 1
    v_cndmask_b32 v192, v192, v194, vcc
    v_cndmask_b32 v208, v208, v210, vcc
    v_cmp_eq_u32 vcc, 3, v28
    s_nop 1
    v_cndmask_b32 v192, v192, v195, vcc
    v_cndmask_b32 v208, v208, v211, vcc
    v_cvt_pk_bf16_f32 v208, v208, v208
    v_lshlrev_b32 v208, 16, v208
    v_mul_f32 v29, 0xbfb8aa3b, v208
    v_exp_f32 v29, v29
    s_nop 0
    v_add_f32 v29, 1.0, v29
    v_rcp_f32_e64 v208, v29
    s_nop 0
    v_cvt_pk_bf16_f32 v208, v208, v208
    v_lshlrev_b32 v208, 16, v208
    v_lshrrev_b32 v29, 4, v0
    v_lshl_add_u32 v28, v29, 2, v28
    s_lshl_b32 s96, s53, 6
    s_lshl_b32 s97, s54, 4
    s_add_u32 s96, s96, s97
    v_add_u32_e64 v28, s96, v28
    v_cvt_pk_bf16_f32 v30, v192, v192
    v_and_b32 v30, 0xffff0000, v30
    v_ashrrev_i32 v31, 31, v30
    v_or_b32 v31, 0x80000000, v31
    v_xor_b32 v30, v30, v31
    v_and_b32 v30, 0xffff0000, v30
    v_sub_u32 v31, 0xffff, v28
    v_or_b32 v30, v30, v31
    s_nop 1
    v_max_u32_dpp v30, v30, v30 row_ror:1 row_mask:0xf bank_mask:0xf
    s_nop 1
    v_max_u32_dpp v30, v30, v30 row_ror:2 row_mask:0xf bank_mask:0xf
    v_mov_b32 v31, v30
    s_nop 1
    v_permlane16_swap_b32 v30, v31
    v_max_u32 v30, v30, v31
    v_mov_b32 v31, v30
    s_nop 1
    v_permlane32_swap_b32 v30, v31
    v_max_u32 v40, v30, v31
    v_lshlrev_b32 v41, 2, v28
    v_mov_b32 v29, 0x40000000
    v_and_b32 v31, 12, v0
    v_cmp_eq_u32 vcc, 0, v31
    s_nop 1
    v_cndmask_b32 v41, v29, v41, vcc
    v_cmp_eq_u32 vcc, 0, v0
    s_nop 1
    v_cndmask_b32 v42, v29, 0, vcc
    s_cmp_eq_u32 s56, 1
    s_cbranch_scc1 L_cenok_10
    v_and_b32 v238, 7, v0
    v_lshlrev_b32 v238, 5, v238
L_cen_9:
    global_load_dword v239, v238, s[32:33] sc1
    s_waitcnt vmcnt(0)
L_cen_9_w:
    v_lshrrev_b32 v30, 16, v239
    s_mov_b32 s96, 0
    v_readlane_b32 s97, v30, 0
    s_add_u32 s96, s96, s97
    v_readlane_b32 s97, v30, 1
    s_add_u32 s96, s96, s97
    v_readlane_b32 s97, v30, 2
    s_add_u32 s96, s96, s97
    v_readlane_b32 s97, v30, 3
    s_add_u32 s96, s96, s97
    v_readlane_b32 s97, v30, 4
    s_add_u32 s96, s96, s97
    v_readlane_b32 s97, v30, 5
    s_add_u32 s96, s96, s97
    v_readlane_b32 s97, v30, 6
    s_add_u32 s96, s96, s97
    v_readlane_b32 s97, v30, 7
    s_add_u32 s96, s96, s97
    s_cmp_eq_u32 s96, 256
    s_cbranch_scc1 L_cen_9_done
    s_sub_u32 s57, s57, 1
    s_cbranch_scc1 L_exit
    s_branch L_cen_9
L_cen_9_done:
    s_mov_b32 s56, 1
    v_cmp_ne_u32 vcc, 0x200020, v239
    s_cbranch_vccz L_cenok_10
    s_lshr_b32 s52, s2, 5
    s_and_b32 s53, s2, 31
    s_mov_b32 s55, 1
    s_waitcnt vmcnt(0)
    s_barrier
    s_branch L_dispatch
    s_nop 0
    s_nop 0
    s_nop 0
    s_nop 0
    s_nop 0
L_cenok_10:
    s_mov_b32 s96, 524288
    buffer_store_dword v208, v41, s[36:39], s96 offen sc1
    s_mov_b32 s96, 16384
    buffer_atomic_umax v40, v42, s[36:39], s96 offen
    s_waitcnt vmcnt(0)
    s_barrier
    s_cmp_lg_u32 s54, 0
    s_cbranch_scc1 L_mod_cnt
    v_mov_b32_e64 v29, 1
    s_mov_b32 s96, 16512
    buffer_atomic_add v29, v42, s[36:39], s96 offen
L_mod_cnt:
    s_mov_b32 s96, 16512
L_poll_11:
    buffer_load_dword v29, off, s[36:39], s96 sc1
    s_waitcnt vmcnt(0)
    v_cmp_gt_u32 vcc, 32, v29
    s_cbranch_vccz L_poll_11_ok
    s_sub_u32 s57, s57, 1
    s_cbranch_scc1 L_exit
    s_branch L_poll_11
L_poll_11_ok:
    s_mov_b32 s96, 16384
    buffer_load_dword v43, off, s[36:39], s96 sc1
    s_waitcnt vmcnt(0)
    v_readfirstlane_b32 s98, v43
    s_and_b32 s98, s98, 0xffff
    s_sub_u32 s98, 0xffff, s98
    s_and_b32 s98, s98, 2047
    v_and_b32 v43, 0xffff0000, v43
    v_ashrrev_i32 v29, 31, v43
    v_not_b32 v29, v29
    v_or_b32 v29, 0x80000000, v29
    v_xor_b32 v43, v43, v29
    v_and_b32 v43, 0xffff0000, v43
    s_lshl_b32 s96, s98, 11
    s_lshl_b32 s97, s54, 9
    s_add_u32 s96, s96, s97
    v_lshlrev_b32 v28, 3, v0
    buffer_load_dwordx2 v[30:31], v28, s[44:47], s96 offen
    s_lshl_b32 s97, s54, 10
    v_lshl_add_u32 v28, v0, 2, s97
    s_waitcnt vmcnt(0)
    v_lshlrev_b32 v32, 16, v30
    v_and_b32 v33, 0xffff0000, v30
    v_lshlrev_b32_e64 v34, 16, v31
    v_and_b32 v35, 0xffff0000, v31
    ds_write_b32 v28, v32 offset:0
    ds_write_b32 v28, v33 offset:256
    ds_write_b32 v28, v34 offset:512
    ds_write_b32 v28, v35 offset:768
    s_mov_b32 s40, s22
    s_and_b32 s41, s23, 0xffff
    s_mov_b32 s42, 0x700000
    s_mov_b32 s43, 0x20000
    s_mov_b32 s48, s24
    s_and_b32 s49, s25, 0xffff
    s_mov_b32 s50, 0x700000
    s_mov_b32 s51, 0x20000
    v_mul_u32_u24 v28, 4682, v0
    v_lshrrev_b32 v28, 16, v28
    v_mul_u32_u24 v29, 14, v28
    v_sub_u32 v29, v0, v29
    v_mul_u32_u24 v30, 7168, v28
    v_lshl_add_u32 v2, v29, 4, v30
    v_mov_b32 v30, 0x40000000
    v_cmp_gt_u32 vcc, 56, v0
    s_nop 1
    v_cndmask_b32 v2, v30, v2, vcc
    v_and_b32 v30, 3, v28
    v_lshl_add_u32 v3, v30, 8, s97
    s_mul_i32 s96, s54, 14336
    s_add_u32 s96, s96, 4096
    v_mul_u32_u24 v30, 896, v28
    v_lshl_add_u32 v30, v29, 5, v30
    v_add_u32_e64 v4, s96, v30
    s_mul_i32 s62, s54, 1835008
    s_mul_i32 s96, s53, 224
    s_add_u32 s62, s62, s96
    v_mov_b32 v8, 0
    v_mov_b32 v9, 0
    v_mov_b32 v10, 0
    v_mov_b32 v11, 0
    v_mov_b32 v12, 0
    v_mov_b32 v13, 0
    v_mov_b32 v14, 0
    v_mov_b32 v15, 0
    v_mov_b32 v16, 0
    v_mov_b32 v17, 0
    v_mov_b32 v18, 0
    v_mov_b32 v19, 0
    v_mov_b32 v20, 0
    v_mov_b32 v21, 0
    v_mov_b32 v22, 0
    v_mov_b32_e64 v23, 0
    buffer_load_dwordx4 v[64:67], v2, s[40:43], s62 offen nt
    buffer_load_dwordx4 v[68:71], v2, s[48:51], s62 offen nt
    s_add_u32 s62, s62, 28672
    buffer_load_dwordx4 v[72:75], v2, s[40:43], s62 offen nt
    buffer_load_dwordx4 v[76:79], v2, s[48:51], s62 offen nt
    s_add_u32 s62, s62, 28672
    buffer_load_dwordx4 v[80:83], v2, s[40:43], s62 offen nt
    buffer_load_dwordx4 v[84:87], v2, s[48:51], s62 offen nt
    s_add_u32 s62, s62, 28672
    buffer_load_dwordx4 v[88:91], v2, s[40:43], s62 offen nt
    buffer_load_dwordx4 v[92:95], v2, s[48:51], s62 offen nt
    s_add_u32 s62, s62, 28672
    buffer_load_dwordx4 v[96:99], v2, s[40:43], s62 offen nt
    buffer_load_dwordx4 v[100:103], v2, s[48:51], s62 offen nt
    s_add_u32 s62, s62, 28672
    buffer_load_dwordx4 v[104:107], v2, s[40:43], s62 offen nt
    buffer_load_dwordx4 v[108:111], v2, s[48:51], s62 offen nt
    s_add_u32 s62, s62, 28672
    buffer_load_dwordx4 v[112:115], v2, s[40:43], s62 offen nt
    buffer_load_dwordx4 v[116:119], v2, s[48:51], s62 offen nt
    s_add_u32 s62, s62, 28672
    buffer_load_dwordx4 v[120:123], v2, s[40:43], s62 offen nt
    buffer_load_dwordx4 v[124:127], v2, s[48:51], s62 offen nt
    s_add_u32 s62, s62, 28672
    s_mov_b32 s63, 3
    s_waitcnt lgkmcnt(0)
L_mod_b:
    buffer_load_dwordx4 v[128:131], v2, s[40:43], s62 offen nt
    buffer_load_dwordx4 v[132:135], v2, s[48:51], s62 offen nt
    s_add_u32 s62, s62, 28672
    buffer_load_dwordx4 v[136:139], v2, s[40:43], s62 offen nt
    buffer_load_dwordx4 v[140:143], v2, s[48:51], s62 offen nt
    s_add_u32 s62, s62, 28672
    buffer_load_dwordx4 v[144:147], v2, s[40:43], s62 offen nt
    buffer_load_dwordx4 v[148:151], v2, s[48:51], s62 offen nt
    s_add_u32 s62, s62, 28672
    buffer_load_dwordx4 v[152:155], v2, s[40:43], s62 offen nt
    buffer_load_dwordx4 v[156:159], v2, s[48:51], s62 offen nt
    s_add_u32 s62, s62, 28672
    buffer_load_dwordx4 v[160:163], v2, s[40:43], s62 offen nt
    buffer_load_dwordx4 v[164:167], v2, s[48:51], s62 offen nt
    s_add_u32 s62, s62, 28672
    buffer_load_dwordx4 v[168:171], v2, s[40:43], s62 offen nt
    buffer_load_dwordx4 v[172:175], v2, s[48:51], s62 offen nt
    s_add_u32 s62, s62, 28672
    buffer_load_dwordx4 v[176:179], v2, s[40:43], s62 offen nt
    buffer_load_dwordx4 v[180:183], v2, s[48:51], s62 offen nt
    s_add_u32 s62, s62, 28672
    buffer_load_dwordx4 v[184:187], v2, s[40:43], s62 offen nt
    buffer_load_dwordx4 v[188:191], v2, s[48:51], s62 offen nt
    s_add_u32 s62, s62, 28672
    ds_read_b128 v[24:27], v3
    ds_read_b128 v[28:31], v3 offset:16
    v_add_u32 v3, 32, v3
    s_waitcnt lgkmcnt(0)
    s_waitcnt vmcnt(30)
    v_lshlrev_b32 v5, 16, v64
    v_and_b32 v6, 0xffff0000, v64
    v_fmac_f32 v8, v5, v24
    v_fmac_f32 v9, v6, v24
    v_lshlrev_b32 v5, 16, v65
    v_and_b32 v6, 0xffff0000, v65
    v_fmac_f32 v10, v5, v24
    v_fmac_f32 v11, v6, v24
    v_lshlrev_b32 v5, 16, v66
    v_and_b32 v6, 0xffff0000, v66
    v_fmac_f32 v12, v5, v24
    v_fmac_f32 v13, v6, v24
    v_lshlrev_b32_e64 v5, 16, v67
    v_and_b32 v6, 0xffff0000, v67
    v_fmac_f32 v14, v5, v24
    v_fmac_f32 v15, v6, v24
    v_lshlrev_b32 v5, 16, v68
    v_and_b32 v6, 0xffff0000, v68
    v_fmac_f32 v16, v5, v24
    v_fmac_f32 v17, v6, v24
    v_lshlrev_b32 v5, 16, v69
    v_and_b32 v6, 0xffff0000, v69
    v_fmac_f32 v18, v5, v24
    v_fmac_f32 v19, v6, v24
    v_lshlrev_b32_e64 v5, 16, v70
    v_and_b32 v6, 0xffff0000, v70
    v_fmac_f32 v20, v5, v24
    v_fmac_f32 v21, v6, v24
    v_lshlrev_b32 v5, 16, v71
    v_and_b32 v6, 0xffff0000, v71
    v_fmac_f32 v22, v5, v24
    v_fmac_f32 v23, v6, v24
    s_waitcnt vmcnt(28)
    v_lshlrev_b32 v5, 16, v72
    v_and_b32 v6, 0xffff0000, v72
    v_fmac_f32 v8, v5, v25
    v_fmac_f32 v9, v6, v25
    v_lshlrev_b32 v5, 16, v73
    v_and_b32 v6, 0xffff0000, v73
    v_fmac_f32 v10, v5, v25
    v_fmac_f32 v11, v6, v25
    v_lshlrev_b32 v5, 16, v74
    v_and_b32 v6, 0xffff0000, v74
    v_fmac_f32 v12, v5, v25
    v_fmac_f32 v13, v6, v25
    v_lshlrev_b32 v5, 16, v75
    v_and_b32 v6, 0xffff0000, v75
    v_fmac_f32 v14, v5, v25
    v_fmac_f32 v15, v6, v25
    v_lshlrev_b32_e64 v5, 16, v76
    v_and_b32 v6, 0xffff0000, v76
    v_fmac_f32 v16, v5, v25
    v_fmac_f32 v17, v6, v25
    v_lshlrev_b32 v5, 16, v77
    v_and_b32 v6, 0xffff0000, v77
    v_fmac_f32 v18, v5, v25
    v_fmac_f32 v19, v6, v25
    v_lshlrev_b32 v5, 16, v78
    v_and_b32 v6, 0xffff0000, v78
    v_fmac_f32 v20, v5, v25
    v_fmac_f32 v21, v6, v25
    v_lshlrev_b32_e64 v5, 16, v79
    v_and_b32 v6, 0xffff0000, v79
    v_fmac_f32 v22, v5, v25
    v_fmac_f32 v23, v6, v25
    s_waitcnt vmcnt(26)
    v_lshlrev_b32 v5, 16, v80
    v_and_b32 v6, 0xffff0000, v80
    v_fmac_f32 v8, v5, v26
    v_fmac_f32 v9, v6, v26
    v_lshlrev_b32 v5, 16, v81
    v_and_b32 v6, 0xffff0000, v81
    v_fmac_f32 v10, v5, v26
    v_fmac_f32 v11, v6, v26
    v_lshlrev_b32 v5, 16, v82
    v_and_b32 v6, 0xffff0000, v82
    v_fmac_f32 v12, v5, v26
    v_fmac_f32 v13, v6, v26
    v_lshlrev_b32 v5, 16, v83
    v_and_b32 v6, 0xffff0000, v83
    v_fmac_f32 v14, v5, v26
    v_fmac_f32 v15, v6, v26
    v_lshlrev_b32 v5, 16, v84
    v_and_b32 v6, 0xffff0000, v84
    v_fmac_f32 v16, v5, v26
    v_fmac_f32 v17, v6, v26
    v_lshlrev_b32_e64 v5, 16, v85
    v_and_b32 v6, 0xffff0000, v85
    v_fmac_f32 v18, v5, v26
    v_fmac_f32 v19, v6, v26
    v_lshlrev_b32 v5, 16, v86
    v_and_b32 v6, 0xffff0000, v86
    v_fmac_f32 v20, v5, v26
    v_fmac_f32 v21, v6, v26
    v_lshlrev_b32 v5, 16, v87
    v_and_b32 v6, 0xffff0000, v87
    v_fmac_f32 v22, v5, v26
    v_fmac_f32 v23, v6, v26
    s_waitcnt vmcnt(24)
    v_lshlrev_b32 v5, 16, v88
    v_and_b32 v6, 0xffff0000, v88
    v_fmac_f32 v8, v5, v27
    v_fmac_f32 v9, v6, v27
    v_lshlrev_b32 v5, 16, v89
    v_and_b32 v6, 0xffff0000, v89
    v_fmac_f32 v10, v5, v27
    v_fmac_f32 v11, v6, v27
    v_lshlrev_b32 v5, 16, v90
    v_and_b32 v6, 0xffff0000, v90
    v_fmac_f32 v12, v5, v27
    v_fmac_f32 v13, v6, v27
    v_lshlrev_b32_e64 v5, 16, v91
    v_and_b32 v6, 0xffff0000, v91
    v_fmac_f32 v14, v5, v27
    v_fmac_f32 v15, v6, v27
    v_lshlrev_b32 v5, 16, v92
    v_and_b32 v6, 0xffff0000, v92
    v_fmac_f32 v16, v5, v27
    v_fmac_f32 v17, v6, v27
    v_lshlrev_b32 v5, 16, v93
    v_and_b32 v6, 0xffff0000, v93
    v_fmac_f32 v18, v5, v27
    v_fmac_f32 v19, v6, v27
    v_lshlrev_b32_e64 v5, 16, v94
    v_and_b32 v6, 0xffff0000, v94
    v_fmac_f32 v20, v5, v27
    v_fmac_f32 v21, v6, v27
    v_lshlrev_b32 v5, 16, v95
    v_and_b32 v6, 0xffff0000, v95
    v_fmac_f32 v22, v5, v27
    v_fmac_f32 v23, v6, v27
    s_waitcnt vmcnt(22)
    v_lshlrev_b32 v5, 16, v96
    v_and_b32 v6, 0xffff0000, v96
    v_fmac_f32 v8, v5, v28
    v_fmac_f32 v9, v6, v28
    v_lshlrev_b32 v5, 16, v97
    v_and_b32 v6, 0xffff0000, v97
    v_fmac_f32 v10, v5, v28
    v_fmac_f32 v11, v6, v28
    v_lshlrev_b32 v5, 16, v98
    v_and_b32 v6, 0xffff0000, v98
    v_fmac_f32 v12, v5, v28
    v_fmac_f32 v13, v6, v28
    v_lshlrev_b32 v5, 16, v99
    v_and_b32 v6, 0xffff0000, v99
    v_fmac_f32 v14, v5, v28
    v_fmac_f32 v15, v6, v28
    v_lshlrev_b32_e64 v5, 16, v100
    v_and_b32 v6, 0xffff0000, v100
    v_fmac_f32 v16, v5, v28
    v_fmac_f32 v17, v6, v28
    v_lshlrev_b32 v5, 16, v101
    v_and_b32 v6, 0xffff0000, v101
    v_fmac_f32 v18, v5, v28
    v_fmac_f32 v19, v6, v28
    v_lshlrev_b32 v5, 16, v102
    v_and_b32 v6, 0xffff0000, v102
    v_fmac_f32 v20, v5, v28
    v_fmac_f32 v21, v6, v28
    v_lshlrev_b32_e64 v5, 16, v103
    v_and_b32 v6, 0xffff0000, v103
    v_fmac_f32 v22, v5, v28
    v_fmac_f32 v23, v6, v28
    s_waitcnt vmcnt(20)
    v_lshlrev_b32 v5, 16, v104
    v_and_b32 v6, 0xffff0000, v104
    v_fmac_f32 v8, v5, v29
    v_fmac_f32 v9, v6, v29
    v_lshlrev_b32 v5, 16, v105
    v_and_b32 v6, 0xffff0000, v105
    v_fmac_f32 v10, v5, v29
    v_fmac_f32 v11, v6, v29
    v_lshlrev_b32 v5, 16, v106
    v_and_b32 v6, 0xffff0000, v106
    v_fmac_f32 v12, v5, v29
    v_fmac_f32 v13, v6, v29
    v_lshlrev_b32 v5, 16, v107
    v_and_b32 v6, 0xffff0000, v107
    v_fmac_f32 v14, v5, v29
    v_fmac_f32 v15, v6, v29
    v_lshlrev_b32 v5, 16, v108
    v_and_b32 v6, 0xffff0000, v108
    v_fmac_f32 v16, v5, v29
    v_fmac_f32 v17, v6, v29
    v_lshlrev_b32_e64 v5, 16, v109
    v_and_b32 v6, 0xffff0000, v109
    v_fmac_f32 v18, v5, v29
    v_fmac_f32 v19, v6, v29
    v_lshlrev_b32 v5, 16, v110
    v_and_b32 v6, 0xffff0000, v110
    v_fmac_f32 v20, v5, v29
    v_fmac_f32 v21, v6, v29
    v_lshlrev_b32 v5, 16, v111
    v_and_b32 v6, 0xffff0000, v111
    v_fmac_f32 v22, v5, v29
    v_fmac_f32 v23, v6, v29
    s_waitcnt vmcnt(18)
    v_lshlrev_b32 v5, 16, v112
    v_and_b32 v6, 0xffff0000, v112
    v_fmac_f32 v8, v5, v30
    v_fmac_f32 v9, v6, v30
    v_lshlrev_b32 v5, 16, v113
    v_and_b32 v6, 0xffff0000, v113
    v_fmac_f32 v10, v5, v30
    v_fmac_f32 v11, v6, v30
    v_lshlrev_b32 v5, 16, v114
    v_and_b32 v6, 0xffff0000, v114
    v_fmac_f32 v12, v5, v30
    v_fmac_f32 v13, v6, v30
    v_lshlrev_b32_e64 v5, 16, v115
    v_and_b32 v6, 0xffff0000, v115
    v_fmac_f32 v14, v5, v30
    v_fmac_f32 v15, v6, v30
    v_lshlrev_b32 v5, 16, v116
    v_and_b32 v6, 0xffff0000, v116
    v_fmac_f32 v16, v5, v30
    v_fmac_f32 v17, v6, v30
    v_lshlrev_b32 v5, 16, v117
    v_and_b32 v6, 0xffff0000, v117
    v_fmac_f32 v18, v5, v30
    v_fmac_f32 v19, v6, v30
    v_lshlrev_b32_e64 v5, 16, v118
    v_and_b32 v6, 0xffff0000, v118
    v_fmac_f32 v20, v5, v30
    v_fmac_f32 v21, v6, v30
    v_lshlrev_b32 v5, 16, v119
    v_and_b32 v6, 0xffff0000, v119
    v_fmac_f32 v22, v5, v30
    v_fmac_f32 v23, v6, v30
    s_waitcnt vmcnt(16)
    v_lshlrev_b32 v5, 16, v120
    v_and_b32 v6, 0xffff0000, v120
    v_fmac_f32 v8, v5, v31
    v_fmac_f32 v9, v6, v31
    v_lshlrev_b32 v5, 16, v121
    v_and_b32 v6, 0xffff0000, v121
    v_fmac_f32 v10, v5, v31
    v_fmac_f32 v11, v6, v31
    v_lshlrev_b32 v5, 16, v122
    v_and_b32 v6, 0xffff0000, v122
    v_fmac_f32 v12, v5, v31
    v_fmac_f32 v13, v6, v31
    v_lshlrev_b32 v5, 16, v123
    v_and_b32 v6, 0xffff0000, v123
    v_fmac_f32 v14, v5, v31
    v_fmac_f32 v15, v6, v31
    v_lshlrev_b32_e64 v5, 16, v124
    v_and_b32 v6, 0xffff0000, v124
    v_fmac_f32 v16, v5, v31
    v_fmac_f32 v17, v6, v31
    v_lshlrev_b32 v5, 16, v125
    v_and_b32 v6, 0xffff0000, v125
    v_fmac_f32 v18, v5, v31
    v_fmac_f32 v19, v6, v31
    v_lshlrev_b32 v5, 16, v126
    v_and_b32 v6, 0xffff0000, v126
    v_fmac_f32 v20, v5, v31
    v_fmac_f32 v21, v6, v31
    v_lshlrev_b32_e64 v5, 16, v127
    v_and_b32 v6, 0xffff0000, v127
    v_fmac_f32 v22, v5, v31
    v_fmac_f32 v23, v6, v31
    buffer_load_dwordx4 v[64:67], v2, s[40:43], s62 offen nt
    buffer_load_dwordx4 v[68:71], v2, s[48:51], s62 offen nt
    s_add_u32 s62, s62, 28672
    buffer_load_dwordx4 v[72:75], v2, s[40:43], s62 offen nt
    buffer_load_dwordx4 v[76:79], v2, s[48:51], s62 offen nt
    s_add_u32 s62, s62, 28672
    buffer_load_dwordx4 v[80:83], v2, s[40:43], s62 offen nt
    buffer_load_dwordx4 v[84:87], v2, s[48:51], s62 offen nt
    s_add_u32 s62, s62, 28672
    buffer_load_dwordx4 v[88:91], v2, s[40:43], s62 offen nt
    buffer_load_dwordx4 v[92:95], v2, s[48:51], s62 offen nt
    s_add_u32 s62, s62, 28672
    buffer_load_dwordx4 v[96:99], v2, s[40:43], s62 offen nt
    buffer_load_dwordx4 v[100:103], v2, s[48:51], s62 offen nt
    s_add_u32 s62, s62, 28672
    buffer_load_dwordx4 v[104:107], v2, s[40:43], s62 offen nt
    buffer_load_dwordx4 v[108:111], v2, s[48:51], s62 offen nt
    s_add_u32 s62, s62, 28672
    buffer_load_dwordx4 v[112:115], v2, s[40:43], s62 offen nt
    buffer_load_dwordx4 v[116:119], v2, s[48:51], s62 offen nt
    s_add_u32 s62, s62, 28672
    buffer_load_dwordx4 v[120:123], v2, s[40:43], s62 offen nt
    buffer_load_dwordx4 v[124:127], v2, s[48:51], s62 offen nt
    s_add_u32 s62, s62, 28672
    ds_read_b128 v[24:27], v3
    ds_read_b128 v[28:31], v3 offset:16
    v_add_u32 v3, 32, v3
    s_waitcnt lgkmcnt(0)
    s_waitcnt vmcnt(30)
    v_lshlrev_b32 v5, 16, v128
    v_and_b32 v6, 0xffff0000, v128
    v_fmac_f32 v8, v5, v24
    v_fmac_f32 v9, v6, v24
    v_lshlrev_b32 v5, 16, v129
    v_and_b32 v6, 0xffff0000, v129
    v_fmac_f32 v10, v5, v24
    v_fmac_f32 v11, v6, v24
    v_lshlrev_b32 v5, 16, v130
    v_and_b32 v6, 0xffff0000, v130
    v_fmac_f32 v12, v5, v24
    v_fmac_f32 v13, v6, v24
    v_lshlrev_b32 v5, 16, v131
    v_and_b32 v6, 0xffff0000, v131
    v_fmac_f32 v14, v5, v24
    v_fmac_f32 v15, v6, v24
    v_lshlrev_b32 v5, 16, v132
    v_and_b32 v6, 0xffff0000, v132
    v_fmac_f32 v16, v5, v24
    v_fmac_f32 v17, v6, v24
    v_lshlrev_b32 v5, 16, v133
    v_and_b32 v6, 0xffff0000, v133
    v_fmac_f32 v18, v5, v24
    v_fmac_f32 v19, v6, v24
    v_lshlrev_b32 v5, 16, v134
    v_and_b32 v6, 0xffff0000, v134
    v_fmac_f32 v20, v5, v24
    v_fmac_f32 v21, v6, v24
    v_lshlrev_b32_e64 v5, 16, v135
    v_and_b32 v6, 0xffff0000, v135
    v_fmac_f32 v22, v5, v24
    v_fmac_f32 v23, v6, v24
    s_waitcnt vmcnt(28)
    v_lshlrev_b32 v5, 16, v136
    v_and_b32 v6, 0xffff0000, v136
    v_fmac_f32 v8, v5, v25
    v_fmac_f32 v9, v6, v25
    v_lshlrev_b32 v5, 16, v137
    v_and_b32 v6, 0xffff0000, v137
    v_fmac_f32 v10, v5, v25
    v_fmac_f32 v11, v6, v25
    v_lshlrev_b32 v5, 16, v138
    v_and_b32 v6, 0xffff0000, v138
    v_fmac_f32 v12, v5, v25
    v_fmac_f32 v13, v6, v25
    v_lshlrev_b32 v5, 16, v139
    v_and_b32 v6, 0xffff0000, v139
    v_fmac_f32 v14, v5, v25
    v_fmac_f32 v15, v6, v25
    v_lshlrev_b32 v5, 16, v140
    v_and_b32 v6, 0xffff0000, v140
    v_fmac_f32 v16, v5, v25
    v_fmac_f32 v17, v6, v25
    v_lshlrev_b32_e64 v5, 16, v141
    v_and_b32 v6, 0xffff0000, v141
    v_fmac_f32 v18, v5, v25
    v_fmac_f32 v19, v6, v25
    v_lshlrev_b32 v5, 16, v142
    v_and_b32 v6, 0xffff0000, v142
    v_fmac_f32 v20, v5, v25
    v_fmac_f32 v21, v6, v25
    v_lshlrev_b32 v5, 16, v143
    v_and_b32 v6, 0xffff0000, v143
    v_fmac_f32 v22, v5, v25
    v_fmac_f32 v23, v6, v25
    s_waitcnt vmcnt(26)
    v_lshlrev_b32 v5, 16, v144
    v_and_b32 v6, 0xffff0000, v144
    v_fmac_f32 v8, v5, v26
    v_fmac_f32 v9, v6, v26
    v_lshlrev_b32 v5, 16, v145
    v_and_b32 v6, 0xffff0000, v145
    v_fmac_f32 v10, v5, v26
    v_fmac_f32 v11, v6, v26
    v_lshlrev_b32 v5, 16, v146
    v_and_b32 v6, 0xffff0000, v146
    v_fmac_f32 v12, v5, v26
    v_fmac_f32 v13, v6, v26
    v_lshlrev_b32_e64 v5, 16, v147
    v_and_b32 v6, 0xffff0000, v147
    v_fmac_f32 v14, v5, v26
    v_fmac_f32 v15, v6, v26
    v_lshlrev_b32 v5, 16, v148
    v_and_b32 v6, 0xffff0000, v148
    v_fmac_f32 v16, v5, v26
    v_fmac_f32 v17, v6, v26
    v_lshlrev_b32 v5, 16, v149
    v_and_b32 v6, 0xffff0000, v149
    v_fmac_f32 v18, v5, v26
    v_fmac_f32 v19, v6, v26
    v_lshlrev_b32_e64 v5, 16, v150
    v_and_b32 v6, 0xffff0000, v150
    v_fmac_f32 v20, v5, v26
    v_fmac_f32 v21, v6, v26
    v_lshlrev_b32 v5, 16, v151
    v_and_b32 v6, 0xffff0000, v151
    v_fmac_f32 v22, v5, v26
    v_fmac_f32 v23, v6, v26
    s_waitcnt vmcnt(24)
    v_lshlrev_b32 v5, 16, v152
    v_and_b32 v6, 0xffff0000, v152
    v_fmac_f32 v8, v5, v27
    v_fmac_f32 v9, v6, v27
    v_lshlrev_b32 v5, 16, v153
    v_and_b32 v6, 0xffff0000, v153
    v_fmac_f32 v10, v5, v27
    v_fmac_f32 v11, v6, v27
    v_lshlrev_b32 v5, 16, v154
    v_and_b32 v6, 0xffff0000, v154
    v_fmac_f32 v12, v5, v27
    v_fmac_f32 v13, v6, v27
    v_lshlrev_b32 v5, 16, v155
    v_and_b32 v6, 0xffff0000, v155
    v_fmac_f32 v14, v5, v27
    v_fmac_f32 v15, v6, v27
    v_lshlrev_b32_e64 v5, 16, v156
    v_and_b32 v6, 0xffff0000, v156
    v_fmac_f32 v16, v5, v27
    v_fmac_f32 v17, v6, v27
    v_lshlrev_b32 v5, 16, v157
    v_and_b32 v6, 0xffff0000, v157
    v_fmac_f32 v18, v5, v27
    v_fmac_f32 v19, v6, v27
    v_lshlrev_b32 v5, 16, v158
    v_and_b32 v6, 0xffff0000, v158
    v_fmac_f32 v20, v5, v27
    v_fmac_f32 v21, v6, v27
    v_lshlrev_b32_e64 v5, 16, v159
    v_and_b32 v6, 0xffff0000, v159
    v_fmac_f32 v22, v5, v27
    v_fmac_f32 v23, v6, v27
    s_waitcnt vmcnt(22)
    v_lshlrev_b32 v5, 16, v160
    v_and_b32 v6, 0xffff0000, v160
    v_fmac_f32 v8, v5, v28
    v_fmac_f32 v9, v6, v28
    v_lshlrev_b32 v5, 16, v161
    v_and_b32 v6, 0xffff0000, v161
    v_fmac_f32 v10, v5, v28
    v_fmac_f32 v11, v6, v28
    v_lshlrev_b32 v5, 16, v162
    v_and_b32 v6, 0xffff0000, v162
    v_fmac_f32 v12, v5, v28
    v_fmac_f32 v13, v6, v28
    v_lshlrev_b32 v5, 16, v163
    v_and_b32 v6, 0xffff0000, v163
    v_fmac_f32 v14, v5, v28
    v_fmac_f32 v15, v6, v28
    v_lshlrev_b32 v5, 16, v164
    v_and_b32 v6, 0xffff0000, v164
    v_fmac_f32 v16, v5, v28
    v_fmac_f32 v17, v6, v28
    v_lshlrev_b32_e64 v5, 16, v165
    v_and_b32 v6, 0xffff0000, v165
    v_fmac_f32 v18, v5, v28
    v_fmac_f32 v19, v6, v28
    v_lshlrev_b32 v5, 16, v166
    v_and_b32 v6, 0xffff0000, v166
    v_fmac_f32 v20, v5, v28
    v_fmac_f32 v21, v6, v28
    v_lshlrev_b32 v5, 16, v167
    v_and_b32 v6, 0xffff0000, v167
    v_fmac_f32 v22, v5, v28
    v_fmac_f32 v23, v6, v28
    s_waitcnt vmcnt(20)
    v_lshlrev_b32 v5, 16, v168
    v_and_b32 v6, 0xffff0000, v168
    v_fmac_f32 v8, v5, v29
    v_fmac_f32 v9, v6, v29
    v_lshlrev_b32 v5, 16, v169
    v_and_b32 v6, 0xffff0000, v169
    v_fmac_f32 v10, v5, v29
    v_fmac_f32 v11, v6, v29
    v_lshlrev_b32 v5, 16, v170
    v_and_b32 v6, 0xffff0000, v170
    v_fmac_f32 v12, v5, v29
    v_fmac_f32 v13, v6, v29
    v_lshlrev_b32_e64 v5, 16, v171
    v_and_b32 v6, 0xffff0000, v171
    v_fmac_f32 v14, v5, v29
    v_fmac_f32 v15, v6, v29
    v_lshlrev_b32 v5, 16, v172
    v_and_b32 v6, 0xffff0000, v172
    v_fmac_f32 v16, v5, v29
    v_fmac_f32 v17, v6, v29
    v_lshlrev_b32 v5, 16, v173
    v_and_b32 v6, 0xffff0000, v173
    v_fmac_f32 v18, v5, v29
    v_fmac_f32 v19, v6, v29
    v_lshlrev_b32_e64 v5, 16, v174
    v_and_b32 v6, 0xffff0000, v174
    v_fmac_f32 v20, v5, v29
    v_fmac_f32 v21, v6, v29
    v_lshlrev_b32 v5, 16, v175
    v_and_b32 v6, 0xffff0000, v175
    v_fmac_f32 v22, v5, v29
    v_fmac_f32 v23, v6, v29
    s_waitcnt vmcnt(18)
    v_lshlrev_b32 v5, 16, v176
    v_and_b32 v6, 0xffff0000, v176
    v_fmac_f32 v8, v5, v30
    v_fmac_f32 v9, v6, v30
    v_lshlrev_b32 v5, 16, v177
    v_and_b32 v6, 0xffff0000, v177
    v_fmac_f32 v10, v5, v30
    v_fmac_f32 v11, v6, v30
    v_lshlrev_b32 v5, 16, v178
    v_and_b32 v6, 0xffff0000, v178
    v_fmac_f32 v12, v5, v30
    v_fmac_f32 v13, v6, v30
    v_lshlrev_b32 v5, 16, v179
    v_and_b32 v6, 0xffff0000, v179
    v_fmac_f32 v14, v5, v30
    v_fmac_f32 v15, v6, v30
    v_lshlrev_b32_e64 v5, 16, v180
    v_and_b32 v6, 0xffff0000, v180
    v_fmac_f32 v16, v5, v30
    v_fmac_f32 v17, v6, v30
    v_lshlrev_b32 v5, 16, v181
    v_and_b32 v6, 0xffff0000, v181
    v_fmac_f32 v18, v5, v30
    v_fmac_f32 v19, v6, v30
    v_lshlrev_b32 v5, 16, v182
    v_and_b32 v6, 0xffff0000, v182
    v_fmac_f32 v20, v5, v30
    v_fmac_f32 v21, v6, v30
    v_lshlrev_b32_e64 v5, 16, v183
    v_and_b32 v6, 0xffff0000, v183
    v_fmac_f32 v22, v5, v30
    v_fmac_f32 v23, v6, v30
    s_waitcnt vmcnt(16)
    v_lshlrev_b32 v5, 16, v184
    v_and_b32 v6, 0xffff0000, v184
    v_fmac_f32 v8, v5, v31
    v_fmac_f32 v9, v6, v31
    v_lshlrev_b32 v5, 16, v185
    v_and_b32 v6, 0xffff0000, v185
    v_fmac_f32 v10, v5, v31
    v_fmac_f32 v11, v6, v31
    v_lshlrev_b32 v5, 16, v186
    v_and_b32 v6, 0xffff0000, v186
    v_fmac_f32 v12, v5, v31
    v_fmac_f32 v13, v6, v31
    v_lshlrev_b32 v5, 16, v187
    v_and_b32 v6, 0xffff0000, v187
    v_fmac_f32 v14, v5, v31
    v_fmac_f32 v15, v6, v31
    v_lshlrev_b32 v5, 16, v188
    v_and_b32 v6, 0xffff0000, v188
    v_fmac_f32 v16, v5, v31
    v_fmac_f32 v17, v6, v31
    v_lshlrev_b32_e64 v5, 16, v189
    v_and_b32 v6, 0xffff0000, v189
    v_fmac_f32 v18, v5, v31
    v_fmac_f32 v19, v6, v31
    v_lshlrev_b32 v5, 16, v190
    v_and_b32 v6, 0xffff0000, v190
    v_fmac_f32 v20, v5, v31
    v_fmac_f32 v21, v6, v31
    v_lshlrev_b32 v5, 16, v191
    v_and_b32 v6, 0xffff0000, v191
    v_fmac_f32 v22, v5, v31
    v_fmac_f32_e64 v23, v6, v31
    s_sub_u32 s63, s63, 1
    s_cmp_lg_u32 s63, 0
    s_cbranch_scc1 L_mod_b
    buffer_load_dwordx4 v[128:131], v2, s[40:43], s62 offen nt
    buffer_load_dwordx4 v[132:135], v2, s[48:51], s62 offen nt
    s_add_u32 s62, s62, 28672
    buffer_load_dwordx4 v[136:139], v2, s[40:43], s62 offen nt
    buffer_load_dwordx4 v[140:143], v2, s[48:51], s62 offen nt
    s_add_u32 s62, s62, 28672
    buffer_load_dwordx4 v[144:147], v2, s[40:43], s62 offen nt
    buffer_load_dwordx4 v[148:151], v2, s[48:51], s62 offen nt
    s_add_u32 s62, s62, 28672
    buffer_load_dwordx4 v[152:155], v2, s[40:43], s62 offen nt
    buffer_load_dwordx4 v[156:159], v2, s[48:51], s62 offen nt
    s_add_u32 s62, s62, 28672
    buffer_load_dwordx4 v[160:163], v2, s[40:43], s62 offen nt
    buffer_load_dwordx4 v[164:167], v2, s[48:51], s62 offen nt
    s_add_u32 s62, s62, 28672
    buffer_load_dwordx4 v[168:171], v2, s[40:43], s62 offen nt
    buffer_load_dwordx4 v[172:175], v2, s[48:51], s62 offen nt
    s_add_u32 s62, s62, 28672
    buffer_load_dwordx4 v[176:179], v2, s[40:43], s62 offen nt
    buffer_load_dwordx4 v[180:183], v2, s[48:51], s62 offen nt
    s_add_u32 s62, s62, 28672
    buffer_load_dwordx4 v[184:187], v2, s[40:43], s62 offen nt
    buffer_load_dwordx4 v[188:191], v2, s[48:51], s62 offen nt
    s_add_u32 s62, s62, 28672
    ds_read_b128 v[24:27], v3
    ds_read_b128 v[28:31], v3 offset:16
    v_add_u32 v3, 32, v3
    s_waitcnt lgkmcnt(0)
    s_waitcnt vmcnt(30)
    v_lshlrev_b32 v5, 16, v64
    v_and_b32 v6, 0xffff0000, v64
    v_fmac_f32 v8, v5, v24
    v_fmac_f32 v9, v6, v24
    v_lshlrev_b32_e64 v5, 16, v65
    v_and_b32 v6, 0xffff0000, v65
    v_fmac_f32 v10, v5, v24
    v_fmac_f32 v11, v6, v24
    v_lshlrev_b32 v5, 16, v66
    v_and_b32 v6, 0xffff0000, v66
    v_fmac_f32 v12, v5, v24
    v_fmac_f32 v13, v6, v24
    v_lshlrev_b32 v5, 16, v67
    v_and_b32 v6, 0xffff0000, v67
    v_fmac_f32 v14, v5, v24
    v_fmac_f32 v15, v6, v24
    v_lshlrev_b32_e64 v5, 16, v68
    v_and_b32 v6, 0xffff0000, v68
    v_fmac_f32 v16, v5, v24
    v_fmac_f32 v17, v6, v24
    v_lshlrev_b32 v5, 16, v69
    v_and_b32 v6, 0xffff0000, v69
    v_fmac_f32 v18, v5, v24
    v_fmac_f32 v19, v6, v24
    v_lshlrev_b32 v5, 16, v70
    v_and_b32 v6, 0xffff0000, v70
    v_fmac_f32 v20, v5, v24
    v_fmac_f32 v21, v6, v24
    v_lshlrev_b32_e64 v5, 16, v71
    v_and_b32 v6, 0xffff0000, v71
    v_fmac_f32 v22, v5, v24
    v_fmac_f32 v23, v6, v24
    s_waitcnt vmcnt(28)
    v_lshlrev_b32 v5, 16, v72
    v_and_b32 v6, 0xffff0000, v72
    v_fmac_f32 v8, v5, v25
    v_fmac_f32 v9, v6, v25
    v_lshlrev_b32 v5, 16, v73
    v_and_b32 v6, 0xffff0000, v73
    v_fmac_f32 v10, v5, v25
    v_fmac_f32 v11, v6, v25
    v_lshlrev_b32 v5, 16, v74
    v_and_b32 v6, 0xffff0000, v74
    v_fmac_f32 v12, v5, v25
    v_fmac_f32 v13, v6, v25
    v_lshlrev_b32 v5, 16, v75
    v_and_b32 v6, 0xffff0000, v75
    v_fmac_f32 v14, v5, v25
    v_fmac_f32 v15, v6, v25
    v_lshlrev_b32 v5, 16, v76
    v_and_b32 v6, 0xffff0000, v76
    v_fmac_f32 v16, v5, v25
    v_fmac_f32 v17, v6, v25
    v_lshlrev_b32_e64 v5, 16, v77
    v_and_b32 v6, 0xffff0000, v77
    v_fmac_f32 v18, v5, v25
    v_fmac_f32 v19, v6, v25
    v_lshlrev_b32 v5, 16, v78
    v_and_b32 v6, 0xffff0000, v78
    v_fmac_f32 v20, v5, v25
    v_fmac_f32 v21, v6, v25
    v_lshlrev_b32 v5, 16, v79
    v_and_b32 v6, 0xffff0000, v79
    v_fmac_f32 v22, v5, v25
    v_fmac_f32 v23, v6, v25
    s_waitcnt vmcnt(26)
    v_lshlrev_b32 v5, 16, v80
    v_and_b32 v6, 0xffff0000, v80
    v_fmac_f32 v8, v5, v26
    v_fmac_f32 v9, v6, v26
    v_lshlrev_b32 v5, 16, v81
    v_and_b32 v6, 0xffff0000, v81
    v_fmac_f32 v10, v5, v26
    v_fmac_f32 v11, v6, v26
    v_lshlrev_b32 v5, 16, v82
    v_and_b32 v6, 0xffff0000, v82
    v_fmac_f32 v12, v5, v26
    v_fmac_f32 v13, v6, v26
    v_lshlrev_b32_e64 v5, 16, v83
    v_and_b32 v6, 0xffff0000, v83
    v_fmac_f32 v14, v5, v26
    v_fmac_f32 v15, v6, v26
    v_lshlrev_b32 v5, 16, v84
    v_and_b32 v6, 0xffff0000, v84
    v_fmac_f32 v16, v5, v26
    v_fmac_f32 v17, v6, v26
    v_lshlrev_b32 v5, 16, v85
    v_and_b32 v6, 0xffff0000, v85
    v_fmac_f32 v18, v5, v26
    v_fmac_f32 v19, v6, v26
    v_lshlrev_b32_e64 v5, 16, v86
    v_and_b32 v6, 0xffff0000, v86
    v_fmac_f32 v20, v5, v26
    v_fmac_f32 v21, v6, v26
    v_lshlrev_b32 v5, 16, v87
    v_and_b32 v6, 0xffff0000, v87
    v_fmac_f32 v22, v5, v26
    v_fmac_f32 v23, v6, v26
    s_waitcnt vmcnt(24)
    v_lshlrev_b32 v5, 16, v88
    v_and_b32 v6, 0xffff0000, v88
    v_fmac_f32 v8, v5, v27
    v_fmac_f32 v9, v6, v27
    v_lshlrev_b32 v5, 16, v89
    v_and_b32 v6, 0xffff0000, v89
    v_fmac_f32 v10, v5, v27
    v_fmac_f32 v11, v6, v27
    v_lshlrev_b32 v5, 16, v90
    v_and_b32 v6, 0xffff0000, v90
    v_fmac_f32 v12, v5, v27
    v_fmac_f32 v13, v6, v27
    v_lshlrev_b32 v5, 16, v91
    v_and_b32 v6, 0xffff0000, v91
    v_fmac_f32 v14, v5, v27
    v_fmac_f32 v15, v6, v27
    v_lshlrev_b32_e64 v5, 16, v92
    v_and_b32 v6, 0xffff0000, v92
    v_fmac_f32 v16, v5, v27
    v_fmac_f32 v17, v6, v27
    v_lshlrev_b32 v5, 16, v93
    v_and_b32 v6, 0xffff0000, v93
    v_fmac_f32 v18, v5, v27
    v_fmac_f32 v19, v6, v27
    v_lshlrev_b32 v5, 16, v94
    v_and_b32 v6, 0xffff0000, v94
    v_fmac_f32 v20, v5, v27
    v_fmac_f32 v21, v6, v27
    v_lshlrev_b32_e64 v5, 16, v95
    v_and_b32 v6, 0xffff0000, v95
    v_fmac_f32 v22, v5, v27
    v_fmac_f32 v23, v6, v27
    s_waitcnt vmcnt(22)
    v_lshlrev_b32 v5, 16, v96
    v_and_b32 v6, 0xffff0000, v96
    v_fmac_f32 v8, v5, v28
    v_fmac_f32 v9, v6, v28
    v_lshlrev_b32 v5, 16, v97
    v_and_b32 v6, 0xffff0000, v97
    v_fmac_f32 v10, v5, v28
    v_fmac_f32 v11, v6, v28
    v_lshlrev_b32 v5, 16, v98
    v_and_b32 v6, 0xffff0000, v98
    v_fmac_f32 v12, v5, v28
    v_fmac_f32 v13, v6, v28
    v_lshlrev_b32 v5, 16, v99
    v_and_b32 v6, 0xffff0000, v99
    v_fmac_f32 v14, v5, v28
    v_fmac_f32 v15, v6, v28
    v_lshlrev_b32 v5, 16, v100
    v_and_b32 v6, 0xffff0000, v100
    v_fmac_f32 v16, v5, v28
    v_fmac_f32 v17, v6, v28
    v_lshlrev_b32_e64 v5, 16, v101
    v_and_b32 v6, 0xffff0000, v101
    v_fmac_f32 v18, v5, v28
    v_fmac_f32 v19, v6, v28
    v_lshlrev_b32 v5, 16, v102
    v_and_b32 v6, 0xffff0000, v102
    v_fmac_f32 v20, v5, v28
    v_fmac_f32 v21, v6, v28
    v_lshlrev_b32 v5, 16, v103
    v_and_b32 v6, 0xffff0000, v103
    v_fmac_f32 v22, v5, v28
    v_fmac_f32 v23, v6, v28
    s_waitcnt vmcnt(20)
    v_lshlrev_b32 v5, 16, v104
    v_and_b32 v6, 0xffff0000, v104
    v_fmac_f32 v8, v5, v29
    v_fmac_f32 v9, v6, v29
    v_lshlrev_b32 v5, 16, v105
    v_and_b32 v6, 0xffff0000, v105
    v_fmac_f32 v10, v5, v29
    v_fmac_f32 v11, v6, v29
    v_lshlrev_b32 v5, 16, v106
    v_and_b32 v6, 0xffff0000, v106
    v_fmac_f32 v12, v5, v29
    v_fmac_f32 v13, v6, v29
    v_lshlrev_b32_e64 v5, 16, v107
    v_and_b32 v6, 0xffff0000, v107
    v_fmac_f32 v14, v5, v29
    v_fmac_f32 v15, v6, v29
    v_lshlrev_b32 v5, 16, v108
    v_and_b32 v6, 0xffff0000, v108
    v_fmac_f32 v16, v5, v29
    v_fmac_f32 v17, v6, v29
    v_lshlrev_b32 v5, 16, v109
    v_and_b32 v6, 0xffff0000, v109
    v_fmac_f32 v18, v5, v29
    v_fmac_f32 v19, v6, v29
    v_lshlrev_b32_e64 v5, 16, v110
    v_and_b32 v6, 0xffff0000, v110
    v_fmac_f32 v20, v5, v29
    v_fmac_f32 v21, v6, v29
    v_lshlrev_b32 v5, 16, v111
    v_and_b32 v6, 0xffff0000, v111
    v_fmac_f32 v22, v5, v29
    v_fmac_f32 v23, v6, v29
    s_waitcnt vmcnt(18)
    v_lshlrev_b32 v5, 16, v112
    v_and_b32 v6, 0xffff0000, v112
    v_fmac_f32 v8, v5, v30
    v_fmac_f32 v9, v6, v30
    v_lshlrev_b32 v5, 16, v113
    v_and_b32 v6, 0xffff0000, v113
    v_fmac_f32 v10, v5, v30
    v_fmac_f32 v11, v6, v30
    v_lshlrev_b32 v5, 16, v114
    v_and_b32 v6, 0xffff0000, v114
    v_fmac_f32 v12, v5, v30
    v_fmac_f32 v13, v6, v30
    v_lshlrev_b32 v5, 16, v115
    v_and_b32 v6, 0xffff0000, v115
    v_fmac_f32 v14, v5, v30
    v_fmac_f32 v15, v6, v30
    v_lshlrev_b32_e64 v5, 16, v116
    v_and_b32 v6, 0xffff0000, v116
    v_fmac_f32 v16, v5, v30
    v_fmac_f32 v17, v6, v30
    v_lshlrev_b32 v5, 16, v117
    v_and_b32 v6, 0xffff0000, v117
    v_fmac_f32 v18, v5, v30
    v_fmac_f32 v19, v6, v30
    v_lshlrev_b32 v5, 16, v118
    v_and_b32 v6, 0xffff0000, v118
    v_fmac_f32 v20, v5, v30
    v_fmac_f32 v21, v6, v30
    v_lshlrev_b32_e64 v5, 16, v119
    v_and_b32 v6, 0xffff0000, v119
    v_fmac_f32 v22, v5, v30
    v_fmac_f32 v23, v6, v30
    s_waitcnt vmcnt(16)
    v_lshlrev_b32 v5, 16, v120
    v_and_b32 v6, 0xffff0000, v120
    v_fmac_f32 v8, v5, v31
    v_fmac_f32 v9, v6, v31
    v_lshlrev_b32 v5, 16, v121
    v_and_b32 v6, 0xffff0000, v121
    v_fmac_f32 v10, v5, v31
    v_fmac_f32 v11, v6, v31
    v_lshlrev_b32 v5, 16, v122
    v_and_b32 v6, 0xffff0000, v122
    v_fmac_f32 v12, v5, v31
    v_fmac_f32 v13, v6, v31
    v_lshlrev_b32 v5, 16, v123
    v_and_b32 v6, 0xffff0000, v123
    v_fmac_f32 v14, v5, v31
    v_fmac_f32 v15, v6, v31
    v_lshlrev_b32 v5, 16, v124
    v_and_b32 v6, 0xffff0000, v124
    v_fmac_f32 v16, v5, v31
    v_fmac_f32 v17, v6, v31
    v_lshlrev_b32_e64 v5, 16, v125
    v_and_b32 v6, 0xffff0000, v125
    v_fmac_f32 v18, v5, v31
    v_fmac_f32 v19, v6, v31
    v_lshlrev_b32 v5, 16, v126
    v_and_b32 v6, 0xffff0000, v126
    v_fmac_f32 v20, v5, v31
    v_fmac_f32 v21, v6, v31
    v_lshlrev_b32 v5, 16, v127
    v_and_b32 v6, 0xffff0000, v127
    v_fmac_f32 v22, v5, v31
    v_fmac_f32 v23, v6, v31
    ds_read_b128 v[24:27], v3
    ds_read_b128 v[28:31], v3 offset:16
    v_add_u32 v3, 32, v3
    s_waitcnt lgkmcnt(0)
    s_waitcnt vmcnt(14)
    v_lshlrev_b32 v5, 16, v128
    v_and_b32 v6, 0xffff0000, v128
    v_fmac_f32 v8, v5, v24
    v_fmac_f32 v9, v6, v24
    v_lshlrev_b32 v5, 16, v129
    v_and_b32 v6, 0xffff0000, v129
    v_fmac_f32 v10, v5, v24
    v_fmac_f32 v11, v6, v24
    v_lshlrev_b32 v5, 16, v130
    v_and_b32 v6, 0xffff0000, v130
    v_fmac_f32 v12, v5, v24
    v_fmac_f32 v13, v6, v24
    v_lshlrev_b32 v5, 16, v131
    v_and_b32 v6, 0xffff0000, v131
    v_fmac_f32 v14, v5, v24
    v_fmac_f32 v15, v6, v24
    v_lshlrev_b32 v5, 16, v132
    v_and_b32 v6, 0xffff0000, v132
    v_fmac_f32 v16, v5, v24
    v_fmac_f32 v17, v6, v24
    v_lshlrev_b32_e64 v5, 16, v133
    v_and_b32 v6, 0xffff0000, v133
    v_fmac_f32 v18, v5, v24
    v_fmac_f32 v19, v6, v24
    v_lshlrev_b32 v5, 16, v134
    v_and_b32 v6, 0xffff0000, v134
    v_fmac_f32 v20, v5, v24
    v_fmac_f32 v21, v6, v24
    v_lshlrev_b32 v5, 16, v135
    v_and_b32 v6, 0xffff0000, v135
    v_fmac_f32 v22, v5, v24
    v_fmac_f32 v23, v6, v24
    s_waitcnt vmcnt(12)
    v_lshlrev_b32 v5, 16, v136
    v_and_b32 v6, 0xffff0000, v136
    v_fmac_f32 v8, v5, v25
    v_fmac_f32 v9, v6, v25
    v_lshlrev_b32 v5, 16, v137
    v_and_b32 v6, 0xffff0000, v137
    v_fmac_f32 v10, v5, v25
    v_fmac_f32 v11, v6, v25
    v_lshlrev_b32 v5, 16, v138
    v_and_b32 v6, 0xffff0000, v138
    v_fmac_f32 v12, v5, v25
    v_fmac_f32 v13, v6, v25
    v_lshlrev_b32_e64 v5, 16, v139
    v_and_b32 v6, 0xffff0000, v139
    v_fmac_f32 v14, v5, v25
    v_fmac_f32 v15, v6, v25
    v_lshlrev_b32 v5, 16, v140
    v_and_b32 v6, 0xffff0000, v140
    v_fmac_f32 v16, v5, v25
    v_fmac_f32 v17, v6, v25
    v_lshlrev_b32 v5, 16, v141
    v_and_b32 v6, 0xffff0000, v141
    v_fmac_f32 v18, v5, v25
    v_fmac_f32 v19, v6, v25
    v_lshlrev_b32_e64 v5, 16, v142
    v_and_b32 v6, 0xffff0000, v142
    v_fmac_f32 v20, v5, v25
    v_fmac_f32 v21, v6, v25
    v_lshlrev_b32 v5, 16, v143
    v_and_b32 v6, 0xffff0000, v143
    v_fmac_f32 v22, v5, v25
    v_fmac_f32 v23, v6, v25
    s_waitcnt vmcnt(10)
    v_lshlrev_b32 v5, 16, v144
    v_and_b32 v6, 0xffff0000, v144
    v_fmac_f32 v8, v5, v26
    v_fmac_f32 v9, v6, v26
    v_lshlrev_b32 v5, 16, v145
    v_and_b32 v6, 0xffff0000, v145
    v_fmac_f32 v10, v5, v26
    v_fmac_f32 v11, v6, v26
    v_lshlrev_b32 v5, 16, v146
    v_and_b32 v6, 0xffff0000, v146
    v_fmac_f32 v12, v5, v26
    v_fmac_f32 v13, v6, v26
    v_lshlrev_b32 v5, 16, v147
    v_and_b32 v6, 0xffff0000, v147
    v_fmac_f32 v14, v5, v26
    v_fmac_f32 v15, v6, v26
    v_lshlrev_b32_e64 v5, 16, v148
    v_and_b32 v6, 0xffff0000, v148
    v_fmac_f32 v16, v5, v26
    v_fmac_f32 v17, v6, v26
    v_lshlrev_b32 v5, 16, v149
    v_and_b32 v6, 0xffff0000, v149
    v_fmac_f32 v18, v5, v26
    v_fmac_f32 v19, v6, v26
    v_lshlrev_b32 v5, 16, v150
    v_and_b32 v6, 0xffff0000, v150
    v_fmac_f32 v20, v5, v26
    v_fmac_f32 v21, v6, v26
    v_lshlrev_b32_e64 v5, 16, v151
    v_and_b32 v6, 0xffff0000, v151
    v_fmac_f32 v22, v5, v26
    v_fmac_f32 v23, v6, v26
    s_waitcnt vmcnt(8)
    v_lshlrev_b32 v5, 16, v152
    v_and_b32 v6, 0xffff0000, v152
    v_fmac_f32 v8, v5, v27
    v_fmac_f32 v9, v6, v27
    v_lshlrev_b32 v5, 16, v153
    v_and_b32 v6, 0xffff0000, v153
    v_fmac_f32 v10, v5, v27
    v_fmac_f32 v11, v6, v27
    v_lshlrev_b32 v5, 16, v154
    v_and_b32 v6, 0xffff0000, v154
    v_fmac_f32 v12, v5, v27
    v_fmac_f32 v13, v6, v27
    v_lshlrev_b32 v5, 16, v155
    v_and_b32 v6, 0xffff0000, v155
    v_fmac_f32 v14, v5, v27
    v_fmac_f32 v15, v6, v27
    v_lshlrev_b32 v5, 16, v156
    v_and_b32 v6, 0xffff0000, v156
    v_fmac_f32 v16, v5, v27
    v_fmac_f32 v17, v6, v27
    v_lshlrev_b32_e64 v5, 16, v157
    v_and_b32 v6, 0xffff0000, v157
    v_fmac_f32 v18, v5, v27
    v_fmac_f32 v19, v6, v27
    v_lshlrev_b32 v5, 16, v158
    v_and_b32 v6, 0xffff0000, v158
    v_fmac_f32 v20, v5, v27
    v_fmac_f32 v21, v6, v27
    v_lshlrev_b32 v5, 16, v159
    v_and_b32 v6, 0xffff0000, v159
    v_fmac_f32 v22, v5, v27
    v_fmac_f32 v23, v6, v27
    s_waitcnt vmcnt(6)
    v_lshlrev_b32 v5, 16, v160
    v_and_b32 v6, 0xffff0000, v160
    v_fmac_f32 v8, v5, v28
    v_fmac_f32 v9, v6, v28
    v_lshlrev_b32 v5, 16, v161
    v_and_b32 v6, 0xffff0000, v161
    v_fmac_f32 v10, v5, v28
    v_fmac_f32 v11, v6, v28
    v_lshlrev_b32 v5, 16, v162
    v_and_b32 v6, 0xffff0000, v162
    v_fmac_f32 v12, v5, v28
    v_fmac_f32 v13, v6, v28
    v_lshlrev_b32_e64 v5, 16, v163
    v_and_b32 v6, 0xffff0000, v163
    v_fmac_f32 v14, v5, v28
    v_fmac_f32 v15, v6, v28
    v_lshlrev_b32 v5, 16, v164
    v_and_b32 v6, 0xffff0000, v164
    v_fmac_f32 v16, v5, v28
    v_fmac_f32 v17, v6, v28
    v_lshlrev_b32 v5, 16, v165
    v_and_b32 v6, 0xffff0000, v165
    v_fmac_f32 v18, v5, v28
    v_fmac_f32 v19, v6, v28
    v_lshlrev_b32_e64 v5, 16, v166
    v_and_b32 v6, 0xffff0000, v166
    v_fmac_f32 v20, v5, v28
    v_fmac_f32 v21, v6, v28
    v_lshlrev_b32 v5, 16, v167
    v_and_b32 v6, 0xffff0000, v167
    v_fmac_f32 v22, v5, v28
    v_fmac_f32 v23, v6, v28
    s_waitcnt vmcnt(4)
    v_lshlrev_b32 v5, 16, v168
    v_and_b32 v6, 0xffff0000, v168
    v_fmac_f32 v8, v5, v29
    v_fmac_f32 v9, v6, v29
    v_lshlrev_b32 v5, 16, v169
    v_and_b32 v6, 0xffff0000, v169
    v_fmac_f32 v10, v5, v29
    v_fmac_f32 v11, v6, v29
    v_lshlrev_b32 v5, 16, v170
    v_and_b32 v6, 0xffff0000, v170
    v_fmac_f32 v12, v5, v29
    v_fmac_f32 v13, v6, v29
    v_lshlrev_b32 v5, 16, v171
    v_and_b32 v6, 0xffff0000, v171
    v_fmac_f32 v14, v5, v29
    v_fmac_f32 v15, v6, v29
    v_lshlrev_b32_e64 v5, 16, v172
    v_and_b32 v6, 0xffff0000, v172
    v_fmac_f32 v16, v5, v29
    v_fmac_f32 v17, v6, v29
    v_lshlrev_b32 v5, 16, v173
    v_and_b32 v6, 0xffff0000, v173
    v_fmac_f32 v18, v5, v29
    v_fmac_f32 v19, v6, v29
    v_lshlrev_b32 v5, 16, v174
    v_and_b32 v6, 0xffff0000, v174
    v_fmac_f32 v20, v5, v29
    v_fmac_f32 v21, v6, v29
    v_lshlrev_b32_e64 v5, 16, v175
    v_and_b32 v6, 0xffff0000, v175
    v_fmac_f32 v22, v5, v29
    v_fmac_f32 v23, v6, v29
    s_waitcnt vmcnt(2)
    v_lshlrev_b32 v5, 16, v176
    v_and_b32 v6, 0xffff0000, v176
    v_fmac_f32 v8, v5, v30
    v_fmac_f32 v9, v6, v30
    v_lshlrev_b32 v5, 16, v177
    v_and_b32 v6, 0xffff0000, v177
    v_fmac_f32 v10, v5, v30
    v_fmac_f32 v11, v6, v30
    v_lshlrev_b32 v5, 16, v178
    v_and_b32 v6, 0xffff0000, v178
    v_fmac_f32 v12, v5, v30
    v_fmac_f32 v13, v6, v30
    v_lshlrev_b32 v5, 16, v179
    v_and_b32 v6, 0xffff0000, v179
    v_fmac_f32 v14, v5, v30
    v_fmac_f32 v15, v6, v30
    v_lshlrev_b32 v5, 16, v180
    v_and_b32 v6, 0xffff0000, v180
    v_fmac_f32 v16, v5, v30
    v_fmac_f32 v17, v6, v30
    v_lshlrev_b32_e64 v5, 16, v181
    v_and_b32 v6, 0xffff0000, v181
    v_fmac_f32 v18, v5, v30
    v_fmac_f32 v19, v6, v30
    v_lshlrev_b32 v5, 16, v182
    v_and_b32 v6, 0xffff0000, v182
    v_fmac_f32 v20, v5, v30
    v_fmac_f32 v21, v6, v30
    v_lshlrev_b32 v5, 16, v183
    v_and_b32 v6, 0xffff0000, v183
    v_fmac_f32 v22, v5, v30
    v_fmac_f32 v23, v6, v30
    s_waitcnt vmcnt(0)
    v_lshlrev_b32 v5, 16, v184
    v_and_b32 v6, 0xffff0000, v184
    v_fmac_f32 v8, v5, v31
    v_fmac_f32 v9, v6, v31
    v_lshlrev_b32 v5, 16, v185
    v_and_b32 v6, 0xffff0000, v185
    v_fmac_f32 v10, v5, v31
    v_fmac_f32 v11, v6, v31
    v_lshlrev_b32 v5, 16, v186
    v_and_b32 v6, 0xffff0000, v186
    v_fmac_f32 v12, v5, v31
    v_fmac_f32 v13, v6, v31
    v_lshlrev_b32_e64 v5, 16, v187
    v_and_b32 v6, 0xffff0000, v187
    v_fmac_f32 v14, v5, v31
    v_fmac_f32 v15, v6, v31
    v_lshlrev_b32 v5, 16, v188
    v_and_b32 v6, 0xffff0000, v188
    v_fmac_f32 v16, v5, v31
    v_fmac_f32 v17, v6, v31
    v_lshlrev_b32 v5, 16, v189
    v_and_b32 v6, 0xffff0000, v189
    v_fmac_f32 v18, v5, v31
    v_fmac_f32 v19, v6, v31
    v_lshlrev_b32_e64 v5, 16, v190
    v_and_b32 v6, 0xffff0000, v190
    v_fmac_f32 v20, v5, v31
    v_fmac_f32 v21, v6, v31
    v_lshlrev_b32 v5, 16, v191
    v_and_b32 v6, 0xffff0000, v191
    v_fmac_f32 v22, v5, v31
    v_fmac_f32_e64 v23, v6, v31
    s_mov_b32 exec_hi, 0xffffff
    ds_write_b128 v4, v[8:11] offset:0
    ds_write_b128 v4, v[12:15] offset:16
    ds_write_b128 v4, v[16:19] offset:448
    ds_write_b128 v4, v[20:23] offset:464
    s_mov_b64 exec, -1
    s_waitcnt lgkmcnt(0)
    s_barrier
    s_lshl_b32 s96, s54, 8
    v_lshl_add_u32 v28, v0, 2, s96
    v_min_u32 v28, 444, v28
    ds_read_b32 v64, v28 offset:4096
    ds_read_b32 v65, v28 offset:4992
    ds_read_b32 v66, v28 offset:5888
    ds_read_b32 v67, v28 offset:6784
    ds_read_b32 v68, v28 offset:18432
    ds_read_b32 v69, v28 offset:19328
    ds_read_b32 v70, v28 offset:20224
    ds_read_b32 v71, v28 offset:21120
    ds_read_b32 v72, v28 offset:32768
    ds_read_b32 v73, v28 offset:33664
    ds_read_b32 v74, v28 offset:34560
    ds_read_b32 v75, v28 offset:35456
    ds_read_b32 v76, v28 offset:47104
    ds_read_b32 v77, v28 offset:48000
    ds_read_b32 v78, v28 offset:48896
    ds_read_b32 v79, v28 offset:49792
    ds_read_b32 v80, v28 offset:4544
    ds_read_b32 v81, v28 offset:5440
    ds_read_b32 v82, v28 offset:6336
    ds_read_b32 v83, v28 offset:7232
    ds_read_b32 v84, v28 offset:18880
    ds_read_b32 v85, v28 offset:19776
    ds_read_b32 v86, v28 offset:20672
    ds_read_b32 v87, v28 offset:21568
    ds_read_b32 v88, v28 offset:33216
    ds_read_b32 v89, v28 offset:34112
    ds_read_b32 v90, v28 offset:35008
    ds_read_b32 v91, v28 offset:35904
    ds_read_b32 v92, v28 offset:47552
    ds_read_b32 v93, v28 offset:48448
    ds_read_b32 v94, v28 offset:49344
    ds_read_b32 v95, v28 offset:50240
    s_waitcnt lgkmcnt(0)
    v_add_f32 v64, v64, v65
    v_add_f32 v64, v64, v66
    v_add_f32 v64, v64, v67
    v_add_f32 v64, v64, v68
    v_add_f32 v64, v64, v69
    v_add_f32 v64, v64, v70
    v_add_f32 v64, v64, v71
    v_add_f32 v64, v64, v72
    v_add_f32 v64, v64, v73
    v_add_f32 v64, v64, v74
    v_add_f32 v64, v64, v75
    v_add_f32 v64, v64, v76
    v_add_f32 v64, v64, v77
    v_add_f32 v64, v64, v78
    v_add_f32 v64, v64, v79
    v_add_f32 v80, v80, v81
    v_add_f32 v80, v80, v82
    v_add_f32 v80, v80, v83
    v_add_f32 v80, v80, v84
    v_add_f32 v80, v80, v85
    v_add_f32 v80, v80, v86
    v_add_f32 v80, v80, v87
    v_add_f32 v80, v80, v88
    v_add_f32 v80, v80, v89
    v_add_f32 v80, v80, v90
    v_add_f32 v80, v80, v91
    v_add_f32 v80, v80, v92
    v_add_f32 v80, v80, v93
    v_add_f32 v80, v80, v94
    v_add_f32 v80, v80, v95
    v_cvt_pk_bf16_f32 v64, v64, v64
    v_lshlrev_b32 v64, 16, v64
    v_cvt_pk_bf16_f32 v80, v80, v80
    v_lshlrev_b32 v80, 16, v80
    v_mov_b32 v65, v64
    v_mul_f32 v29, 0xbfb8aa3b, v65
    v_exp_f32 v29, v29
    s_nop 0
    v_add_f32 v29, 1.0, v29
    v_rcp_f32 v65, v29
    s_nop 0
    v_mul_f32 v64, v64, v65
    v_cvt_pk_bf16_f32 v64, v64, v64
    v_lshlrev_b32 v64, 16, v64
    v_mul_f32 v64, v64, v80
    v_cvt_pk_bf16_f32 v64, v64, v64
    v_lshlrev_b32_e64 v64, 16, v64
    s_mov_b32 s40, s26
    s_and_b32 s41, s27, 0xffff
    s_mov_b32 s42, 0x700000
    s_mov_b32 s43, 0x20000
    ds_write_b32 v28, v64
    s_mul_i32 s62, s53, 229376
    s_mul_i32 s96, s54, 57344
    s_add_u32 s62, s62, s96
    buffer_load_dwordx4 v[64:67], v1, s[40:43], s62 offen offset:0 nt
    buffer_load_dwordx4 v[68:71], v1, s[40:43], s62 offen offset:1024 nt
    buffer_load_dwordx4 v[72:75], v1, s[40:43], s62 offen offset:2048 nt
    buffer_load_dwordx4 v[76:79], v1, s[40:43], s62 offen offset:3072 nt
    s_add_u32 s62, s62, 4096
    buffer_load_dwordx4 v[80:83], v1, s[40:43], s62 offen offset:0 nt
    buffer_load_dwordx4 v[84:87], v1, s[40:43], s62 offen offset:1024 nt
    buffer_load_dwordx4 v[88:91], v1, s[40:43], s62 offen offset:2048 nt
    buffer_load_dwordx4 v[92:95], v1, s[40:43], s62 offen offset:3072 nt
    s_add_u32 s62, s62, 4096
    buffer_load_dwordx4 v[96:99], v1, s[40:43], s62 offen offset:0 nt
    buffer_load_dwordx4 v[100:103], v1, s[40:43], s62 offen offset:1024 nt
    buffer_load_dwordx4 v[104:107], v1, s[40:43], s62 offen offset:2048 nt
    buffer_load_dwordx4 v[108:111], v1, s[40:43], s62 offen offset:3072 nt
    s_add_u32 s62, s62, 4096
    buffer_load_dwordx4 v[112:115], v1, s[40:43], s62 offen offset:0 nt
    buffer_load_dwordx4 v[116:119], v1, s[40:43], s62 offen offset:1024 nt
    s_add_u32 s62, s62, 2048
    buffer_load_dwordx4 v[120:123], v1, s[40:43], s62 offen offset:0 nt
    buffer_load_dwordx4 v[124:127], v1, s[40:43], s62 offen offset:1024 nt
    buffer_load_dwordx4 v[128:131], v1, s[40:43], s62 offen offset:2048 nt
    buffer_load_dwordx4 v[132:135], v1, s[40:43], s62 offen offset:3072 nt
    s_add_u32 s62, s62, 4096
    buffer_load_dwordx4 v[136:139], v1, s[40:43], s62 offen offset:0 nt
    buffer_load_dwordx4 v[140:143], v1, s[40:43], s62 offen offset:1024 nt
    buffer_load_dwordx4 v[144:147], v1, s[40:43], s62 offen offset:2048 nt
    buffer_load_dwordx4 v[148:151], v1, s[40:43], s62 offen offset:3072 nt
    s_add_u32 s62, s62, 4096
    buffer_load_dwordx4 v[152:155], v1, s[40:43], s62 offen offset:0 nt
    buffer_load_dwordx4 v[156:159], v1, s[40:43], s62 offen offset:1024 nt
    buffer_load_dwordx4 v[160:163], v1, s[40:43], s62 offen offset:2048 nt
    buffer_load_dwordx4 v[164:167], v1, s[40:43], s62 offen offset:3072 nt
    s_add_u32 s62, s62, 4096
    buffer_load_dwordx4 v[168:171], v1, s[40:43], s62 offen offset:0 nt
    buffer_load_dwordx4 v[172:175], v1, s[40:43], s62 offen offset:1024 nt
    s_add_u32 s62, s62, 2048
    buffer_load_dwordx4 v[176:179], v1, s[40:43], s62 offen offset:0 nt
    buffer_load_dwordx4 v[180:183], v1, s[40:43], s62 offen offset:1024 nt
    buffer_load_dwordx4 v[184:187], v1, s[40:43], s62 offen offset:2048 nt
    buffer_load_dwordx4 v[188:191], v1, s[40:43], s62 offen offset:3072 nt
    s_add_u32 s62, s62, 4096
    buffer_load_dwordx4 v[192:195], v1, s[40:43], s62 offen offset:0 nt
    buffer_load_dwordx4 v[196:199], v1, s[40:43], s62 offen offset:1024 nt
    buffer_load_dwordx4 v[200:203], v1, s[40:43], s62 offen offset:2048 nt
    buffer_load_dwordx4 v[204:207], v1, s[40:43], s62 offen offset:3072 nt
    s_add_u32 s62, s62, 4096
    buffer_load_dwordx4 v[208:211], v1, s[40:43], s62 offen offset:0 nt
    buffer_load_dwordx4 v[212:215], v1, s[40:43], s62 offen offset:1024 nt
    buffer_load_dwordx4 v[216:219], v1, s[40:43], s62 offen offset:2048 nt
    buffer_load_dwordx4 v[220:223], v1, s[40:43], s62 offen offset:3072 nt
    s_add_u32 s62, s62, 4096
    buffer_load_dwordx4 v[224:227], v1, s[40:43], s62 offen offset:0 nt
    buffer_load_dwordx4 v[228:231], v1, s[40:43], s62 offen offset:1024 nt
    s_add_u32 s62, s62, 2048
    s_waitcnt lgkmcnt(0)
    s_barrier
    s_mul_i32 s96, s54, 112
    v_mov_b32_e64 v28, s96
    ds_read_b128 v[32:35], v28 offset:0
    ds_read_b128 v[36:39], v28 offset:16
    ds_read_b128 v[40:43], v28 offset:32
    ds_read_b128 v[44:47], v28 offset:48
    ds_read_b128 v[48:51], v28 offset:64
    ds_read_b128 v[52:55], v28 offset:80
    ds_read_b128 v[56:59], v28 offset:96
    v_mov_b32 v8, 0
    v_mov_b32 v9, 0
    v_mov_b32 v10, 0
    v_mov_b32 v11, 0
    v_mov_b32 v12, 0
    v_mov_b32 v13, 0
    v_mov_b32 v14, 0
    v_mov_b32 v15, 0
    v_mov_b32 v16, 0
    v_mov_b32 v17, 0
    v_mov_b32 v18, 0
    v_mov_b32 v19, 0
    v_mov_b32 v20, 0
    v_mov_b32 v21, 0
    v_mov_b32 v22, 0
    v_mov_b32 v23, 0
    s_waitcnt lgkmcnt(0)
    s_waitcnt vmcnt(40)
    v_lshlrev_b32 v5, 16, v64
    v_and_b32 v6, 0xffff0000, v64
    v_fmac_f32 v8, v5, v32
    v_fmac_f32 v9, v6, v32
    v_lshlrev_b32 v5, 16, v65
    v_and_b32 v6, 0xffff0000, v65
    v_fmac_f32 v10, v5, v32
    v_fmac_f32 v11, v6, v32
    v_lshlrev_b32 v5, 16, v66
    v_and_b32 v6, 0xffff0000, v66
    v_fmac_f32 v12, v5, v32
    v_fmac_f32 v13, v6, v32
    v_lshlrev_b32 v5, 16, v67
    v_and_b32 v6, 0xffff0000, v67
    v_fmac_f32 v14, v5, v32
    v_fmac_f32 v15, v6, v32
    v_lshlrev_b32_e64 v5, 16, v68
    v_and_b32 v6, 0xffff0000, v68
    v_fmac_f32 v16, v5, v32
    v_fmac_f32 v17, v6, v32
    v_lshlrev_b32 v5, 16, v69
    v_and_b32 v6, 0xffff0000, v69
    v_fmac_f32 v18, v5, v32
    v_fmac_f32 v19, v6, v32
    v_lshlrev_b32 v5, 16, v70
    v_and_b32 v6, 0xffff0000, v70
    v_fmac_f32 v20, v5, v32
    v_fmac_f32 v21, v6, v32
    v_lshlrev_b32_e64 v5, 16, v71
    v_and_b32 v6, 0xffff0000, v71
    v_fmac_f32 v22, v5, v32
    v_fmac_f32 v23, v6, v32
    s_waitcnt vmcnt(38)
    v_lshlrev_b32 v5, 16, v72
    v_and_b32 v6, 0xffff0000, v72
    v_fmac_f32 v8, v5, v33
    v_fmac_f32 v9, v6, v33
    v_lshlrev_b32 v5, 16, v73
    v_and_b32 v6, 0xffff0000, v73
    v_fmac_f32 v10, v5, v33
    v_fmac_f32 v11, v6, v33
    v_lshlrev_b32 v5, 16, v74
    v_and_b32 v6, 0xffff0000, v74
    v_fmac_f32 v12, v5, v33
    v_fmac_f32 v13, v6, v33
    v_lshlrev_b32 v5, 16, v75
    v_and_b32 v6, 0xffff0000, v75
    v_fmac_f32 v14, v5, v33
    v_fmac_f32 v15, v6, v33
    v_lshlrev_b32 v5, 16, v76
    v_and_b32 v6, 0xffff0000, v76
    v_fmac_f32 v16, v5, v33
    v_fmac_f32 v17, v6, v33
    v_lshlrev_b32_e64 v5, 16, v77
    v_and_b32 v6, 0xffff0000, v77
    v_fmac_f32 v18, v5, v33
    v_fmac_f32 v19, v6, v33
    v_lshlrev_b32 v5, 16, v78
    v_and_b32 v6, 0xffff0000, v78
    v_fmac_f32 v20, v5, v33
    v_fmac_f32 v21, v6, v33
    v_lshlrev_b32 v5, 16, v79
    v_and_b32 v6, 0xffff0000, v79
    v_fmac_f32 v22, v5, v33
    v_fmac_f32 v23, v6, v33
    s_waitcnt vmcnt(36)
    v_lshlrev_b32 v5, 16, v80
    v_and_b32 v6, 0xffff0000, v80
    v_fmac_f32 v8, v5, v34
    v_fmac_f32 v9, v6, v34
    v_lshlrev_b32 v5, 16, v81
    v_and_b32 v6, 0xffff0000, v81
    v_fmac_f32 v10, v5, v34
    v_fmac_f32 v11, v6, v34
    v_lshlrev_b32 v5, 16, v82
    v_and_b32 v6, 0xffff0000, v82
    v_fmac_f32 v12, v5, v34
    v_fmac_f32 v13, v6, v34
    v_lshlrev_b32_e64 v5, 16, v83
    v_and_b32 v6, 0xffff0000, v83
    v_fmac_f32 v14, v5, v34
    v_fmac_f32 v15, v6, v34
    v_lshlrev_b32 v5, 16, v84
    v_and_b32 v6, 0xffff0000, v84
    v_fmac_f32 v16, v5, v34
    v_fmac_f32 v17, v6, v34
    v_lshlrev_b32 v5, 16, v85
    v_and_b32 v6, 0xffff0000, v85
    v_fmac_f32 v18, v5, v34
    v_fmac_f32 v19, v6, v34
    v_lshlrev_b32_e64 v5, 16, v86
    v_and_b32 v6, 0xffff0000, v86
    v_fmac_f32 v20, v5, v34
    v_fmac_f32 v21, v6, v34
    v_lshlrev_b32 v5, 16, v87
    v_and_b32 v6, 0xffff0000, v87
    v_fmac_f32 v22, v5, v34
    v_fmac_f32 v23, v6, v34
    s_waitcnt vmcnt(34)
    v_lshlrev_b32 v5, 16, v88
    v_and_b32 v6, 0xffff0000, v88
    v_fmac_f32 v8, v5, v35
    v_fmac_f32 v9, v6, v35
    v_lshlrev_b32 v5, 16, v89
    v_and_b32 v6, 0xffff0000, v89
    v_fmac_f32 v10, v5, v35
    v_fmac_f32 v11, v6, v35
    v_lshlrev_b32 v5, 16, v90
    v_and_b32 v6, 0xffff0000, v90
    v_fmac_f32 v12, v5, v35
    v_fmac_f32 v13, v6, v35
    v_lshlrev_b32 v5, 16, v91
    v_and_b32 v6, 0xffff0000, v91
    v_fmac_f32 v14, v5, v35
    v_fmac_f32 v15, v6, v35
    v_lshlrev_b32_e64 v5, 16, v92
    v_and_b32 v6, 0xffff0000, v92
    v_fmac_f32 v16, v5, v35
    v_fmac_f32 v17, v6, v35
    v_lshlrev_b32 v5, 16, v93
    v_and_b32 v6, 0xffff0000, v93
    v_fmac_f32 v18, v5, v35
    v_fmac_f32 v19, v6, v35
    v_lshlrev_b32 v5, 16, v94
    v_and_b32 v6, 0xffff0000, v94
    v_fmac_f32 v20, v5, v35
    v_fmac_f32 v21, v6, v35
    v_lshlrev_b32_e64 v5, 16, v95
    v_and_b32 v6, 0xffff0000, v95
    v_fmac_f32 v22, v5, v35
    v_fmac_f32 v23, v6, v35
    s_waitcnt vmcnt(32)
    v_lshlrev_b32 v5, 16, v96
    v_and_b32 v6, 0xffff0000, v96
    v_fmac_f32 v8, v5, v36
    v_fmac_f32 v9, v6, v36
    v_lshlrev_b32 v5, 16, v97
    v_and_b32 v6, 0xffff0000, v97
    v_fmac_f32 v10, v5, v36
    v_fmac_f32 v11, v6, v36
    v_lshlrev_b32 v5, 16, v98
    v_and_b32 v6, 0xffff0000, v98
    v_fmac_f32 v12, v5, v36
    v_fmac_f32 v13, v6, v36
    v_lshlrev_b32 v5, 16, v99
    v_and_b32 v6, 0xffff0000, v99
    v_fmac_f32 v14, v5, v36
    v_fmac_f32 v15, v6, v36
    v_lshlrev_b32 v5, 16, v100
    v_and_b32 v6, 0xffff0000, v100
    v_fmac_f32 v16, v5, v36
    v_fmac_f32 v17, v6, v36
    v_lshlrev_b32_e64 v5, 16, v101
    v_and_b32 v6, 0xffff0000, v101
    v_fmac_f32 v18, v5, v36
    v_fmac_f32 v19, v6, v36
    v_lshlrev_b32 v5, 16, v102
    v_and_b32 v6, 0xffff0000, v102
    v_fmac_f32 v20, v5, v36
    v_fmac_f32 v21, v6, v36
    v_lshlrev_b32 v5, 16, v103
    v_and_b32 v6, 0xffff0000, v103
    v_fmac_f32 v22, v5, v36
    v_fmac_f32 v23, v6, v36
    s_waitcnt vmcnt(30)
    v_lshlrev_b32 v5, 16, v104
    v_and_b32 v6, 0xffff0000, v104
    v_fmac_f32 v8, v5, v37
    v_fmac_f32 v9, v6, v37
    v_lshlrev_b32 v5, 16, v105
    v_and_b32 v6, 0xffff0000, v105
    v_fmac_f32 v10, v5, v37
    v_fmac_f32 v11, v6, v37
    v_lshlrev_b32 v5, 16, v106
    v_and_b32 v6, 0xffff0000, v106
    v_fmac_f32 v12, v5, v37
    v_fmac_f32 v13, v6, v37
    v_lshlrev_b32_e64 v5, 16, v107
    v_and_b32 v6, 0xffff0000, v107
    v_fmac_f32 v14, v5, v37
    v_fmac_f32 v15, v6, v37
    v_lshlrev_b32 v5, 16, v108
    v_and_b32 v6, 0xffff0000, v108
    v_fmac_f32 v16, v5, v37
    v_fmac_f32 v17, v6, v37
    v_lshlrev_b32 v5, 16, v109
    v_and_b32 v6, 0xffff0000, v109
    v_fmac_f32 v18, v5, v37
    v_fmac_f32 v19, v6, v37
    v_lshlrev_b32_e64 v5, 16, v110
    v_and_b32 v6, 0xffff0000, v110
    v_fmac_f32 v20, v5, v37
    v_fmac_f32 v21, v6, v37
    v_lshlrev_b32 v5, 16, v111
    v_and_b32 v6, 0xffff0000, v111
    v_fmac_f32 v22, v5, v37
    v_fmac_f32 v23, v6, v37
    s_waitcnt vmcnt(28)
    v_lshlrev_b32 v5, 16, v112
    v_and_b32 v6, 0xffff0000, v112
    v_fmac_f32 v8, v5, v38
    v_fmac_f32 v9, v6, v38
    v_lshlrev_b32 v5, 16, v113
    v_and_b32 v6, 0xffff0000, v113
    v_fmac_f32 v10, v5, v38
    v_fmac_f32 v11, v6, v38
    v_lshlrev_b32 v5, 16, v114
    v_and_b32 v6, 0xffff0000, v114
    v_fmac_f32 v12, v5, v38
    v_fmac_f32 v13, v6, v38
    v_lshlrev_b32 v5, 16, v115
    v_and_b32 v6, 0xffff0000, v115
    v_fmac_f32 v14, v5, v38
    v_fmac_f32 v15, v6, v38
    v_lshlrev_b32_e64 v5, 16, v116
    v_and_b32 v6, 0xffff0000, v116
    v_fmac_f32 v16, v5, v38
    v_fmac_f32 v17, v6, v38
    v_lshlrev_b32 v5, 16, v117
    v_and_b32 v6, 0xffff0000, v117
    v_fmac_f32 v18, v5, v38
    v_fmac_f32 v19, v6, v38
    v_lshlrev_b32 v5, 16, v118
    v_and_b32 v6, 0xffff0000, v118
    v_fmac_f32 v20, v5, v38
    v_fmac_f32 v21, v6, v38
    v_lshlrev_b32_e64 v5, 16, v119
    v_and_b32 v6, 0xffff0000, v119
    v_fmac_f32 v22, v5, v38
    v_fmac_f32 v23, v6, v38
    buffer_load_dwordx4 v[64:67], v1, s[40:43], s62 offen offset:0 nt
    buffer_load_dwordx4 v[68:71], v1, s[40:43], s62 offen offset:1024 nt
    buffer_load_dwordx4 v[72:75], v1, s[40:43], s62 offen offset:2048 nt
    buffer_load_dwordx4 v[76:79], v1, s[40:43], s62 offen offset:3072 nt
    s_add_u32 s62, s62, 4096
    buffer_load_dwordx4 v[80:83], v1, s[40:43], s62 offen offset:0 nt
    buffer_load_dwordx4 v[84:87], v1, s[40:43], s62 offen offset:1024 nt
    buffer_load_dwordx4 v[88:91], v1, s[40:43], s62 offen offset:2048 nt
    buffer_load_dwordx4 v[92:95], v1, s[40:43], s62 offen offset:3072 nt
    s_add_u32 s62, s62, 4096
    buffer_load_dwordx4 v[96:99], v1, s[40:43], s62 offen offset:0 nt
    buffer_load_dwordx4 v[100:103], v1, s[40:43], s62 offen offset:1024 nt
    buffer_load_dwordx4 v[104:107], v1, s[40:43], s62 offen offset:2048 nt
    buffer_load_dwordx4 v[108:111], v1, s[40:43], s62 offen offset:3072 nt
    s_add_u32 s62, s62, 4096
    buffer_load_dwordx4 v[112:115], v1, s[40:43], s62 offen offset:0 nt
    buffer_load_dwordx4 v[116:119], v1, s[40:43], s62 offen offset:1024 nt
    s_add_u32 s62, s62, 2048
    s_waitcnt vmcnt(40)
    v_lshlrev_b32 v5, 16, v120
    v_and_b32 v6, 0xffff0000, v120
    v_fmac_f32 v8, v5, v39
    v_fmac_f32 v9, v6, v39
    v_lshlrev_b32_e64 v5, 16, v121
    v_and_b32 v6, 0xffff0000, v121
    v_fmac_f32 v10, v5, v39
    v_fmac_f32 v11, v6, v39
    v_lshlrev_b32 v5, 16, v122
    v_and_b32 v6, 0xffff0000, v122
    v_fmac_f32 v12, v5, v39
    v_fmac_f32 v13, v6, v39
    v_lshlrev_b32 v5, 16, v123
    v_and_b32 v6, 0xffff0000, v123
    v_fmac_f32 v14, v5, v39
    v_fmac_f32 v15, v6, v39
    v_lshlrev_b32_e64 v5, 16, v124
    v_and_b32 v6, 0xffff0000, v124
    v_fmac_f32 v16, v5, v39
    v_fmac_f32 v17, v6, v39
    v_lshlrev_b32 v5, 16, v125
    v_and_b32 v6, 0xffff0000, v125
    v_fmac_f32 v18, v5, v39
    v_fmac_f32 v19, v6, v39
    v_lshlrev_b32 v5, 16, v126
    v_and_b32 v6, 0xffff0000, v126
    v_fmac_f32 v20, v5, v39
    v_fmac_f32 v21, v6, v39
    v_lshlrev_b32_e64 v5, 16, v127
    v_and_b32 v6, 0xffff0000, v127
    v_fmac_f32 v22, v5, v39
    v_fmac_f32 v23, v6, v39
    s_waitcnt vmcnt(38)
    v_lshlrev_b32 v5, 16, v128
    v_and_b32 v6, 0xffff0000, v128
    v_fmac_f32 v8, v5, v40
    v_fmac_f32 v9, v6, v40
    v_lshlrev_b32 v5, 16, v129
    v_and_b32 v6, 0xffff0000, v129
    v_fmac_f32 v10, v5, v40
    v_fmac_f32 v11, v6, v40
    v_lshlrev_b32 v5, 16, v130
    v_and_b32 v6, 0xffff0000, v130
    v_fmac_f32 v12, v5, v40
    v_fmac_f32 v13, v6, v40
    v_lshlrev_b32 v5, 16, v131
    v_and_b32 v6, 0xffff0000, v131
    v_fmac_f32 v14, v5, v40
    v_fmac_f32 v15, v6, v40
    v_lshlrev_b32 v5, 16, v132
    v_and_b32 v6, 0xffff0000, v132
    v_fmac_f32 v16, v5, v40
    v_fmac_f32 v17, v6, v40
    v_lshlrev_b32_e64 v5, 16, v133
    v_and_b32 v6, 0xffff0000, v133
    v_fmac_f32 v18, v5, v40
    v_fmac_f32 v19, v6, v40
    v_lshlrev_b32 v5, 16, v134
    v_and_b32 v6, 0xffff0000, v134
    v_fmac_f32 v20, v5, v40
    v_fmac_f32 v21, v6, v40
    v_lshlrev_b32 v5, 16, v135
    v_and_b32 v6, 0xffff0000, v135
    v_fmac_f32 v22, v5, v40
    v_fmac_f32 v23, v6, v40
    s_waitcnt vmcnt(36)
    v_lshlrev_b32 v5, 16, v136
    v_and_b32 v6, 0xffff0000, v136
    v_fmac_f32 v8, v5, v41
    v_fmac_f32 v9, v6, v41
    v_lshlrev_b32 v5, 16, v137
    v_and_b32 v6, 0xffff0000, v137
    v_fmac_f32 v10, v5, v41
    v_fmac_f32 v11, v6, v41
    v_lshlrev_b32 v5, 16, v138
    v_and_b32 v6, 0xffff0000, v138
    v_fmac_f32 v12, v5, v41
    v_fmac_f32 v13, v6, v41
    v_lshlrev_b32_e64 v5, 16, v139
    v_and_b32 v6, 0xffff0000, v139
    v_fmac_f32 v14, v5, v41
    v_fmac_f32 v15, v6, v41
    v_lshlrev_b32 v5, 16, v140
    v_and_b32 v6, 0xffff0000, v140
    v_fmac_f32 v16, v5, v41
    v_fmac_f32 v17, v6, v41
    v_lshlrev_b32 v5, 16, v141
    v_and_b32 v6, 0xffff0000, v141
    v_fmac_f32 v18, v5, v41
    v_fmac_f32 v19, v6, v41
    v_lshlrev_b32_e64 v5, 16, v142
    v_and_b32 v6, 0xffff0000, v142
    v_fmac_f32 v20, v5, v41
    v_fmac_f32 v21, v6, v41
    v_lshlrev_b32 v5, 16, v143
    v_and_b32 v6, 0xffff0000, v143
    v_fmac_f32 v22, v5, v41
    v_fmac_f32 v23, v6, v41
    s_waitcnt vmcnt(34)
    v_lshlrev_b32 v5, 16, v144
    v_and_b32 v6, 0xffff0000, v144
    v_fmac_f32 v8, v5, v42
    v_fmac_f32 v9, v6, v42
    v_lshlrev_b32 v5, 16, v145
    v_and_b32 v6, 0xffff0000, v145
    v_fmac_f32 v10, v5, v42
    v_fmac_f32 v11, v6, v42
    v_lshlrev_b32 v5, 16, v146
    v_and_b32 v6, 0xffff0000, v146
    v_fmac_f32 v12, v5, v42
    v_fmac_f32 v13, v6, v42
    v_lshlrev_b32 v5, 16, v147
    v_and_b32 v6, 0xffff0000, v147
    v_fmac_f32 v14, v5, v42
    v_fmac_f32 v15, v6, v42
    v_lshlrev_b32_e64 v5, 16, v148
    v_and_b32 v6, 0xffff0000, v148
    v_fmac_f32 v16, v5, v42
    v_fmac_f32 v17, v6, v42
    v_lshlrev_b32 v5, 16, v149
    v_and_b32 v6, 0xffff0000, v149
    v_fmac_f32 v18, v5, v42
    v_fmac_f32 v19, v6, v42
    v_lshlrev_b32 v5, 16, v150
    v_and_b32 v6, 0xffff0000, v150
    v_fmac_f32 v20, v5, v42
    v_fmac_f32 v21, v6, v42
    v_lshlrev_b32_e64 v5, 16, v151
    v_and_b32 v6, 0xffff0000, v151
    v_fmac_f32 v22, v5, v42
    v_fmac_f32 v23, v6, v42
    s_waitcnt vmcnt(32)
    v_lshlrev_b32 v5, 16, v152
    v_and_b32 v6, 0xffff0000, v152
    v_fmac_f32 v8, v5, v43
    v_fmac_f32 v9, v6, v43
    v_lshlrev_b32 v5, 16, v153
    v_and_b32 v6, 0xffff0000, v153
    v_fmac_f32 v10, v5, v43
    v_fmac_f32 v11, v6, v43
    v_lshlrev_b32 v5, 16, v154
    v_and_b32 v6, 0xffff0000, v154
    v_fmac_f32 v12, v5, v43
    v_fmac_f32 v13, v6, v43
    v_lshlrev_b32 v5, 16, v155
    v_and_b32 v6, 0xffff0000, v155
    v_fmac_f32 v14, v5, v43
    v_fmac_f32 v15, v6, v43
    v_lshlrev_b32 v5, 16, v156
    v_and_b32 v6, 0xffff0000, v156
    v_fmac_f32 v16, v5, v43
    v_fmac_f32 v17, v6, v43
    v_lshlrev_b32_e64 v5, 16, v157
    v_and_b32 v6, 0xffff0000, v157
    v_fmac_f32 v18, v5, v43
    v_fmac_f32 v19, v6, v43
    v_lshlrev_b32 v5, 16, v158
    v_and_b32 v6, 0xffff0000, v158
    v_fmac_f32 v20, v5, v43
    v_fmac_f32 v21, v6, v43
    v_lshlrev_b32 v5, 16, v159
    v_and_b32 v6, 0xffff0000, v159
    v_fmac_f32 v22, v5, v43
    v_fmac_f32 v23, v6, v43
    s_waitcnt vmcnt(30)
    v_lshlrev_b32 v5, 16, v160
    v_and_b32 v6, 0xffff0000, v160
    v_fmac_f32 v8, v5, v44
    v_fmac_f32 v9, v6, v44
    v_lshlrev_b32 v5, 16, v161
    v_and_b32 v6, 0xffff0000, v161
    v_fmac_f32 v10, v5, v44
    v_fmac_f32 v11, v6, v44
    v_lshlrev_b32 v5, 16, v162
    v_and_b32 v6, 0xffff0000, v162
    v_fmac_f32 v12, v5, v44
    v_fmac_f32 v13, v6, v44
    v_lshlrev_b32_e64 v5, 16, v163
    v_and_b32 v6, 0xffff0000, v163
    v_fmac_f32 v14, v5, v44
    v_fmac_f32 v15, v6, v44
    v_lshlrev_b32 v5, 16, v164
    v_and_b32 v6, 0xffff0000, v164
    v_fmac_f32 v16, v5, v44
    v_fmac_f32 v17, v6, v44
    v_lshlrev_b32 v5, 16, v165
    v_and_b32 v6, 0xffff0000, v165
    v_fmac_f32 v18, v5, v44
    v_fmac_f32 v19, v6, v44
    v_lshlrev_b32_e64 v5, 16, v166
    v_and_b32 v6, 0xffff0000, v166
    v_fmac_f32 v20, v5, v44
    v_fmac_f32 v21, v6, v44
    v_lshlrev_b32 v5, 16, v167
    v_and_b32 v6, 0xffff0000, v167
    v_fmac_f32 v22, v5, v44
    v_fmac_f32 v23, v6, v44
    s_waitcnt vmcnt(28)
    v_lshlrev_b32 v5, 16, v168
    v_and_b32 v6, 0xffff0000, v168
    v_fmac_f32 v8, v5, v45
    v_fmac_f32 v9, v6, v45
    v_lshlrev_b32 v5, 16, v169
    v_and_b32 v6, 0xffff0000, v169
    v_fmac_f32 v10, v5, v45
    v_fmac_f32 v11, v6, v45
    v_lshlrev_b32 v5, 16, v170
    v_and_b32 v6, 0xffff0000, v170
    v_fmac_f32 v12, v5, v45
    v_fmac_f32 v13, v6, v45
    v_lshlrev_b32 v5, 16, v171
    v_and_b32 v6, 0xffff0000, v171
    v_fmac_f32 v14, v5, v45
    v_fmac_f32 v15, v6, v45
    v_lshlrev_b32_e64 v5, 16, v172
    v_and_b32 v6, 0xffff0000, v172
    v_fmac_f32 v16, v5, v45
    v_fmac_f32 v17, v6, v45
    v_lshlrev_b32 v5, 16, v173
    v_and_b32 v6, 0xffff0000, v173
    v_fmac_f32 v18, v5, v45
    v_fmac_f32 v19, v6, v45
    v_lshlrev_b32 v5, 16, v174
    v_and_b32 v6, 0xffff0000, v174
    v_fmac_f32 v20, v5, v45
    v_fmac_f32 v21, v6, v45
    v_lshlrev_b32_e64 v5, 16, v175
    v_and_b32 v6, 0xffff0000, v175
    v_fmac_f32 v22, v5, v45
    v_fmac_f32 v23, v6, v45
    s_waitcnt vmcnt(26)
    v_lshlrev_b32 v5, 16, v176
    v_and_b32 v6, 0xffff0000, v176
    v_fmac_f32 v8, v5, v46
    v_fmac_f32 v9, v6, v46
    v_lshlrev_b32 v5, 16, v177
    v_and_b32 v6, 0xffff0000, v177
    v_fmac_f32 v10, v5, v46
    v_fmac_f32 v11, v6, v46
    v_lshlrev_b32 v5, 16, v178
    v_and_b32 v6, 0xffff0000, v178
    v_fmac_f32 v12, v5, v46
    v_fmac_f32 v13, v6, v46
    v_lshlrev_b32 v5, 16, v179
    v_and_b32 v6, 0xffff0000, v179
    v_fmac_f32 v14, v5, v46
    v_fmac_f32 v15, v6, v46
    v_lshlrev_b32 v5, 16, v180
    v_and_b32 v6, 0xffff0000, v180
    v_fmac_f32 v16, v5, v46
    v_fmac_f32 v17, v6, v46
    v_lshlrev_b32_e64 v5, 16, v181
    v_and_b32 v6, 0xffff0000, v181
    v_fmac_f32 v18, v5, v46
    v_fmac_f32 v19, v6, v46
    v_lshlrev_b32 v5, 16, v182
    v_and_b32 v6, 0xffff0000, v182
    v_fmac_f32 v20, v5, v46
    v_fmac_f32 v21, v6, v46
    v_lshlrev_b32 v5, 16, v183
    v_and_b32 v6, 0xffff0000, v183
    v_fmac_f32 v22, v5, v46
    v_fmac_f32 v23, v6, v46
    s_waitcnt vmcnt(24)
    v_lshlrev_b32 v5, 16, v184
    v_and_b32 v6, 0xffff0000, v184
    v_fmac_f32 v8, v5, v47
    v_fmac_f32 v9, v6, v47
    v_lshlrev_b32 v5, 16, v185
    v_and_b32 v6, 0xffff0000, v185
    v_fmac_f32 v10, v5, v47
    v_fmac_f32 v11, v6, v47
    v_lshlrev_b32 v5, 16, v186
    v_and_b32 v6, 0xffff0000, v186
    v_fmac_f32 v12, v5, v47
    v_fmac_f32 v13, v6, v47
    v_lshlrev_b32_e64 v5, 16, v187
    v_and_b32 v6, 0xffff0000, v187
    v_fmac_f32 v14, v5, v47
    v_fmac_f32 v15, v6, v47
    v_lshlrev_b32 v5, 16, v188
    v_and_b32 v6, 0xffff0000, v188
    v_fmac_f32 v16, v5, v47
    v_fmac_f32 v17, v6, v47
    v_lshlrev_b32 v5, 16, v189
    v_and_b32 v6, 0xffff0000, v189
    v_fmac_f32 v18, v5, v47
    v_fmac_f32 v19, v6, v47
    v_lshlrev_b32_e64 v5, 16, v190
    v_and_b32 v6, 0xffff0000, v190
    v_fmac_f32 v20, v5, v47
    v_fmac_f32 v21, v6, v47
    v_lshlrev_b32 v5, 16, v191
    v_and_b32 v6, 0xffff0000, v191
    v_fmac_f32 v22, v5, v47
    v_fmac_f32 v23, v6, v47
    s_waitcnt vmcnt(22)
    v_lshlrev_b32 v5, 16, v192
    v_and_b32 v6, 0xffff0000, v192
    v_fmac_f32 v8, v5, v48
    v_fmac_f32 v9, v6, v48
    v_lshlrev_b32 v5, 16, v193
    v_and_b32 v6, 0xffff0000, v193
    v_fmac_f32 v10, v5, v48
    v_fmac_f32 v11, v6, v48
    v_lshlrev_b32 v5, 16, v194
    v_and_b32 v6, 0xffff0000, v194
    v_fmac_f32 v12, v5, v48
    v_fmac_f32 v13, v6, v48
    v_lshlrev_b32 v5, 16, v195
    v_and_b32 v6, 0xffff0000, v195
    v_fmac_f32 v14, v5, v48
    v_fmac_f32 v15, v6, v48
    v_lshlrev_b32_e64 v5, 16, v196
    v_and_b32 v6, 0xffff0000, v196
    v_fmac_f32 v16, v5, v48
    v_fmac_f32 v17, v6, v48
    v_lshlrev_b32 v5, 16, v197
    v_and_b32 v6, 0xffff0000, v197
    v_fmac_f32 v18, v5, v48
    v_fmac_f32 v19, v6, v48
    v_lshlrev_b32 v5, 16, v198
    v_and_b32 v6, 0xffff0000, v198
    v_fmac_f32 v20, v5, v48
    v_fmac_f32 v21, v6, v48
    v_lshlrev_b32_e64 v5, 16, v199
    v_and_b32 v6, 0xffff0000, v199
    v_fmac_f32 v22, v5, v48
    v_fmac_f32 v23, v6, v48
    s_waitcnt vmcnt(20)
    v_lshlrev_b32 v5, 16, v200
    v_and_b32 v6, 0xffff0000, v200
    v_fmac_f32 v8, v5, v49
    v_fmac_f32 v9, v6, v49
    v_lshlrev_b32 v5, 16, v201
    v_and_b32 v6, 0xffff0000, v201
    v_fmac_f32 v10, v5, v49
    v_fmac_f32 v11, v6, v49
    v_lshlrev_b32 v5, 16, v202
    v_and_b32 v6, 0xffff0000, v202
    v_fmac_f32 v12, v5, v49
    v_fmac_f32 v13, v6, v49
    v_lshlrev_b32 v5, 16, v203
    v_and_b32 v6, 0xffff0000, v203
    v_fmac_f32 v14, v5, v49
    v_fmac_f32 v15, v6, v49
    v_lshlrev_b32 v5, 16, v204
    v_and_b32 v6, 0xffff0000, v204
    v_fmac_f32 v16, v5, v49
    v_fmac_f32 v17, v6, v49
    v_lshlrev_b32_e64 v5, 16, v205
    v_and_b32 v6, 0xffff0000, v205
    v_fmac_f32 v18, v5, v49
    v_fmac_f32 v19, v6, v49
    v_lshlrev_b32 v5, 16, v206
    v_and_b32 v6, 0xffff0000, v206
    v_fmac_f32 v20, v5, v49
    v_fmac_f32 v21, v6, v49
    v_lshlrev_b32 v5, 16, v207
    v_and_b32 v6, 0xffff0000, v207
    v_fmac_f32 v22, v5, v49
    v_fmac_f32 v23, v6, v49
    s_waitcnt vmcnt(18)
    v_lshlrev_b32 v5, 16, v208
    v_and_b32 v6, 0xffff0000, v208
    v_fmac_f32 v8, v5, v50
    v_fmac_f32 v9, v6, v50
    v_lshlrev_b32 v5, 16, v209
    v_and_b32 v6, 0xffff0000, v209
    v_fmac_f32 v10, v5, v50
    v_fmac_f32 v11, v6, v50
    v_lshlrev_b32 v5, 16, v210
    v_and_b32 v6, 0xffff0000, v210
    v_fmac_f32 v12, v5, v50
    v_fmac_f32 v13, v6, v50
    v_lshlrev_b32_e64 v5, 16, v211
    v_and_b32 v6, 0xffff0000, v211
    v_fmac_f32 v14, v5, v50
    v_fmac_f32 v15, v6, v50
    v_lshlrev_b32 v5, 16, v212
    v_and_b32 v6, 0xffff0000, v212
    v_fmac_f32 v16, v5, v50
    v_fmac_f32 v17, v6, v50
    v_lshlrev_b32 v5, 16, v213
    v_and_b32 v6, 0xffff0000, v213
    v_fmac_f32 v18, v5, v50
    v_fmac_f32 v19, v6, v50
    v_lshlrev_b32_e64 v5, 16, v214
    v_and_b32 v6, 0xffff0000, v214
    v_fmac_f32 v20, v5, v50
    v_fmac_f32 v21, v6, v50
    v_lshlrev_b32 v5, 16, v215
    v_and_b32 v6, 0xffff0000, v215
    v_fmac_f32 v22, v5, v50
    v_fmac_f32 v23, v6, v50
    s_waitcnt vmcnt(16)
    v_lshlrev_b32 v5, 16, v216
    v_and_b32 v6, 0xffff0000, v216
    v_fmac_f32 v8, v5, v51
    v_fmac_f32 v9, v6, v51
    v_lshlrev_b32 v5, 16, v217
    v_and_b32 v6, 0xffff0000, v217
    v_fmac_f32 v10, v5, v51
    v_fmac_f32 v11, v6, v51
    v_lshlrev_b32 v5, 16, v218
    v_and_b32 v6, 0xffff0000, v218
    v_fmac_f32 v12, v5, v51
    v_fmac_f32 v13, v6, v51
    v_lshlrev_b32 v5, 16, v219
    v_and_b32 v6, 0xffff0000, v219
    v_fmac_f32 v14, v5, v51
    v_fmac_f32 v15, v6, v51
    v_lshlrev_b32_e64 v5, 16, v220
    v_and_b32 v6, 0xffff0000, v220
    v_fmac_f32 v16, v5, v51
    v_fmac_f32 v17, v6, v51
    v_lshlrev_b32 v5, 16, v221
    v_and_b32 v6, 0xffff0000, v221
    v_fmac_f32 v18, v5, v51
    v_fmac_f32 v19, v6, v51
    v_lshlrev_b32 v5, 16, v222
    v_and_b32 v6, 0xffff0000, v222
    v_fmac_f32 v20, v5, v51
    v_fmac_f32 v21, v6, v51
    v_lshlrev_b32_e64 v5, 16, v223
    v_and_b32 v6, 0xffff0000, v223
    v_fmac_f32 v22, v5, v51
    v_fmac_f32 v23, v6, v51
    s_waitcnt vmcnt(14)
    v_lshlrev_b32 v5, 16, v224
    v_and_b32 v6, 0xffff0000, v224
    v_fmac_f32 v8, v5, v52
    v_fmac_f32 v9, v6, v52
    v_lshlrev_b32 v5, 16, v225
    v_and_b32 v6, 0xffff0000, v225
    v_fmac_f32 v10, v5, v52
    v_fmac_f32 v11, v6, v52
    v_lshlrev_b32 v5, 16, v226
    v_and_b32 v6, 0xffff0000, v226
    v_fmac_f32 v12, v5, v52
    v_fmac_f32 v13, v6, v52
    v_lshlrev_b32 v5, 16, v227
    v_and_b32 v6, 0xffff0000, v227
    v_fmac_f32 v14, v5, v52
    v_fmac_f32 v15, v6, v52
    v_lshlrev_b32 v5, 16, v228
    v_and_b32 v6, 0xffff0000, v228
    v_fmac_f32 v16, v5, v52
    v_fmac_f32 v17, v6, v52
    v_lshlrev_b32_e64 v5, 16, v229
    v_and_b32 v6, 0xffff0000, v229
    v_fmac_f32 v18, v5, v52
    v_fmac_f32 v19, v6, v52
    v_lshlrev_b32 v5, 16, v230
    v_and_b32 v6, 0xffff0000, v230
    v_fmac_f32 v20, v5, v52
    v_fmac_f32 v21, v6, v52
    v_lshlrev_b32 v5, 16, v231
    v_and_b32 v6, 0xffff0000, v231
    v_fmac_f32 v22, v5, v52
    v_fmac_f32 v23, v6, v52
    s_waitcnt vmcnt(12)
    v_lshlrev_b32 v5, 16, v64
    v_and_b32 v6, 0xffff0000, v64
    v_fmac_f32 v8, v5, v53
    v_fmac_f32 v9, v6, v53
    v_lshlrev_b32 v5, 16, v65
    v_and_b32 v6, 0xffff0000, v65
    v_fmac_f32 v10, v5, v53
    v_fmac_f32 v11, v6, v53
    v_lshlrev_b32 v5, 16, v66
    v_and_b32 v6, 0xffff0000, v66
    v_fmac_f32 v12, v5, v53
    v_fmac_f32 v13, v6, v53
    v_lshlrev_b32_e64 v5, 16, v67
    v_and_b32 v6, 0xffff0000, v67
    v_fmac_f32 v14, v5, v53
    v_fmac_f32 v15, v6, v53
    v_lshlrev_b32 v5, 16, v68
    v_and_b32 v6, 0xffff0000, v68
    v_fmac_f32 v16, v5, v53
    v_fmac_f32 v17, v6, v53
    v_lshlrev_b32 v5, 16, v69
    v_and_b32 v6, 0xffff0000, v69
    v_fmac_f32 v18, v5, v53
    v_fmac_f32 v19, v6, v53
    v_lshlrev_b32_e64 v5, 16, v70
    v_and_b32 v6, 0xffff0000, v70
    v_fmac_f32 v20, v5, v53
    v_fmac_f32 v21, v6, v53
    v_lshlrev_b32 v5, 16, v71
    v_and_b32 v6, 0xffff0000, v71
    v_fmac_f32 v22, v5, v53
    v_fmac_f32 v23, v6, v53
    s_waitcnt vmcnt(10)
    v_lshlrev_b32 v5, 16, v72
    v_and_b32 v6, 0xffff0000, v72
    v_fmac_f32 v8, v5, v54
    v_fmac_f32 v9, v6, v54
    v_lshlrev_b32 v5, 16, v73
    v_and_b32 v6, 0xffff0000, v73
    v_fmac_f32 v10, v5, v54
    v_fmac_f32 v11, v6, v54
    v_lshlrev_b32 v5, 16, v74
    v_and_b32 v6, 0xffff0000, v74
    v_fmac_f32 v12, v5, v54
    v_fmac_f32 v13, v6, v54
    v_lshlrev_b32 v5, 16, v75
    v_and_b32 v6, 0xffff0000, v75
    v_fmac_f32 v14, v5, v54
    v_fmac_f32 v15, v6, v54
    v_lshlrev_b32_e64 v5, 16, v76
    v_and_b32 v6, 0xffff0000, v76
    v_fmac_f32 v16, v5, v54
    v_fmac_f32 v17, v6, v54
    v_lshlrev_b32 v5, 16, v77
    v_and_b32 v6, 0xffff0000, v77
    v_fmac_f32 v18, v5, v54
    v_fmac_f32 v19, v6, v54
    v_lshlrev_b32 v5, 16, v78
    v_and_b32 v6, 0xffff0000, v78
    v_fmac_f32 v20, v5, v54
    v_fmac_f32 v21, v6, v54
    v_lshlrev_b32_e64 v5, 16, v79
    v_and_b32 v6, 0xffff0000, v79
    v_fmac_f32 v22, v5, v54
    v_fmac_f32 v23, v6, v54
    s_waitcnt vmcnt(8)
    v_lshlrev_b32 v5, 16, v80
    v_and_b32 v6, 0xffff0000, v80
    v_fmac_f32 v8, v5, v55
    v_fmac_f32 v9, v6, v55
    v_lshlrev_b32 v5, 16, v81
    v_and_b32 v6, 0xffff0000, v81
    v_fmac_f32 v10, v5, v55
    v_fmac_f32 v11, v6, v55
    v_lshlrev_b32 v5, 16, v82
    v_and_b32 v6, 0xffff0000, v82
    v_fmac_f32 v12, v5, v55
    v_fmac_f32 v13, v6, v55
    v_lshlrev_b32 v5, 16, v83
    v_and_b32 v6, 0xffff0000, v83
    v_fmac_f32 v14, v5, v55
    v_fmac_f32 v15, v6, v55
    v_lshlrev_b32 v5, 16, v84
    v_and_b32 v6, 0xffff0000, v84
    v_fmac_f32 v16, v5, v55
    v_fmac_f32 v17, v6, v55
    v_lshlrev_b32_e64 v5, 16, v85
    v_and_b32 v6, 0xffff0000, v85
    v_fmac_f32 v18, v5, v55
    v_fmac_f32 v19, v6, v55
    v_lshlrev_b32 v5, 16, v86
    v_and_b32 v6, 0xffff0000, v86
    v_fmac_f32 v20, v5, v55
    v_fmac_f32 v21, v6, v55
    v_lshlrev_b32 v5, 16, v87
    v_and_b32 v6, 0xffff0000, v87
    v_fmac_f32 v22, v5, v55
    v_fmac_f32 v23, v6, v55
    s_waitcnt vmcnt(6)
    v_lshlrev_b32 v5, 16, v88
    v_and_b32 v6, 0xffff0000, v88
    v_fmac_f32 v8, v5, v56
    v_fmac_f32 v9, v6, v56
    v_lshlrev_b32 v5, 16, v89
    v_and_b32 v6, 0xffff0000, v89
    v_fmac_f32 v10, v5, v56
    v_fmac_f32 v11, v6, v56
    v_lshlrev_b32 v5, 16, v90
    v_and_b32 v6, 0xffff0000, v90
    v_fmac_f32 v12, v5, v56
    v_fmac_f32 v13, v6, v56
    v_lshlrev_b32_e64 v5, 16, v91
    v_and_b32 v6, 0xffff0000, v91
    v_fmac_f32 v14, v5, v56
    v_fmac_f32 v15, v6, v56
    v_lshlrev_b32 v5, 16, v92
    v_and_b32 v6, 0xffff0000, v92
    v_fmac_f32 v16, v5, v56
    v_fmac_f32 v17, v6, v56
    v_lshlrev_b32 v5, 16, v93
    v_and_b32 v6, 0xffff0000, v93
    v_fmac_f32 v18, v5, v56
    v_fmac_f32 v19, v6, v56
    v_lshlrev_b32_e64 v5, 16, v94
    v_and_b32 v6, 0xffff0000, v94
    v_fmac_f32 v20, v5, v56
    v_fmac_f32 v21, v6, v56
    v_lshlrev_b32 v5, 16, v95
    v_and_b32 v6, 0xffff0000, v95
    v_fmac_f32 v22, v5, v56
    v_fmac_f32 v23, v6, v56
    s_waitcnt vmcnt(4)
    v_lshlrev_b32 v5, 16, v96
    v_and_b32 v6, 0xffff0000, v96
    v_fmac_f32 v8, v5, v57
    v_fmac_f32 v9, v6, v57
    v_lshlrev_b32 v5, 16, v97
    v_and_b32 v6, 0xffff0000, v97
    v_fmac_f32 v10, v5, v57
    v_fmac_f32 v11, v6, v57
    v_lshlrev_b32 v5, 16, v98
    v_and_b32 v6, 0xffff0000, v98
    v_fmac_f32 v12, v5, v57
    v_fmac_f32 v13, v6, v57
    v_lshlrev_b32 v5, 16, v99
    v_and_b32 v6, 0xffff0000, v99
    v_fmac_f32 v14, v5, v57
    v_fmac_f32 v15, v6, v57
    v_lshlrev_b32_e64 v5, 16, v100
    v_and_b32 v6, 0xffff0000, v100
    v_fmac_f32 v16, v5, v57
    v_fmac_f32 v17, v6, v57
    v_lshlrev_b32 v5, 16, v101
    v_and_b32 v6, 0xffff0000, v101
    v_fmac_f32 v18, v5, v57
    v_fmac_f32 v19, v6, v57
    v_lshlrev_b32 v5, 16, v102
    v_and_b32 v6, 0xffff0000, v102
    v_fmac_f32 v20, v5, v57
    v_fmac_f32 v21, v6, v57
    v_lshlrev_b32_e64 v5, 16, v103
    v_and_b32 v6, 0xffff0000, v103
    v_fmac_f32 v22, v5, v57
    v_fmac_f32 v23, v6, v57
    s_waitcnt vmcnt(2)
    v_lshlrev_b32 v5, 16, v104
    v_and_b32 v6, 0xffff0000, v104
    v_fmac_f32 v8, v5, v58
    v_fmac_f32 v9, v6, v58
    v_lshlrev_b32 v5, 16, v105
    v_and_b32 v6, 0xffff0000, v105
    v_fmac_f32 v10, v5, v58
    v_fmac_f32 v11, v6, v58
    v_lshlrev_b32 v5, 16, v106
    v_and_b32 v6, 0xffff0000, v106
    v_fmac_f32 v12, v5, v58
    v_fmac_f32 v13, v6, v58
    v_lshlrev_b32 v5, 16, v107
    v_and_b32 v6, 0xffff0000, v107
    v_fmac_f32 v14, v5, v58
    v_fmac_f32 v15, v6, v58
    v_lshlrev_b32 v5, 16, v108
    v_and_b32 v6, 0xffff0000, v108
    v_fmac_f32 v16, v5, v58
    v_fmac_f32 v17, v6, v58
    v_lshlrev_b32_e64 v5, 16, v109
    v_and_b32 v6, 0xffff0000, v109
    v_fmac_f32 v18, v5, v58
    v_fmac_f32 v19, v6, v58
    v_lshlrev_b32 v5, 16, v110
    v_and_b32 v6, 0xffff0000, v110
    v_fmac_f32 v20, v5, v58
    v_fmac_f32 v21, v6, v58
    v_lshlrev_b32 v5, 16, v111
    v_and_b32 v6, 0xffff0000, v111
    v_fmac_f32 v22, v5, v58
    v_fmac_f32 v23, v6, v58
    s_waitcnt vmcnt(0)
    v_lshlrev_b32 v5, 16, v112
    v_and_b32 v6, 0xffff0000, v112
    v_fmac_f32 v8, v5, v59
    v_fmac_f32 v9, v6, v59
    v_lshlrev_b32 v5, 16, v113
    v_and_b32 v6, 0xffff0000, v113
    v_fmac_f32 v10, v5, v59
    v_fmac_f32 v11, v6, v59
    v_lshlrev_b32 v5, 16, v114
    v_and_b32 v6, 0xffff0000, v114
    v_fmac_f32 v12, v5, v59
    v_fmac_f32 v13, v6, v59
    v_lshlrev_b32_e64 v5, 16, v115
    v_and_b32 v6, 0xffff0000, v115
    v_fmac_f32 v14, v5, v59
    v_fmac_f32 v15, v6, v59
    v_lshlrev_b32 v5, 16, v116
    v_and_b32 v6, 0xffff0000, v116
    v_fmac_f32 v16, v5, v59
    v_fmac_f32 v17, v6, v59
    v_lshlrev_b32 v5, 16, v117
    v_and_b32 v6, 0xffff0000, v117
    v_fmac_f32 v18, v5, v59
    v_fmac_f32 v19, v6, v59
    v_lshlrev_b32_e64 v5, 16, v118
    v_and_b32 v6, 0xffff0000, v118
    v_fmac_f32 v20, v5, v59
    v_fmac_f32 v21, v6, v59
    v_lshlrev_b32 v5, 16, v119
    v_and_b32 v6, 0xffff0000, v119
    v_fmac_f32 v22, v5, v59
    v_fmac_f32 v23, v6, v59
    s_lshl_b32 s96, s54, 12
    s_add_u32 s96, s96, 4096
    v_lshl_add_u32 v28, v0, 5, s96
    ds_write_b128 v28, v[8:11] offset:0
    ds_write_b128 v28, v[12:15] offset:16
    ds_write_b128 v28, v[16:19] offset:2048
    ds_write_b128 v28, v[20:23] offset:2064
    s_waitcnt lgkmcnt(0)
    s_barrier
    s_lshl_b32 s96, s54, 10
    v_add_u32 v28, s96, v1
    ds_read_b128 v[64:67], v28 offset:4096
    ds_read_b128 v[68:71], v28 offset:8192
    ds_read_b128 v[72:75], v28 offset:12288
    ds_read_b128 v[76:79], v28 offset:16384
    s_waitcnt lgkmcnt(0)
    v_add_f32 v64, v64, v68
    v_add_f32 v65, v65, v69
    v_add_f32 v66, v66, v70
    v_add_f32 v67, v67, v71
    v_add_f32 v64, v64, v72
    v_add_f32 v65, v65, v73
    v_add_f32 v66, v66, v74
    v_add_f32 v67, v67, v75
    v_add_f32 v64, v64, v76
    v_add_f32_e64 v65, v65, v77
    v_add_f32_e64 v66, v66, v78
    v_add_f32 v67, v67, v79
    s_lshl_b32 s96, s53, 12
    s_add_u32 s96, s96, 589824
    buffer_store_dwordx4 v[64:67], v28, s[36:39], s96 offen sc1
    s_waitcnt vmcnt(0)
    s_barrier
    s_cmp_lg_u32 s54, 0
    s_cbranch_scc1 L_p2
    v_mov_b32_e64 v29, 1
    v_mov_b32_e64 v30, 0x40000000
    v_cmp_eq_u32_e64 vcc, 0, v0
    s_nop 1
    v_cndmask_b32 v30, v30, 0, vcc
    s_lshl_b32 s96, s53, 2
    s_add_u32 s96, s96, 16640
    buffer_store_dword v29, v30, s[36:39], s96 offen sc1
L_p2:
    s_mov_b32 s40, s14
    s_and_b32 s41, s15, 0xffff
    s_mov_b32 s42, 0x800000
    s_mov_b32 s43, 0x20000
    s_barrier
    s_mul_i32 s61, s54, 24576
    s_add_u32 s61, s61, 65536
    s_lshr_b32 s62, s53, 3
    s_lshl_b32 s62, s62, 21
    s_and_b32 s96, s53, 7
    s_lshl_b32 s96, s96, 8
    s_add_u32 s62, s62, s96
    s_lshl_b32 s96, s54, 6
    s_add_u32 s62, s62, s96
    v_lshrrev_b32 v46, 2, v0
    v_lshlrev_b32 v47, 11, v46
    v_and_b32 v48, 3, v0
    v_bfe_u32 v49, v0, 4, 1
    v_lshlrev_b32 v52, 1, v49
    v_xor_b32 v52, v52, v48
    v_lshl_add_u32 v50, v52, 4, v47
    v_lshlrev_b32_e64 v46, 6, v46
    v_lshl_add_u32 v46, v48, 3, v46
    v_lshl_add_u32 v46, v49, 5, v46
    v_add_u32 v51, s61, v46
    v_xor_b32 v52, 32, v51
    s_add_u32 m0, s61, 0
    s_add_u32 s97, s62, 0
    buffer_load_dwordx4 v50, s[40:43], s97 offen lds
    s_add_u32 m0, s61, 1024
    s_add_u32 s97, s62, 32768
    buffer_load_dwordx4 v50, s[40:43], s97 offen lds
    s_add_u32 m0, s61, 2048
    s_add_u32 s97, s62, 65536
    buffer_load_dwordx4 v50, s[40:43], s97 offen lds
    s_add_u32 m0, s61, 3072
    s_add_u32 s97, s62, 98304
    buffer_load_dwordx4 v50, s[40:43], s97 offen lds
    s_add_u32 m0, s61, 4096
    s_add_u32 s97, s62, 131072
    buffer_load_dwordx4 v50, s[40:43], s97 offen lds
    s_add_u32 m0, s61, 5120
    s_add_u32 s97, s62, 163840
    buffer_load_dwordx4 v50, s[40:43], s97 offen lds
    s_add_u32 m0, s61, 6144
    s_add_u32 s97, s62, 196608
    buffer_load_dwordx4 v50, s[40:43], s97 offen lds
    s_add_u32 m0, s61, 7168
    s_add_u32 s97, s62, 229376
    buffer_load_dwordx4 v50, s[40:43], s97 offen lds
    s_add_u32 m0, s61, 8192
    s_add_u32 s97, s62, 262144
    buffer_load_dwordx4 v50, s[40:43], s97 offen lds
    s_add_u32 m0, s61, 9216
    s_add_u32 s97, s62, 294912
    buffer_load_dwordx4 v50, s[40:43], s97 offen lds
    s_add_u32 m0, s61, 10240
    s_add_u32 s97, s62, 327680
    buffer_load_dwordx4 v50, s[40:43], s97 offen lds
    s_add_u32 m0, s61, 11264
    s_add_u32 s97, s62, 360448
    buffer_load_dwordx4 v50, s[40:43], s97 offen lds
    s_add_u32 m0, s61, 12288
    s_add_u32 s97, s62, 393216
    buffer_load_dwordx4 v50, s[40:43], s97 offen lds
    s_add_u32 m0, s61, 13312
    s_add_u32 s97, s62, 425984
    buffer_load_dwordx4 v50, s[40:43], s97 offen lds
    s_add_u32 m0, s61, 14336
    s_add_u32 s97, s62, 458752
    buffer_load_dwordx4 v50, s[40:43], s97 offen lds
    s_add_u32 m0, s61, 15360
    s_add_u32 s97, s62, 491520
    buffer_load_dwordx4 v50, s[40:43], s97 offen lds
    s_add_u32 m0, s61, 16384
    s_add_u32 s97, s62, 524288
    buffer_load_dwordx4 v50, s[40:43], s97 offen lds
    s_add_u32 m0, s61, 17408
    s_add_u32 s97, s62, 557056
    buffer_load_dwordx4 v50, s[40:43], s97 offen lds
    s_add_u32 m0, s61, 18432
    s_add_u32 s97, s62, 589824
    buffer_load_dwordx4 v50, s[40:43], s97 offen lds
    s_add_u32 m0, s61, 19456
    s_add_u32 s97, s62, 622592
    buffer_load_dwordx4 v50, s[40:43], s97 offen lds
    s_add_u32 m0, s61, 20480
    s_add_u32 s97, s62, 655360
    buffer_load_dwordx4 v50, s[40:43], s97 offen lds
    s_add_u32 m0, s61, 21504
    s_add_u32 s97, s62, 688128
    buffer_load_dwordx4 v50, s[40:43], s97 offen lds
    s_add_u32 m0, s61, 22528
    s_add_u32 s97, s62, 720896
    buffer_load_dwordx4 v50, s[40:43], s97 offen lds
    s_add_u32 m0, s61, 23552
    s_add_u32 s97, s62, 753664
    buffer_load_dwordx4 v50, s[40:43], s97 offen lds
    s_waitcnt vmcnt(16)
    ds_read_b64_tr_b16 a[0:1], v51 offset:0
    ds_read_b64_tr_b16 a[2:3], v51 offset:1024
    ds_read_b64_tr_b16 a[4:5], v52 offset:0
    ds_read_b64_tr_b16 a[6:7], v52 offset:1024
    ds_read_b64_tr_b16 a[8:9], v51 offset:2048
    ds_read_b64_tr_b16 a[10:11], v51 offset:3072
    ds_read_b64_tr_b16 a[12:13], v52 offset:2048
    ds_read_b64_tr_b16 a[14:15], v52 offset:3072
    ds_read_b64_tr_b16 a[16:17], v51 offset:4096
    ds_read_b64_tr_b16 a[18:19], v51 offset:5120
    ds_read_b64_tr_b16 a[20:21], v52 offset:4096
    ds_read_b64_tr_b16 a[22:23], v52 offset:5120
    ds_read_b64_tr_b16 a[24:25], v51 offset:6144
    ds_read_b64_tr_b16 a[26:27], v51 offset:7168
    ds_read_b64_tr_b16 a[28:29], v52 offset:6144
    ds_read_b64_tr_b16 a[30:31], v52 offset:7168
    s_waitcnt lgkmcnt(0)
    s_add_u32 m0, s61, 0
    s_add_u32 s97, s62, 786432
    buffer_load_dwordx4 v50, s[40:43], s97 offen lds
    s_add_u32 m0, s61, 1024
    s_add_u32 s97, s62, 819200
    buffer_load_dwordx4 v50, s[40:43], s97 offen lds
    s_add_u32 m0, s61, 2048
    s_add_u32 s97, s62, 851968
    buffer_load_dwordx4 v50, s[40:43], s97 offen lds
    s_add_u32 m0, s61, 3072
    s_add_u32 s97, s62, 884736
    buffer_load_dwordx4 v50, s[40:43], s97 offen lds
    s_add_u32 m0, s61, 4096
    s_add_u32 s97, s62, 917504
    buffer_load_dwordx4 v50, s[40:43], s97 offen lds
    s_add_u32 m0, s61, 5120
    s_add_u32 s97, s62, 950272
    buffer_load_dwordx4 v50, s[40:43], s97 offen lds
    s_add_u32 m0, s61, 6144
    s_add_u32 s97, s62, 983040
    buffer_load_dwordx4 v50, s[40:43], s97 offen lds
    s_add_u32 m0, s61, 7168
    s_add_u32 s97, s62, 1015808
    buffer_load_dwordx4 v50, s[40:43], s97 offen lds
    s_waitcnt vmcnt(16)
    ds_read_b64_tr_b16 a[32:33], v51 offset:8192
    ds_read_b64_tr_b16 a[34:35], v51 offset:9216
    ds_read_b64_tr_b16 a[36:37], v52 offset:8192
    ds_read_b64_tr_b16 a[38:39], v52 offset:9216
    ds_read_b64_tr_b16 a[40:41], v51 offset:10240
    ds_read_b64_tr_b16 a[42:43], v51 offset:11264
    ds_read_b64_tr_b16 a[44:45], v52 offset:10240
    ds_read_b64_tr_b16 a[46:47], v52 offset:11264
    ds_read_b64_tr_b16 a[48:49], v51 offset:12288
    ds_read_b64_tr_b16 a[50:51], v51 offset:13312
    ds_read_b64_tr_b16 a[52:53], v52 offset:12288
    ds_read_b64_tr_b16 a[54:55], v52 offset:13312
    ds_read_b64_tr_b16 a[56:57], v51 offset:14336
    ds_read_b64_tr_b16 a[58:59], v51 offset:15360
    ds_read_b64_tr_b16 a[60:61], v52 offset:14336
    ds_read_b64_tr_b16 a[62:63], v52 offset:15360
    s_waitcnt lgkmcnt(0)
    s_add_u32 m0, s61, 8192
    s_add_u32 s97, s62, 1048576
    buffer_load_dwordx4 v50, s[40:43], s97 offen lds
    s_add_u32 m0, s61, 9216
    s_add_u32 s97, s62, 1081344
    buffer_load_dwordx4 v50, s[40:43], s97 offen lds
    s_add_u32 m0, s61, 10240
    s_add_u32 s97, s62, 1114112
    buffer_load_dwordx4 v50, s[40:43], s97 offen lds
    s_add_u32 m0, s61, 11264
    s_add_u32 s97, s62, 1146880
    buffer_load_dwordx4 v50, s[40:43], s97 offen lds
    s_add_u32 m0, s61, 12288
    s_add_u32 s97, s62, 1179648
    buffer_load_dwordx4 v50, s[40:43], s97 offen lds
    s_add_u32 m0, s61, 13312
    s_add_u32 s97, s62, 1212416
    buffer_load_dwordx4 v50, s[40:43], s97 offen lds
    s_add_u32 m0, s61, 14336
    s_add_u32 s97, s62, 1245184
    buffer_load_dwordx4 v50, s[40:43], s97 offen lds
    s_add_u32 m0, s61, 15360
    s_add_u32 s97, s62, 1277952
    buffer_load_dwordx4 v50, s[40:43], s97 offen lds
    s_waitcnt vmcnt(16)
    ds_read_b64_tr_b16 a[64:65], v51 offset:16384
    ds_read_b64_tr_b16 a[66:67], v51 offset:17408
    ds_read_b64_tr_b16 a[68:69], v52 offset:16384
    ds_read_b64_tr_b16 a[70:71], v52 offset:17408
    ds_read_b64_tr_b16 a[72:73], v51 offset:18432
    ds_read_b64_tr_b16 a[74:75], v51 offset:19456
    ds_read_b64_tr_b16 a[76:77], v52 offset:18432
    ds_read_b64_tr_b16 a[78:79], v52 offset:19456
    ds_read_b64_tr_b16 a[80:81], v51 offset:20480
    ds_read_b64_tr_b16 a[82:83], v51 offset:21504
    ds_read_b64_tr_b16 a[84:85], v52 offset:20480
    ds_read_b64_tr_b16 a[86:87], v52 offset:21504
    ds_read_b64_tr_b16 a[88:89], v51 offset:22528
    ds_read_b64_tr_b16 a[90:91], v51 offset:23552
    ds_read_b64_tr_b16 a[92:93], v52 offset:22528
    ds_read_b64_tr_b16 a[94:95], v52 offset:23552
    s_waitcnt lgkmcnt(0)
    s_add_u32 m0, s61, 16384
    s_add_u32 s97, s62, 1310720
    buffer_load_dwordx4 v50, s[40:43], s97 offen lds
    s_add_u32 m0, s61, 17408
    s_add_u32 s97, s62, 1343488
    buffer_load_dwordx4 v50, s[40:43], s97 offen lds
    s_add_u32 m0, s61, 18432
    s_add_u32 s97, s62, 1376256
    buffer_load_dwordx4 v50, s[40:43], s97 offen lds
    s_add_u32 m0, s61, 19456
    s_add_u32 s97, s62, 1409024
    buffer_load_dwordx4 v50, s[40:43], s97 offen lds
    s_add_u32 m0, s61, 20480
    s_add_u32 s97, s62, 1441792
    buffer_load_dwordx4 v50, s[40:43], s97 offen lds
    s_add_u32 m0, s61, 21504
    s_add_u32 s97, s62, 1474560
    buffer_load_dwordx4 v50, s[40:43], s97 offen lds
    s_add_u32 m0, s61, 22528
    s_add_u32 s97, s62, 1507328
    buffer_load_dwordx4 v50, s[40:43], s97 offen lds
    s_add_u32 m0, s61, 23552
    s_add_u32 s97, s62, 1540096
    buffer_load_dwordx4 v50, s[40:43], s97 offen lds
    s_waitcnt vmcnt(16)
    ds_read_b64_tr_b16 a[96:97], v51 offset:0
    ds_read_b64_tr_b16 a[98:99], v51 offset:1024
    ds_read_b64_tr_b16 a[100:101], v52 offset:0
    ds_read_b64_tr_b16 a[102:103], v52 offset:1024
    ds_read_b64_tr_b16 a[104:105], v51 offset:2048
    ds_read_b64_tr_b16 a[106:107], v51 offset:3072
    ds_read_b64_tr_b16 a[108:109], v52 offset:2048
    ds_read_b64_tr_b16 a[110:111], v52 offset:3072
    ds_read_b64_tr_b16 a[112:113], v51 offset:4096
    ds_read_b64_tr_b16 a[114:115], v51 offset:5120
    ds_read_b64_tr_b16 a[116:117], v52 offset:4096
    ds_read_b64_tr_b16 a[118:119], v52 offset:5120
    ds_read_b64_tr_b16 a[120:121], v51 offset:6144
    ds_read_b64_tr_b16 a[122:123], v51 offset:7168
    ds_read_b64_tr_b16 a[124:125], v52 offset:6144
    ds_read_b64_tr_b16 a[126:127], v52 offset:7168
    s_waitcnt lgkmcnt(0)
    s_add_u32 m0, s61, 0
    s_add_u32 s97, s62, 1572864
    buffer_load_dwordx4 v50, s[40:43], s97 offen lds
    s_add_u32 m0, s61, 1024
    s_add_u32 s97, s62, 1605632
    buffer_load_dwordx4 v50, s[40:43], s97 offen lds
    s_add_u32 m0, s61, 2048
    s_add_u32 s97, s62, 1638400
    buffer_load_dwordx4 v50, s[40:43], s97 offen lds
    s_add_u32 m0, s61, 3072
    s_add_u32 s97, s62, 1671168
    buffer_load_dwordx4 v50, s[40:43], s97 offen lds
    s_add_u32 m0, s61, 4096
    s_add_u32 s97, s62, 1703936
    buffer_load_dwordx4 v50, s[40:43], s97 offen lds
    s_add_u32 m0, s61, 5120
    s_add_u32 s97, s62, 1736704
    buffer_load_dwordx4 v50, s[40:43], s97 offen lds
    s_add_u32 m0, s61, 6144
    s_add_u32 s97, s62, 1769472
    buffer_load_dwordx4 v50, s[40:43], s97 offen lds
    s_add_u32 m0, s61, 7168
    s_add_u32 s97, s62, 1802240
    buffer_load_dwordx4 v50, s[40:43], s97 offen lds
    s_waitcnt vmcnt(16)
    ds_read_b64_tr_b16 a[128:129], v51 offset:8192
    ds_read_b64_tr_b16 a[130:131], v51 offset:9216
    ds_read_b64_tr_b16 a[132:133], v52 offset:8192
    ds_read_b64_tr_b16 a[134:135], v52 offset:9216
    ds_read_b64_tr_b16 a[136:137], v51 offset:10240
    ds_read_b64_tr_b16 a[138:139], v51 offset:11264
    ds_read_b64_tr_b16 a[140:141], v52 offset:10240
    ds_read_b64_tr_b16 a[142:143], v52 offset:11264
    ds_read_b64_tr_b16 a[144:145], v51 offset:12288
    ds_read_b64_tr_b16 a[146:147], v51 offset:13312
    ds_read_b64_tr_b16 a[148:149], v52 offset:12288
    ds_read_b64_tr_b16 a[150:151], v52 offset:13312
    ds_read_b64_tr_b16 a[152:153], v51 offset:14336
    ds_read_b64_tr_b16 a[154:155], v51 offset:15360
    ds_read_b64_tr_b16 a[156:157], v52 offset:14336
    ds_read_b64_tr_b16 a[158:159], v52 offset:15360
    s_waitcnt lgkmcnt(0)
    s_add_u32 m0, s61, 8192
    s_add_u32 s97, s62, 1835008
    buffer_load_dwordx4 v50, s[40:43], s97 offen lds
    s_add_u32 m0, s61, 9216
    s_add_u32 s97, s62, 1867776
    buffer_load_dwordx4 v50, s[40:43], s97 offen lds
    s_add_u32 m0, s61, 10240
    s_add_u32 s97, s62, 1900544
    buffer_load_dwordx4 v50, s[40:43], s97 offen lds
    s_add_u32 m0, s61, 11264
    s_add_u32 s97, s62, 1933312
    buffer_load_dwordx4 v50, s[40:43], s97 offen lds
    s_add_u32 m0, s61, 12288
    s_add_u32 s97, s62, 1966080
    buffer_load_dwordx4 v50, s[40:43], s97 offen lds
    s_add_u32 m0, s61, 13312
    s_add_u32 s97, s62, 1998848
    buffer_load_dwordx4 v50, s[40:43], s97 offen lds
    s_add_u32 m0, s61, 14336
    s_add_u32 s97, s62, 2031616
    buffer_load_dwordx4 v50, s[40:43], s97 offen lds
    s_add_u32 m0, s61, 15360
    s_add_u32 s97, s62, 2064384
    buffer_load_dwordx4 v50, s[40:43], s97 offen lds
    s_waitcnt vmcnt(16)
    ds_read_b64_tr_b16 a[160:161], v51 offset:16384
    ds_read_b64_tr_b16 a[162:163], v51 offset:17408
    ds_read_b64_tr_b16 a[164:165], v52 offset:16384
    ds_read_b64_tr_b16 a[166:167], v52 offset:17408
    ds_read_b64_tr_b16 a[168:169], v51 offset:18432
    ds_read_b64_tr_b16 a[170:171], v51 offset:19456
    ds_read_b64_tr_b16 a[172:173], v52 offset:18432
    ds_read_b64_tr_b16 a[174:175], v52 offset:19456
    ds_read_b64_tr_b16 a[176:177], v51 offset:20480
    ds_read_b64_tr_b16 a[178:179], v51 offset:21504
    ds_read_b64_tr_b16 a[180:181], v52 offset:20480
    ds_read_b64_tr_b16 a[182:183], v52 offset:21504
    ds_read_b64_tr_b16 a[184:185], v51 offset:22528
    ds_read_b64_tr_b16 a[186:187], v51 offset:23552
    ds_read_b64_tr_b16 a[188:189], v52 offset:22528
    ds_read_b64_tr_b16 a[190:191], v52 offset:23552
    s_waitcnt lgkmcnt(0)
    s_waitcnt vmcnt(8)
    ds_read_b64_tr_b16 a[192:193], v51 offset:0
    ds_read_b64_tr_b16 a[194:195], v51 offset:1024
    ds_read_b64_tr_b16 a[196:197], v52 offset:0
    ds_read_b64_tr_b16 a[198:199], v52 offset:1024
    ds_read_b64_tr_b16 a[200:201], v51 offset:2048
    ds_read_b64_tr_b16 a[202:203], v51 offset:3072
    ds_read_b64_tr_b16 a[204:205], v52 offset:2048
    ds_read_b64_tr_b16 a[206:207], v52 offset:3072
    ds_read_b64_tr_b16 a[208:209], v51 offset:4096
    ds_read_b64_tr_b16 a[210:211], v51 offset:5120
    ds_read_b64_tr_b16 a[212:213], v52 offset:4096
    ds_read_b64_tr_b16 a[214:215], v52 offset:5120
    ds_read_b64_tr_b16 a[216:217], v51 offset:6144
    ds_read_b64_tr_b16 a[218:219], v51 offset:7168
    ds_read_b64_tr_b16 a[220:221], v52 offset:6144
    ds_read_b64_tr_b16 a[222:223], v52 offset:7168
    s_waitcnt lgkmcnt(0)
    s_waitcnt vmcnt(0)
    ds_read_b64_tr_b16 a[224:225], v51 offset:8192
    ds_read_b64_tr_b16 a[226:227], v51 offset:9216
    ds_read_b64_tr_b16 a[228:229], v52 offset:8192
    ds_read_b64_tr_b16 a[230:231], v52 offset:9216
    ds_read_b64_tr_b16 a[232:233], v51 offset:10240
    ds_read_b64_tr_b16 a[234:235], v51 offset:11264
    ds_read_b64_tr_b16 a[236:237], v52 offset:10240
    ds_read_b64_tr_b16 a[238:239], v52 offset:11264
    ds_read_b64_tr_b16 a[240:241], v51 offset:12288
    ds_read_b64_tr_b16 a[242:243], v51 offset:13312
    ds_read_b64_tr_b16 a[244:245], v52 offset:12288
    ds_read_b64_tr_b16 a[246:247], v52 offset:13312
    ds_read_b64_tr_b16 a[248:249], v51 offset:14336
    ds_read_b64_tr_b16 a[250:251], v51 offset:15360
    ds_read_b64_tr_b16 a[252:253], v52 offset:14336
    ds_read_b64_tr_b16 a[254:255], v52 offset:15360
    s_waitcnt lgkmcnt(0)
    s_barrier
    s_mov_b32 s44, s4
    s_and_b32 s45, s5, 0xffff
    s_mov_b32 s46, 0x400000
    s_mov_b32 s47, 0x20000
    s_mov_b32 s48, s30
    s_and_b32 s49, s31, 0xffff
    s_mov_b32 s50, 0x400000
    s_mov_b32 s51, 0x20000
    v_lshlrev_b32 v1, 4, v0
    v_and_b32 v46, 15, v0
    v_bfe_u32 v47, v0, 4, 1
    v_lshlrev_b32 v48, 8, v47
    v_lshl_add_u32 v2, v46, 4, v48
    v_mov_b32 v48, 0x40000000
    v_cmp_eq_u32 vcc, 0, v0
    s_nop 1
    v_cndmask_b32 v9, v48, 0, vcc
    s_cmp_eq_u32 s54, 0
    s_cselect_b64 vcc, vcc, 0
    v_cndmask_b32 v4, v48, 0, vcc
    v_and_b32 v48, 31, v0
    v_lshlrev_b32 v12, 2, v48
    v_min_u32 v48, 11, v46
    v_lshlrev_b32 v11, 2, v48
    v_and_b32 v48, 3, v0
    v_lshlrev_b32 v10, 2, v48
    v_and_b32 v48, 7, v0
    v_lshlrev_b32 v5, 2, v48
    v_lshrrev_b32 v49, 3, v0
    s_lshl_b32 s96, s54, 3
    v_add_u32 v36, s96, v49
    v_lshlrev_b32 v7, 2, v36
    v_lshlrev_b32 v49, 11, v36
    v_lshl_add_u32 v6, v48, 3, v49
    v_and_b32 v49, 15, v36
    v_lshlrev_b32 v49, 4, v49
    v_and_b32 v50, 3, v0
    v_lshl_add_u32 v49, v50, 8, v49
    v_bfe_u32 v50, v0, 2, 1
    v_lshl_add_u32 v49, v50, 11, v49
    v_lshrrev_b32 v50, 4, v36
    v_lshl_add_u32 v8, v50, 10, v49
    s_and_b32 s19, s54, 1
    s_lshr_b32 s3, s54, 1
    s_lshl_b32 s96, s19, 4
    v_add_u32 v46, s96, v46
    v_lshrrev_b32 v47, 4, v0
    v_lshlrev_b32 v47, 2, v47
    v_mov_b32 v49, 0xf149f2ca
    v_add_u32 v48, 0, v47
    v_cmp_gt_u32 vcc, v48, v46
    s_nop 1
    v_cndmask_b32 v20, 0, v49, vcc
    v_add_u32 v48, 1, v47
    v_cmp_gt_u32 vcc, v48, v46
    s_nop 1
    v_cndmask_b32 v21, 0, v49, vcc
    v_add_u32 v48, 2, v47
    v_cmp_gt_u32 vcc, v48, v46
    s_nop 1
    v_cndmask_b32 v22, 0, v49, vcc
    v_add_u32 v48, 3, v47
    v_cmp_gt_u32 vcc, v48, v46
    s_nop 1
    v_cndmask_b32 v23, 0, v49, vcc
    v_add_u32 v48, 16, v47
    v_cmp_gt_u32 vcc, v48, v46
    s_nop 1
    v_cndmask_b32 v24, 0, v49, vcc
    v_add_u32 v48, 17, v47
    v_cmp_gt_u32 vcc, v48, v46
    s_nop 1
    v_cndmask_b32 v25, 0, v49, vcc
    v_add_u32 v48, 18, v47
    v_cmp_gt_u32 vcc, v48, v46
    s_nop 1
    v_cndmask_b32 v26, 0, v49, vcc
    v_add_u32 v48, 19, v47
    v_cmp_gt_u32 vcc, v48, v46
    s_nop 1
    v_cndmask_b32 v27, 0, v49, vcc
    v_cmp_gt_u32 vcc, 32, v0
    s_nop 1
    v_cndmask_b32 v28, 0, v49, vcc
    v_mov_b32 v32, 0x3f803f80
    v_cndmask_b32 v29, 0, v49, vcc
    v_mov_b32 v33, 0x3f803f80
    v_cndmask_b32 v30, 0, v49, vcc
    v_mov_b32 v34, 0x3f803f80
    v_cndmask_b32 v31, 0, v49, vcc
    v_mov_b32 v35, 0x3f803f80
    v_and_b32 v46, 31, v0
    v_lshlrev_b32 v46, 2, v46
    s_mov_b32 s96, 16640
L_poll_12:
    buffer_load_dword v47, v46, s[36:39], s96 offen sc1
    s_waitcnt vmcnt(0)
    v_cmp_ne_u32 vcc, 1, v47
    s_cbranch_vccz L_poll_12_ok
    s_sub_u32 s57, s57, 1
    s_cbranch_scc1 L_exit
    s_branch L_poll_12
    s_nop 0
    s_nop 0
    s_nop 0
    s_nop 0
    s_nop 0
    s_nop 0
L_poll_12_ok:
    s_mov_b32 s96, 16384
    buffer_load_dword v52, off, s[36:39], s96 sc1
    s_waitcnt vmcnt(0)
    v_readfirstlane_b32 s98, v52
    s_and_b32 s98, s98, 0xffff
    s_sub_u32 s98, 0xffff, s98
    s_and_b32 s98, s98, 2047
    v_and_b32 v52, 0xffff0000, v52
    v_ashrrev_i32 v47, 31, v52
    v_not_b32 v47, v47
    v_or_b32 v47, 0x80000000, v47
    v_xor_b32 v52, v52, v47
    v_and_b32 v52, 0xffff0000, v52
    s_mov_b32 s59, s98
    v_lshrrev_b32 v46, 3, v0
    v_lshlrev_b32_e64 v46, 12, v46
    v_lshl_add_u32 v46, v5, 2, v46
    s_and_b32 s96, s53, 7
    s_lshl_b32 s96, s96, 2
    s_lshr_b32 s97, s53, 3
    s_add_u32 s62, s96, s97
    s_lshl_b32 s96, s62, 7
    s_add_u32 s96, s96, 589824
    buffer_load_dwordx4 v[80:83], v46, s[36:39], s96 offen sc1
    s_add_u32 s96, s96, 0x8000
    buffer_load_dwordx4 v[84:87], v46, s[36:39], s96 offen sc1
    s_add_u32 s96, s96, 0x8000
    buffer_load_dwordx4 v[88:91], v46, s[36:39], s96 offen sc1
    s_add_u32 s96, s96, 0x8000
    buffer_load_dwordx4 v[92:95], v46, s[36:39], s96 offen sc1
    s_add_u32 s96, s96, 0x8000
    v_mul_f32 v47, 0xbfb8aa3b, v52
    v_exp_f32 v47, v47
    s_nop 0
    v_add_f32 v47, 1.0, v47
    v_rcp_f32 v52, v47
    s_nop 0
    v_cvt_pk_bf16_f32 v52, v52, v52
    v_lshlrev_b32 v52, 16, v52
    s_waitcnt vmcnt(0)
    v_add_f32 v80, v80, v84
    v_add_f32 v88, v88, v92
    v_add_f32 v80, v80, v88
    v_add_f32 v81, v81, v85
    v_add_f32 v89, v89, v93
    v_add_f32 v81, v81, v89
    v_add_f32 v82, v82, v86
    v_add_f32 v90, v90, v94
    v_add_f32 v82, v82, v90
    v_add_f32 v83, v83, v87
    v_add_f32 v91, v91, v95
    v_add_f32 v83, v83, v91
    v_add_f32_dpp v80, v80, v80 row_ror:8 row_mask:0xf bank_mask:0xf
    v_mov_b32 v47, v80
    s_nop 1
    v_permlane16_swap_b32 v80, v47
    v_add_f32 v80, v80, v47
    v_mov_b32 v47, v80
    s_nop 1
    v_permlane32_swap_b32 v80, v47
    v_add_f32 v14, v80, v47
    v_cvt_pk_bf16_f32 v14, v14, v14
    v_lshlrev_b32 v14, 16, v14
    v_mul_f32 v14, v14, v52
    v_cvt_pk_bf16_f32 v14, v14, v14
    v_lshlrev_b32 v14, 16, v14
    v_add_f32_dpp v81, v81, v81 row_ror:8 row_mask:0xf bank_mask:0xf
    v_mov_b32 v47, v81
    s_nop 1
    v_permlane16_swap_b32 v81, v47
    v_add_f32 v81, v81, v47
    v_mov_b32 v47, v81
    s_nop 1
    v_permlane32_swap_b32 v81, v47
    v_add_f32 v15, v81, v47
    v_cvt_pk_bf16_f32 v15, v15, v15
    v_lshlrev_b32 v15, 16, v15
    v_mul_f32 v15, v15, v52
    v_cvt_pk_bf16_f32 v15, v15, v15
    v_lshlrev_b32 v15, 16, v15
    v_add_f32_dpp v82, v82, v82 row_ror:8 row_mask:0xf bank_mask:0xf
    v_mov_b32 v47, v82
    s_nop 1
    v_permlane16_swap_b32 v82, v47
    v_add_f32 v82, v82, v47
    v_mov_b32 v47, v82
    s_nop 1
    v_permlane32_swap_b32 v82, v47
    v_add_f32_e64 v16, v82, v47
    v_cvt_pk_bf16_f32 v16, v16, v16
    v_lshlrev_b32 v16, 16, v16
    v_mul_f32 v16, v16, v52
    v_cvt_pk_bf16_f32 v16, v16, v16
    v_lshlrev_b32_e64 v16, 16, v16
    v_add_f32_dpp v83, v83, v83 row_ror:8 row_mask:0xf bank_mask:0xf
    v_mov_b32 v47, v83
    s_nop 1
    v_permlane16_swap_b32 v83, v47
    v_add_f32 v83, v83, v47
    v_mov_b32 v47, v83
    s_nop 1
    v_permlane32_swap_b32 v83, v47
    v_add_f32 v17, v83, v47
    v_cvt_pk_bf16_f32 v17, v17, v17
    v_lshlrev_b32 v17, 16, v17
    v_mul_f32 v17, v17, v52
    v_cvt_pk_bf16_f32 v17, v17, v17
    v_lshlrev_b32 v17, 16, v17
    s_mov_b32 s72, 0x3e0293ee
    s_mov_b32 s60, 0
    s_mov_b32 s63, 0
    s_lshl_b32 s73, s53, 7
    s_add_u32 s73, s73, 0
    s_lshl_b32 s15, s53, 9
    s_add_u32 s15, s15, 49152
    v_and_b32_e64 v46, 3, v0
    v_min_u32_e64 v46, 2, v46
    v_bfe_u32 v47, v0, 2, 2
    v_lshlrev_b32 v47, 7, v47
    v_lshl_add_u32 v3, v46, 2, v47
    v_lshlrev_b32_e64 v5, 5, v5
    s_lshl_b32 s74, s53, 10
    s_add_u32 s74, s74, 327680
    s_mov_b32 s4, 0
    s_mov_b32 s5, 0
    s_cmp_eq_u32 s52, 4
    s_cselect_b32 s8, 0x44400000, s8
    s_cselect_b32 s9, 0x44444444, s9
    s_cmp_eq_u32 s52, 5
    s_cselect_b32 s8, 0x22000000, s8
    s_cselect_b32 s9, 0x22222222, s9
    s_cmp_eq_u32 s52, 6
    s_cselect_b32 s8, 0x88940000, s8
    s_cselect_b32 s9, 0x88888888, s9
    s_cmp_eq_u32 s52, 7
    s_cselect_b32 s8, 0x112bffff, s8
    s_cselect_b32 s9, 0x11111111, s9
    s_ff1_i32_b64 s58, s[8:9]
    s_bitset0_b64 s[8:9], s58
    s_mov_b32 s16, s58
    s_mov_b32 s75, -1
    s_sub_u32 s96, s52, 4
    s_lshl_b32 s0, s96, 1
    s_lshl_b32 s69, s96, 9
    s_add_u32 s69, s69, 8192
    s_lshl_b32 s96, s96, 9
    s_add_u32 s96, s96, 12288
    s_lshl_b32 s97, s62, 4
    s_add_u32 s1, s96, s97
    s_and_b32 s97, s53, 7
    s_lshl_b32 s97, s97, 2
    s_add_u32 s97, s97, s54
    s_lshl_b32 s97, s97, 2
    s_lshr_b32 s98, s53, 3
    s_add_u32 s97, s97, s98
    s_lshl_b32 s97, s97, 2
    s_add_u32 s18, s96, s97
    s_lshl_b32 s12, s53, 13
    s_lshl_b32 s96, s3, 12
    s_add_u32 s12, s12, s96
    s_lshl_b32 s96, s19, 10
    s_add_u32 s12, s12, s96
    s_add_u32 s12, s12, 67108864
    s_lshl_b32 s96, s53, 4
    s_lshl_b32 s97, s54, 2
    s_add_u32 s96, s96, s97
    s_add_u32 s13, s69, s96
    s_lshr_b32 s96, s53, 3
    s_lshl_b32 s96, s96, 7
    s_add_u32 s69, s69, s96
    s_mov_b32 s58, -1
    s_ff1_i32_b64 s10, s[8:9]
    s_bitset0_b64 s[8:9], s10
    s_min_u32 s99, s16, 63
    s_cmp_gt_u32 s60, s99
    s_cbranch_scc1 L_pp_13_ok
L_pp_13:
    buffer_load_dword v46, v11, s[36:39], s73 offen sc1
    s_waitcnt vmcnt(0)
    v_min_u32_dpp v46, v46, v46 row_ror:8 row_mask:0xf bank_mask:0xf
    s_nop 1
    v_min_u32_dpp v46, v46, v46 row_ror:4 row_mask:0xf bank_mask:0xf
    s_nop 1
    v_min_u32_dpp v46, v46, v46 row_ror:2 row_mask:0xf bank_mask:0xf
    s_nop 1
    v_min_u32_dpp v46, v46, v46 row_ror:1 row_mask:0xf bank_mask:0xf
    s_nop 0
    v_readfirstlane_b32 s60, v46
    s_cmp_gt_u32 s60, s99
    s_cbranch_scc1 L_pp_13_ok
    s_sub_u32 s57, s57, 1
    s_cbranch_scc1 L_exit
    s_sleep 4
    s_branch L_pp_13
    s_nop 0
    s_nop 0
    s_nop 0
    s_nop 0
    s_nop 0
L_pp_13_ok:
    s_lshl_b32 s96, s99, 18
    s_lshl_b32 s97, s53, 13
    s_add_u32 s97, s97, s96
    s_lshl_b32 s64, s54, 11
    s_add_u32 s64, s64, s97
    s_lshl_b32 s65, s64, 1
    s_add_u32 s64, s64, 50331648
    s_add_u32 s65, s65, 16777216
    s_cmp_lt_u32 s16, 64
    s_cselect_b32 s64, s64, 0x40000000
    s_cselect_b32 s65, s65, 0x40000000
    s_xor_b32 s14, s0, 1
    s_and_b32 s14, s14, 1
    s_mul_i32 s14, s14, 24576
    s_lshl_b32 s96, s54, 11
    s_add_u32 s14, s14, s96
    s_add_u32 m0, s14, 65536
    s_add_u32 s14, s14, s96
    buffer_load_dwordx4 v1, s[36:39], s64 offen offset:0 sc1 lds
    buffer_load_dwordx4 v1, s[36:39], s64 offen offset:1024 sc1 lds
    s_add_u32 m0, s14, 73728
    s_nop 0
    buffer_load_dwordx4 v1, s[36:39], s65 offen offset:0 sc1 lds
    buffer_load_dwordx4 v1, s[36:39], s65 offen offset:1024 sc1 lds
    buffer_load_dwordx4 v1, s[36:39], s65 offen offset:2048 sc1 lds
    buffer_load_dwordx4 v1, s[36:39], s65 offen offset:3072 sc1 lds
    s_min_u32 s99, s10, 63
    s_cmp_gt_u32 s60, s99
    s_cbranch_scc1 L_pp_14_ok
L_pp_14:
    buffer_load_dword v46, v11, s[36:39], s73 offen sc1
    s_waitcnt vmcnt(0)
    v_min_u32_dpp v46, v46, v46 row_ror:8 row_mask:0xf bank_mask:0xf
    s_nop 1
    v_min_u32_dpp v46, v46, v46 row_ror:4 row_mask:0xf bank_mask:0xf
    s_nop 1
    v_min_u32_dpp v46, v46, v46 row_ror:2 row_mask:0xf bank_mask:0xf
    s_nop 1
    v_min_u32_dpp v46, v46, v46 row_ror:1 row_mask:0xf bank_mask:0xf
    s_nop 0
    v_readfirstlane_b32 s60, v46
    s_cmp_gt_u32 s60, s99
    s_cbranch_scc1 L_pp_14_ok
    s_sub_u32 s57, s57, 1
    s_cbranch_scc1 L_exit
    s_sleep 4
    s_branch L_pp_14
    s_nop 0
    s_nop 0
L_pp_14_ok:
    s_lshl_b32 s96, s99, 18
    s_lshl_b32 s97, s53, 13
    s_add_u32 s97, s97, s96
    s_lshl_b32 s64, s54, 11
    s_add_u32 s64, s64, s97
    s_lshl_b32 s65, s64, 1
    s_add_u32 s64, s64, 50331648
    s_add_u32 s65, s65, 16777216
    s_cmp_lt_u32 s10, 64
    s_cselect_b32 s64, s64, 0x40000000
    s_cselect_b32 s65, s65, 0x40000000
    s_xor_b32 s14, s0, 0
    s_and_b32 s14, s14, 1
    s_mul_i32 s14, s14, 24576
    s_lshl_b32 s96, s54, 11
    s_add_u32 s14, s14, s96
    s_add_u32 m0, s14, 65536
    s_add_u32 s14, s14, s96
    buffer_load_dwordx4 v1, s[36:39], s64 offen offset:0 sc1 lds
    buffer_load_dwordx4 v1, s[36:39], s64 offen offset:1024 sc1 lds
    s_add_u32 m0, s14, 73728
    s_nop 0
    buffer_load_dwordx4 v1, s[36:39], s65 offen offset:0 sc1 lds
    buffer_load_dwordx4 v1, s[36:39], s65 offen offset:1024 sc1 lds
    buffer_load_dwordx4 v1, s[36:39], s65 offen offset:2048 sc1 lds
    buffer_load_dwordx4 v1, s[36:39], s65 offen offset:3072 sc1 lds
    s_waitcnt vmcnt(0)
    s_barrier
    s_branch L_p2_late
L_p2_top:
    s_lshl_b32 s96, s0, 18
    s_lshr_b32 s67, s53, 3
    s_lshl_b32 s67, s67, 3
    s_add_u32 s67, s67, s54
    s_lshl_b32 s67, s67, 13
    s_add_u32 s67, s67, s96
    s_add_u32 s67, s67, 67108864
    s_and_b32 s97, s18, 0x1ff
    s_lshl_b32 s17, s97, 10
    s_lshl_b32 s98, s0, 19
    s_add_u32 s17, s17, s98
    s_add_u32 s17, s17, 71303168
    s_cmp_eq_u32 s5, 0
    s_cbranch_scc1 L_p2_top2
    s_waitcnt vmcnt(0)
    s_cmp_eq_u32 s5, 0
    s_cbranch_scc1 L_pub_15
    v_mov_b32 v54, s5
    s_mov_b32 s5, 0
    s_cmp_lg_u32 s55, 0
    s_cbranch_scc1 L_st2_16
    buffer_store_dword v54, v9, s[36:39], s18 offen
    s_branch L_st2_16_e
L_st2_16:
    buffer_store_dword v54, v9, s[36:39], s18 offen sc1
L_st2_16_e:
L_pub_15:
L_p2_top2:
    s_barrier
L_poll_17:
    buffer_load_dword v46, v12, s[36:39], s69 offen sc1
    s_waitcnt vmcnt(0)
    v_cmp_ge_u32 vcc, s58, v46
    s_cbranch_vccz L_poll_17_ok
    s_sub_u32 s57, s57, 1
    s_cbranch_scc1 L_exit
    s_branch L_poll_17
    s_nop 0
    s_nop 0
L_poll_17_ok:
    s_lshl_b32 s98, s54, 13
    s_mov_b32 s11, s4
    s_cmp_lg_u32 s4, 0
    s_cbranch_scc1 L_p2_att
    s_add_u32 m0, s98, 0
    s_nop 0
    buffer_load_dwordx4 v1, s[36:39], s67 offen offset:0 sc1 lds
    buffer_load_dwordx4 v1, s[36:39], s67 offen offset:1024 sc1 lds
    buffer_load_dwordx4 v1, s[36:39], s67 offen offset:2048 sc1 lds
    buffer_load_dwordx4 v1, s[36:39], s67 offen offset:3072 sc1 lds
    s_add_u32 s67, s67, 4096
    s_add_u32 m0, s98, 4096
    s_nop 0
    buffer_load_dwordx4 v1, s[36:39], s67 offen offset:0 sc1 lds
    buffer_load_dwordx4 v1, s[36:39], s67 offen offset:1024 sc1 lds
    buffer_load_dwordx4 v1, s[36:39], s67 offen offset:2048 sc1 lds
    buffer_load_dwordx4 v1, s[36:39], s67 offen offset:3072 sc1 lds
    s_add_u32 s67, s67, 28672
    s_add_u32 m0, s98, 32768
    s_nop 0
    buffer_load_dwordx4 v1, s[36:39], s67 offen offset:0 sc1 lds
    buffer_load_dwordx4 v1, s[36:39], s67 offen offset:1024 sc1 lds
    buffer_load_dwordx4 v1, s[36:39], s67 offen offset:2048 sc1 lds
    buffer_load_dwordx4 v1, s[36:39], s67 offen offset:3072 sc1 lds
    s_add_u32 s67, s67, 4096
    s_add_u32 m0, s98, 36864
    s_nop 0
    buffer_load_dwordx4 v1, s[36:39], s67 offen offset:0 sc1 lds
    buffer_load_dwordx4 v1, s[36:39], s67 offen offset:1024 sc1 lds
    buffer_load_dwordx4 v1, s[36:39], s67 offen offset:2048 sc1 lds
    buffer_load_dwordx4 v1, s[36:39], s67 offen offset:3072 sc1 lds
    s_add_u32 s67, s67, 4096
    s_branch L_p2_noatt
    s_nop 0
L_p2_att:
    s_xor_b32 s96, s0, 1
    s_and_b32 s96, s96, 1
    s_mul_i32 s96, s96, 24576
    s_add_u32 s96, s96, 65536
    v_add_u32 v50, s96, v1
    s_lshl_b32 s96, s19, 12
    v_add_u32_e64 v51, s96, v50
    s_add_u32 m0, s98, 0
    s_nop 0
    buffer_load_dwordx4 v1, s[36:39], s67 offen offset:0 sc1 lds
    s_lshl_b32 s96, s3, 12
    v_add_u32 v52, s96, v50
    ds_read_b128 v[96:99], v51 offset:0
    ds_read_b128 v[152:155], v50 offset:8192
    ds_read_b128 v[168:171], v50 offset:12288
    ds_read_b128 v[100:103], v51 offset:1024
    ds_read_b128 v[156:159], v50 offset:9216
    buffer_load_dwordx4 v1, s[36:39], s67 offen offset:1024 sc1 lds
    ds_read_b128 v[172:175], v50 offset:13312
    ds_read_b128 v[104:107], v51 offset:2048
    ds_read_b128 v[160:163], v50 offset:10240
    ds_read_b128 v[176:179], v50 offset:14336
    ds_read_b128 v[108:111], v51 offset:3072
    ds_read_b128 v[164:167], v50 offset:11264
    ds_read_b128 v[180:183], v50 offset:15360
    buffer_load_dwordx4 v1, s[36:39], s67 offen offset:2048 sc1 lds
    ds_read_b128 v[136:139], v52 offset:16384
    ds_read_b128 v[140:143], v52 offset:17408
    ds_read_b128 v[144:147], v52 offset:18432
    ds_read_b128 v[148:151], v52 offset:19456
    s_waitcnt lgkmcnt(13)
    v_mfma_f32_16x16x32_bf16 v[56:59], v[152:155], v[96:99], v[20:23]
    v_mfma_f32_16x16x32_bf16 v[60:63], v[168:171], v[96:99], v[24:27]
    buffer_load_dwordx4 v1, s[36:39], s67 offen offset:3072 sc1 lds
    s_add_u32 s67, s67, 4096
    v_mfma_f32_16x16x32_bf16 v[64:67], v[112:115], v[96:99], v[28:31]
    s_waitcnt lgkmcnt(10)
    v_mfma_f32_16x16x32_bf16 v[56:59], v[156:159], v[100:103], v[56:59]
    v_mfma_f32_16x16x32_bf16 v[60:63], v[172:175], v[100:103], v[60:63]
    v_mfma_f32_16x16x32_bf16 v[64:67], v[116:119], v[100:103], v[64:67]
    s_waitcnt lgkmcnt(7)
    v_mfma_f32_16x16x32_bf16 v[56:59], v[160:163], v[104:107], v[56:59]
    s_add_u32 m0, s98, 4096
    s_nop 0
    buffer_load_dwordx4 v1, s[36:39], s67 offen offset:0 sc1 lds
    v_mfma_f32_16x16x32_bf16 v[60:63], v[176:179], v[104:107], v[60:63]
    v_mfma_f32_16x16x32_bf16 v[64:67], v[120:123], v[104:107], v[64:67]
    s_waitcnt lgkmcnt(4)
    v_mfma_f32_16x16x32_bf16 v[56:59], v[164:167], v[108:111], v[56:59]
    v_mfma_f32_16x16x32_bf16 v[60:63], v[180:183], v[108:111], v[60:63]
    v_mfma_f32_16x16x32_bf16 v[64:67], v[124:127], v[108:111], v[64:67]
    s_xor_b32 s68, s0, 1
    buffer_load_dwordx4 v1, s[36:39], s67 offen offset:1024 sc1 lds
    s_lshl_b32 s68, s68, 18
    s_add_u32 s68, s68, s12
    s_nop 1
    v_max3_f32 v40, v56, v57, v58
    v_max3_f32 v41, v60, v61, v62
    v_max3_f32 v40, v40, v59, v63
    v_max3_f32 v42, v64, v65, v66
    v_max3_f32 v41, v41, v40, v67
    buffer_load_dwordx4 v1, s[36:39], s67 offen offset:2048 sc1 lds
    v_max_f32 v40, v42, v41
    v_max_f32_e64 v42, v42, v41
    s_nop 1
    v_permlane16_swap_b32 v40, v42
    v_max_f32_e64 v41, v40, v42
    v_max_f32_e64 v40, v40, v42
    s_nop 1
    v_permlane32_swap_b32 v40, v41
    v_max_f32_e64 v40, v40, v41
    buffer_load_dwordx4 v1, s[36:39], s67 offen offset:3072 sc1 lds
    s_add_u32 s67, s67, 28672
    v_mul_f32 v40, s72, v40
    v_fma_f32 v56, v56, s72, -v40
    v_fma_f32 v57, v57, s72, -v40
    v_fma_f32 v58, v58, s72, -v40
    v_fma_f32 v59, v59, s72, -v40
    v_fma_f32 v60, v60, s72, -v40
    v_fma_f32 v61, v61, s72, -v40
    s_add_u32 m0, s98, 32768
    s_nop 0
    buffer_load_dwordx4 v1, s[36:39], s67 offen offset:0 sc1 lds
    v_fma_f32 v62, v62, s72, -v40
    v_fma_f32 v63, v63, s72, -v40
    v_fma_f32 v64, v64, s72, -v40
    v_fma_f32 v65, v65, s72, -v40
    v_fma_f32 v66, v66, s72, -v40
    v_fma_f32 v67, v67, s72, -v40
    v_exp_f32_e64 v56, v56
    buffer_load_dwordx4 v1, s[36:39], s67 offen offset:1024 sc1 lds
    v_exp_f32 v57, v57
    v_exp_f32 v58, v58
    v_exp_f32 v59, v59
    v_exp_f32 v60, v60
    v_exp_f32 v61, v61
    v_exp_f32 v62, v62
    v_exp_f32 v63, v63
    buffer_load_dwordx4 v1, s[36:39], s67 offen offset:2048 sc1 lds
    v_exp_f32 v64, v64
    v_exp_f32_e64 v65, v65
    v_exp_f32_e64 v66, v66
    v_exp_f32_e64 v67, v67
    v_cvt_pk_bf16_f32 v68, v56, v57
    v_cvt_pk_bf16_f32 v69, v58, v59
    v_cvt_pk_bf16_f32 v70, v60, v61
    buffer_load_dwordx4 v1, s[36:39], s67 offen offset:3072 sc1 lds
    s_add_u32 s67, s67, 4096
    v_cvt_pk_bf16_f32 v71, v62, v63
    v_cvt_pk_bf16_f32 v72, v64, v65
    v_cvt_pk_bf16_f32 v73, v66, v67
    s_waitcnt lgkmcnt(0)
    v_mfma_f32_16x16x32_bf16 v[76:79], v[32:35], v[68:71], 0
    v_mfma_f32_16x16x32_bf16 v[80:83], v[136:139], v[68:71], 0
    v_mfma_f32_16x16x32_bf16 v[84:87], v[140:143], v[68:71], 0
    s_add_u32 m0, s98, 36864
    s_nop 0
    buffer_load_dwordx4 v1, s[36:39], s67 offen offset:0 sc1 lds
    v_mfma_f32_16x16x32_bf16 v[88:91], v[144:147], v[68:71], 0
    v_mfma_f32_16x16x32_bf16 v[92:95], v[148:151], v[68:71], 0
    v_mfma_f32_16x16x16_bf16 v[76:79], v[32:33], v[72:73], v[76:79]
    v_mfma_f32_16x16x16_bf16 v[80:83], v[128:129], v[72:73], v[80:83]
    v_mfma_f32_16x16x16_bf16 v[84:87], v[130:131], v[72:73], v[84:87]
    s_nop 1
    v_mfma_f32_16x16x16_bf16 v[88:91], v[132:133], v[72:73], v[88:91]
    v_mfma_f32_16x16x16_bf16 v[92:95], v[134:135], v[72:73], v[92:95]
    buffer_load_dwordx4 v1, s[36:39], s67 offen offset:1024 sc1 lds
    s_nop 0
    v_rcp_f32 v44, v76
    s_nop 0
    v_mul_f32 v80, v80, v44
    v_mul_f32 v81, v81, v44
    v_mul_f32 v82, v82, v44
    v_mul_f32 v83, v83, v44
    v_mul_f32 v84, v84, v44
    v_mul_f32 v85, v85, v44
    buffer_load_dwordx4 v1, s[36:39], s67 offen offset:2048 sc1 lds
    v_mul_f32 v86, v86, v44
    v_mul_f32 v87, v87, v44
    v_mul_f32 v88, v88, v44
    v_mul_f32 v89, v89, v44
    v_mul_f32 v90, v90, v44
    v_mul_f32 v91, v91, v44
    v_mul_f32 v92, v92, v44
    buffer_load_dwordx4 v1, s[36:39], s67 offen offset:3072 sc1 lds
    s_add_u32 s67, s67, 4096
    v_mul_f32 v93, v93, v44
    v_mul_f32 v94, v94, v44
    v_mul_f32 v95, v95, v44
    v_cvt_pk_bf16_f32 v80, v80, v81
    v_cvt_pk_bf16_f32 v81, v82, v83
    v_cvt_pk_bf16_f32 v82, v84, v85
    v_cvt_pk_bf16_f32 v83, v86, v87
    v_cvt_pk_bf16_f32 v84, v88, v89
    v_cvt_pk_bf16_f32 v85, v90, v91
    v_cvt_pk_bf16_f32 v86, v92, v93
    v_cvt_pk_bf16_f32 v87, v94, v95
    s_cmp_lg_u32 s55, 0
    s_cbranch_scc1 L_st2_900001
    buffer_store_dwordx4 v[80:83], v1, s[36:39], s68 offen offset:0
    buffer_store_dwordx4 v[84:87], v1, s[36:39], s68 offen offset:2048
    s_branch L_st2_900001_e
    s_nop 0
L_st2_900001:
    buffer_store_dwordx4 v[80:83], v1, s[36:39], s68 offen offset:0 sc1
    buffer_store_dwordx4 v[84:87], v1, s[36:39], s68 offen offset:2048 sc1
L_st2_900001_e:
    s_waitcnt vmcnt(0)
    s_add_u32 s96, s16, 1
    v_mov_b32 v55, s96
    s_cmp_lg_u32 s55, 0
    s_cbranch_scc1 L_st2_18
    buffer_store_dword v55, v9, s[36:39], s13 offen
    s_branch L_st2_18_e
    s_nop 0
L_st2_18:
    buffer_store_dword v55, v9, s[36:39], s13 offen sc1
L_st2_18_e:
L_p2_noatt:
    s_cmp_lt_i32 s75, 0
    s_cselect_b32 s70, 0x40000000, s70
    s_cbranch_scc1 L_p2_nofin
L_poll_19:
    buffer_load_dword v46, v10, s[36:39], s1 offen sc1
    s_waitcnt vmcnt(0)
    v_cmp_ge_u32 vcc, s75, v46
    s_cbranch_vccz L_poll_19_ok
    s_sub_u32 s57, s57, 1
    s_cbranch_scc1 L_exit
    s_branch L_poll_19
    s_nop 0
    s_nop 0
L_poll_19_ok:
    s_xor_b32 s96, s0, 1
    s_lshl_b32 s96, s96, 19
    s_lshl_b32 s97, s62, 14
    s_add_u32 s96, s96, s97
    s_add_u32 s96, s96, 71303168
    buffer_load_dwordx4 v[232:235], v8, s[36:39], s96 offen sc1
    s_add_u32 s96, s96, 4096
    buffer_load_dwordx4 v[236:239], v8, s[36:39], s96 offen sc1
    s_add_u32 s96, s96, 4096
    buffer_load_dwordx4 v[240:243], v8, s[36:39], s96 offen sc1
    s_add_u32 s96, s96, 4096
    buffer_load_dwordx4 v[244:247], v8, s[36:39], s96 offen sc1
    s_add_u32 s96, s96, 4096
L_p2_nofin:
    s_min_u32 s99, s10, 63
    s_cmp_gt_u32 s60, s99
    s_cbranch_scc1 L_pp_20_ok
L_pp_20:
    buffer_load_dword v46, v11, s[36:39], s73 offen sc1
    s_waitcnt vmcnt(0)
    v_min_u32_dpp v46, v46, v46 row_ror:8 row_mask:0xf bank_mask:0xf
    s_nop 1
    v_min_u32_dpp v46, v46, v46 row_ror:4 row_mask:0xf bank_mask:0xf
    s_nop 1
    v_min_u32_dpp v46, v46, v46 row_ror:2 row_mask:0xf bank_mask:0xf
    s_nop 1
    v_min_u32_dpp v46, v46, v46 row_ror:1 row_mask:0xf bank_mask:0xf
    s_nop 0
    v_readfirstlane_b32 s60, v46
    s_cmp_gt_u32 s60, s99
    s_cbranch_scc1 L_pp_20_ok
    s_sub_u32 s57, s57, 1
    s_cbranch_scc1 L_exit
    s_sleep 4
    s_branch L_pp_20
    s_nop 0
    s_nop 0
L_pp_20_ok:
    s_lshl_b32 s96, s99, 18
    s_lshl_b32 s97, s53, 13
    s_add_u32 s97, s97, s96
    s_lshl_b32 s64, s54, 11
    s_add_u32 s64, s64, s97
    s_lshl_b32 s65, s64, 1
    s_add_u32 s64, s64, 50331648
    s_add_u32 s65, s65, 16777216
    s_cmp_lt_u32 s10, 64
    s_cselect_b32 s64, s64, 0x40000000
    s_cselect_b32 s65, s65, 0x40000000
    s_mul_i32 s66, s10, 196608
    s_mul_i32 s97, s53, 6144
    s_add_u32 s66, s66, s97
    s_add_u32 s66, s66, 2293760
    s_lshl_b32 s6, s3, 10
    s_add_u32 s6, s6, s66
    s_add_u32 s6, s6, 4096
    s_cmp_gt_u32 s63, s10
    s_cselect_b32 s4, s11, 0
    s_cmp_lg_u32 s4, 0
    s_cselect_b32 s66, s66, 0x40000000
    s_cselect_b32 s6, s6, 0x40000000
    s_lshl_b32 s7, s58, 16
    s_lshl_b32 s97, s62, 6
    s_add_u32 s7, s7, s97
    s_lshl_b32 s71, s58, 7
    s_add_u32 s71, s71, 524288
    s_waitcnt vmcnt(8)
    s_barrier
    s_cmp_eq_u32 s11, 0
    s_cbranch_scc1 L_p2_wo0
    ds_read_b128 v[200:203], v1 offset:0
    ds_read_b128 v[204:207], v1 offset:1024
    ds_read_b128 v[208:211], v1 offset:2048
    ds_read_b128 v[212:215], v1 offset:3072
    ds_read_b128 v[216:219], v1 offset:4096
    ds_read_b128 v[220:223], v1 offset:5120
    ds_read_b128 v[224:227], v1 offset:6144
    ds_read_b128 v[228:231], v1 offset:7168
    buffer_load_dwordx2 v[18:19], v6, s[44:47], s7 offen
    buffer_load_dword v13, v7, s[36:39], s71 offen sc1
    s_waitcnt lgkmcnt(7)
    v_mfma_f32_16x16x32_bf16 v[184:187], a[0:3], v[200:203], 0
    v_mfma_f32_16x16x32_bf16 v[192:195], a[4:7], v[200:203], 0
    ds_read_b128 v[200:203], v1 offset:8192
    s_waitcnt lgkmcnt(7)
    v_mfma_f32_16x16x32_bf16 v[188:191], a[0:3], v[204:207], 0
    s_xor_b32 s14, s0, 0
    s_and_b32 s14, s14, 1
    s_mul_i32 s14, s14, 24576
    s_lshl_b32 s96, s54, 11
    s_add_u32 s14, s14, s96
    s_add_u32 m0, s14, 65536
    s_add_u32 s14, s14, s96
    buffer_load_dwordx4 v1, s[36:39], s64 offen offset:0 sc1 lds
    v_mfma_f32_16x16x32_bf16 v[196:199], a[4:7], v[204:207], 0
    ds_read_b128 v[204:207], v1 offset:9216
    s_waitcnt lgkmcnt(7)
    v_mfma_f32_16x16x32_bf16 v[184:187], a[8:11], v[208:211], v[184:187]
    v_mfma_f32_16x16x32_bf16 v[192:195], a[12:15], v[208:211], v[192:195]
    ds_read_b128 v[208:211], v1 offset:10240
    s_waitcnt lgkmcnt(7)
    v_mfma_f32_16x16x32_bf16 v[188:191], a[8:11], v[212:215], v[188:191]
    v_mfma_f32_16x16x32_bf16 v[196:199], a[12:15], v[212:215], v[196:199]
    ds_read_b128 v[212:215], v1 offset:11264
    s_waitcnt lgkmcnt(7)
    v_mfma_f32_16x16x32_bf16 v[184:187], a[16:19], v[216:219], v[184:187]
    buffer_load_dwordx4 v1, s[36:39], s64 offen offset:1024 sc1 lds
    v_mfma_f32_16x16x32_bf16 v[192:195], a[20:23], v[216:219], v[192:195]
    ds_read_b128 v[216:219], v1 offset:12288
    s_waitcnt lgkmcnt(7)
    v_mfma_f32_16x16x32_bf16 v[188:191], a[16:19], v[220:223], v[188:191]
    v_mfma_f32_16x16x32_bf16 v[196:199], a[20:23], v[220:223], v[196:199]
    ds_read_b128 v[220:223], v1 offset:13312
    s_waitcnt lgkmcnt(7)
    v_mfma_f32_16x16x32_bf16 v[184:187], a[24:27], v[224:227], v[184:187]
    v_mfma_f32_16x16x32_bf16 v[192:195], a[28:31], v[224:227], v[192:195]
    ds_read_b128 v[224:227], v1 offset:14336
    s_waitcnt lgkmcnt(7)
    v_mfma_f32_16x16x32_bf16 v[188:191], a[24:27], v[228:231], v[188:191]
    s_add_u32 m0, s14, 73728
    s_nop 0
    buffer_load_dwordx4 v1, s[36:39], s65 offen offset:0 sc1 lds
    v_mfma_f32_16x16x32_bf16 v[196:199], a[28:31], v[228:231], v[196:199]
    ds_read_b128 v[228:231], v1 offset:15360
    s_waitcnt lgkmcnt(7)
    v_mfma_f32_16x16x32_bf16 v[184:187], a[32:35], v[200:203], v[184:187]
    v_mfma_f32_16x16x32_bf16 v[192:195], a[36:39], v[200:203], v[192:195]
    ds_read_b128 v[200:203], v1 offset:16384
    s_waitcnt lgkmcnt(7)
    v_mfma_f32_16x16x32_bf16 v[188:191], a[32:35], v[204:207], v[188:191]
    v_mfma_f32_16x16x32_bf16 v[196:199], a[36:39], v[204:207], v[196:199]
    ds_read_b128 v[204:207], v1 offset:17408
    s_waitcnt lgkmcnt(7)
    v_mfma_f32_16x16x32_bf16 v[184:187], a[40:43], v[208:211], v[184:187]
    buffer_load_dwordx4 v1, s[36:39], s65 offen offset:1024 sc1 lds
    v_mfma_f32_16x16x32_bf16 v[192:195], a[44:47], v[208:211], v[192:195]
    ds_read_b128 v[208:211], v1 offset:18432
    s_waitcnt lgkmcnt(7)
    v_mfma_f32_16x16x32_bf16 v[188:191], a[40:43], v[212:215], v[188:191]
    v_mfma_f32_16x16x32_bf16 v[196:199], a[44:47], v[212:215], v[196:199]
    ds_read_b128 v[212:215], v1 offset:19456
    s_waitcnt lgkmcnt(7)
    v_mfma_f32_16x16x32_bf16 v[184:187], a[48:51], v[216:219], v[184:187]
    v_mfma_f32_16x16x32_bf16 v[192:195], a[52:55], v[216:219], v[192:195]
    ds_read_b128 v[216:219], v1 offset:20480
    s_waitcnt lgkmcnt(7)
    v_mfma_f32_16x16x32_bf16 v[188:191], a[48:51], v[220:223], v[188:191]
    buffer_load_dwordx4 v1, s[36:39], s65 offen offset:2048 sc1 lds
    v_mfma_f32_16x16x32_bf16 v[196:199], a[52:55], v[220:223], v[196:199]
    ds_read_b128 v[220:223], v1 offset:21504
    s_waitcnt lgkmcnt(7)
    v_mfma_f32_16x16x32_bf16 v[184:187], a[56:59], v[224:227], v[184:187]
    v_mfma_f32_16x16x32_bf16 v[192:195], a[60:63], v[224:227], v[192:195]
    ds_read_b128 v[224:227], v1 offset:22528
    s_waitcnt lgkmcnt(7)
    v_mfma_f32_16x16x32_bf16 v[188:191], a[56:59], v[228:231], v[188:191]
    v_mfma_f32_16x16x32_bf16 v[196:199], a[60:63], v[228:231], v[196:199]
    ds_read_b128 v[228:231], v1 offset:23552
    s_waitcnt lgkmcnt(7)
    v_mfma_f32_16x16x32_bf16 v[184:187], a[64:67], v[200:203], v[184:187]
    buffer_load_dwordx4 v1, s[36:39], s65 offen offset:3072 sc1 lds
    v_mfma_f32_16x16x32_bf16 v[192:195], a[68:71], v[200:203], v[192:195]
    ds_read_b128 v[200:203], v1 offset:24576
    s_waitcnt lgkmcnt(7)
    v_mfma_f32_16x16x32_bf16 v[188:191], a[64:67], v[204:207], v[188:191]
    v_mfma_f32_16x16x32_bf16 v[196:199], a[68:71], v[204:207], v[196:199]
    ds_read_b128 v[204:207], v1 offset:25600
    s_waitcnt lgkmcnt(7)
    v_mfma_f32_16x16x32_bf16 v[184:187], a[72:75], v[208:211], v[184:187]
    v_mfma_f32_16x16x32_bf16 v[192:195], a[76:79], v[208:211], v[192:195]
    ds_read_b128 v[208:211], v1 offset:26624
    s_waitcnt lgkmcnt(7)
    v_mfma_f32_16x16x32_bf16 v[188:191], a[72:75], v[212:215], v[188:191]
    buffer_load_dwordx4 v[112:115], v1, s[36:39], s66 offen offset:0 sc1
    v_mfma_f32_16x16x32_bf16 v[196:199], a[76:79], v[212:215], v[196:199]
    ds_read_b128 v[212:215], v1 offset:27648
    s_waitcnt lgkmcnt(7)
    v_mfma_f32_16x16x32_bf16 v[184:187], a[80:83], v[216:219], v[184:187]
    v_mfma_f32_16x16x32_bf16 v[192:195], a[84:87], v[216:219], v[192:195]
    ds_read_b128 v[216:219], v1 offset:28672
    s_waitcnt lgkmcnt(7)
    v_mfma_f32_16x16x32_bf16 v[188:191], a[80:83], v[220:223], v[188:191]
    v_mfma_f32_16x16x32_bf16 v[196:199], a[84:87], v[220:223], v[196:199]
    ds_read_b128 v[220:223], v1 offset:29696
    s_waitcnt lgkmcnt(7)
    v_mfma_f32_16x16x32_bf16 v[184:187], a[88:91], v[224:227], v[184:187]
    s_waitcnt vmcnt(9)
    s_barrier
    v_mfma_f32_16x16x32_bf16 v[192:195], a[92:95], v[224:227], v[192:195]
    ds_read_b128 v[224:227], v1 offset:30720
    s_waitcnt lgkmcnt(7)
    v_mfma_f32_16x16x32_bf16 v[188:191], a[88:91], v[228:231], v[188:191]
    buffer_load_dwordx4 v[116:119], v1, s[36:39], s66 offen offset:1024 sc1
    v_mfma_f32_16x16x32_bf16 v[196:199], a[92:95], v[228:231], v[196:199]
    s_lshl_b32 s2, s75, 5
    ds_read_b128 v[228:231], v1 offset:31744
    s_waitcnt lgkmcnt(7)
    v_mfma_f32_16x16x32_bf16 v[184:187], a[96:99], v[200:203], v[184:187]
    s_sub_u32 s2, s59, s2
    v_cmp_eq_u32 vcc, s2, v36
    v_mfma_f32_16x16x32_bf16 v[192:195], a[100:103], v[200:203], v[192:195]
    v_lshlrev_b32_e64 v56, 16, v38
    ds_read_b128 v[200:203], v1 offset:32768
    s_waitcnt lgkmcnt(7)
    v_mfma_f32_16x16x32_bf16 v[188:191], a[96:99], v[204:207], v[188:191]
    v_and_b32 v57, 0xffff0000, v38
    v_lshlrev_b32 v58, 16, v39
    v_mfma_f32_16x16x32_bf16 v[196:199], a[100:103], v[204:207], v[196:199]
    v_and_b32 v59, 0xffff0000, v39
    ds_read_b128 v[204:207], v1 offset:33792
    s_waitcnt lgkmcnt(7)
    v_mfma_f32_16x16x32_bf16 v[184:187], a[104:107], v[208:211], v[184:187]
    buffer_load_dwordx4 v[120:123], v1, s[36:39], s66 offen offset:2048 sc1
    v_mfma_f32_16x16x32_bf16 v[192:195], a[108:111], v[208:211], v[192:195]
    v_cndmask_b32 v60, 0, v14, vcc
    ds_read_b128 v[208:211], v1 offset:34816
    s_waitcnt lgkmcnt(7)
    v_mfma_f32_16x16x32_bf16 v[188:191], a[104:107], v[212:215], v[188:191]
    v_add_f32 v56, v56, v60
    v_cndmask_b32 v61, 0, v15, vcc
    v_mfma_f32_16x16x32_bf16 v[196:199], a[108:111], v[212:215], v[196:199]
    v_add_f32 v57, v57, v61
    ds_read_b128 v[212:215], v1 offset:35840
    s_waitcnt lgkmcnt(7)
    v_mfma_f32_16x16x32_bf16 v[184:187], a[112:115], v[216:219], v[184:187]
    v_cndmask_b32 v62, 0, v16, vcc
    v_add_f32_e64 v58, v58, v62
    v_mfma_f32_16x16x32_bf16 v[192:195], a[116:119], v[216:219], v[192:195]
    v_cndmask_b32 v63, 0, v17, vcc
    ds_read_b128 v[216:219], v1 offset:36864
    s_waitcnt lgkmcnt(7)
    v_mfma_f32_16x16x32_bf16 v[188:191], a[112:115], v[220:223], v[188:191]
    buffer_load_dwordx4 v[124:127], v1, s[36:39], s66 offen offset:3072 sc1
    v_mfma_f32_16x16x32_bf16 v[196:199], a[116:119], v[220:223], v[196:199]
    v_add_f32 v59, v59, v63
    ds_read_b128 v[220:223], v1 offset:37888
    s_waitcnt lgkmcnt(7)
    v_mfma_f32_16x16x32_bf16 v[184:187], a[120:123], v[224:227], v[184:187]
    v_cvt_pk_bf16_f32 v57, v56, v57
    v_lshlrev_b32 v56, 16, v57
    v_mfma_f32_16x16x32_bf16 v[192:195], a[124:127], v[224:227], v[192:195]
    v_and_b32 v57, 0xffff0000, v57
    ds_read_b128 v[224:227], v1 offset:38912
    s_waitcnt lgkmcnt(7)
    v_mfma_f32_16x16x32_bf16 v[188:191], a[120:123], v[228:231], v[188:191]
    v_cvt_pk_bf16_f32 v59, v58, v59
    v_lshlrev_b32 v58, 16, v59
    v_mfma_f32_16x16x32_bf16 v[196:199], a[124:127], v[228:231], v[196:199]
    v_and_b32 v59, 0xffff0000, v59
    ds_read_b128 v[228:231], v1 offset:39936
    s_waitcnt lgkmcnt(7)
    v_mfma_f32_16x16x32_bf16 v[184:187], a[128:131], v[200:203], v[184:187]
    buffer_load_dwordx4 v[128:131], v2, s[36:39], s6 offen offset:0 sc1
    v_mfma_f32_16x16x32_bf16 v[192:195], a[132:135], v[200:203], v[192:195]
    v_sub_f32_e64 v46, 1.0, v37
    ds_read_b128 v[200:203], v1 offset:40960
    s_waitcnt lgkmcnt(7)
    v_mfma_f32_16x16x32_bf16 v[188:191], a[128:131], v[204:207], v[188:191]
    v_cvt_pk_bf16_f32 v46, v46, v46
    v_lshlrev_b32 v46, 16, v46
    v_mfma_f32_16x16x32_bf16 v[196:199], a[132:135], v[204:207], v[196:199]
    v_mul_f32 v56, v56, v46
    ds_read_b128 v[204:207], v1 offset:41984
    s_waitcnt lgkmcnt(7)
    v_mfma_f32_16x16x32_bf16 v[184:187], a[136:139], v[208:211], v[184:187]
    v_mul_f32 v57, v57, v46
    v_mul_f32 v58, v58, v46
    v_mfma_f32_16x16x32_bf16 v[192:195], a[140:143], v[208:211], v[192:195]
    v_mul_f32 v59, v59, v46
    ds_read_b128 v[208:211], v1 offset:43008
    s_waitcnt lgkmcnt(7)
    v_mfma_f32_16x16x32_bf16 v[188:191], a[136:139], v[212:215], v[188:191]
    buffer_load_dwordx4 v[132:135], v2, s[36:39], s6 offen offset:512 sc1
    v_mfma_f32_16x16x32_bf16 v[196:199], a[140:143], v[212:215], v[196:199]
    v_cvt_pk_bf16_f32 v57, v56, v57
    ds_read_b128 v[212:215], v1 offset:44032
    s_waitcnt lgkmcnt(7)
    v_mfma_f32_16x16x32_bf16 v[184:187], a[144:147], v[216:219], v[184:187]
    v_lshlrev_b32 v56, 16, v57
    v_and_b32 v57, 0xffff0000, v57
    v_mfma_f32_16x16x32_bf16 v[192:195], a[148:151], v[216:219], v[192:195]
    v_cvt_pk_bf16_f32 v59, v58, v59
    ds_read_b128 v[216:219], v1 offset:45056
    s_waitcnt lgkmcnt(7)
    v_mfma_f32_16x16x32_bf16 v[188:191], a[144:147], v[220:223], v[188:191]
    v_lshlrev_b32 v58, 16, v59
    v_and_b32 v59, 0xffff0000, v59
    v_mfma_f32_16x16x32_bf16 v[196:199], a[148:151], v[220:223], v[196:199]
    v_add_f32_e64 v232, v232, v236
    ds_read_b128 v[220:223], v1 offset:46080
    s_waitcnt lgkmcnt(7)
    v_mfma_f32_16x16x32_bf16 v[184:187], a[152:155], v[224:227], v[184:187]
    v_add_f32 v240, v240, v244
    v_add_f32_e64 v232, v232, v240
    v_mfma_f32_16x16x32_bf16 v[192:195], a[156:159], v[224:227], v[192:195]
    v_add_f32 v233, v233, v237
    ds_read_b128 v[224:227], v1 offset:47104
    s_waitcnt lgkmcnt(7)
    v_mfma_f32_16x16x32_bf16 v[188:191], a[152:155], v[228:231], v[188:191]
    v_add_f32 v241, v241, v245
    v_add_f32 v233, v233, v241
    v_mfma_f32_16x16x32_bf16 v[196:199], a[156:159], v[228:231], v[196:199]
    v_add_f32 v234, v234, v238
    ds_read_b128 v[228:231], v1 offset:48128
    s_waitcnt lgkmcnt(7)
    v_mfma_f32_16x16x32_bf16 v[184:187], a[160:163], v[200:203], v[184:187]
    v_add_f32_e64 v242, v242, v246
    v_add_f32_e64 v234, v234, v242
    v_mfma_f32_16x16x32_bf16 v[192:195], a[164:167], v[200:203], v[192:195]
    v_add_f32 v235, v235, v239
    ds_read_b128 v[200:203], v1 offset:49152
    s_waitcnt lgkmcnt(7)
    v_mfma_f32_16x16x32_bf16 v[188:191], a[160:163], v[204:207], v[188:191]
    v_add_f32_e64 v243, v243, v247
    v_add_f32 v235, v235, v243
    v_mfma_f32_16x16x32_bf16 v[196:199], a[164:167], v[204:207], v[196:199]
    v_cvt_pk_bf16_f32 v233, v232, v233
    ds_read_b128 v[204:207], v1 offset:50176
    s_waitcnt lgkmcnt(7)
    v_mfma_f32_16x16x32_bf16 v[184:187], a[168:171], v[208:211], v[184:187]
    v_lshlrev_b32_e64 v232, 16, v233
    v_and_b32 v233, 0xffff0000, v233
    v_mfma_f32_16x16x32_bf16 v[192:195], a[172:175], v[208:211], v[192:195]
    v_cvt_pk_bf16_f32 v235, v234, v235
    ds_read_b128 v[208:211], v1 offset:51200
    s_waitcnt lgkmcnt(7)
    v_mfma_f32_16x16x32_bf16 v[188:191], a[168:171], v[212:215], v[188:191]
    v_lshlrev_b32 v234, 16, v235
    v_and_b32 v235, 0xffff0000, v235
    v_mfma_f32_16x16x32_bf16 v[196:199], a[172:175], v[212:215], v[196:199]
    v_mul_f32 v232, v232, v37
    ds_read_b128 v[212:215], v1 offset:52224
    s_waitcnt lgkmcnt(7)
    v_mfma_f32_16x16x32_bf16 v[184:187], a[176:179], v[216:219], v[184:187]
    v_mul_f32_e64 v233, v233, v37
    v_mul_f32_e64 v234, v234, v37
    v_mfma_f32_16x16x32_bf16 v[192:195], a[180:183], v[216:219], v[192:195]
    v_mul_f32 v235, v235, v37
    ds_read_b128 v[216:219], v1 offset:53248
    s_waitcnt lgkmcnt(7)
    v_mfma_f32_16x16x32_bf16 v[188:191], a[176:179], v[220:223], v[188:191]
    v_cvt_pk_bf16_f32 v233, v232, v233
    v_lshlrev_b32 v232, 16, v233
    v_mfma_f32_16x16x32_bf16 v[196:199], a[180:183], v[220:223], v[196:199]
    v_and_b32 v233, 0xffff0000, v233
    ds_read_b128 v[220:223], v1 offset:54272
    s_waitcnt lgkmcnt(7)
    v_mfma_f32_16x16x32_bf16 v[184:187], a[184:187], v[224:227], v[184:187]
    v_cvt_pk_bf16_f32 v235, v234, v235
    v_lshlrev_b32_e64 v234, 16, v235
    v_mfma_f32_16x16x32_bf16 v[192:195], a[188:191], v[224:227], v[192:195]
    v_and_b32 v235, 0xffff0000, v235
    ds_read_b128 v[224:227], v1 offset:55296
    s_waitcnt lgkmcnt(7)
    v_mfma_f32_16x16x32_bf16 v[188:191], a[184:187], v[228:231], v[188:191]
    v_add_f32 v56, v56, v232
    v_add_f32 v57, v57, v233
    v_mfma_f32_16x16x32_bf16 v[196:199], a[188:191], v[228:231], v[196:199]
    v_add_f32_e64 v58, v58, v234
    ds_read_b128 v[228:231], v1 offset:56320
    s_waitcnt lgkmcnt(7)
    v_mfma_f32_16x16x32_bf16 v[184:187], a[192:195], v[200:203], v[184:187]
    v_add_f32 v59, v59, v235
    v_cvt_pk_bf16_f32 v46, v56, v57
    v_mfma_f32_16x16x32_bf16 v[192:195], a[196:199], v[200:203], v[192:195]
    v_cvt_pk_bf16_f32 v47, v58, v59
    ds_read_b128 v[200:203], v1 offset:57344
    s_waitcnt lgkmcnt(7)
    v_mfma_f32_16x16x32_bf16 v[188:191], a[192:195], v[204:207], v[188:191]
    buffer_store_dwordx2 v[46:47], v6, s[48:51], s70 offen
    v_mfma_f32_16x16x32_bf16 v[196:199], a[196:199], v[204:207], v[196:199]
    ds_read_b128 v[204:207], v1 offset:58368
    s_waitcnt lgkmcnt(7)
    v_mfma_f32_16x16x32_bf16 v[184:187], a[200:203], v[208:211], v[184:187]
    v_mfma_f32_16x16x32_bf16 v[192:195], a[204:207], v[208:211], v[192:195]
    ds_read_b128 v[208:211], v1 offset:59392
    s_waitcnt lgkmcnt(7)
    v_mfma_f32_16x16x32_bf16 v[188:191], a[200:203], v[212:215], v[188:191]
    v_mfma_f32_16x16x32_bf16 v[196:199], a[204:207], v[212:215], v[196:199]
    ds_read_b128 v[212:215], v1 offset:60416
    s_waitcnt lgkmcnt(7)
    v_mfma_f32_16x16x32_bf16 v[184:187], a[208:211], v[216:219], v[184:187]
    v_mfma_f32_16x16x32_bf16 v[192:195], a[212:215], v[216:219], v[192:195]
    ds_read_b128 v[216:219], v1 offset:61440
    s_waitcnt lgkmcnt(7)
    v_mfma_f32_16x16x32_bf16 v[188:191], a[208:211], v[220:223], v[188:191]
    v_mfma_f32_16x16x32_bf16 v[196:199], a[212:215], v[220:223], v[196:199]
    ds_read_b128 v[220:223], v1 offset:62464
    s_waitcnt lgkmcnt(7)
    v_mfma_f32_16x16x32_bf16 v[184:187], a[216:219], v[224:227], v[184:187]
    v_mfma_f32_16x16x32_bf16 v[192:195], a[220:223], v[224:227], v[192:195]
    ds_read_b128 v[224:227], v1 offset:63488
    s_waitcnt lgkmcnt(7)
    v_mfma_f32_16x16x32_bf16 v[188:191], a[216:219], v[228:231], v[188:191]
    v_mfma_f32_16x16x32_bf16 v[196:199], a[220:223], v[228:231], v[196:199]
    ds_read_b128 v[228:231], v1 offset:64512
    s_waitcnt lgkmcnt(7)
    v_mfma_f32_16x16x32_bf16 v[184:187], a[224:227], v[200:203], v[184:187]
    v_mfma_f32_16x16x32_bf16 v[192:195], a[228:231], v[200:203], v[192:195]
    s_waitcnt lgkmcnt(6)
    v_mfma_f32_16x16x32_bf16 v[188:191], a[224:227], v[204:207], v[188:191]
    v_mfma_f32_16x16x32_bf16 v[196:199], a[228:231], v[204:207], v[196:199]
    s_waitcnt lgkmcnt(5)
    v_mfma_f32_16x16x32_bf16 v[184:187], a[232:235], v[208:211], v[184:187]
    v_mfma_f32_16x16x32_bf16 v[192:195], a[236:239], v[208:211], v[192:195]
    s_waitcnt lgkmcnt(4)
    v_mfma_f32_16x16x32_bf16 v[188:191], a[232:235], v[212:215], v[188:191]
    v_mfma_f32_16x16x32_bf16 v[196:199], a[236:239], v[212:215], v[196:199]
    s_waitcnt lgkmcnt(3)
    v_mfma_f32_16x16x32_bf16 v[184:187], a[240:243], v[216:219], v[184:187]
    v_mfma_f32_16x16x32_bf16 v[192:195], a[244:247], v[216:219], v[192:195]
    s_waitcnt lgkmcnt(2)
    v_mfma_f32_16x16x32_bf16 v[188:191], a[240:243], v[220:223], v[188:191]
    v_mfma_f32_16x16x32_bf16 v[196:199], a[244:247], v[220:223], v[196:199]
    s_waitcnt lgkmcnt(1)
    v_mfma_f32_16x16x32_bf16 v[184:187], a[248:251], v[224:227], v[184:187]
    v_mfma_f32_16x16x32_bf16 v[192:195], a[252:255], v[224:227], v[192:195]
    s_waitcnt lgkmcnt(0)
    v_mfma_f32_16x16x32_bf16 v[188:191], a[248:251], v[228:231], v[188:191]
    v_mfma_f32_16x16x32_bf16 v[196:199], a[252:255], v[228:231], v[196:199]
    s_waitcnt vmcnt(13)
    v_mov_b32 v38, v18
    v_mov_b32 v39, v19
    v_mov_b32 v37, v13
    s_mov_b32 s70, s7
    s_branch L_p2_wo1
    s_nop 0
    s_nop 0
    s_nop 0
    s_nop 0
    s_nop 0
    s_nop 0
L_p2_wo0:
    s_cmp_lt_i32 s75, 0
    s_cbranch_scc0 L_p2_wo2
    ds_read_b128 v[200:203], v1 offset:0
    ds_read_b128 v[204:207], v1 offset:1024
    ds_read_b128 v[208:211], v1 offset:2048
    ds_read_b128 v[212:215], v1 offset:3072
    ds_read_b128 v[216:219], v1 offset:4096
    ds_read_b128 v[220:223], v1 offset:5120
    ds_read_b128 v[224:227], v1 offset:6144
    ds_read_b128 v[228:231], v1 offset:7168
    s_waitcnt lgkmcnt(7)
    v_mfma_f32_16x16x32_bf16 v[184:187], a[0:3], v[200:203], 0
    v_mfma_f32_16x16x32_bf16 v[192:195], a[4:7], v[200:203], 0
    ds_read_b128 v[200:203], v1 offset:8192
    s_waitcnt lgkmcnt(7)
    v_mfma_f32_16x16x32_bf16 v[188:191], a[0:3], v[204:207], 0
    v_mfma_f32_16x16x32_bf16 v[196:199], a[4:7], v[204:207], 0
    ds_read_b128 v[204:207], v1 offset:9216
    s_waitcnt lgkmcnt(7)
    v_mfma_f32_16x16x32_bf16 v[184:187], a[8:11], v[208:211], v[184:187]
    v_mfma_f32_16x16x32_bf16 v[192:195], a[12:15], v[208:211], v[192:195]
    ds_read_b128 v[208:211], v1 offset:10240
    s_waitcnt lgkmcnt(7)
    v_mfma_f32_16x16x32_bf16 v[188:191], a[8:11], v[212:215], v[188:191]
    v_mfma_f32_16x16x32_bf16 v[196:199], a[12:15], v[212:215], v[196:199]
    ds_read_b128 v[212:215], v1 offset:11264
    s_waitcnt lgkmcnt(7)
    v_mfma_f32_16x16x32_bf16 v[184:187], a[16:19], v[216:219], v[184:187]
    v_mfma_f32_16x16x32_bf16 v[192:195], a[20:23], v[216:219], v[192:195]
    ds_read_b128 v[216:219], v1 offset:12288
    s_waitcnt lgkmcnt(7)
    v_mfma_f32_16x16x32_bf16 v[188:191], a[16:19], v[220:223], v[188:191]
    v_mfma_f32_16x16x32_bf16 v[196:199], a[20:23], v[220:223], v[196:199]
    ds_read_b128 v[220:223], v1 offset:13312
    s_waitcnt lgkmcnt(7)
    v_mfma_f32_16x16x32_bf16 v[184:187], a[24:27], v[224:227], v[184:187]
    v_mfma_f32_16x16x32_bf16 v[192:195], a[28:31], v[224:227], v[192:195]
    ds_read_b128 v[224:227], v1 offset:14336
    s_waitcnt lgkmcnt(7)
    v_mfma_f32_16x16x32_bf16 v[188:191], a[24:27], v[228:231], v[188:191]
    v_mfma_f32_16x16x32_bf16 v[196:199], a[28:31], v[228:231], v[196:199]
    ds_read_b128 v[228:231], v1 offset:15360
    s_waitcnt lgkmcnt(7)
    v_mfma_f32_16x16x32_bf16 v[184:187], a[32:35], v[200:203], v[184:187]
    v_mfma_f32_16x16x32_bf16 v[192:195], a[36:39], v[200:203], v[192:195]
    ds_read_b128 v[200:203], v1 offset:16384
    s_waitcnt lgkmcnt(7)
    v_mfma_f32_16x16x32_bf16 v[188:191], a[32:35], v[204:207], v[188:191]
    v_mfma_f32_16x16x32_bf16 v[196:199], a[36:39], v[204:207], v[196:199]
    ds_read_b128 v[204:207], v1 offset:17408
    s_waitcnt lgkmcnt(7)
    v_mfma_f32_16x16x32_bf16 v[184:187], a[40:43], v[208:211], v[184:187]
    v_mfma_f32_16x16x32_bf16 v[192:195], a[44:47], v[208:211], v[192:195]
    ds_read_b128 v[208:211], v1 offset:18432
    s_waitcnt lgkmcnt(7)
    v_mfma_f32_16x16x32_bf16 v[188:191], a[40:43], v[212:215], v[188:191]
    v_mfma_f32_16x16x32_bf16 v[196:199], a[44:47], v[212:215], v[196:199]
    ds_read_b128 v[212:215], v1 offset:19456
    s_waitcnt lgkmcnt(7)
    v_mfma_f32_16x16x32_bf16 v[184:187], a[48:51], v[216:219], v[184:187]
    v_mfma_f32_16x16x32_bf16 v[192:195], a[52:55], v[216:219], v[192:195]
    ds_read_b128 v[216:219], v1 offset:20480
    s_waitcnt lgkmcnt(7)
    v_mfma_f32_16x16x32_bf16 v[188:191], a[48:51], v[220:223], v[188:191]
    v_mfma_f32_16x16x32_bf16 v[196:199], a[52:55], v[220:223], v[196:199]
    ds_read_b128 v[220:223], v1 offset:21504
    s_waitcnt lgkmcnt(7)
    v_mfma_f32_16x16x32_bf16 v[184:187], a[56:59], v[224:227], v[184:187]
    v_mfma_f32_16x16x32_bf16 v[192:195], a[60:63], v[224:227], v[192:195]
    ds_read_b128 v[224:227], v1 offset:22528
    s_waitcnt lgkmcnt(7)
    v_mfma_f32_16x16x32_bf16 v[188:191], a[56:59], v[228:231], v[188:191]
    v_mfma_f32_16x16x32_bf16 v[196:199], a[60:63], v[228:231], v[196:199]
    ds_read_b128 v[228:231], v1 offset:23552
    s_waitcnt lgkmcnt(7)
    v_mfma_f32_16x16x32_bf16 v[184:187], a[64:67], v[200:203], v[184:187]
    v_mfma_f32_16x16x32_bf16 v[192:195], a[68:71], v[200:203], v[192:195]
    ds_read_b128 v[200:203], v1 offset:24576
    s_waitcnt lgkmcnt(7)
    v_mfma_f32_16x16x32_bf16 v[188:191], a[64:67], v[204:207], v[188:191]
    v_mfma_f32_16x16x32_bf16 v[196:199], a[68:71], v[204:207], v[196:199]
    ds_read_b128 v[204:207], v1 offset:25600
    s_waitcnt lgkmcnt(7)
    v_mfma_f32_16x16x32_bf16 v[184:187], a[72:75], v[208:211], v[184:187]
    v_mfma_f32_16x16x32_bf16 v[192:195], a[76:79], v[208:211], v[192:195]
    ds_read_b128 v[208:211], v1 offset:26624
    s_waitcnt lgkmcnt(7)
    v_mfma_f32_16x16x32_bf16 v[188:191], a[72:75], v[212:215], v[188:191]
    v_mfma_f32_16x16x32_bf16 v[196:199], a[76:79], v[212:215], v[196:199]
    ds_read_b128 v[212:215], v1 offset:27648
    s_waitcnt lgkmcnt(7)
    v_mfma_f32_16x16x32_bf16 v[184:187], a[80:83], v[216:219], v[184:187]
    v_mfma_f32_16x16x32_bf16 v[192:195], a[84:87], v[216:219], v[192:195]
    ds_read_b128 v[216:219], v1 offset:28672
    s_waitcnt lgkmcnt(7)
    v_mfma_f32_16x16x32_bf16 v[188:191], a[80:83], v[220:223], v[188:191]
    v_mfma_f32_16x16x32_bf16 v[196:199], a[84:87], v[220:223], v[196:199]
    ds_read_b128 v[220:223], v1 offset:29696
    s_waitcnt lgkmcnt(7)
    v_mfma_f32_16x16x32_bf16 v[184:187], a[88:91], v[224:227], v[184:187]
    s_waitcnt vmcnt(0)
    s_barrier
    v_mfma_f32_16x16x32_bf16 v[192:195], a[92:95], v[224:227], v[192:195]
    ds_read_b128 v[224:227], v1 offset:30720
    s_waitcnt lgkmcnt(7)
    v_mfma_f32_16x16x32_bf16 v[188:191], a[88:91], v[228:231], v[188:191]
    buffer_load_dwordx2 v[18:19], v6, s[44:47], s7 offen
    buffer_load_dword v13, v7, s[36:39], s71 offen sc1
    v_mfma_f32_16x16x32_bf16 v[196:199], a[92:95], v[228:231], v[196:199]
    ds_read_b128 v[228:231], v1 offset:31744
    s_waitcnt lgkmcnt(7)
    v_mfma_f32_16x16x32_bf16 v[184:187], a[96:99], v[200:203], v[184:187]
    v_mfma_f32_16x16x32_bf16 v[192:195], a[100:103], v[200:203], v[192:195]
    ds_read_b128 v[200:203], v1 offset:32768
    s_waitcnt lgkmcnt(7)
    v_mfma_f32_16x16x32_bf16 v[188:191], a[96:99], v[204:207], v[188:191]
    v_mfma_f32_16x16x32_bf16 v[196:199], a[100:103], v[204:207], v[196:199]
    ds_read_b128 v[204:207], v1 offset:33792
    s_waitcnt lgkmcnt(7)
    v_mfma_f32_16x16x32_bf16 v[184:187], a[104:107], v[208:211], v[184:187]
    s_xor_b32 s14, s0, 0
    s_and_b32 s14, s14, 1
    s_mul_i32 s14, s14, 24576
    s_lshl_b32 s96, s54, 11
    s_add_u32 s14, s14, s96
    s_add_u32 m0, s14, 65536
    s_add_u32 s14, s14, s96
    buffer_load_dwordx4 v1, s[36:39], s64 offen offset:0 sc1 lds
    v_mfma_f32_16x16x32_bf16 v[192:195], a[108:111], v[208:211], v[192:195]
    ds_read_b128 v[208:211], v1 offset:34816
    s_waitcnt lgkmcnt(7)
    v_mfma_f32_16x16x32_bf16 v[188:191], a[104:107], v[212:215], v[188:191]
    v_mfma_f32_16x16x32_bf16 v[196:199], a[108:111], v[212:215], v[196:199]
    ds_read_b128 v[212:215], v1 offset:35840
    s_waitcnt lgkmcnt(7)
    v_mfma_f32_16x16x32_bf16 v[184:187], a[112:115], v[216:219], v[184:187]
    v_mfma_f32_16x16x32_bf16 v[192:195], a[116:119], v[216:219], v[192:195]
    ds_read_b128 v[216:219], v1 offset:36864
    s_waitcnt lgkmcnt(7)
    v_mfma_f32_16x16x32_bf16 v[188:191], a[112:115], v[220:223], v[188:191]
    buffer_load_dwordx4 v1, s[36:39], s64 offen offset:1024 sc1 lds
    v_mfma_f32_16x16x32_bf16 v[196:199], a[116:119], v[220:223], v[196:199]
    ds_read_b128 v[220:223], v1 offset:37888
    s_waitcnt lgkmcnt(7)
    v_mfma_f32_16x16x32_bf16 v[184:187], a[120:123], v[224:227], v[184:187]
    v_mfma_f32_16x16x32_bf16 v[192:195], a[124:127], v[224:227], v[192:195]
    ds_read_b128 v[224:227], v1 offset:38912
    s_waitcnt lgkmcnt(7)
    v_mfma_f32_16x16x32_bf16 v[188:191], a[120:123], v[228:231], v[188:191]
    v_mfma_f32_16x16x32_bf16 v[196:199], a[124:127], v[228:231], v[196:199]
    ds_read_b128 v[228:231], v1 offset:39936
    s_waitcnt lgkmcnt(7)
    v_mfma_f32_16x16x32_bf16 v[184:187], a[128:131], v[200:203], v[184:187]
    s_add_u32 m0, s14, 73728
    s_nop 0
    buffer_load_dwordx4 v1, s[36:39], s65 offen offset:0 sc1 lds
    v_mfma_f32_16x16x32_bf16 v[192:195], a[132:135], v[200:203], v[192:195]
    ds_read_b128 v[200:203], v1 offset:40960
    s_waitcnt lgkmcnt(7)
    v_mfma_f32_16x16x32_bf16 v[188:191], a[128:131], v[204:207], v[188:191]
    v_mfma_f32_16x16x32_bf16 v[196:199], a[132:135], v[204:207], v[196:199]
    ds_read_b128 v[204:207], v1 offset:41984
    s_waitcnt lgkmcnt(7)
    v_mfma_f32_16x16x32_bf16 v[184:187], a[136:139], v[208:211], v[184:187]
    v_mfma_f32_16x16x32_bf16 v[192:195], a[140:143], v[208:211], v[192:195]
    ds_read_b128 v[208:211], v1 offset:43008
    s_waitcnt lgkmcnt(7)
    v_mfma_f32_16x16x32_bf16 v[188:191], a[136:139], v[212:215], v[188:191]
    buffer_load_dwordx4 v1, s[36:39], s65 offen offset:1024 sc1 lds
    v_mfma_f32_16x16x32_bf16 v[196:199], a[140:143], v[212:215], v[196:199]
    ds_read_b128 v[212:215], v1 offset:44032
    s_waitcnt lgkmcnt(7)
    v_mfma_f32_16x16x32_bf16 v[184:187], a[144:147], v[216:219], v[184:187]
    v_mfma_f32_16x16x32_bf16 v[192:195], a[148:151], v[216:219], v[192:195]
    ds_read_b128 v[216:219], v1 offset:45056
    s_waitcnt lgkmcnt(7)
    v_mfma_f32_16x16x32_bf16 v[188:191], a[144:147], v[220:223], v[188:191]
    v_mfma_f32_16x16x32_bf16 v[196:199], a[148:151], v[220:223], v[196:199]
    ds_read_b128 v[220:223], v1 offset:46080
    s_waitcnt lgkmcnt(7)
    v_mfma_f32_16x16x32_bf16 v[184:187], a[152:155], v[224:227], v[184:187]
    buffer_load_dwordx4 v1, s[36:39], s65 offen offset:2048 sc1 lds
    v_mfma_f32_16x16x32_bf16 v[192:195], a[156:159], v[224:227], v[192:195]
    ds_read_b128 v[224:227], v1 offset:47104
    s_waitcnt lgkmcnt(7)
    v_mfma_f32_16x16x32_bf16 v[188:191], a[152:155], v[228:231], v[188:191]
    v_mfma_f32_16x16x32_bf16 v[196:199], a[156:159], v[228:231], v[196:199]
    ds_read_b128 v[228:231], v1 offset:48128
    s_waitcnt lgkmcnt(7)
    v_mfma_f32_16x16x32_bf16 v[184:187], a[160:163], v[200:203], v[184:187]
    v_mfma_f32_16x16x32_bf16 v[192:195], a[164:167], v[200:203], v[192:195]
    ds_read_b128 v[200:203], v1 offset:49152
    s_waitcnt lgkmcnt(7)
    v_mfma_f32_16x16x32_bf16 v[188:191], a[160:163], v[204:207], v[188:191]
    buffer_load_dwordx4 v1, s[36:39], s65 offen offset:3072 sc1 lds
    v_mfma_f32_16x16x32_bf16 v[196:199], a[164:167], v[204:207], v[196:199]
    ds_read_b128 v[204:207], v1 offset:50176
    s_waitcnt lgkmcnt(7)
    v_mfma_f32_16x16x32_bf16 v[184:187], a[168:171], v[208:211], v[184:187]
    v_mfma_f32_16x16x32_bf16 v[192:195], a[172:175], v[208:211], v[192:195]
    ds_read_b128 v[208:211], v1 offset:51200
    s_waitcnt lgkmcnt(7)
    v_mfma_f32_16x16x32_bf16 v[188:191], a[168:171], v[212:215], v[188:191]
    v_mfma_f32_16x16x32_bf16 v[196:199], a[172:175], v[212:215], v[196:199]
    ds_read_b128 v[212:215], v1 offset:52224
    s_waitcnt lgkmcnt(7)
    v_mfma_f32_16x16x32_bf16 v[184:187], a[176:179], v[216:219], v[184:187]
    v_mfma_f32_16x16x32_bf16 v[192:195], a[180:183], v[216:219], v[192:195]
    ds_read_b128 v[216:219], v1 offset:53248
    s_waitcnt lgkmcnt(7)
    v_mfma_f32_16x16x32_bf16 v[188:191], a[176:179], v[220:223], v[188:191]
    v_mfma_f32_16x16x32_bf16 v[196:199], a[180:183], v[220:223], v[196:199]
    ds_read_b128 v[220:223], v1 offset:54272
    s_waitcnt lgkmcnt(7)
    v_mfma_f32_16x16x32_bf16 v[184:187], a[184:187], v[224:227], v[184:187]
    v_mfma_f32_16x16x32_bf16 v[192:195], a[188:191], v[224:227], v[192:195]
    ds_read_b128 v[224:227], v1 offset:55296
    s_waitcnt lgkmcnt(7)
    v_mfma_f32_16x16x32_bf16 v[188:191], a[184:187], v[228:231], v[188:191]
    v_mfma_f32_16x16x32_bf16 v[196:199], a[188:191], v[228:231], v[196:199]
    ds_read_b128 v[228:231], v1 offset:56320
    s_waitcnt lgkmcnt(7)
    v_mfma_f32_16x16x32_bf16 v[184:187], a[192:195], v[200:203], v[184:187]
    v_mfma_f32_16x16x32_bf16 v[192:195], a[196:199], v[200:203], v[192:195]
    ds_read_b128 v[200:203], v1 offset:57344
    s_waitcnt lgkmcnt(7)
    v_mfma_f32_16x16x32_bf16 v[188:191], a[192:195], v[204:207], v[188:191]
    v_mfma_f32_16x16x32_bf16 v[196:199], a[196:199], v[204:207], v[196:199]
    ds_read_b128 v[204:207], v1 offset:58368
    s_waitcnt lgkmcnt(7)
    v_mfma_f32_16x16x32_bf16 v[184:187], a[200:203], v[208:211], v[184:187]
    v_mfma_f32_16x16x32_bf16 v[192:195], a[204:207], v[208:211], v[192:195]
    ds_read_b128 v[208:211], v1 offset:59392
    s_waitcnt lgkmcnt(7)
    v_mfma_f32_16x16x32_bf16 v[188:191], a[200:203], v[212:215], v[188:191]
    v_mfma_f32_16x16x32_bf16 v[196:199], a[204:207], v[212:215], v[196:199]
    ds_read_b128 v[212:215], v1 offset:60416
    s_waitcnt lgkmcnt(7)
    v_mfma_f32_16x16x32_bf16 v[184:187], a[208:211], v[216:219], v[184:187]
    v_mfma_f32_16x16x32_bf16 v[192:195], a[212:215], v[216:219], v[192:195]
    ds_read_b128 v[216:219], v1 offset:61440
    s_waitcnt lgkmcnt(7)
    v_mfma_f32_16x16x32_bf16 v[188:191], a[208:211], v[220:223], v[188:191]
    v_mfma_f32_16x16x32_bf16 v[196:199], a[212:215], v[220:223], v[196:199]
    ds_read_b128 v[220:223], v1 offset:62464
    s_waitcnt lgkmcnt(7)
    v_mfma_f32_16x16x32_bf16 v[184:187], a[216:219], v[224:227], v[184:187]
    v_mfma_f32_16x16x32_bf16 v[192:195], a[220:223], v[224:227], v[192:195]
    ds_read_b128 v[224:227], v1 offset:63488
    s_waitcnt lgkmcnt(7)
    v_mfma_f32_16x16x32_bf16 v[188:191], a[216:219], v[228:231], v[188:191]
    v_mfma_f32_16x16x32_bf16 v[196:199], a[220:223], v[228:231], v[196:199]
    ds_read_b128 v[228:231], v1 offset:64512
    s_waitcnt lgkmcnt(7)
    v_mfma_f32_16x16x32_bf16 v[184:187], a[224:227], v[200:203], v[184:187]
    v_mfma_f32_16x16x32_bf16 v[192:195], a[228:231], v[200:203], v[192:195]
    s_waitcnt lgkmcnt(6)
    v_mfma_f32_16x16x32_bf16 v[188:191], a[224:227], v[204:207], v[188:191]
    v_mfma_f32_16x16x32_bf16 v[196:199], a[228:231], v[204:207], v[196:199]
    s_waitcnt lgkmcnt(5)
    v_mfma_f32_16x16x32_bf16 v[184:187], a[232:235], v[208:211], v[184:187]
    v_mfma_f32_16x16x32_bf16 v[192:195], a[236:239], v[208:211], v[192:195]
    s_waitcnt lgkmcnt(4)
    v_mfma_f32_16x16x32_bf16 v[188:191], a[232:235], v[212:215], v[188:191]
    v_mfma_f32_16x16x32_bf16 v[196:199], a[236:239], v[212:215], v[196:199]
    s_waitcnt lgkmcnt(3)
    v_mfma_f32_16x16x32_bf16 v[184:187], a[240:243], v[216:219], v[184:187]
    v_mfma_f32_16x16x32_bf16 v[192:195], a[244:247], v[216:219], v[192:195]
    s_waitcnt lgkmcnt(2)
    v_mfma_f32_16x16x32_bf16 v[188:191], a[240:243], v[220:223], v[188:191]
    v_mfma_f32_16x16x32_bf16 v[196:199], a[244:247], v[220:223], v[196:199]
    s_waitcnt lgkmcnt(1)
    v_mfma_f32_16x16x32_bf16 v[184:187], a[248:251], v[224:227], v[184:187]
    v_mfma_f32_16x16x32_bf16 v[192:195], a[252:255], v[224:227], v[192:195]
    s_waitcnt lgkmcnt(0)
    v_mfma_f32_16x16x32_bf16 v[188:191], a[248:251], v[228:231], v[188:191]
    v_mfma_f32_16x16x32_bf16 v[196:199], a[252:255], v[228:231], v[196:199]
    s_waitcnt vmcnt(6)
    v_mov_b32 v38, v18
    v_mov_b32 v39, v19
    v_mov_b32 v37, v13
    s_mov_b32 s70, s7
    s_branch L_p2_wo1
    s_nop 0
    s_nop 0
L_p2_wo2:
    ds_read_b128 v[200:203], v1 offset:0
    ds_read_b128 v[204:207], v1 offset:1024
    ds_read_b128 v[208:211], v1 offset:2048
    ds_read_b128 v[212:215], v1 offset:3072
    ds_read_b128 v[216:219], v1 offset:4096
    ds_read_b128 v[220:223], v1 offset:5120
    ds_read_b128 v[224:227], v1 offset:6144
    ds_read_b128 v[228:231], v1 offset:7168
    s_waitcnt lgkmcnt(7)
    v_mfma_f32_16x16x32_bf16 v[184:187], a[0:3], v[200:203], 0
    v_mfma_f32_16x16x32_bf16 v[192:195], a[4:7], v[200:203], 0
    ds_read_b128 v[200:203], v1 offset:8192
    s_waitcnt lgkmcnt(7)
    v_mfma_f32_16x16x32_bf16 v[188:191], a[0:3], v[204:207], 0
    v_mfma_f32_16x16x32_bf16 v[196:199], a[4:7], v[204:207], 0
    ds_read_b128 v[204:207], v1 offset:9216
    s_waitcnt lgkmcnt(7)
    v_mfma_f32_16x16x32_bf16 v[184:187], a[8:11], v[208:211], v[184:187]
    v_mfma_f32_16x16x32_bf16 v[192:195], a[12:15], v[208:211], v[192:195]
    ds_read_b128 v[208:211], v1 offset:10240
    s_waitcnt lgkmcnt(7)
    v_mfma_f32_16x16x32_bf16 v[188:191], a[8:11], v[212:215], v[188:191]
    v_mfma_f32_16x16x32_bf16 v[196:199], a[12:15], v[212:215], v[196:199]
    ds_read_b128 v[212:215], v1 offset:11264
    s_waitcnt lgkmcnt(7)
    v_mfma_f32_16x16x32_bf16 v[184:187], a[16:19], v[216:219], v[184:187]
    v_mfma_f32_16x16x32_bf16 v[192:195], a[20:23], v[216:219], v[192:195]
    ds_read_b128 v[216:219], v1 offset:12288
    s_waitcnt lgkmcnt(7)
    v_mfma_f32_16x16x32_bf16 v[188:191], a[16:19], v[220:223], v[188:191]
    v_mfma_f32_16x16x32_bf16 v[196:199], a[20:23], v[220:223], v[196:199]
    ds_read_b128 v[220:223], v1 offset:13312
    s_waitcnt lgkmcnt(7)
    v_mfma_f32_16x16x32_bf16 v[184:187], a[24:27], v[224:227], v[184:187]
    v_mfma_f32_16x16x32_bf16 v[192:195], a[28:31], v[224:227], v[192:195]
    ds_read_b128 v[224:227], v1 offset:14336
    s_waitcnt lgkmcnt(7)
    v_mfma_f32_16x16x32_bf16 v[188:191], a[24:27], v[228:231], v[188:191]
    v_mfma_f32_16x16x32_bf16 v[196:199], a[28:31], v[228:231], v[196:199]
    ds_read_b128 v[228:231], v1 offset:15360
    s_waitcnt lgkmcnt(7)
    v_mfma_f32_16x16x32_bf16 v[184:187], a[32:35], v[200:203], v[184:187]
    v_mfma_f32_16x16x32_bf16 v[192:195], a[36:39], v[200:203], v[192:195]
    ds_read_b128 v[200:203], v1 offset:16384
    s_waitcnt lgkmcnt(7)
    v_mfma_f32_16x16x32_bf16 v[188:191], a[32:35], v[204:207], v[188:191]
    v_mfma_f32_16x16x32_bf16 v[196:199], a[36:39], v[204:207], v[196:199]
    ds_read_b128 v[204:207], v1 offset:17408
    s_waitcnt lgkmcnt(7)
    v_mfma_f32_16x16x32_bf16 v[184:187], a[40:43], v[208:211], v[184:187]
    v_mfma_f32_16x16x32_bf16 v[192:195], a[44:47], v[208:211], v[192:195]
    ds_read_b128 v[208:211], v1 offset:18432
    s_waitcnt lgkmcnt(7)
    v_mfma_f32_16x16x32_bf16 v[188:191], a[40:43], v[212:215], v[188:191]
    v_mfma_f32_16x16x32_bf16 v[196:199], a[44:47], v[212:215], v[196:199]
    ds_read_b128 v[212:215], v1 offset:19456
    s_waitcnt lgkmcnt(7)
    v_mfma_f32_16x16x32_bf16 v[184:187], a[48:51], v[216:219], v[184:187]
    v_mfma_f32_16x16x32_bf16 v[192:195], a[52:55], v[216:219], v[192:195]
    ds_read_b128 v[216:219], v1 offset:20480
    s_waitcnt lgkmcnt(7)
    v_mfma_f32_16x16x32_bf16 v[188:191], a[48:51], v[220:223], v[188:191]
    v_mfma_f32_16x16x32_bf16 v[196:199], a[52:55], v[220:223], v[196:199]
    ds_read_b128 v[220:223], v1 offset:21504
    s_waitcnt lgkmcnt(7)
    v_mfma_f32_16x16x32_bf16 v[184:187], a[56:59], v[224:227], v[184:187]
    v_mfma_f32_16x16x32_bf16 v[192:195], a[60:63], v[224:227], v[192:195]
    ds_read_b128 v[224:227], v1 offset:22528
    s_waitcnt lgkmcnt(7)
    v_mfma_f32_16x16x32_bf16 v[188:191], a[56:59], v[228:231], v[188:191]
    v_mfma_f32_16x16x32_bf16 v[196:199], a[60:63], v[228:231], v[196:199]
    ds_read_b128 v[228:231], v1 offset:23552
    s_waitcnt lgkmcnt(7)
    v_mfma_f32_16x16x32_bf16 v[184:187], a[64:67], v[200:203], v[184:187]
    v_mfma_f32_16x16x32_bf16 v[192:195], a[68:71], v[200:203], v[192:195]
    ds_read_b128 v[200:203], v1 offset:24576
    s_waitcnt lgkmcnt(7)
    v_mfma_f32_16x16x32_bf16 v[188:191], a[64:67], v[204:207], v[188:191]
    v_mfma_f32_16x16x32_bf16 v[196:199], a[68:71], v[204:207], v[196:199]
    ds_read_b128 v[204:207], v1 offset:25600
    s_waitcnt lgkmcnt(7)
    v_mfma_f32_16x16x32_bf16 v[184:187], a[72:75], v[208:211], v[184:187]
    v_mfma_f32_16x16x32_bf16 v[192:195], a[76:79], v[208:211], v[192:195]
    ds_read_b128 v[208:211], v1 offset:26624
    s_waitcnt lgkmcnt(7)
    v_mfma_f32_16x16x32_bf16 v[188:191], a[72:75], v[212:215], v[188:191]
    v_mfma_f32_16x16x32_bf16 v[196:199], a[76:79], v[212:215], v[196:199]
    ds_read_b128 v[212:215], v1 offset:27648
    s_waitcnt lgkmcnt(7)
    v_mfma_f32_16x16x32_bf16 v[184:187], a[80:83], v[216:219], v[184:187]
    v_mfma_f32_16x16x32_bf16 v[192:195], a[84:87], v[216:219], v[192:195]
    ds_read_b128 v[216:219], v1 offset:28672
    s_waitcnt lgkmcnt(7)
    v_mfma_f32_16x16x32_bf16 v[188:191], a[80:83], v[220:223], v[188:191]
    v_mfma_f32_16x16x32_bf16 v[196:199], a[84:87], v[220:223], v[196:199]
    ds_read_b128 v[220:223], v1 offset:29696
    s_waitcnt lgkmcnt(7)
    v_mfma_f32_16x16x32_bf16 v[184:187], a[88:91], v[224:227], v[184:187]
    s_waitcnt vmcnt(0)
    s_barrier
    v_mfma_f32_16x16x32_bf16 v[192:195], a[92:95], v[224:227], v[192:195]
    ds_read_b128 v[224:227], v1 offset:30720
    s_waitcnt lgkmcnt(7)
    v_mfma_f32_16x16x32_bf16 v[188:191], a[88:91], v[228:231], v[188:191]
    buffer_load_dwordx2 v[18:19], v6, s[44:47], s7 offen
    buffer_load_dword v13, v7, s[36:39], s71 offen sc1
    v_mfma_f32_16x16x32_bf16 v[196:199], a[92:95], v[228:231], v[196:199]
    s_lshl_b32 s2, s75, 5
    ds_read_b128 v[228:231], v1 offset:31744
    s_waitcnt lgkmcnt(7)
    v_mfma_f32_16x16x32_bf16 v[184:187], a[96:99], v[200:203], v[184:187]
    s_sub_u32 s2, s59, s2
    v_cmp_eq_u32 vcc, s2, v36
    v_mfma_f32_16x16x32_bf16 v[192:195], a[100:103], v[200:203], v[192:195]
    v_lshlrev_b32 v56, 16, v38
    ds_read_b128 v[200:203], v1 offset:32768
    s_waitcnt lgkmcnt(7)
    v_mfma_f32_16x16x32_bf16 v[188:191], a[96:99], v[204:207], v[188:191]
    v_and_b32 v57, 0xffff0000, v38
    v_lshlrev_b32 v58, 16, v39
    v_mfma_f32_16x16x32_bf16 v[196:199], a[100:103], v[204:207], v[196:199]
    v_and_b32 v59, 0xffff0000, v39
    ds_read_b128 v[204:207], v1 offset:33792
    s_waitcnt lgkmcnt(7)
    v_mfma_f32_16x16x32_bf16 v[184:187], a[104:107], v[208:211], v[184:187]
    s_xor_b32 s14, s0, 0
    s_and_b32 s14, s14, 1
    s_mul_i32 s14, s14, 24576
    s_lshl_b32 s96, s54, 11
    s_add_u32 s14, s14, s96
    s_add_u32 m0, s14, 65536
    s_add_u32 s14, s14, s96
    buffer_load_dwordx4 v1, s[36:39], s64 offen offset:0 sc1 lds
    v_mfma_f32_16x16x32_bf16 v[192:195], a[108:111], v[208:211], v[192:195]
    v_cndmask_b32 v60, 0, v14, vcc
    ds_read_b128 v[208:211], v1 offset:34816
    s_waitcnt lgkmcnt(7)
    v_mfma_f32_16x16x32_bf16 v[188:191], a[104:107], v[212:215], v[188:191]
    v_add_f32 v56, v56, v60
    v_cndmask_b32_e64 v61, 0, v15, vcc
    v_mfma_f32_16x16x32_bf16 v[196:199], a[108:111], v[212:215], v[196:199]
    v_add_f32 v57, v57, v61
    ds_read_b128 v[212:215], v1 offset:35840
    s_waitcnt lgkmcnt(7)
    v_mfma_f32_16x16x32_bf16 v[184:187], a[112:115], v[216:219], v[184:187]
    v_cndmask_b32 v62, 0, v16, vcc
    v_add_f32 v58, v58, v62
    v_mfma_f32_16x16x32_bf16 v[192:195], a[116:119], v[216:219], v[192:195]
    v_cndmask_b32 v63, 0, v17, vcc
    ds_read_b128 v[216:219], v1 offset:36864
    s_waitcnt lgkmcnt(7)
    v_mfma_f32_16x16x32_bf16 v[188:191], a[112:115], v[220:223], v[188:191]
    buffer_load_dwordx4 v1, s[36:39], s64 offen offset:1024 sc1 lds
    v_mfma_f32_16x16x32_bf16 v[196:199], a[116:119], v[220:223], v[196:199]
    v_add_f32_e64 v59, v59, v63
    ds_read_b128 v[220:223], v1 offset:37888
    s_waitcnt lgkmcnt(7)
    v_mfma_f32_16x16x32_bf16 v[184:187], a[120:123], v[224:227], v[184:187]
    v_cvt_pk_bf16_f32 v57, v56, v57
    v_lshlrev_b32 v56, 16, v57
    v_mfma_f32_16x16x32_bf16 v[192:195], a[124:127], v[224:227], v[192:195]
    v_and_b32 v57, 0xffff0000, v57
    ds_read_b128 v[224:227], v1 offset:38912
    s_waitcnt lgkmcnt(7)
    v_mfma_f32_16x16x32_bf16 v[188:191], a[120:123], v[228:231], v[188:191]
    v_cvt_pk_bf16_f32 v59, v58, v59
    v_lshlrev_b32 v58, 16, v59
    v_mfma_f32_16x16x32_bf16 v[196:199], a[124:127], v[228:231], v[196:199]
    v_and_b32 v59, 0xffff0000, v59
    ds_read_b128 v[228:231], v1 offset:39936
    s_waitcnt lgkmcnt(7)
    v_mfma_f32_16x16x32_bf16 v[184:187], a[128:131], v[200:203], v[184:187]
    s_add_u32 m0, s14, 73728
    s_nop 0
    buffer_load_dwordx4 v1, s[36:39], s65 offen offset:0 sc1 lds
    v_mfma_f32_16x16x32_bf16 v[192:195], a[132:135], v[200:203], v[192:195]
    v_sub_f32 v46, 1.0, v37
    ds_read_b128 v[200:203], v1 offset:40960
    s_waitcnt lgkmcnt(7)
    v_mfma_f32_16x16x32_bf16 v[188:191], a[128:131], v[204:207], v[188:191]
    v_cvt_pk_bf16_f32 v46, v46, v46
    v_lshlrev_b32 v46, 16, v46
    v_mfma_f32_16x16x32_bf16 v[196:199], a[132:135], v[204:207], v[196:199]
    v_mul_f32 v56, v56, v46
    ds_read_b128 v[204:207], v1 offset:41984
    s_waitcnt lgkmcnt(7)
    v_mfma_f32_16x16x32_bf16 v[184:187], a[136:139], v[208:211], v[184:187]
    v_mul_f32 v57, v57, v46
    v_mul_f32_e64 v58, v58, v46
    v_mfma_f32_16x16x32_bf16 v[192:195], a[140:143], v[208:211], v[192:195]
    v_mul_f32 v59, v59, v46
    ds_read_b128 v[208:211], v1 offset:43008
    s_waitcnt lgkmcnt(7)
    v_mfma_f32_16x16x32_bf16 v[188:191], a[136:139], v[212:215], v[188:191]
    buffer_load_dwordx4 v1, s[36:39], s65 offen offset:1024 sc1 lds
    v_mfma_f32_16x16x32_bf16 v[196:199], a[140:143], v[212:215], v[196:199]
    v_cvt_pk_bf16_f32 v57, v56, v57
    ds_read_b128 v[212:215], v1 offset:44032
    s_waitcnt lgkmcnt(7)
    v_mfma_f32_16x16x32_bf16 v[184:187], a[144:147], v[216:219], v[184:187]
    v_lshlrev_b32 v56, 16, v57
    v_and_b32 v57, 0xffff0000, v57
    v_mfma_f32_16x16x32_bf16 v[192:195], a[148:151], v[216:219], v[192:195]
    v_cvt_pk_bf16_f32 v59, v58, v59
    ds_read_b128 v[216:219], v1 offset:45056
    s_waitcnt lgkmcnt(7)
    v_mfma_f32_16x16x32_bf16 v[188:191], a[144:147], v[220:223], v[188:191]
    v_lshlrev_b32 v58, 16, v59
    v_and_b32 v59, 0xffff0000, v59
    v_mfma_f32_16x16x32_bf16 v[196:199], a[148:151], v[220:223], v[196:199]
    v_add_f32 v232, v232, v236
    ds_read_b128 v[220:223], v1 offset:46080
    s_waitcnt lgkmcnt(7)
    v_mfma_f32_16x16x32_bf16 v[184:187], a[152:155], v[224:227], v[184:187]
    buffer_load_dwordx4 v1, s[36:39], s65 offen offset:2048 sc1 lds
    v_mfma_f32_16x16x32_bf16 v[192:195], a[156:159], v[224:227], v[192:195]
    v_add_f32 v240, v240, v244
    ds_read_b128 v[224:227], v1 offset:47104
    s_waitcnt lgkmcnt(7)
    v_mfma_f32_16x16x32_bf16 v[188:191], a[152:155], v[228:231], v[188:191]
    v_add_f32 v232, v232, v240
    v_add_f32 v233, v233, v237
    v_mfma_f32_16x16x32_bf16 v[196:199], a[156:159], v[228:231], v[196:199]
    v_add_f32 v241, v241, v245
    ds_read_b128 v[228:231], v1 offset:48128
    s_waitcnt lgkmcnt(7)
    v_mfma_f32_16x16x32_bf16 v[184:187], a[160:163], v[200:203], v[184:187]
    v_add_f32 v233, v233, v241
    v_add_f32 v234, v234, v238
    v_mfma_f32_16x16x32_bf16 v[192:195], a[164:167], v[200:203], v[192:195]
    v_add_f32 v242, v242, v246
    ds_read_b128 v[200:203], v1 offset:49152
    s_waitcnt lgkmcnt(7)
    v_mfma_f32_16x16x32_bf16 v[188:191], a[160:163], v[204:207], v[188:191]
    buffer_load_dwordx4 v1, s[36:39], s65 offen offset:3072 sc1 lds
    v_mfma_f32_16x16x32_bf16 v[196:199], a[164:167], v[204:207], v[196:199]
    v_add_f32 v234, v234, v242
    ds_read_b128 v[204:207], v1 offset:50176
    s_waitcnt lgkmcnt(7)
    v_mfma_f32_16x16x32_bf16 v[184:187], a[168:171], v[208:211], v[184:187]
    v_add_f32_e64 v235, v235, v239
    v_add_f32_e64 v243, v243, v247
    v_mfma_f32_16x16x32_bf16 v[192:195], a[172:175], v[208:211], v[192:195]
    v_add_f32 v235, v235, v243
    ds_read_b128 v[208:211], v1 offset:51200
    s_waitcnt lgkmcnt(7)
    v_mfma_f32_16x16x32_bf16 v[188:191], a[168:171], v[212:215], v[188:191]
    v_cvt_pk_bf16_f32 v233, v232, v233
    v_lshlrev_b32 v232, 16, v233
    v_mfma_f32_16x16x32_bf16 v[196:199], a[172:175], v[212:215], v[196:199]
    v_and_b32 v233, 0xffff0000, v233
    ds_read_b128 v[212:215], v1 offset:52224
    s_waitcnt lgkmcnt(7)
    v_mfma_f32_16x16x32_bf16 v[184:187], a[176:179], v[216:219], v[184:187]
    v_cvt_pk_bf16_f32 v235, v234, v235
    v_lshlrev_b32_e64 v234, 16, v235
    v_mfma_f32_16x16x32_bf16 v[192:195], a[180:183], v[216:219], v[192:195]
    v_and_b32 v235, 0xffff0000, v235
    ds_read_b128 v[216:219], v1 offset:53248
    s_waitcnt lgkmcnt(7)
    v_mfma_f32_16x16x32_bf16 v[188:191], a[176:179], v[220:223], v[188:191]
    v_mul_f32 v232, v232, v37
    v_mul_f32 v233, v233, v37
    v_mfma_f32_16x16x32_bf16 v[196:199], a[180:183], v[220:223], v[196:199]
    v_mul_f32_e64 v234, v234, v37
    ds_read_b128 v[220:223], v1 offset:54272
    s_waitcnt lgkmcnt(7)
    v_mfma_f32_16x16x32_bf16 v[184:187], a[184:187], v[224:227], v[184:187]
    v_mul_f32_e64 v235, v235, v37
    v_cvt_pk_bf16_f32 v233, v232, v233
    v_mfma_f32_16x16x32_bf16 v[192:195], a[188:191], v[224:227], v[192:195]
    v_lshlrev_b32 v232, 16, v233
    ds_read_b128 v[224:227], v1 offset:55296
    s_waitcnt lgkmcnt(7)
    v_mfma_f32_16x16x32_bf16 v[188:191], a[184:187], v[228:231], v[188:191]
    v_and_b32 v233, 0xffff0000, v233
    v_cvt_pk_bf16_f32 v235, v234, v235
    v_mfma_f32_16x16x32_bf16 v[196:199], a[188:191], v[228:231], v[196:199]
    v_lshlrev_b32 v234, 16, v235
    ds_read_b128 v[228:231], v1 offset:56320
    s_waitcnt lgkmcnt(7)
    v_mfma_f32_16x16x32_bf16 v[184:187], a[192:195], v[200:203], v[184:187]
    v_and_b32 v235, 0xffff0000, v235
    v_add_f32_e64 v56, v56, v232
    v_mfma_f32_16x16x32_bf16 v[192:195], a[196:199], v[200:203], v[192:195]
    v_add_f32 v57, v57, v233
    ds_read_b128 v[200:203], v1 offset:57344
    s_waitcnt lgkmcnt(7)
    v_mfma_f32_16x16x32_bf16 v[188:191], a[192:195], v[204:207], v[188:191]
    v_add_f32_e64 v58, v58, v234
    v_add_f32 v59, v59, v235
    v_mfma_f32_16x16x32_bf16 v[196:199], a[196:199], v[204:207], v[196:199]
    v_cvt_pk_bf16_f32 v46, v56, v57
    ds_read_b128 v[204:207], v1 offset:58368
    s_waitcnt lgkmcnt(7)
    v_mfma_f32_16x16x32_bf16 v[184:187], a[200:203], v[208:211], v[184:187]
    v_cvt_pk_bf16_f32 v47, v58, v59
    buffer_store_dwordx2 v[46:47], v6, s[48:51], s70 offen
    v_mfma_f32_16x16x32_bf16 v[192:195], a[204:207], v[208:211], v[192:195]
    ds_read_b128 v[208:211], v1 offset:59392
    s_waitcnt lgkmcnt(7)
    v_mfma_f32_16x16x32_bf16 v[188:191], a[200:203], v[212:215], v[188:191]
    v_mfma_f32_16x16x32_bf16 v[196:199], a[204:207], v[212:215], v[196:199]
    ds_read_b128 v[212:215], v1 offset:60416
    s_waitcnt lgkmcnt(7)
    v_mfma_f32_16x16x32_bf16 v[184:187], a[208:211], v[216:219], v[184:187]
    v_mfma_f32_16x16x32_bf16 v[192:195], a[212:215], v[216:219], v[192:195]
    ds_read_b128 v[216:219], v1 offset:61440
    s_waitcnt lgkmcnt(7)
    v_mfma_f32_16x16x32_bf16 v[188:191], a[208:211], v[220:223], v[188:191]
    v_mfma_f32_16x16x32_bf16 v[196:199], a[212:215], v[220:223], v[196:199]
    ds_read_b128 v[220:223], v1 offset:62464
    s_waitcnt lgkmcnt(7)
    v_mfma_f32_16x16x32_bf16 v[184:187], a[216:219], v[224:227], v[184:187]
    v_mfma_f32_16x16x32_bf16 v[192:195], a[220:223], v[224:227], v[192:195]
    ds_read_b128 v[224:227], v1 offset:63488
    s_waitcnt lgkmcnt(7)
    v_mfma_f32_16x16x32_bf16 v[188:191], a[216:219], v[228:231], v[188:191]
    v_mfma_f32_16x16x32_bf16 v[196:199], a[220:223], v[228:231], v[196:199]
    ds_read_b128 v[228:231], v1 offset:64512
    s_waitcnt lgkmcnt(7)
    v_mfma_f32_16x16x32_bf16 v[184:187], a[224:227], v[200:203], v[184:187]
    v_mfma_f32_16x16x32_bf16 v[192:195], a[228:231], v[200:203], v[192:195]
    s_waitcnt lgkmcnt(6)
    v_mfma_f32_16x16x32_bf16 v[188:191], a[224:227], v[204:207], v[188:191]
    v_mfma_f32_16x16x32_bf16 v[196:199], a[228:231], v[204:207], v[196:199]
    s_waitcnt lgkmcnt(5)
    v_mfma_f32_16x16x32_bf16 v[184:187], a[232:235], v[208:211], v[184:187]
    v_mfma_f32_16x16x32_bf16 v[192:195], a[236:239], v[208:211], v[192:195]
    s_waitcnt lgkmcnt(4)
    v_mfma_f32_16x16x32_bf16 v[188:191], a[232:235], v[212:215], v[188:191]
    v_mfma_f32_16x16x32_bf16 v[196:199], a[236:239], v[212:215], v[196:199]
    s_waitcnt lgkmcnt(3)
    v_mfma_f32_16x16x32_bf16 v[184:187], a[240:243], v[216:219], v[184:187]
    v_mfma_f32_16x16x32_bf16 v[192:195], a[244:247], v[216:219], v[192:195]
    s_waitcnt lgkmcnt(2)
    v_mfma_f32_16x16x32_bf16 v[188:191], a[240:243], v[220:223], v[188:191]
    v_mfma_f32_16x16x32_bf16 v[196:199], a[244:247], v[220:223], v[196:199]
    s_waitcnt lgkmcnt(1)
    v_mfma_f32_16x16x32_bf16 v[184:187], a[248:251], v[224:227], v[184:187]
    v_mfma_f32_16x16x32_bf16 v[192:195], a[252:255], v[224:227], v[192:195]
    s_waitcnt lgkmcnt(0)
    v_mfma_f32_16x16x32_bf16 v[188:191], a[248:251], v[228:231], v[188:191]
    v_mfma_f32_16x16x32_bf16 v[196:199], a[252:255], v[228:231], v[196:199]
    s_waitcnt vmcnt(7)
    v_mov_b32 v38, v18
    v_mov_b32 v39, v19
    v_mov_b32 v37, v13
    s_mov_b32 s70, s7
L_p2_wo1:
    s_cmp_lg_u32 s55, 0
    s_cbranch_scc1 L_st2_21
    buffer_store_dwordx4 v[184:187], v1, s[36:39], s17 offen offset:0
    buffer_store_dwordx4 v[188:191], v1, s[36:39], s17 offen offset:1024
    buffer_store_dwordx4 v[192:195], v1, s[36:39], s17 offen offset:2048
    buffer_store_dwordx4 v[196:199], v1, s[36:39], s17 offen offset:3072
    s_branch L_st2_21_e
    s_nop 0
    s_nop 0
    s_nop 0
    s_nop 0
    s_nop 0
    s_nop 0
    s_nop 0
L_st2_21:
    buffer_store_dwordx4 v[184:187], v1, s[36:39], s17 offen offset:0 sc1
    buffer_store_dwordx4 v[188:191], v1, s[36:39], s17 offen offset:1024 sc1
    buffer_store_dwordx4 v[192:195], v1, s[36:39], s17 offen offset:2048 sc1
    buffer_store_dwordx4 v[196:199], v1, s[36:39], s17 offen offset:3072 sc1
L_st2_21_e:
    s_add_u32 s5, s58, 1
    s_mov_b32 s75, s58
    s_cmp_lg_u32 s11, 0
    s_cbranch_scc1 L_p2_shift
    s_cmp_lt_u32 s16, 64
    s_cbranch_scc0 L_p2_end
    s_waitcnt vmcnt(0)
    s_cmp_eq_u32 s5, 0
    s_cbranch_scc1 L_pub_22
    v_mov_b32 v54, s5
    s_mov_b32 s5, 0
    s_cmp_lg_u32 s55, 0
    s_cbranch_scc1 L_st2_23
    buffer_store_dword v54, v9, s[36:39], s18 offen
    s_branch L_st2_23_e
    s_nop 0
L_st2_23:
    buffer_store_dword v54, v9, s[36:39], s18 offen sc1
L_st2_23_e:
L_pub_22:
L_p2_late:
    s_xor_b32 s96, s0, 1
    s_and_b32 s96, s96, 1
    s_mul_i32 s96, s96, 24576
    s_add_u32 s96, s96, 65536
    v_add_u32 v50, s96, v1
    s_lshl_b32 s96, s19, 12
    v_add_u32 v51, s96, v50
    s_lshl_b32 s96, s3, 12
    v_add_u32 v52, s96, v50
    ds_read_b128 v[96:99], v51 offset:0
    ds_read_b128 v[152:155], v50 offset:8192
    ds_read_b128 v[168:171], v50 offset:12288
    ds_read_b128 v[100:103], v51 offset:1024
    ds_read_b128 v[156:159], v50 offset:9216
    ds_read_b128 v[172:175], v50 offset:13312
    ds_read_b128 v[104:107], v51 offset:2048
    ds_read_b128 v[160:163], v50 offset:10240
    ds_read_b128 v[176:179], v50 offset:14336
    ds_read_b128 v[108:111], v51 offset:3072
    ds_read_b128 v[164:167], v50 offset:11264
    ds_read_b128 v[180:183], v50 offset:15360
    ds_read_b128 v[136:139], v52 offset:16384
    ds_read_b128 v[140:143], v52 offset:17408
    ds_read_b128 v[144:147], v52 offset:18432
    ds_read_b128 v[148:151], v52 offset:19456
    s_cmp_gt_u32 s63, s16
    s_cbranch_scc1 L_p2_cf
    s_cmp_eq_u32 s16, 63
    s_cselect_b64 vcc, -1, 0
    s_cselect_b32 s74, s15, s74
    v_cndmask_b32 v5, v5, v3, vcc
L_pc_24:
    buffer_load_dword v46, v5, s[36:39], s74 offen sc1
    s_waitcnt vmcnt(0)
    v_min_u32_dpp v46, v46, v46 row_ror:8 row_mask:0xf bank_mask:0xf
    s_nop 1
    v_min_u32_dpp v46, v46, v46 row_ror:4 row_mask:0xf bank_mask:0xf
    s_nop 1
    v_min_u32_dpp v46, v46, v46 row_ror:2 row_mask:0xf bank_mask:0xf
    s_nop 1
    v_min_u32_dpp v46, v46, v46 row_ror:1 row_mask:0xf bank_mask:0xf
    s_nop 0
    v_readfirstlane_b32 s63, v46
    s_cmp_gt_u32 s63, s16
    s_cbranch_scc1 L_p2_cf
    s_cmp_lt_i32 s75, 0
    s_cbranch_scc1 L_pc_24_w
    s_xor_b32 s0, s0, 1
L_poll_25:
    buffer_load_dword v46, v10, s[36:39], s1 offen sc1
    s_waitcnt vmcnt(0)
    v_cmp_ge_u32 vcc, s75, v46
    s_cbranch_vccz L_poll_25_ok
    s_sub_u32 s57, s57, 1
    s_cbranch_scc1 L_exit
    s_branch L_poll_25
    s_nop 0
L_poll_25_ok:
    s_xor_b32 s96, s0, 1
    s_lshl_b32 s96, s96, 19
    s_lshl_b32 s97, s62, 14
    s_add_u32 s96, s96, s97
    s_add_u32 s96, s96, 71303168
    buffer_load_dwordx4 v[232:235], v8, s[36:39], s96 offen sc1
    s_add_u32 s96, s96, 4096
    buffer_load_dwordx4 v[236:239], v8, s[36:39], s96 offen sc1
    s_add_u32 s96, s96, 4096
    buffer_load_dwordx4 v[240:243], v8, s[36:39], s96 offen sc1
    s_add_u32 s96, s96, 4096
    buffer_load_dwordx4 v[244:247], v8, s[36:39], s96 offen sc1
    s_add_u32 s96, s96, 4096
    s_waitcnt vmcnt(0)
    s_lshl_b32 s2, s75, 5
    s_sub_u32 s2, s59, s2
    v_cmp_eq_u32 vcc, s2, v36
    v_lshlrev_b32 v56, 16, v38
    v_and_b32 v57, 0xffff0000, v38
    v_lshlrev_b32 v58, 16, v39
    v_and_b32 v59, 0xffff0000, v39
    v_cndmask_b32 v60, 0, v14, vcc
    v_add_f32 v56, v56, v60
    v_cndmask_b32 v61, 0, v15, vcc
    v_add_f32 v57, v57, v61
    v_cndmask_b32 v62, 0, v16, vcc
    v_add_f32 v58, v58, v62
    v_cndmask_b32 v63, 0, v17, vcc
    v_add_f32 v59, v59, v63
    v_cvt_pk_bf16_f32 v57, v56, v57
    v_lshlrev_b32 v56, 16, v57
    v_and_b32 v57, 0xffff0000, v57
    v_cvt_pk_bf16_f32 v59, v58, v59
    v_lshlrev_b32 v58, 16, v59
    v_and_b32 v59, 0xffff0000, v59
    v_sub_f32 v46, 1.0, v37
    v_cvt_pk_bf16_f32 v46, v46, v46
    v_lshlrev_b32 v46, 16, v46
    v_mul_f32 v56, v56, v46
    v_mul_f32 v57, v57, v46
    v_mul_f32 v58, v58, v46
    v_mul_f32 v59, v59, v46
    v_cvt_pk_bf16_f32 v57, v56, v57
    v_lshlrev_b32 v56, 16, v57
    v_and_b32 v57, 0xffff0000, v57
    v_cvt_pk_bf16_f32 v59, v58, v59
    v_lshlrev_b32 v58, 16, v59
    v_and_b32 v59, 0xffff0000, v59
    v_add_f32 v232, v232, v236
    v_add_f32 v240, v240, v244
    v_add_f32 v232, v232, v240
    v_add_f32 v233, v233, v237
    v_add_f32 v241, v241, v245
    v_add_f32 v233, v233, v241
    v_add_f32 v234, v234, v238
    v_add_f32 v242, v242, v246
    v_add_f32 v234, v234, v242
    v_add_f32 v235, v235, v239
    v_add_f32 v243, v243, v247
    v_add_f32 v235, v235, v243
    v_cvt_pk_bf16_f32 v233, v232, v233
    v_lshlrev_b32 v232, 16, v233
    v_and_b32 v233, 0xffff0000, v233
    v_cvt_pk_bf16_f32 v235, v234, v235
    v_lshlrev_b32 v234, 16, v235
    v_and_b32 v235, 0xffff0000, v235
    v_mul_f32 v232, v232, v37
    v_mul_f32 v233, v233, v37
    v_mul_f32 v234, v234, v37
    v_mul_f32 v235, v235, v37
    v_cvt_pk_bf16_f32 v233, v232, v233
    v_lshlrev_b32_e64 v232, 16, v233
    v_and_b32 v233, 0xffff0000, v233
    v_cvt_pk_bf16_f32 v235, v234, v235
    v_lshlrev_b32 v234, 16, v235
    v_and_b32 v235, 0xffff0000, v235
    v_add_f32 v56, v56, v232
    v_add_f32 v57, v57, v233
    v_add_f32 v58, v58, v234
    v_add_f32_e64 v59, v59, v235
    v_cvt_pk_bf16_f32 v46, v56, v57
    v_cvt_pk_bf16_f32 v47, v58, v59
    buffer_store_dwordx2 v[46:47], v6, s[48:51], s70 offen
    s_xor_b32 s0, s0, 1
    s_mov_b32 s75, -1
    s_branch L_pc_24
L_pc_24_w:
    s_sub_u32 s57, s57, 1
    s_cbranch_scc1 L_exit
    s_sleep 1
    s_branch L_pc_24
L_p2_cf:
    s_mul_i32 s66, s16, 196608
    s_mul_i32 s97, s53, 6144
    s_add_u32 s66, s66, s97
    s_add_u32 s66, s66, 2293760
    s_lshl_b32 s6, s3, 10
    s_add_u32 s6, s6, s66
    s_add_u32 s6, s6, 4096
    buffer_load_dwordx4 v[112:115], v1, s[36:39], s66 offen offset:0 sc1
    buffer_load_dwordx4 v[116:119], v1, s[36:39], s66 offen offset:1024 sc1
    buffer_load_dwordx4 v[120:123], v1, s[36:39], s66 offen offset:2048 sc1
    buffer_load_dwordx4 v[124:127], v1, s[36:39], s66 offen offset:3072 sc1
    buffer_load_dwordx4 v[128:131], v2, s[36:39], s6 offen offset:0 sc1
    buffer_load_dwordx4 v[132:135], v2, s[36:39], s6 offen offset:512 sc1
    s_waitcnt lgkmcnt(0)
    v_mfma_f32_16x16x32_bf16 v[56:59], v[152:155], v[96:99], v[20:23]
    v_mfma_f32_16x16x32_bf16 v[60:63], v[168:171], v[96:99], v[24:27]
    s_waitcnt lgkmcnt(0)
    v_mfma_f32_16x16x32_bf16 v[56:59], v[156:159], v[100:103], v[56:59]
    v_mfma_f32_16x16x32_bf16 v[60:63], v[172:175], v[100:103], v[60:63]
    s_waitcnt lgkmcnt(0)
    v_mfma_f32_16x16x32_bf16 v[56:59], v[160:163], v[104:107], v[56:59]
    v_mfma_f32_16x16x32_bf16 v[60:63], v[176:179], v[104:107], v[60:63]
    s_waitcnt lgkmcnt(0)
    v_mfma_f32_16x16x32_bf16 v[56:59], v[164:167], v[108:111], v[56:59]
    v_mfma_f32_16x16x32_bf16 v[60:63], v[180:183], v[108:111], v[60:63]
    s_waitcnt vmcnt(5)
    v_mfma_f32_16x16x32_bf16 v[64:67], v[112:115], v[96:99], v[28:31]
    s_waitcnt vmcnt(4)
    v_mfma_f32_16x16x32_bf16 v[64:67], v[116:119], v[100:103], v[64:67]
    s_waitcnt vmcnt(3)
    v_mfma_f32_16x16x32_bf16 v[64:67], v[120:123], v[104:107], v[64:67]
    s_waitcnt vmcnt(2)
    v_mfma_f32_16x16x32_bf16 v[64:67], v[124:127], v[108:111], v[64:67]
    s_xor_b32 s68, s0, 1
    s_lshl_b32 s68, s68, 18
    s_add_u32 s68, s68, s12
    v_max3_f32 v40, v56, v57, v58
    v_max3_f32 v41, v60, v61, v62
    v_max3_f32 v40, v40, v59, v63
    s_nop 1
    v_max3_f32 v42, v64, v65, v66
    v_max3_f32 v41, v41, v40, v67
    v_max_f32 v40, v42, v41
    v_max_f32 v42, v42, v41
    s_nop 1
    v_permlane16_swap_b32 v40, v42
    v_max_f32 v41, v40, v42
    v_max_f32 v40, v40, v42
    s_nop 1
    v_permlane32_swap_b32 v40, v41
    v_max_f32 v40, v40, v41
    v_mul_f32 v40, s72, v40
    v_fma_f32 v56, v56, s72, -v40
    v_fma_f32 v57, v57, s72, -v40
    v_fma_f32 v58, v58, s72, -v40
    v_fma_f32 v59, v59, s72, -v40
    v_fma_f32 v60, v60, s72, -v40
    v_fma_f32 v61, v61, s72, -v40
    v_fma_f32 v62, v62, s72, -v40
    v_fma_f32 v63, v63, s72, -v40
    v_fma_f32 v64, v64, s72, -v40
    v_fma_f32 v65, v65, s72, -v40
    v_fma_f32 v66, v66, s72, -v40
    v_fma_f32 v67, v67, s72, -v40
    v_exp_f32 v56, v56
    v_exp_f32 v57, v57
    v_exp_f32 v58, v58
    v_exp_f32 v59, v59
    v_exp_f32 v60, v60
    v_exp_f32 v61, v61
    v_exp_f32_e64 v62, v62
    v_exp_f32_e64 v63, v63
    v_exp_f32_e64 v64, v64
    v_exp_f32_e64 v65, v65
    v_exp_f32_e64 v66, v66
    v_exp_f32 v67, v67
    v_cvt_pk_bf16_f32 v68, v56, v57
    v_cvt_pk_bf16_f32 v69, v58, v59
    v_cvt_pk_bf16_f32 v70, v60, v61
    v_cvt_pk_bf16_f32 v71, v62, v63
    v_cvt_pk_bf16_f32 v72, v64, v65
    v_cvt_pk_bf16_f32 v73, v66, v67
    s_waitcnt lgkmcnt(0)
    v_mfma_f32_16x16x32_bf16 v[76:79], v[32:35], v[68:71], 0
    v_mfma_f32_16x16x32_bf16 v[80:83], v[136:139], v[68:71], 0
    v_mfma_f32_16x16x32_bf16 v[84:87], v[140:143], v[68:71], 0
    v_mfma_f32_16x16x32_bf16 v[88:91], v[144:147], v[68:71], 0
    v_mfma_f32_16x16x32_bf16 v[92:95], v[148:151], v[68:71], 0
    s_nop 1
    v_mfma_f32_16x16x16_bf16 v[76:79], v[32:33], v[72:73], v[76:79]
    s_waitcnt vmcnt(0)
    v_mfma_f32_16x16x16_bf16 v[80:83], v[128:129], v[72:73], v[80:83]
    v_mfma_f32_16x16x16_bf16 v[84:87], v[130:131], v[72:73], v[84:87]
    v_mfma_f32_16x16x16_bf16 v[88:91], v[132:133], v[72:73], v[88:91]
    v_mfma_f32_16x16x16_bf16 v[92:95], v[134:135], v[72:73], v[92:95]
    s_nop 2
    v_rcp_f32 v44, v76
    s_nop 0
    v_mul_f32 v80, v80, v44
    v_mul_f32 v81, v81, v44
    v_mul_f32 v82, v82, v44
    v_mul_f32 v83, v83, v44
    v_mul_f32 v84, v84, v44
    v_mul_f32 v85, v85, v44
    v_mul_f32 v86, v86, v44
    v_mul_f32 v87, v87, v44
    v_mul_f32 v88, v88, v44
    v_mul_f32 v89, v89, v44
    v_mul_f32 v90, v90, v44
    v_mul_f32 v91, v91, v44
    v_mul_f32 v92, v92, v44
    v_mul_f32 v93, v93, v44
    v_mul_f32 v94, v94, v44
    v_mul_f32_e64 v95, v95, v44
    v_cvt_pk_bf16_f32 v80, v80, v81
    v_cvt_pk_bf16_f32 v81, v82, v83
    v_cvt_pk_bf16_f32 v82, v84, v85
    v_cvt_pk_bf16_f32 v83, v86, v87
    v_cvt_pk_bf16_f32 v84, v88, v89
    v_cvt_pk_bf16_f32 v85, v90, v91
    v_cvt_pk_bf16_f32 v86, v92, v93
    v_cvt_pk_bf16_f32 v87, v94, v95
    s_cmp_lg_u32 s55, 0
    s_cbranch_scc1 L_st2_26
    buffer_store_dwordx4 v[80:83], v1, s[36:39], s68 offen offset:0
    buffer_store_dwordx4 v[84:87], v1, s[36:39], s68 offen offset:2048
    s_branch L_st2_26_e
    s_nop 0
L_st2_26:
    buffer_store_dwordx4 v[80:83], v1, s[36:39], s68 offen offset:0 sc1
    buffer_store_dwordx4 v[84:87], v1, s[36:39], s68 offen offset:2048 sc1
L_st2_26_e:
    s_waitcnt vmcnt(0)
    s_add_u32 s96, s16, 1
    v_mov_b32 v55, s96
    s_cmp_lg_u32 s55, 0
    s_cbranch_scc1 L_st2_27
    buffer_store_dword v55, v9, s[36:39], s13 offen
    s_branch L_st2_27_e
L_st2_27:
    buffer_store_dword v55, v9, s[36:39], s13 offen sc1
L_st2_27_e:
    s_mov_b32 s4, 0
    s_cmp_lt_u32 s10, 64
    s_cbranch_scc0 L_p2_shift
    s_mul_i32 s66, s10, 196608
    s_mul_i32 s97, s53, 6144
    s_add_u32 s66, s66, s97
    s_add_u32 s66, s66, 2293760
    s_lshl_b32 s6, s3, 10
    s_add_u32 s6, s6, s66
    s_add_u32 s6, s6, 4096
    s_cmp_gt_u32 s63, s10
    s_cselect_b32 s4, 1, 0
    s_cselect_b32 s66, s66, 0x40000000
    s_cselect_b32 s6, s6, 0x40000000
    buffer_load_dwordx4 v[112:115], v1, s[36:39], s66 offen offset:0 sc1
    buffer_load_dwordx4 v[116:119], v1, s[36:39], s66 offen offset:1024 sc1
    buffer_load_dwordx4 v[120:123], v1, s[36:39], s66 offen offset:2048 sc1
    buffer_load_dwordx4 v[124:127], v1, s[36:39], s66 offen offset:3072 sc1
    buffer_load_dwordx4 v[128:131], v2, s[36:39], s6 offen offset:0 sc1
    buffer_load_dwordx4 v[132:135], v2, s[36:39], s6 offen offset:512 sc1
L_p2_shift:
    s_mov_b32 s58, s16
    s_mov_b32 s16, s10
    s_ff1_i32_b64 s10, s[8:9]
    s_bitset0_b64 s[8:9], s10
    s_xor_b32 s0, s0, 1
    s_branch L_p2_top
    s_nop 0
    s_nop 0
L_p2_end:
    s_xor_b32 s0, s0, 1
    s_lshl_b32 s2, s75, 5
    s_sub_u32 s2, s59, s2
    v_cmp_eq_u32 vcc, s2, v36
    v_lshlrev_b32 v56, 16, v38
    v_and_b32 v57, 0xffff0000, v38
    v_lshlrev_b32 v58, 16, v39
    v_and_b32 v59, 0xffff0000, v39
    v_cndmask_b32 v60, 0, v14, vcc
    v_add_f32 v56, v56, v60
    v_cndmask_b32 v61, 0, v15, vcc
    v_add_f32 v57, v57, v61
    v_cndmask_b32 v62, 0, v16, vcc
    v_add_f32 v58, v58, v62
    v_cndmask_b32 v63, 0, v17, vcc
    v_add_f32 v59, v59, v63
    v_cvt_pk_bf16_f32 v57, v56, v57
    v_lshlrev_b32 v56, 16, v57
    v_and_b32 v57, 0xffff0000, v57
    v_cvt_pk_bf16_f32 v59, v58, v59
    v_lshlrev_b32 v58, 16, v59
    v_and_b32 v59, 0xffff0000, v59
    v_sub_f32 v46, 1.0, v37
    v_cvt_pk_bf16_f32 v46, v46, v46
    v_lshlrev_b32 v46, 16, v46
    v_mul_f32 v56, v56, v46
    v_mul_f32 v57, v57, v46
    v_mul_f32 v58, v58, v46
    v_mul_f32 v59, v59, v46
    v_cvt_pk_bf16_f32 v57, v56, v57
    v_lshlrev_b32 v56, 16, v57
    v_and_b32 v57, 0xffff0000, v57
    v_cvt_pk_bf16_f32 v59, v58, v59
    v_lshlrev_b32 v58, 16, v59
    v_and_b32 v59, 0xffff0000, v59
    s_waitcnt vmcnt(0)
    s_cmp_eq_u32 s5, 0
    s_cbranch_scc1 L_pub_28
    v_mov_b32 v54, s5
    s_mov_b32 s5, 0
    s_cmp_lg_u32 s55, 0
    s_cbranch_scc1 L_st2_29
    buffer_store_dword v54, v9, s[36:39], s18 offen
    s_branch L_st2_29_e
L_st2_29:
    buffer_store_dword v54, v9, s[36:39], s18 offen sc1
L_st2_29_e:
L_pub_28:
L_poll_30:
    buffer_load_dword v46, v10, s[36:39], s1 offen sc1
    s_waitcnt vmcnt(0)
    v_cmp_ge_u32 vcc, s75, v46
    s_cbranch_vccz L_poll_30_ok
    s_sub_u32 s57, s57, 1
    s_cbranch_scc1 L_exit
    s_branch L_poll_30
L_poll_30_ok:
    s_xor_b32 s96, s0, 1
    s_lshl_b32 s96, s96, 19
    s_lshl_b32 s97, s62, 14
    s_add_u32 s96, s96, s97
    s_add_u32 s96, s96, 71303168
    buffer_load_dwordx4 v[232:235], v8, s[36:39], s96 offen sc1
    s_add_u32 s96, s96, 4096
    buffer_load_dwordx4 v[236:239], v8, s[36:39], s96 offen sc1
    s_add_u32 s96, s96, 4096
    buffer_load_dwordx4 v[240:243], v8, s[36:39], s96 offen sc1
    s_add_u32 s96, s96, 4096
    buffer_load_dwordx4 v[244:247], v8, s[36:39], s96 offen sc1
    s_add_u32 s96, s96, 4096
    s_waitcnt vmcnt(0)
    v_add_f32 v232, v232, v236
    v_add_f32 v240, v240, v244
    v_add_f32 v232, v232, v240
    v_add_f32 v233, v233, v237
    v_add_f32 v241, v241, v245
    v_add_f32 v233, v233, v241
    v_add_f32 v234, v234, v238
    v_add_f32 v242, v242, v246
    v_add_f32 v234, v234, v242
    v_add_f32 v235, v235, v239
    v_add_f32 v243, v243, v247
    v_add_f32 v235, v235, v243
    v_cvt_pk_bf16_f32 v233, v232, v233
    v_lshlrev_b32 v232, 16, v233
    v_and_b32 v233, 0xffff0000, v233
    v_cvt_pk_bf16_f32 v235, v234, v235
    v_lshlrev_b32 v234, 16, v235
    v_and_b32 v235, 0xffff0000, v235
    v_mul_f32 v232, v232, v37
    v_mul_f32 v233, v233, v37
    v_mul_f32 v234, v234, v37
    v_mul_f32_e64 v235, v235, v37
    v_cvt_pk_bf16_f32 v233, v232, v233
    v_lshlrev_b32 v232, 16, v233
    v_and_b32 v233, 0xffff0000, v233
    v_cvt_pk_bf16_f32 v235, v234, v235
    v_lshlrev_b32 v234, 16, v235
    v_and_b32 v235, 0xffff0000, v235
    v_add_f32 v56, v56, v232
    v_add_f32 v57, v57, v233
    v_add_f32 v58, v58, v234
    v_add_f32 v59, v59, v235
    v_cvt_pk_bf16_f32 v46, v56, v57
    v_cvt_pk_bf16_f32 v47, v58, v59
    buffer_store_dwordx2 v[46:47], v6, s[48:51], s70 offen
    s_branch L_exit
    s_nop 0
    s_nop 0
L_chain:
    s_lshr_b32 s96, s53, 4
    s_lshl_b32 s59, s52, 1
    s_add_u32 s59, s59, s96
    s_and_b32 s60, s53, 15
    s_lshr_b32 s96, s60, 3
    s_lshl_b32 s96, s96, 1
    s_xor_b32 s96, s96, s54
    s_mov_b32 s19, s96
    s_mov_b32 s80, s6
    s_and_b32 s81, s7, 0xffff
    s_mov_b32 s82, 0x4000
    s_mov_b32 s83, 0x20000
    v_and_b32 v28, 7, v0
    v_lshlrev_b32 v28, 11, v28
    v_lshrrev_b32 v29, 4, v0
    v_lshl_add_u32 v28, v29, 5, v28
    v_bfe_u32 v29, v0, 3, 1
    v_lshl_add_u32 v28, v29, 2, v28
    s_lshl_b32 s96, s54, 9
    buffer_load_dword v48, v28, s[80:83], s96 offen offset:0
    buffer_load_dword v49, v28, s[80:83], s96 offen offset:8
    buffer_load_dword v50, v28, s[80:83], s96 offen offset:16
    buffer_load_dword v51, v28, s[80:83], s96 offen offset:24
    buffer_load_dword v52, v28, s[80:83], s96 offen offset:128
    buffer_load_dword v53, v28, s[80:83], s96 offen offset:136
    buffer_load_dword v54, v28, s[80:83], s96 offen offset:144
    buffer_load_dword v55, v28, s[80:83], s96 offen offset:152
    buffer_load_dword v56, v28, s[80:83], s96 offen offset:256
    buffer_load_dword v57, v28, s[80:83], s96 offen offset:264
    buffer_load_dword v58, v28, s[80:83], s96 offen offset:272
    buffer_load_dword v59, v28, s[80:83], s96 offen offset:280
    buffer_load_dword v60, v28, s[80:83], s96 offen offset:384
    buffer_load_dword v61, v28, s[80:83], s96 offen offset:392
    buffer_load_dword v62, v28, s[80:83], s96 offen offset:400
    buffer_load_dword v63, v28, s[80:83], s96 offen offset:408
    s_mov_b32 s40, s8
    s_and_b32 s41, s9, 0xffff
    s_mov_b32 s42, 0x800000
    s_mov_b32 s43, 0x20000
    s_mov_b32 s44, s10
    s_and_b32 s45, s11, 0xffff
    s_mov_b32 s46, 0x800000
    s_mov_b32 s47, 0x20000
    s_mov_b32 s48, s12
    s_and_b32 s49, s13, 0xffff
    s_mov_b32 s50, 0x800000
    s_mov_b32 s51, 0x20000
    v_lshrrev_b32 v28, 5, v0
    v_lshlrev_b32_e64 v28, 4, v28
    v_bfe_u32 v29, v0, 4, 1
    v_lshl_add_u32 v28, v29, 0, v28
    v_bfe_u32 v30, v0, 2, 1
    v_lshl_add_u32 v28, v30, 2, v28
    v_bfe_u32 v30, v0, 3, 1
    v_lshl_add_u32 v28, v30, 1, v28
    v_lshlrev_b32 v28, 13, v28
    v_and_b32 v30, 3, v0
    v_lshlrev_b32 v29, 1, v29
    v_xor_b32 v30, v30, v29
    v_lshl_add_u32 v232, v30, 4, v28
    s_mul_i32 s99, s54, 40960
    v_lshrrev_b32 v28, 2, v0
    v_lshlrev_b32 v28, 6, v28
    v_and_b32_e64 v30, 3, v0
    v_lshl_add_u32 v28, v30, 3, v28
    v_bfe_u32 v29, v0, 4, 1
    v_lshl_add_u32 v233, v29, 5, v28
    v_add_u32 v233, s99, v233
    v_xor_b32 v234, 32, v233
    v_lshrrev_b32 v28, 2, v0
    v_lshlrev_b32 v28, 6, v28
    v_bfe_u32 v30, v0, 1, 1
    v_lshl_add_u32 v28, v30, 3, v28
    v_xor_b32 v29, v29, v0
    v_and_b32 v29, 1, v29
    v_lshl_add_u32 v230, v29, 5, v28
    v_add_u32 v230, s99, v230
    v_add_u32 v231, 16, v230
    s_and_b32 s97, s19, 1
    s_lshl_b32 s97, s97, 4
    v_add_u32 v231, s97, v230
    v_xor_b32 v230, 16, v231
    s_lshl_b32 s96, s54, 21
    s_lshl_b32 s97, s59, 10
    s_add_u32 s96, s96, s97
    s_lshl_b32 s97, s60, 6
    s_add_u32 s96, s96, s97
    v_lshrrev_b32 v28, 5, v0
    v_lshlrev_b32_e64 v28, 4, v28
    v_bfe_u32 v29, v0, 3, 1
    v_add_u32 v28, v28, v29
    v_bfe_u32 v29, v0, 4, 1
    v_lshl_add_u32 v28, v29, 5, v28
    v_lshlrev_b32 v28, 11, v28
    v_bfe_u32 v29, v0, 4, 2
    v_lshlrev_b32 v29, 1, v29
    v_and_b32 v30, 7, v0
    v_xor_b32 v30, v30, v29
    v_lshl_add_u32 v235, v30, 4, v28
    v_lshrrev_b32 v28, 2, v0
    v_lshlrev_b32_e64 v28, 7, v28
    v_and_b32_e64 v30, 3, v0
    v_lshl_add_u32 v28, v30, 3, v28
    v_bfe_u32 v29, v0, 3, 2
    v_xor_b32 v29, s54, v29
    v_lshl_add_u32 v236, v29, 5, v28
    s_lshl_b32 s98, s59, 20
    s_lshl_b32 s97, s54, 18
    s_add_u32 s98, s98, s97
    s_lshl_b32 s97, s60, 7
    s_add_u32 s98, s98, s97
    s_mov_b32 s80, s14
    s_and_b32 s81, s15, 0xffff
    s_mov_b32 s82, 0x800000
    s_mov_b32 s83, 0x20000
    s_add_u32 m0, s99, 0
    s_add_u32 s97, s98, 0
    buffer_load_dwordx4 v235, s[80:83], s97 offen  lds
    s_add_u32 m0, s99, 1024
    s_add_u32 s97, s98, 8192
    buffer_load_dwordx4 v235, s[80:83], s97 offen  lds
    s_add_u32 m0, s99, 2048
    s_add_u32 s97, s98, 4096
    buffer_load_dwordx4 v235, s[80:83], s97 offen  lds
    s_add_u32 m0, s99, 3072
    s_add_u32 s97, s98, 12288
    buffer_load_dwordx4 v235, s[80:83], s97 offen  lds
    s_add_u32 m0, s99, 4096
    s_add_u32 s97, s98, 16384
    buffer_load_dwordx4 v235, s[80:83], s97 offen  lds
    s_add_u32 m0, s99, 5120
    s_add_u32 s97, s98, 24576
    buffer_load_dwordx4 v235, s[80:83], s97 offen  lds
    s_add_u32 m0, s99, 6144
    s_add_u32 s97, s98, 20480
    buffer_load_dwordx4 v235, s[80:83], s97 offen  lds
    s_add_u32 m0, s99, 7168
    s_add_u32 s97, s98, 28672
    buffer_load_dwordx4 v235, s[80:83], s97 offen  lds
    s_add_u32 m0, s99, 8192
    s_add_u32 s97, s98, 131072
    buffer_load_dwordx4 v235, s[80:83], s97 offen  lds
    s_add_u32 m0, s99, 9216
    s_add_u32 s97, s98, 139264
    buffer_load_dwordx4 v235, s[80:83], s97 offen  lds
    s_add_u32 m0, s99, 10240
    s_add_u32 s97, s98, 135168
    buffer_load_dwordx4 v235, s[80:83], s97 offen  lds
    s_add_u32 m0, s99, 11264
    s_add_u32 s97, s98, 143360
    buffer_load_dwordx4 v235, s[80:83], s97 offen  lds
    s_add_u32 m0, s99, 12288
    s_add_u32 s97, s98, 147456
    buffer_load_dwordx4 v235, s[80:83], s97 offen  lds
    s_add_u32 m0, s99, 13312
    s_add_u32 s97, s98, 155648
    buffer_load_dwordx4 v235, s[80:83], s97 offen  lds
    s_add_u32 m0, s99, 14336
    s_add_u32 s97, s98, 151552
    buffer_load_dwordx4 v235, s[80:83], s97 offen  lds
    s_add_u32 m0, s99, 15360
    s_add_u32 s97, s98, 159744
    buffer_load_dwordx4 v235, s[80:83], s97 offen  lds
    s_add_u32 m0, s99, 16384
    s_add_u32 s97, s96, 0
    buffer_load_dwordx4 v232, s[40:43], s97 offen lds
    s_add_u32 m0, s99, 17408
    s_add_u32 s97, s96, 65536
    buffer_load_dwordx4 v232, s[40:43], s97 offen lds
    s_add_u32 m0, s99, 18432
    s_add_u32 s97, s96, 262144
    buffer_load_dwordx4 v232, s[40:43], s97 offen lds
    s_add_u32 m0, s99, 19456
    s_add_u32 s97, s96, 327680
    buffer_load_dwordx4 v232, s[40:43], s97 offen lds
    s_add_u32 m0, s99, 20480
    s_add_u32 s97, s96, 0
    buffer_load_dwordx4 v232, s[44:47], s97 offen lds
    s_add_u32 m0, s99, 21504
    s_add_u32 s97, s96, 65536
    buffer_load_dwordx4 v232, s[44:47], s97 offen lds
    s_add_u32 m0, s99, 22528
    s_add_u32 s97, s96, 262144
    buffer_load_dwordx4 v232, s[44:47], s97 offen lds
    s_add_u32 m0, s99, 23552
    s_add_u32 s97, s96, 327680
    buffer_load_dwordx4 v232, s[44:47], s97 offen lds
    s_add_u32 m0, s99, 24576
    s_add_u32 s97, s96, 0
    buffer_load_dwordx4 v232, s[48:51], s97 offen lds
    s_add_u32 m0, s99, 25600
    s_add_u32 s97, s96, 65536
    buffer_load_dwordx4 v232, s[48:51], s97 offen lds
    s_add_u32 m0, s99, 26624
    s_add_u32 s97, s96, 262144
    buffer_load_dwordx4 v232, s[48:51], s97 offen lds
    s_add_u32 m0, s99, 27648
    s_add_u32 s97, s96, 327680
    buffer_load_dwordx4 v232, s[48:51], s97 offen lds
    s_add_u32 m0, s99, 28672
    s_add_u32 s97, s96, 524288
    buffer_load_dwordx4 v232, s[40:43], s97 offen lds
    s_add_u32 m0, s99, 29696
    s_add_u32 s97, s96, 589824
    buffer_load_dwordx4 v232, s[40:43], s97 offen lds
    s_add_u32 m0, s99, 30720
    s_add_u32 s97, s96, 786432
    buffer_load_dwordx4 v232, s[40:43], s97 offen lds
    s_add_u32 m0, s99, 31744
    s_add_u32 s97, s96, 851968
    buffer_load_dwordx4 v232, s[40:43], s97 offen lds
    s_add_u32 m0, s99, 32768
    s_add_u32 s97, s96, 524288
    buffer_load_dwordx4 v232, s[44:47], s97 offen lds
    s_add_u32 m0, s99, 33792
    s_add_u32 s97, s96, 589824
    buffer_load_dwordx4 v232, s[44:47], s97 offen lds
    s_add_u32 m0, s99, 34816
    s_add_u32 s97, s96, 786432
    buffer_load_dwordx4 v232, s[44:47], s97 offen lds
    s_add_u32 m0, s99, 35840
    s_add_u32 s97, s96, 851968
    buffer_load_dwordx4 v232, s[44:47], s97 offen lds
    s_add_u32 m0, s99, 36864
    s_add_u32 s97, s96, 524288
    buffer_load_dwordx4 v232, s[48:51], s97 offen lds
    s_add_u32 m0, s99, 37888
    s_add_u32 s97, s96, 589824
    buffer_load_dwordx4 v232, s[48:51], s97 offen lds
    s_add_u32 m0, s99, 38912
    s_add_u32 s97, s96, 786432
    buffer_load_dwordx4 v232, s[48:51], s97 offen lds
    s_add_u32 m0, s99, 39936
    s_add_u32 s97, s96, 851968
    buffer_load_dwordx4 v232, s[48:51], s97 offen lds
    s_waitcnt vmcnt(16)
    ds_read_b64_tr_b16 a[0:1], v230 offset:16384
    ds_read_b64_tr_b16 a[16:17], v231 offset:16384
    ds_read_b64_tr_b16 a[2:3], v230 offset:17408
    ds_read_b64_tr_b16 a[18:19], v231 offset:17408
    ds_read_b64_tr_b16 a[4:5], v230 offset:18432
    ds_read_b64_tr_b16 a[20:21], v231 offset:18432
    ds_read_b64_tr_b16 a[6:7], v230 offset:19456
    ds_read_b64_tr_b16 a[22:23], v231 offset:19456
    ds_read_b64_tr_b16 a[8:9], v230 offset:20480
    ds_read_b64_tr_b16 a[24:25], v231 offset:20480
    ds_read_b64_tr_b16 a[10:11], v230 offset:21504
    ds_read_b64_tr_b16 a[26:27], v231 offset:21504
    ds_read_b64_tr_b16 a[12:13], v230 offset:22528
    ds_read_b64_tr_b16 a[28:29], v231 offset:22528
    ds_read_b64_tr_b16 a[14:15], v230 offset:23552
    ds_read_b64_tr_b16 a[30:31], v231 offset:23552
    s_waitcnt lgkmcnt(0)
    s_add_u32 m0, s99, 16384
    s_add_u32 s97, s96, 1048576
    buffer_load_dwordx4 v232, s[40:43], s97 offen lds
    s_add_u32 m0, s99, 17408
    s_add_u32 s97, s96, 1114112
    buffer_load_dwordx4 v232, s[40:43], s97 offen lds
    s_add_u32 m0, s99, 18432
    s_add_u32 s97, s96, 1310720
    buffer_load_dwordx4 v232, s[40:43], s97 offen lds
    s_add_u32 m0, s99, 19456
    s_add_u32 s97, s96, 1376256
    buffer_load_dwordx4 v232, s[40:43], s97 offen lds
    s_add_u32 m0, s99, 20480
    s_add_u32 s97, s96, 1048576
    buffer_load_dwordx4 v232, s[44:47], s97 offen lds
    s_add_u32 m0, s99, 21504
    s_add_u32 s97, s96, 1114112
    buffer_load_dwordx4 v232, s[44:47], s97 offen lds
    s_add_u32 m0, s99, 22528
    s_add_u32 s97, s96, 1310720
    buffer_load_dwordx4 v232, s[44:47], s97 offen lds
    s_add_u32 m0, s99, 23552
    s_add_u32 s97, s96, 1376256
    buffer_load_dwordx4 v232, s[44:47], s97 offen lds
    v_and_b32 v238, 7, v0
    v_lshlrev_b32 v238, 5, v238
    global_load_dword v239, v238, s[32:33] sc1
    s_waitcnt vmcnt(17)
    ds_read_b64_tr_b16 a[32:33], v233 offset:24576
    ds_read_b64_tr_b16 a[40:41], v234 offset:24576
    ds_read_b64_tr_b16 a[34:35], v233 offset:25600
    ds_read_b64_tr_b16 a[42:43], v234 offset:25600
    ds_read_b64_tr_b16 a[36:37], v233 offset:26624
    ds_read_b64_tr_b16 a[44:45], v234 offset:26624
    ds_read_b64_tr_b16 a[38:39], v233 offset:27648
    ds_read_b64_tr_b16 a[46:47], v234 offset:27648
    ds_read_b64_tr_b16 a[48:49], v230 offset:28672
    ds_read_b64_tr_b16 a[64:65], v231 offset:28672
    ds_read_b64_tr_b16 a[50:51], v230 offset:29696
    ds_read_b64_tr_b16 a[66:67], v231 offset:29696
    ds_read_b64_tr_b16 a[52:53], v230 offset:30720
    ds_read_b64_tr_b16 a[68:69], v231 offset:30720
    ds_read_b64_tr_b16 a[54:55], v230 offset:31744
    ds_read_b64_tr_b16 a[70:71], v231 offset:31744
    s_waitcnt lgkmcnt(0)
    s_add_u32 m0, s99, 24576
    s_add_u32 s97, s96, 1048576
    buffer_load_dwordx4 v232, s[48:51], s97 offen lds
    s_add_u32 m0, s99, 25600
    s_add_u32 s97, s96, 1114112
    buffer_load_dwordx4 v232, s[48:51], s97 offen lds
    s_add_u32 m0, s99, 26624
    s_add_u32 s97, s96, 1310720
    buffer_load_dwordx4 v232, s[48:51], s97 offen lds
    s_add_u32 m0, s99, 27648
    s_add_u32 s97, s96, 1376256
    buffer_load_dwordx4 v232, s[48:51], s97 offen lds
    s_add_u32 m0, s99, 28672
    s_add_u32 s97, s96, 1572864
    buffer_load_dwordx4 v232, s[40:43], s97 offen lds
    s_add_u32 m0, s99, 29696
    s_add_u32 s97, s96, 1638400
    buffer_load_dwordx4 v232, s[40:43], s97 offen lds
    s_add_u32 m0, s99, 30720
    s_add_u32 s97, s96, 1835008
    buffer_load_dwordx4 v232, s[40:43], s97 offen lds
    s_add_u32 m0, s99, 31744
    s_add_u32 s97, s96, 1900544
    buffer_load_dwordx4 v232, s[40:43], s97 offen lds
    s_waitcnt vmcnt(17)
    ds_read_b64_tr_b16 a[56:57], v230 offset:32768
    ds_read_b64_tr_b16 a[72:73], v231 offset:32768
    ds_read_b64_tr_b16 a[58:59], v230 offset:33792
    ds_read_b64_tr_b16 a[74:75], v231 offset:33792
    ds_read_b64_tr_b16 a[60:61], v230 offset:34816
    ds_read_b64_tr_b16 a[76:77], v231 offset:34816
    ds_read_b64_tr_b16 a[62:63], v230 offset:35840
    ds_read_b64_tr_b16 a[78:79], v231 offset:35840
    ds_read_b64_tr_b16 a[80:81], v233 offset:36864
    ds_read_b64_tr_b16 a[88:89], v234 offset:36864
    ds_read_b64_tr_b16 a[82:83], v233 offset:37888
    ds_read_b64_tr_b16 a[90:91], v234 offset:37888
    ds_read_b64_tr_b16 a[84:85], v233 offset:38912
    ds_read_b64_tr_b16 a[92:93], v234 offset:38912
    ds_read_b64_tr_b16 a[86:87], v233 offset:39936
    ds_read_b64_tr_b16 a[94:95], v234 offset:39936
    s_waitcnt lgkmcnt(0)
    s_add_u32 m0, s99, 32768
    s_add_u32 s97, s96, 1572864
    buffer_load_dwordx4 v232, s[44:47], s97 offen lds
    s_add_u32 m0, s99, 33792
    s_add_u32 s97, s96, 1638400
    buffer_load_dwordx4 v232, s[44:47], s97 offen lds
    s_add_u32 m0, s99, 34816
    s_add_u32 s97, s96, 1835008
    buffer_load_dwordx4 v232, s[44:47], s97 offen lds
    s_add_u32 m0, s99, 35840
    s_add_u32 s97, s96, 1900544
    buffer_load_dwordx4 v232, s[44:47], s97 offen lds
    s_add_u32 m0, s99, 36864
    s_add_u32 s97, s96, 1572864
    buffer_load_dwordx4 v232, s[48:51], s97 offen lds
    s_add_u32 m0, s99, 37888
    s_add_u32 s97, s96, 1638400
    buffer_load_dwordx4 v232, s[48:51], s97 offen lds
    s_add_u32 m0, s99, 38912
    s_add_u32 s97, s96, 1835008
    buffer_load_dwordx4 v232, s[48:51], s97 offen lds
    s_add_u32 m0, s99, 39936
    s_add_u32 s97, s96, 1900544
    buffer_load_dwordx4 v232, s[48:51], s97 offen lds
    v_lshlrev_b32_e64 v1, 4, v0
    v_mov_b32 v2, 0x4444
    v_mov_b32 v28, 0xeeee
    v_and_b32 v29, 8, v0
    v_cmp_ne_u32 vcc, 0, v29
    s_nop 1
    v_cndmask_b32 v2, v2, v28, vcc
    v_lshrrev_b32 v28, 5, v0
    v_lshlrev_b32 v28, 7, v28
    v_and_b32 v30, 15, v0
    v_lshl_add_u32 v28, v30, 4, v28
    v_bfe_u32 v30, v0, 4, 1
    v_lshl_add_u32 v28, v30, 3, v28
    v_mov_b32 v30, 0x40000000
    v_cndmask_b32 v3, v28, v30, vcc
    v_bfe_u32 v28, v0, 2, 1
    v_lshlrev_b32 v28, 7, v28
    v_bfe_u32 v29, v0, 1, 1
    v_lshl_add_u32 v28, v29, 3, v28
    v_and_b32 v29, 1, v0
    v_lshl_add_u32 v28, v29, 4, v28
    v_bfe_u32 v29, v0, 4, 1
    v_lshl_add_u32 v28, v29, 6, v28
    v_lshrrev_b32 v29, 5, v0
    v_lshl_add_u32 v28, v29, 5, v28
    v_cndmask_b32 v3, v28, v30, vcc
    v_bfe_u32 v29, v0, 4, 1
    v_lshlrev_b32 v29, 8, v29
    v_and_b32_e64 v30, 15, v0
    v_lshl_add_u32 v5, v30, 4, v29
    v_bfe_u32 v29, v0, 4, 1
    v_lshlrev_b32 v29, 3, v29
    v_lshl_add_u32 v29, v30, 4, v29
    v_lshrrev_b32 v28, 5, v0
    v_lshl_add_u32 v6, v28, 2, v29
    v_lshlrev_b32 v6, 2, v0
    s_lshl_b32 s96, s54, 10
    v_add_u32 v7, s96, v1
    s_lshl_b32 s96, s54, 11
    v_add_u32 v8, s96, v1
    s_min_u32 s96, s19, 2
    s_lshl_b32 s96, s96, 12
    v_add_u32 v9, s96, v1
    s_lshl_b32 s96, s19, 3
    v_add_u32 v4, s96, v1
    v_and_b32 v28, 15, v0
    v_lshlrev_b32 v28, 4, v28
    v_bfe_u32 v29, v0, 4, 1
    v_lshl_add_u32 v28, v29, 3, v28
    v_lshrrev_b32 v29, 5, v0
    v_lshl_add_u32 v28, v29, 8, v28
    s_lshl_b32 s96, s19, 9
    v_add_u32 v4, s96, v28
    v_lshrrev_b32 v28, 5, v0
    v_lshl_add_u32 v28, v28, 3, v5
    s_cmp_eq_u32 s19, 2
    s_cselect_b64 vcc, -1, 0
    v_cndmask_b32 v4, v4, v28, vcc
    v_mov_b32 v28, 0x40000000
    s_cmp_eq_u32 s19, 3
    s_cselect_b64 vcc, -1, 0
    v_cndmask_b32 v4, v4, v28, vcc
    v_and_b32 v28, 15, v0
    v_bfe_u32 v29, v0, 4, 1
    v_lshlrev_b32 v29, 2, v29
    v_add_u32 v30, 0, v29
    v_cmp_eq_u32_e64 vcc, v28, v30
    v_mov_b32 v31, 0x3f80
    s_nop 0
    v_cndmask_b32 v12, 0, v31, vcc
    v_add_u32 v30, 1, v29
    v_cmp_eq_u32 vcc, v28, v30
    v_mov_b32 v31, 0x3f800000
    s_nop 0
    v_cndmask_b32 v31, 0, v31, vcc
    v_or_b32 v12, v12, v31
    v_add_u32 v30, 2, v29
    v_cmp_eq_u32 vcc, v28, v30
    v_mov_b32 v31, 0x3f80
    s_nop 0
    v_cndmask_b32 v13, 0, v31, vcc
    v_add_u32 v30, 3, v29
    v_cmp_eq_u32 vcc, v28, v30
    v_mov_b32 v31, 0x3f800000
    s_nop 0
    v_cndmask_b32 v31, 0, v31, vcc
    v_or_b32 v13, v13, v31
    v_add_u32 v30, 8, v29
    v_cmp_eq_u32 vcc, v28, v30
    v_mov_b32 v31, 0x3f80
    s_nop 0
    v_cndmask_b32 v14, 0, v31, vcc
    v_add_u32 v30, 9, v29
    v_cmp_eq_u32 vcc, v28, v30
    v_mov_b32 v31, 0x3f800000
    s_nop 0
    v_cndmask_b32 v31, 0, v31, vcc
    v_or_b32 v14, v14, v31
    v_add_u32 v30, 10, v29
    v_cmp_eq_u32 vcc, v28, v30
    v_mov_b32 v31, 0x3f80
    s_nop 0
    v_cndmask_b32 v15, 0, v31, vcc
    v_add_u32 v30, 11, v29
    v_cmp_eq_u32 vcc, v28, v30
    v_mov_b32 v31, 0x3f800000
    s_nop 0
    v_cndmask_b32 v31, 0, v31, vcc
    v_or_b32 v15, v15, v31
    v_mov_b32 v29, 0
    v_add_u32 v30, 0, v29
    v_cmp_eq_u32 vcc, v28, v30
    v_mov_b32 v31, 0x3f80
    s_nop 0
    v_cndmask_b32 v16, 0, v31, vcc
    v_add_u32 v30, 1, v29
    v_cmp_eq_u32 vcc, v28, v30
    v_mov_b32 v31, 0x3f800000
    s_nop 0
    v_cndmask_b32 v31, 0, v31, vcc
    v_or_b32 v16, v16, v31
    v_add_u32 v30, 2, v29
    v_cmp_eq_u32 vcc, v28, v30
    v_mov_b32 v31, 0x3f80
    s_nop 0
    v_cndmask_b32 v17, 0, v31, vcc
    v_add_u32 v30, 3, v29
    v_cmp_eq_u32 vcc, v28, v30
    v_mov_b32 v31, 0x3f800000
    s_nop 0
    v_cndmask_b32 v31, 0, v31, vcc
    v_or_b32 v17, v17, v31
    v_add_u32 v30, 4, v29
    v_cmp_eq_u32 vcc, v28, v30
    v_mov_b32 v31, 0x3f80
    s_nop 0
    v_cndmask_b32 v18, 0, v31, vcc
    v_add_u32 v30, 5, v29
    v_cmp_eq_u32 vcc, v28, v30
    v_mov_b32 v31, 0x3f800000
    s_nop 0
    v_cndmask_b32 v31, 0, v31, vcc
    v_or_b32 v18, v18, v31
    v_add_u32 v30, 6, v29
    v_cmp_eq_u32 vcc, v28, v30
    v_mov_b32 v31, 0x3f80
    s_nop 0
    v_cndmask_b32 v19, 0, v31, vcc
    v_add_u32 v30, 7, v29
    v_cmp_eq_u32 vcc, v28, v30
    v_mov_b32 v31, 0x3f800000
    s_nop 0
    v_cndmask_b32 v31, 0, v31, vcc
    v_or_b32_e64 v19, v19, v31
    v_mov_b32 v28, 0xf149f2ca
    v_cmp_gt_u32 vcc, 32, v0
    v_mov_b32 v20, 0x3f803f80
    s_nop 0
    v_cndmask_b32_e64 v24, 0, v28, vcc
    v_mov_b32 v21, 0x3f803f80
    v_cndmask_b32 v25, 0, v28, vcc
    v_mov_b32 v22, 0x3f803f80
    v_cndmask_b32 v26, 0, v28, vcc
    v_mov_b32 v23, 0x3f803f80
    v_cndmask_b32 v27, 0, v28, vcc
    s_mov_b32 s79, 0x3e0293ee
    s_mov_b32 s58, 0
    s_lshl_b32 s96, s52, 14
    s_add_u32 s96, s96, 65536
    s_lshl_b32 s97, s54, 12
    s_add_u32 s66, s96, s97
    s_lshl_b32 s97, s53, 1
    s_add_u32 s97, s97, s19
    s_lshl_b32 s98, s97, 8
    s_add_u32 s67, s96, s98
    s_lshr_b32 s98, s97, 2
    s_lshl_b32 s98, s98, 14
    s_and_b32 s97, s97, 3
    s_lshl_b32 s97, s97, 11
    s_add_u32 s98, s98, s97
    s_add_u32 s61, s98, 1048576
    s_lshl_b32 s98, s60, 14
    s_lshl_b32 s97, s54, 11
    s_add_u32 s98, s98, s97
    s_lshl_b32 s97, s59, 8
    s_add_u32 s98, s98, s97
    s_add_u32 s62, s98, 1048576
    s_mul_i32 s96, s59, 24576
    s_mul_i32 s97, s54, 6144
    s_add_u32 s68, s96, s97
    s_add_u32 s68, s68, 131072
    s_lshr_b32 s97, s60, 2
    s_mul_i32 s97, s97, 6144
    s_add_u32 s96, s96, s97
    s_and_b32 s97, s60, 3
    s_lshl_b32 s98, s97, 10
    s_lshl_b32 s97, s97, 9
    s_add_u32 s97, s97, 4096
    s_cmp_eq_u32 s19, 2
    s_cselect_b32 s97, s97, s98
    s_add_u32 s96, s96, s97
    s_add_u32 s69, s96, 131072
    s_sub_u32 s70, s68, -2162688
    s_and_b32 s98, s60, 7
    s_lshl_b32 s96, s98, 10
    s_lshl_b32 s97, s98, 9
    s_add_u32 s97, s97, 2048
    s_cmp_lt_u32 s98, 4
    s_cselect_b32 s96, s96, s97
    s_cselect_b64 vcc, -1, 0
    s_add_u32 s70, s70, s96
    v_mov_b32 v28, 0x40000000
    v_cmp_gt_u32 s[98:99], 32, v0
    s_or_b64 vcc, vcc, s[98:99]
    s_cmp_lt_u32 s60, 16
    s_cselect_b64 vcc, vcc, 0
    v_cndmask_b32_e64 v208, v28, v1, vcc
    s_and_b32 s96, s60, 7
    s_lshl_b32 s1, s96, 2
    s_lshl_b32 s96, s59, 2
    s_add_u32 s96, s96, s54
    s_lshl_b32 s96, s96, 5
    s_add_u32 s96, s96, s1
    s_lshl_b32 s96, s96, 5
    s_add_u32 s77, s96, 327680
    s_lshl_b32 s96, s59, 2
    s_add_u32 s96, s96, s54
    s_lshl_b32 s76, s96, 7
    s_add_u32 s76, s76, 0
    s_lshl_b32 s96, s96, 14
    s_add_u32 s71, s96, 17301504
    s_mov_b32 s3, 3
    s_add_u32 s72, s71, 4096
    s_add_u32 s73, s71, 8192
    s_add_u32 s74, s71, 12288
    s_mov_b32 s75, 0
    s_lshl_b32 s96, s52, 9
    s_add_u32 s96, s96, 20480
    s_lshl_b32 s97, s54, 7
    s_add_u32 s0, s96, s97
    s_lshr_b32 s97, s53, 3
    s_lshl_b32 s97, s97, 7
    s_add_u32 s96, s96, s97
    s_and_b32 s97, s53, 7
    s_lshl_b32 s97, s97, 1
    s_add_u32 s97, s97, s54
    s_lshl_b32 s97, s97, 2
    s_add_u32 s0, s96, s97
    s_lshl_b32 s96, s59, 9
    s_add_u32 s96, s96, 24576
    s_lshl_b32 s97, s54, 7
    s_add_u32 s0, s96, s97
    s_lshr_b32 s97, s60, 2
    s_lshl_b32 s97, s97, 7
    s_add_u32 s96, s96, s97
    s_and_b32 s97, s60, 3
    s_lshl_b32 s97, s97, 2
    s_add_u32 s0, s96, s97
    v_and_b32 v28, 15, v0
    v_lshlrev_b32 v83, 2, v28
    v_and_b32 v28, 3, v0
    v_lshlrev_b32 v83, 2, v28
    v_mov_b32 v29, 0x40000000
    v_cmp_eq_u32 vcc, 0, v0
    s_nop 1
    v_cndmask_b32 v199, v29, 0, vcc
    v_mov_b32 v194, 1
    v_mov_b32 v198, 0
    v_mov_b32 v222, 0
    s_and_b32 s96, s19, 1
    s_lshl_b32 s96, s96, 12
    v_add_u32 v193, s96, v7
    v_xor_b32 v192, 0x1000, v193
    s_add_u32 s96, s54, 1
    s_and_b32 s96, s96, 3
    s_lshl_b32 s96, s96, 10
    v_add_u32 v195, s96, v9
    s_add_u32 s96, s54, 2
    s_and_b32 s96, s96, 3
    s_lshl_b32 s96, s96, 10
    v_add_u32 v196, s96, v9
    s_add_u32 s96, s54, 3
    s_and_b32 s96, s96, 3
    s_lshl_b32 s96, s96, 10
    v_add_u32 v197, s96, v9
    v_mov_b32 v28, 0x7149f2ca
    v_mov_b32 v29, 0xff61b1e6
    v_and_b32 v30, 8, v0
    v_cmp_ne_u32 vcc, 0, v30
    s_nop 1
    v_cndmask_b32 v203, v29, v28, vcc
    v_and_b32 v223, 7, v0
    v_lshlrev_b32 v223, 2, v223
    s_add_u32 s97, s54, 1
    s_and_b32 s97, s97, 3
    s_lshl_b32 s97, s97, 11
    v_add_u32 v200, s97, v1
    s_add_u32 s97, s54, 2
    s_and_b32 s97, s97, 3
    s_lshl_b32 s97, s97, 11
    v_add_u32 v201, s97, v1
    s_add_u32 s97, s54, 3
    s_and_b32 s97, s97, 3
    s_lshl_b32 s97, s97, 11
    v_add_u32 v202, s97, v1
    v_mov_b32 v29, 0x40000000
    v_cmp_eq_u32 vcc, 0, v0
    s_cmp_ge_u32 s19, 2
    s_cselect_b64 vcc, vcc, 0
    v_cndmask_b32 v209, v29, 0, vcc
    s_cmp_eq_u32 s56, 1
    s_cbranch_scc1 L_cenok_32
    s_waitcnt vmcnt(16)
    s_branch L_cen_31_w
    s_nop 0
    v_and_b32 v238, 7, v0
    v_lshlrev_b32 v238, 5, v238
L_cen_31:
    global_load_dword v239, v238, s[32:33] sc1
    s_waitcnt vmcnt(0)
L_cen_31_w:
    v_lshrrev_b32 v30, 16, v239
    s_mov_b32 s96, 0
    v_readlane_b32 s97, v30, 0
    s_add_u32 s96, s96, s97
    v_readlane_b32 s97, v30, 1
    s_add_u32 s96, s96, s97
    v_readlane_b32 s97, v30, 2
    s_add_u32 s96, s96, s97
    v_readlane_b32 s97, v30, 3
    s_add_u32 s96, s96, s97
    v_readlane_b32 s97, v30, 4
    s_add_u32 s96, s96, s97
    v_readlane_b32 s97, v30, 5
    s_add_u32 s96, s96, s97
    v_readlane_b32 s97, v30, 6
    s_add_u32 s96, s96, s97
    v_readlane_b32 s97, v30, 7
    s_add_u32 s96, s96, s97
    s_cmp_eq_u32 s96, 256
    s_cbranch_scc1 L_cen_31_done
    s_sub_u32 s57, s57, 1
    s_cbranch_scc1 L_exit
    s_branch L_cen_31
    s_nop 0
L_cen_31_done:
    s_mov_b32 s56, 1
    v_cmp_ne_u32 vcc, 0x200020, v239
    s_cbranch_vccz L_cenok_32
    s_lshr_b32 s52, s2, 5
    s_and_b32 s53, s2, 31
    s_mov_b32 s55, 1
    s_waitcnt vmcnt(0)
    s_barrier
    s_branch L_dispatch
    s_nop 0
    s_nop 0
    s_nop 0
    s_nop 0
    s_nop 0
L_cenok_32:
    s_barrier
    s_add_u32 s97, s54, 0
    s_and_b32 s97, s97, 3
    s_mul_i32 s97, s97, 40960
    v_add_u32 v237, s97, v236
    ds_read_b64_tr_b16 a[192:193], v237 offset:0
    ds_read_b64_tr_b16 a[194:195], v237 offset:2048
    ds_read_b64_tr_b16 a[196:197], v237 offset:4096
    ds_read_b64_tr_b16 a[198:199], v237 offset:6144
    ds_read_b64_tr_b16 a[200:201], v237 offset:8192
    ds_read_b64_tr_b16 a[202:203], v237 offset:10240
    ds_read_b64_tr_b16 a[204:205], v237 offset:12288
    ds_read_b64_tr_b16 a[206:207], v237 offset:14336
    s_add_u32 s97, s54, 1
    s_and_b32 s97, s97, 3
    s_mul_i32 s97, s97, 40960
    v_add_u32_e64 v237, s97, v236
    ds_read_b64_tr_b16 a[208:209], v237 offset:0
    ds_read_b64_tr_b16 a[210:211], v237 offset:2048
    ds_read_b64_tr_b16 a[212:213], v237 offset:4096
    ds_read_b64_tr_b16 a[214:215], v237 offset:6144
    ds_read_b64_tr_b16 a[216:217], v237 offset:8192
    ds_read_b64_tr_b16 a[218:219], v237 offset:10240
    ds_read_b64_tr_b16 a[220:221], v237 offset:12288
    ds_read_b64_tr_b16 a[222:223], v237 offset:14336
    s_add_u32 s97, s54, 2
    s_and_b32 s97, s97, 3
    s_mul_i32 s97, s97, 40960
    v_add_u32_e64 v237, s97, v236
    ds_read_b64_tr_b16 a[224:225], v237 offset:0
    ds_read_b64_tr_b16 a[226:227], v237 offset:2048
    ds_read_b64_tr_b16 a[228:229], v237 offset:4096
    ds_read_b64_tr_b16 a[230:231], v237 offset:6144
    ds_read_b64_tr_b16 a[232:233], v237 offset:8192
    ds_read_b64_tr_b16 a[234:235], v237 offset:10240
    ds_read_b64_tr_b16 a[236:237], v237 offset:12288
    ds_read_b64_tr_b16 a[238:239], v237 offset:14336
    s_add_u32 s97, s54, 3
    s_and_b32 s97, s97, 3
    s_mul_i32 s97, s97, 40960
    v_add_u32 v237, s97, v236
    ds_read_b64_tr_b16 a[240:241], v237 offset:0
    ds_read_b64_tr_b16 a[242:243], v237 offset:2048
    ds_read_b64_tr_b16 a[244:245], v237 offset:4096
    ds_read_b64_tr_b16 a[246:247], v237 offset:6144
    ds_read_b64_tr_b16 a[248:249], v237 offset:8192
    ds_read_b64_tr_b16 a[250:251], v237 offset:10240
    ds_read_b64_tr_b16 a[252:253], v237 offset:12288
    ds_read_b64_tr_b16 a[254:255], v237 offset:14336
    s_waitcnt vmcnt(16)
    ds_read_b64_tr_b16 a[96:97], v230 offset:16384
    ds_read_b64_tr_b16 a[112:113], v231 offset:16384
    ds_read_b64_tr_b16 a[98:99], v230 offset:17408
    ds_read_b64_tr_b16 a[114:115], v231 offset:17408
    ds_read_b64_tr_b16 a[100:101], v230 offset:18432
    ds_read_b64_tr_b16 a[116:117], v231 offset:18432
    ds_read_b64_tr_b16 a[102:103], v230 offset:19456
    ds_read_b64_tr_b16 a[118:119], v231 offset:19456
    ds_read_b64_tr_b16 a[104:105], v230 offset:20480
    ds_read_b64_tr_b16 a[120:121], v231 offset:20480
    ds_read_b64_tr_b16 a[106:107], v230 offset:21504
    ds_read_b64_tr_b16 a[122:123], v231 offset:21504
    ds_read_b64_tr_b16 a[108:109], v230 offset:22528
    ds_read_b64_tr_b16 a[124:125], v231 offset:22528
    ds_read_b64_tr_b16 a[110:111], v230 offset:23552
    ds_read_b64_tr_b16 a[126:127], v231 offset:23552
    s_waitcnt vmcnt(8)
    ds_read_b64_tr_b16 a[128:129], v233 offset:24576
    ds_read_b64_tr_b16 a[136:137], v234 offset:24576
    ds_read_b64_tr_b16 a[130:131], v233 offset:25600
    ds_read_b64_tr_b16 a[138:139], v234 offset:25600
    ds_read_b64_tr_b16 a[132:133], v233 offset:26624
    ds_read_b64_tr_b16 a[140:141], v234 offset:26624
    ds_read_b64_tr_b16 a[134:135], v233 offset:27648
    ds_read_b64_tr_b16 a[142:143], v234 offset:27648
    ds_read_b64_tr_b16 a[144:145], v230 offset:28672
    ds_read_b64_tr_b16 a[160:161], v231 offset:28672
    ds_read_b64_tr_b16 a[146:147], v230 offset:29696
    ds_read_b64_tr_b16 a[162:163], v231 offset:29696
    ds_read_b64_tr_b16 a[148:149], v230 offset:30720
    ds_read_b64_tr_b16 a[164:165], v231 offset:30720
    ds_read_b64_tr_b16 a[150:151], v230 offset:31744
    ds_read_b64_tr_b16 a[166:167], v231 offset:31744
    s_waitcnt vmcnt(0)
    buffer_load_dword v222, v223, s[36:39], s76 offen sc1
    ds_read_b64_tr_b16 a[152:153], v230 offset:32768
    ds_read_b64_tr_b16 a[168:169], v231 offset:32768
    ds_read_b64_tr_b16 a[154:155], v230 offset:33792
    ds_read_b64_tr_b16 a[170:171], v231 offset:33792
    ds_read_b64_tr_b16 a[156:157], v230 offset:34816
    ds_read_b64_tr_b16 a[172:173], v231 offset:34816
    ds_read_b64_tr_b16 a[158:159], v230 offset:35840
    ds_read_b64_tr_b16 a[174:175], v231 offset:35840
    ds_read_b64_tr_b16 a[176:177], v233 offset:36864
    ds_read_b64_tr_b16 a[184:185], v234 offset:36864
    ds_read_b64_tr_b16 a[178:179], v233 offset:37888
    ds_read_b64_tr_b16 a[186:187], v234 offset:37888
    ds_read_b64_tr_b16 a[180:181], v233 offset:38912
    ds_read_b64_tr_b16 a[188:189], v234 offset:38912
    ds_read_b64_tr_b16 a[182:183], v233 offset:39936
    ds_read_b64_tr_b16 a[190:191], v234 offset:39936
    s_waitcnt lgkmcnt(0)
    s_barrier
    s_lshl_b32 s96, s59, 16
    s_lshr_b32 s97, s60, 2
    s_lshl_b32 s97, s97, 14
    s_add_u32 s96, s96, s97
    s_and_b32 s97, s60, 3
    s_lshl_b32 s97, s97, 11
    s_add_u32 s96, s96, s97
    s_lshl_b32 s97, s54, 9
    s_add_u32 s96, s96, s97
    s_add_u32 s96, s96, 17301504
    s_add_u32 s40, s34, s96
    s_addc_u32 s41, s35, 0
    v_mov_b32 v96, 0
    v_mov_b32 v97, 0
    v_mov_b32 v98, 0
    v_mov_b32 v99, 0
    v_mov_b32 v100, 0
    v_mov_b32 v101, 0
    v_mov_b32 v102, 0
    v_mov_b32 v103, 0
    v_mov_b32 v104, 0
    v_mov_b32 v105, 0
    v_mov_b32 v106, 0
    v_mov_b32 v107, 0
    v_mov_b32 v108, 0
    v_mov_b32 v109, 0
    v_mov_b32 v110, 0
    v_mov_b32 v111, 0
    v_mov_b32 v112, 0
    v_mov_b32 v113, 0
    v_mov_b32 v114, 0
    v_mov_b32 v115, 0
    v_mov_b32 v116, 0
    v_mov_b32 v117, 0
    v_mov_b32 v118, 0
    v_mov_b32 v119, 0
    v_mov_b32 v88, 0
    v_mov_b32 v89, 0
    v_mov_b32 v90, 0
    v_mov_b32 v91, 0
    v_mov_b32 v224, 0
    v_mov_b32 v225, 0
    v_mov_b32 v226, 0
    v_mov_b32 v227, 0
    v_mov_b32 v228, 0
    v_mov_b32 v229, 0
    s_mov_b32 s96, 0x05040100
    s_mov_b32 s97, 0x07060302
    v_perm_b32 v32, v49, v48, s96
    v_perm_b32 v33, v51, v50, s96
    v_perm_b32 v34, v49, v48, s97
    v_perm_b32 v35, v51, v50, s97
    v_perm_b32 v36, v53, v52, s96
    v_perm_b32 v37, v55, v54, s96
    v_perm_b32 v38, v53, v52, s97
    v_perm_b32 v39, v55, v54, s97
    v_perm_b32 v40, v57, v56, s96
    v_perm_b32 v41, v59, v58, s96
    v_perm_b32 v42, v57, v56, s97
    v_perm_b32 v43, v59, v58, s97
    v_perm_b32 v44, v61, v60, s96
    v_perm_b32 v45, v63, v62, s96
    v_perm_b32 v46, v61, v60, s97
    v_perm_b32 v47, v63, v62, s97
    s_waitcnt vmcnt(0)
    v_min_u32_dpp v222, v222, v222 row_ror:4 row_mask:0xf bank_mask:0xf
    s_nop 1
    v_min_u32_dpp v222, v222, v222 row_ror:2 row_mask:0xf bank_mask:0xf
    s_nop 1
    v_min_u32_dpp v222, v222, v222 row_ror:1 row_mask:0xf bank_mask:0xf
    s_nop 0
    v_readfirstlane_b32 s96, v222
    s_max_u32 s75, s75, s96
    s_cmp_eq_u32 s96, 0
    s_cbranch_scc1 L_nokv0
    s_mov_b32 s3, 2
    s_sub_u32 s71, s71, 0x80000
    s_sub_u32 s72, s72, 0x80000
    buffer_load_dwordx4 v[128:131], v1, s[36:39], s71 offen offset:0 sc1
    buffer_load_dwordx4 v[132:135], v1, s[36:39], s71 offen offset:1024 sc1
    buffer_load_dwordx4 v[136:139], v1, s[36:39], s71 offen offset:2048 sc1
    buffer_load_dwordx4 v[140:143], v1, s[36:39], s71 offen offset:3072 sc1
    buffer_load_dwordx4 v[144:147], v1, s[36:39], s72 offen offset:0 sc1
    buffer_load_dwordx4 v[148:151], v1, s[36:39], s72 offen offset:1024 sc1
    buffer_load_dwordx4 v[152:155], v1, s[36:39], s72 offen offset:2048 sc1
    buffer_load_dwordx4 v[156:159], v1, s[36:39], s72 offen offset:3072 sc1
    s_add_u32 s71, s71, 0x80000
    s_add_u32 s72, s72, 0x80000
L_nokv0:
    s_cmp_ge_u32 s19, 2
    s_cbranch_scc1 L_first_1
L_first_0:
    s_sub_u32 s73, s73, 0x80000
    s_sub_u32 s74, s74, 0x80000
    v_smfmac_f32_16x16x64_bf16 v[96:99], v[32:35], a[0:7], v2
    v_smfmac_f32_16x16x64_bf16 v[100:103], v[32:35], a[8:15], v2
    v_smfmac_f32_16x16x64_bf16 v[104:107], v[32:35], a[16:23], v2
    v_smfmac_f32_16x16x64_bf16 v[108:111], v[32:35], a[24:31], v2
    v_smfmac_f32_16x16x64_bf16 v[96:99], v[36:39], a[48:55], v2
    v_smfmac_f32_16x16x64_bf16 v[100:103], v[36:39], a[56:63], v2
    v_smfmac_f32_16x16x64_bf16 v[104:107], v[36:39], a[64:71], v2
    v_smfmac_f32_16x16x64_bf16 v[108:111], v[36:39], a[72:79], v2
    s_branch L_Bgo2_00
    s_nop 0
L_first_1:
    s_sub_u32 s73, s73, 0x80000
    s_sub_u32 s74, s74, 0x80000
    v_smfmac_f32_16x16x64_bf16 v[96:99], v[32:35], a[0:7], v2
    v_smfmac_f32_16x16x64_bf16 v[100:103], v[32:35], a[8:15], v2
    v_smfmac_f32_16x16x64_bf16 v[104:107], v[32:35], a[16:23], v2
    v_smfmac_f32_16x16x64_bf16 v[108:111], v[32:35], a[24:31], v2
    v_smfmac_f32_16x16x64_bf16 v[96:99], v[36:39], a[48:55], v2
    v_smfmac_f32_16x16x64_bf16 v[100:103], v[36:39], a[56:63], v2
    v_smfmac_f32_16x16x64_bf16 v[104:107], v[36:39], a[64:71], v2
    v_smfmac_f32_16x16x64_bf16 v[108:111], v[36:39], a[72:79], v2
    s_branch L_Bgo2_10
    s_nop 0
    s_nop 0
    s_nop 0
    s_nop 0
    s_nop 0
L_step_00:
    s_cmp_lg_u32 s3, 0
    s_cbranch_scc1 L_re_00
    s_sleep 8
L_reb_00:
L_A_00:
    buffer_load_dwordx4 v[48:51], v1, s[36:39], s63 offen sc0 sc1
    buffer_load_dwordx4 v[52:55], v1, s[36:39], s63 offen offset:1024 sc0 sc1
    s_cmp_lg_u32 s55, 0
    s_waitcnt vmcnt(1)
    v_mfma_f32_16x16x32_bf16 v[84:87], v[48:51], v[16:19], 0
    v_bitop3_b32 v28, v48, v49, v50 bitop3:0x80
    s_waitcnt vmcnt(0)
    v_mfma_f32_16x16x32_bf16 v[84:87], v[52:55], v[16:19], v[84:87]
    v_bitop3_b32 v29, v51, v52, v53 bitop3:0x80
    v_bitop3_b32 v28, v28, v54, v55 bitop3:0x80
    v_bitop3_b32 v28, v28, v29, 1 bitop3:0x80
    v_cmp_ne_u32 vcc, 1, v28
    s_cbranch_vccnz L_Afail_00
    s_nop 2
    v_cvt_pk_bf16_f32 v28, v84, v85
    v_cvt_pk_bf16_f32 v29, v86, v87
    v_and_or_b32 v28, v28, -2, 0
    s_cbranch_scc1 L_Aslow_00
    buffer_store_dwordx2 v[28:29], v3, s[36:39], s67 offen
L_Aback_00:
    s_barrier
    v_mov_b32 v96, 0
    v_mov_b32 v97, 0
    v_mov_b32 v98, 0
    v_mov_b32 v99, 0
    v_mov_b32 v100, 0
    v_mov_b32 v101, 0
    v_mov_b32 v102, 0
    v_mov_b32 v103, 0
    v_mov_b32 v104, 0
    v_mov_b32 v105, 0
    v_mov_b32 v106, 0
    v_mov_b32 v107, 0
    v_mov_b32 v108, 0
    v_mov_b32 v109, 0
    v_mov_b32 v110, 0
    v_mov_b32 v111, 0
    v_mov_b32 v112, 0
    v_mov_b32_e64 v113, 0
    v_mov_b32_e64 v114, 0
    v_mov_b32_e64 v115, 0
    v_mov_b32_e64 v116, 0
    v_mov_b32_e64 v117, 0
    v_mov_b32_e64 v118, 0
    v_mov_b32_e64 v119, 0
    buffer_load_dwordx4 v[32:35], v1, s[36:39], s66 offen offset:0 sc1
    buffer_load_dwordx4 v[36:39], v1, s[36:39], s66 offen offset:1024 sc1
    buffer_load_dwordx4 v[40:43], v1, s[36:39], s66 offen offset:2048 sc1
    buffer_load_dwordx4 v[44:47], v1, s[36:39], s66 offen offset:3072 sc1
    s_load_dword s44, s[40:41], 8192
    s_load_dword s45, s[40:41], 8256
    s_load_dword s46, s[40:41], 8320
    s_load_dword s47, s[40:41], 8384
    s_load_dword s48, s[40:41], 8448
    s_load_dword s49, s[40:41], 8512
    s_load_dword s50, s[40:41], 8576
    s_load_dword s51, s[40:41], 8640
L_B_00:
    s_waitcnt vmcnt(3)
L_Bgo0_00:
    v_smfmac_f32_16x16x64_bf16 v[96:99], v[32:35], a[0:7], v2
    v_bitop3_b32 v28, v32, v34, 1 bitop3:0xa8
    v_cmp_ne_u32 vcc, 0, v28
    v_smfmac_f32_16x16x64_bf16 v[100:103], v[32:35], a[8:15], v2
    s_cbranch_vccnz L_Bfail0_00
    v_smfmac_f32_16x16x64_bf16 v[104:107], v[32:35], a[16:23], v2
    s_waitcnt vmcnt(2)
    v_bitop3_b32 v28, v36, v38, 1 bitop3:0xa8
    v_cmp_ne_u32_e64 vcc, 0, v28
    v_smfmac_f32_16x16x64_bf16 v[108:111], v[32:35], a[24:31], v2
    s_cbranch_vccnz L_Bfail1_00
L_Bgo1_00:
    v_smfmac_f32_16x16x64_bf16 v[96:99], v[36:39], a[48:55], v2
    v_smfmac_f32_16x16x64_bf16 v[100:103], v[36:39], a[56:63], v2
    v_smfmac_f32_16x16x64_bf16 v[104:107], v[36:39], a[64:71], v2
    s_waitcnt vmcnt(0)
    v_bitop3_b32 v29, v40, v42, v44 bitop3:0xfe
    v_bitop3_b32 v28, v29, v46, 1 bitop3:0xa8
    v_cmp_ne_u32 vcc, 0, v28
    v_smfmac_f32_16x16x64_bf16 v[108:111], v[36:39], a[72:79], v2
    s_cbranch_vccnz L_Bfail2_00
L_Bgo2_00:
    v_smfmac_f32_16x16x64_bf16 v[96:99], v[40:43], a[96:103], v2
    buffer_load_dwordx4 v[160:163], v1, s[36:39], s73 offen offset:0 sc1
    v_min_u32_dpp v222, v222, v222 row_ror:4 row_mask:0xf bank_mask:0xf
    v_smfmac_f32_16x16x64_bf16 v[100:103], v[40:43], a[104:111], v2
    s_nop 0
    v_min_u32_dpp v222, v222, v222 row_ror:2 row_mask:0xf bank_mask:0xf
    v_smfmac_f32_16x16x64_bf16 v[96:99], v[44:47], a[144:151], v2
    buffer_load_dwordx4 v[164:167], v1, s[36:39], s73 offen offset:1024 sc1
    v_min_u32_dpp v222, v222, v222 row_ror:1 row_mask:0xf bank_mask:0xf
    v_smfmac_f32_16x16x64_bf16 v[100:103], v[44:47], a[152:159], v2
    v_readfirstlane_b32 s96, v222
    v_smfmac_f32_16x16x64_bf16 v[104:107], v[40:43], a[112:119], v2
    buffer_load_dwordx4 v[168:171], v1, s[36:39], s73 offen offset:2048 sc1
    s_max_u32 s75, s75, s96
    v_smfmac_f32_16x16x64_bf16 v[108:111], v[40:43], a[120:127], v2
    v_smfmac_f32_16x16x64_bf16 v[104:107], v[44:47], a[160:167], v2
    buffer_load_dwordx4 v[172:175], v1, s[36:39], s73 offen offset:3072 sc1
    v_cvt_pk_bf16_f32 v64, v96, v97
    v_cvt_pk_bf16_f32 v65, v98, v99
    v_smfmac_f32_16x16x64_bf16 v[108:111], v[44:47], a[168:175], v2
    v_cvt_pk_bf16_f32 v66, v100, v101
    v_cvt_pk_bf16_f32 v67, v102, v103
    ds_write_b128 v192, v[64:67] offset:0
    s_nop 0
    v_cvt_pk_bf16_f32 v68, v104, v105
    v_cvt_pk_bf16_f32 v69, v106, v107
    s_nop 1
    v_cvt_pk_bf16_f32 v70, v108, v109
    v_cvt_pk_bf16_f32 v71, v110, v111
    s_nop 1
    v_mfma_f32_16x16x32_bf16 v[84:87], v[68:71], v[12:15], 0
    buffer_load_dwordx4 v[176:179], v1, s[36:39], s74 offen offset:0 sc1
    buffer_load_dwordx4 v[180:183], v1, s[36:39], s74 offen offset:1024 sc1
    s_waitcnt lgkmcnt(0)
    s_barrier
    ds_read_b128 v[52:55], v195 offset:0
    ds_read_b128 v[56:59], v196 offset:0
    ds_read_b128 v[60:63], v197 offset:0
    buffer_load_dwordx4 v[184:187], v1, s[36:39], s74 offen offset:2048 sc1
    buffer_load_dwordx4 v[188:191], v1, s[36:39], s74 offen offset:3072 sc1
    v_smfmac_f32_16x16x64_bf16 v[112:115], v[32:35], a[32:39], v2
    v_smfmac_f32_16x16x64_bf16 v[116:119], v[32:35], a[40:47], v2
    v_smfmac_f32_16x16x64_bf16 v[112:115], v[36:39], a[80:87], v2
    s_waitcnt lgkmcnt(2)
    v_mfma_f32_16x16x32_bf16 v[84:87], v[52:55], v[12:15], v[84:87]
    s_waitcnt lgkmcnt(1)
    v_mfma_f32_16x16x32_bf16 v[84:87], v[56:59], v[12:15], v[84:87]
    s_waitcnt lgkmcnt(0)
    v_mfma_f32_16x16x32_bf16 v[84:87], v[60:63], v[12:15], v[84:87]
    v_smfmac_f32_16x16x64_bf16 v[116:119], v[36:39], a[88:95], v2
    v_smfmac_f32_16x16x64_bf16 v[112:115], v[40:43], a[128:135], v2
    s_cmp_lg_u32 s55, 0
    s_nop 4
    v_cvt_pk_bf16_f32 v10, v84, v85
    v_cvt_pk_bf16_f32 v11, v86, v87
    v_and_or_b32 v10, v10, -2, 1
    s_cbranch_scc1 L_Bslow_00
    buffer_store_dwordx2 v[10:11], v4, s[36:39], s69 offen
L_Bback_00:
    v_smfmac_f32_16x16x64_bf16 v[116:119], v[40:43], a[136:143], v2
    v_smfmac_f32_16x16x64_bf16 v[112:115], v[44:47], a[176:183], v2
    v_smfmac_f32_16x16x64_bf16 v[116:119], v[44:47], a[184:191], v2
    v_mov_b32 v88, 0
    v_mov_b32 v89, 0
    v_mov_b32 v90, 0
    v_mov_b32_e64 v91, 0
    s_nop 2
    v_cvt_pk_bf16_f32 v72, v112, v113
    v_cvt_pk_bf16_f32 v73, v114, v115
    v_cvt_pk_bf16_f32 v74, v116, v117
    v_cvt_pk_bf16_f32 v75, v118, v119
    ds_write_b128 v7, v[72:75] offset:8192
    s_waitcnt lgkmcnt(0)
    s_barrier
    s_add_u32 s73, s73, 0x80000
    s_add_u32 s74, s74, 0x80000
    s_cmp_lg_u32 s3, 0
    s_cbranch_scc1 L_kv0_00
L_kv0b_00:
    buffer_load_dwordx4 v[32:35], v1, s[36:39], s68 offen offset:0 sc1
    buffer_load_dwordx4 v[36:39], v1, s[36:39], s68 offen offset:1024 sc1
    buffer_load_dwordx4 v[40:43], v1, s[36:39], s68 offen offset:2048 sc1
    buffer_load_dwordx4 v[44:47], v1, s[36:39], s68 offen offset:3072 sc1
    s_load_dword s44, s[40:41], 0
    s_load_dword s45, s[40:41], 64
    s_load_dword s46, s[40:41], 128
    s_load_dword s47, s[40:41], 192
    s_load_dword s48, s[40:41], 256
    s_load_dword s49, s[40:41], 320
    s_load_dword s50, s[40:41], 384
    s_load_dword s51, s[40:41], 448
    s_add_u32 s40, s40, 0x80000
    s_addc_u32 s41, s41, 0
    s_and_b32 s96, s58, 3
    s_cmp_eq_u32 s96, 3
    s_cselect_b32 s18, s77, 0x40000000
    s_cmp_ge_u32 s58, 58
    s_cselect_b32 s18, s77, s18
    s_and_b32 s96, s58, 3
    s_lshl_b32 s96, s96, 18
    s_add_u32 s64, s62, s96
    s_add_u32 s63, s61, s96
    s_xor_b32 s96, s96, 0x80000
    s_add_u32 s65, s62, s96
    s_add_u32 s97, s58, 8
    s_min_u32 s97, s97, 64
    s_cmp_ge_u32 s75, s97
    s_cselect_b32 s98, 0x40000000, s76
    s_add_u32 s97, s68, 4096
    s_waitcnt vmcnt(3)
L_Cgo0_00:
    v_mfma_f32_16x16x32_bf16 v[64:67], v[128:131], v[32:35], 0
    v_bitop3_b32 v28, v32, v34, 1 bitop3:0x80
    v_cmp_ne_u32_e64 vcc, 1, v28
    v_mfma_f32_16x16x32_bf16 v[68:71], v[144:147], v[32:35], 0
    s_cbranch_vccnz L_Cfail0_00
    s_waitcnt vmcnt(2)
    v_bitop3_b32 v28, v36, v38, 1 bitop3:0x80
    v_cmp_ne_u32 vcc, 1, v28
    v_mfma_f32_16x16x32_bf16 v[72:75], v[32:35], v[32:35], v[24:27]
    s_cbranch_vccnz L_Cfail1_00
L_Cgo1_00:
    v_mfma_f32_16x16x32_bf16 v[64:67], v[132:135], v[36:39], v[64:67]
    v_mfma_f32_16x16x32_bf16 v[68:71], v[148:151], v[36:39], v[68:71]
    s_waitcnt vmcnt(1)
    v_bitop3_b32 v28, v40, v42, 1 bitop3:0x80
    v_cmp_ne_u32 vcc, 1, v28
    v_mfma_f32_16x16x32_bf16 v[72:75], v[36:39], v[36:39], v[72:75]
    s_cbranch_vccnz L_Cfail2_00
L_Cgo2_00:
    v_mfma_f32_16x16x32_bf16 v[64:67], v[136:139], v[40:43], v[64:67]
    v_mfma_f32_16x16x32_bf16 v[68:71], v[152:155], v[40:43], v[68:71]
    s_waitcnt vmcnt(0)
    v_bitop3_b32 v28, v44, v46, 1 bitop3:0x80
    v_cmp_ne_u32 vcc, 1, v28
    v_mfma_f32_16x16x32_bf16 v[72:75], v[40:43], v[40:43], v[72:75]
    s_cbranch_vccnz L_Cfail3_00
L_Cgo3_00:
    v_mfma_f32_16x16x32_bf16 v[64:67], v[140:143], v[44:47], v[64:67]
    v_mfma_f32_16x16x32_bf16 v[68:71], v[156:159], v[44:47], v[68:71]
    v_mfma_f32_16x16x32_bf16 v[72:75], v[44:47], v[44:47], v[72:75]
    s_add_u32 s96, s58, 2
    s_cmp_lt_u32 s75, s96
    s_cselect_b32 s3, 1, 0
    s_nop 2
    v_max3_f32 v92, v64, v65, v66
    v_max3_f32 v93, v68, v69, v70
    v_max3_f32 v92, v92, v67, v71
    v_max3_f32 v94, v72, v73, v74
    v_max3_f32 v93, v93, v92, v75
    v_max_f32 v92, v94, v93
    v_max_f32 v94, v94, v93
    buffer_load_dwordx4 v[48:51], v5, s[36:39], s97 offen offset:0 sc1
    buffer_load_dwordx4 v[52:55], v5, s[36:39], s97 offen offset:512 sc1
    v_permlane16_swap_b32 v92, v94
    v_max_f32 v93, v92, v94
    v_max_f32 v92, v92, v94
    buffer_load_dwordx4 v[56:59], v5, s[36:39], s97 offen offset:1024 sc1
    buffer_load_dwordx4 v[60:63], v5, s[36:39], s97 offen offset:1536 sc1
    v_permlane32_swap_b32 v92, v93
    v_max3_f32 v92, v92, v93, v203
    v_mul_f32 v92, s79, v92
    v_fma_f32 v64, v64, s79, -v92
    v_fma_f32 v65, v65, s79, -v92
    v_exp_f32 v64, v64
    v_fma_f32 v66, v66, s79, -v92
    v_exp_f32 v65, v65
    buffer_load_dwordx4 v[128:131], v1, s[36:39], s71 offen offset:0 sc1
    v_fma_f32 v67, v67, s79, -v92
    v_exp_f32 v66, v66
    v_cvt_pk_bf16_f32 v76, v64, v65
    v_fma_f32 v68, v68, s79, -v92
    v_exp_f32 v67, v67
    v_fma_f32 v69, v69, s79, -v92
    v_exp_f32 v68, v68
    v_cvt_pk_bf16_f32 v77, v66, v67
    v_fma_f32 v70, v70, s79, -v92
    v_exp_f32 v69, v69
    buffer_load_dwordx4 v[132:135], v1, s[36:39], s71 offen offset:1024 sc1
    v_fma_f32 v71, v71, s79, -v92
    v_exp_f32 v70, v70
    v_cvt_pk_bf16_f32 v78, v68, v69
    v_exp_f32_e64 v71, v71
    v_fma_f32 v72, v72, s79, -v92
    v_cvt_pk_bf16_f32 v79, v70, v71
    v_fma_f32 v73, v73, s79, -v92
    v_exp_f32 v72, v72
    v_mfma_f32_16x16x32_bf16 v[84:87], v[20:23], v[76:79], 0
    v_exp_f32 v73, v73
    v_fma_f32 v74, v74, s79, -v92
    v_mfma_f32_16x16x32_bf16 v[96:99], v[160:163], v[76:79], 0
    v_fma_f32 v75, v75, s79, -v92
    v_exp_f32_e64 v74, v74
    v_mfma_f32_16x16x32_bf16 v[100:103], v[164:167], v[76:79], 0
    v_exp_f32_e64 v75, v75
    v_cvt_pk_bf16_f32 v80, v72, v73
    v_mfma_f32_16x16x32_bf16 v[104:107], v[176:179], v[76:79], 0
    v_cvt_pk_bf16_f32 v81, v74, v75
    v_mov_b32_dpp v224, v76 row_shr:8 row_mask:0xf bank_mask:0xc
    v_mov_b32_dpp v225, v77 row_shr:8 row_mask:0xf bank_mask:0xc
    v_mfma_f32_16x16x16_bf16 v[84:87], v[20:21], v[80:81], v[84:87]
    v_mov_b32_dpp v226, v78 row_shr:8 row_mask:0xf bank_mask:0xc
    v_mov_b32_dpp v227, v79 row_shr:8 row_mask:0xf bank_mask:0xc
    v_mfma_f32_16x16x32_bf16 v[108:111], v[180:183], v[76:79], 0
    v_mov_b32_dpp v228, v80 row_shr:8 row_mask:0xf bank_mask:0xc
    v_mov_b32_dpp v229, v81 row_shr:8 row_mask:0xf bank_mask:0xc
    s_waitcnt vmcnt(2)
    v_bitop3_b32 v28, v48, v50, v52 bitop3:0x80
    v_mfma_f32_16x16x32_bf16 v[96:99], v[168:171], v[224:227], v[96:99]
    v_bitop3_b32 v29, v54, v56, v58 bitop3:0x80
    v_bitop3_b32 v28, v28, v60, v62 bitop3:0x80
    v_mfma_f32_16x16x32_bf16 v[100:103], v[172:175], v[224:227], v[100:103]
    v_bitop3_b32 v28, v28, v29, 1 bitop3:0x80
    v_cmp_ne_u32_e64 vcc, 1, v28
    s_cbranch_vccnz L_CfailV_00
L_CgoV_00:
    v_mfma_f32_16x16x16_bf16 v[96:99], v[48:49], v[80:81], v[96:99]
    v_rcp_f32_e64 v82, v84
    buffer_load_dwordx4 v[136:139], v1, s[36:39], s71 offen offset:2048 sc1
    v_mfma_f32_16x16x16_bf16 v[96:99], v[52:53], v[228:229], v[96:99]
    v_mov_b32_dpp v82, v82 row_shr:8 row_mask:0xf bank_mask:0xc
    buffer_load_dwordx4 v[140:143], v1, s[36:39], s71 offen offset:3072 sc1
    v_mfma_f32_16x16x32_bf16 v[104:107], v[184:187], v[224:227], v[104:107]
    buffer_load_dwordx4 v[144:147], v1, s[36:39], s72 offen offset:0 sc1
    v_mfma_f32_16x16x16_bf16 v[100:103], v[50:51], v[80:81], v[100:103]
    buffer_load_dwordx4 v[148:151], v1, s[36:39], s72 offen offset:1024 sc1
    v_mfma_f32_16x16x16_bf16 v[100:103], v[54:55], v[228:229], v[100:103]
    buffer_load_dwordx4 v[152:155], v1, s[36:39], s72 offen offset:2048 sc1
    v_mul_f32 v96, v96, v82
    v_mul_f32 v97, v97, v82
    v_mul_f32 v98, v98, v82
    v_mfma_f32_16x16x32_bf16 v[108:111], v[188:191], v[224:227], v[108:111]
    v_mul_f32 v99, v99, v82
    v_cvt_pk_bf16_f32 v64, v96, v97
    v_cvt_pk_bf16_f32 v65, v98, v99
    v_mfma_f32_16x16x16_bf16 v[104:107], v[56:57], v[80:81], v[104:107]
    buffer_load_dwordx4 v[156:159], v1, s[36:39], s72 offen offset:3072 sc1
    v_mfma_f32_16x16x16_bf16 v[104:107], v[60:61], v[228:229], v[104:107]
    v_mul_f32 v100, v100, v82
    v_mul_f32 v101, v101, v82
    v_mul_f32 v102, v102, v82
    v_mfma_f32_16x16x16_bf16 v[108:111], v[58:59], v[80:81], v[108:111]
    v_mul_f32 v103, v103, v82
    v_cvt_pk_bf16_f32 v66, v100, v101
    v_cvt_pk_bf16_f32 v67, v102, v103
    v_mfma_f32_16x16x16_bf16 v[108:111], v[62:63], v[228:229], v[108:111]
    ds_write_b128 v8, v[64:67] offset:12288
    v_mul_f32 v104, v104, v82
    v_mul_f32 v105, v105, v82
    v_mul_f32 v106, v106, v82
    v_mul_f32 v107, v107, v82
    v_cvt_pk_bf16_f32 v68, v104, v105
    v_cvt_pk_bf16_f32 v69, v106, v107
    s_nop 0
    v_mul_f32 v108, v108, v82
    v_mul_f32_e64 v109, v109, v82
    v_mul_f32_e64 v110, v110, v82
    v_mul_f32_e64 v111, v111, v82
    v_cvt_pk_bf16_f32 v70, v108, v109
    v_cvt_pk_bf16_f32 v71, v110, v111
    ds_write_b128 v8, v[68:71] offset:13312
    s_add_u32 s71, s71, 0x80000
    s_add_u32 s72, s72, 0x80000
    buffer_store_dword v198, v6, s[36:39], s65 offen sc1
    buffer_load_dword v222, v223, s[36:39], s98 offen sc1
    s_waitcnt lgkmcnt(0)
    s_barrier
    ds_read_b128 v[104:107], v200 offset:12288
    ds_read_b128 v[108:111], v200 offset:13312
    ds_read_b128 v[112:115], v201 offset:12288
    ds_read_b128 v[116:119], v201 offset:13312
    ds_read_b128 v[120:123], v202 offset:12288
    ds_read_b128 v[124:127], v202 offset:13312
    v_smfmac_f32_16x16x64_bf16 v[88:91], v[64:67], a[192:199], v2
    v_smfmac_f32_16x16x64_bf16 v[88:91], v[68:71], a[200:207], v2
    v_add_u32_e64 v194, 1, v194
    s_add_u32 s58, s58, 1
    s_waitcnt lgkmcnt(5)
    v_smfmac_f32_16x16x64_bf16 v[88:91], v[104:107], a[208:215], v2
    s_waitcnt lgkmcnt(4)
    v_smfmac_f32_16x16x64_bf16 v[88:91], v[108:111], a[216:223], v2
    s_waitcnt lgkmcnt(3)
    v_smfmac_f32_16x16x64_bf16 v[88:91], v[112:115], a[224:231], v2
    s_waitcnt lgkmcnt(2)
    v_smfmac_f32_16x16x64_bf16 v[88:91], v[116:119], a[232:239], v2
    s_waitcnt lgkmcnt(1)
    v_smfmac_f32_16x16x64_bf16 v[88:91], v[120:123], a[240:247], v2
    s_waitcnt lgkmcnt(0)
    v_smfmac_f32_16x16x64_bf16 v[88:91], v[124:127], a[248:255], v2
    s_nop 7
    v_permlane32_swap_b32 v88, v90
    v_permlane32_swap_b32 v89, v91
    v_add_f32_e64 v28, v88, v90
    v_add_f32_e64 v29, v89, v91
    v_cvt_pk_bf16_f32 v28, v28, v29
    v_or_b32_e64 v28, 1, v28
    buffer_store_dword v28, v6, s[36:39], s64 offen sc1
L_step_01:
    s_cmp_lg_u32 s3, 0
    s_cbranch_scc1 L_re_01
    s_sleep 8
L_reb_01:
L_A_01:
    buffer_load_dwordx4 v[48:51], v1, s[36:39], s63 offen sc0 sc1
    buffer_load_dwordx4 v[52:55], v1, s[36:39], s63 offen offset:1024 sc0 sc1
    s_cmp_lg_u32 s55, 0
    s_waitcnt vmcnt(1)
    v_mfma_f32_16x16x32_bf16 v[84:87], v[48:51], v[16:19], 0
    v_bitop3_b32 v28, v48, v49, v50 bitop3:0x80
    s_waitcnt vmcnt(0)
    v_mfma_f32_16x16x32_bf16 v[84:87], v[52:55], v[16:19], v[84:87]
    v_bitop3_b32 v29, v51, v52, v53 bitop3:0x80
    v_bitop3_b32 v28, v28, v54, v55 bitop3:0x80
    v_bitop3_b32 v28, v28, v29, 1 bitop3:0x80
    v_cmp_ne_u32 vcc, 1, v28
    s_cbranch_vccnz L_Afail_01
    s_nop 2
    v_cvt_pk_bf16_f32 v28, v84, v85
    v_cvt_pk_bf16_f32 v29, v86, v87
    v_and_or_b32 v28, v28, -2, 1
    s_cbranch_scc1 L_Aslow_01
    buffer_store_dwordx2 v[28:29], v3, s[36:39], s67 offen
L_Aback_01:
    s_barrier
    v_mov_b32 v96, 0
    v_mov_b32 v97, 0
    v_mov_b32 v98, 0
    v_mov_b32 v99, 0
    v_mov_b32 v100, 0
    v_mov_b32 v101, 0
    v_mov_b32 v102, 0
    v_mov_b32 v103, 0
    v_mov_b32 v104, 0
    v_mov_b32 v105, 0
    v_mov_b32 v106, 0
    v_mov_b32 v107, 0
    v_mov_b32 v108, 0
    v_mov_b32 v109, 0
    v_mov_b32 v110, 0
    v_mov_b32 v111, 0
    v_mov_b32 v112, 0
    v_mov_b32_e64 v113, 0
    v_mov_b32_e64 v114, 0
    v_mov_b32_e64 v115, 0
    v_mov_b32_e64 v116, 0
    v_mov_b32_e64 v117, 0
    v_mov_b32_e64 v118, 0
    v_mov_b32_e64 v119, 0
    buffer_load_dwordx4 v[32:35], v1, s[36:39], s66 offen offset:0 sc1
    buffer_load_dwordx4 v[36:39], v1, s[36:39], s66 offen offset:1024 sc1
    buffer_load_dwordx4 v[40:43], v1, s[36:39], s66 offen offset:2048 sc1
    buffer_load_dwordx4 v[44:47], v1, s[36:39], s66 offen offset:3072 sc1
    s_load_dword s44, s[40:41], 8192
    s_load_dword s45, s[40:41], 8256
    s_load_dword s46, s[40:41], 8320
    s_load_dword s47, s[40:41], 8384
    s_load_dword s48, s[40:41], 8448
    s_load_dword s49, s[40:41], 8512
    s_load_dword s50, s[40:41], 8576
    s_load_dword s51, s[40:41], 8640
L_B_01:
    s_waitcnt vmcnt(3)
L_Bgo0_01:
    v_smfmac_f32_16x16x64_bf16 v[96:99], v[32:35], a[0:7], v2
    v_bitop3_b32 v28, v32, v34, 1 bitop3:0x80
    v_cmp_ne_u32 vcc, 1, v28
    v_smfmac_f32_16x16x64_bf16 v[100:103], v[32:35], a[8:15], v2
    s_cbranch_vccnz L_Bfail0_01
    v_smfmac_f32_16x16x64_bf16 v[104:107], v[32:35], a[16:23], v2
    s_waitcnt vmcnt(2)
    v_bitop3_b32 v28, v36, v38, 1 bitop3:0x80
    v_cmp_ne_u32_e64 vcc, 1, v28
    v_smfmac_f32_16x16x64_bf16 v[108:111], v[32:35], a[24:31], v2
    s_cbranch_vccnz L_Bfail1_01
L_Bgo1_01:
    v_smfmac_f32_16x16x64_bf16 v[96:99], v[36:39], a[48:55], v2
    v_smfmac_f32_16x16x64_bf16 v[100:103], v[36:39], a[56:63], v2
    v_smfmac_f32_16x16x64_bf16 v[104:107], v[36:39], a[64:71], v2
    s_waitcnt vmcnt(0)
    v_bitop3_b32 v29, v40, v42, v44 bitop3:0x80
    v_bitop3_b32 v28, v29, v46, 1 bitop3:0x80
    v_cmp_ne_u32 vcc, 1, v28
    v_smfmac_f32_16x16x64_bf16 v[108:111], v[36:39], a[72:79], v2
    s_cbranch_vccnz L_Bfail2_01
L_Bgo2_01:
    v_smfmac_f32_16x16x64_bf16 v[96:99], v[40:43], a[96:103], v2
    buffer_load_dwordx4 v[160:163], v1, s[36:39], s73 offen offset:0 sc1
    v_min_u32_dpp v222, v222, v222 row_ror:4 row_mask:0xf bank_mask:0xf
    v_smfmac_f32_16x16x64_bf16 v[100:103], v[40:43], a[104:111], v2
    s_nop 0
    v_min_u32_dpp v222, v222, v222 row_ror:2 row_mask:0xf bank_mask:0xf
    v_smfmac_f32_16x16x64_bf16 v[96:99], v[44:47], a[144:151], v2
    buffer_load_dwordx4 v[164:167], v1, s[36:39], s73 offen offset:1024 sc1
    v_min_u32_dpp v222, v222, v222 row_ror:1 row_mask:0xf bank_mask:0xf
    v_smfmac_f32_16x16x64_bf16 v[100:103], v[44:47], a[152:159], v2
    v_readfirstlane_b32 s96, v222
    v_smfmac_f32_16x16x64_bf16 v[104:107], v[40:43], a[112:119], v2
    buffer_load_dwordx4 v[168:171], v1, s[36:39], s73 offen offset:2048 sc1
    s_max_u32 s75, s75, s96
    v_smfmac_f32_16x16x64_bf16 v[108:111], v[40:43], a[120:127], v2
    v_smfmac_f32_16x16x64_bf16 v[104:107], v[44:47], a[160:167], v2
    buffer_load_dwordx4 v[172:175], v1, s[36:39], s73 offen offset:3072 sc1
    v_cvt_pk_bf16_f32 v64, v96, v97
    v_cvt_pk_bf16_f32 v65, v98, v99
    v_smfmac_f32_16x16x64_bf16 v[108:111], v[44:47], a[168:175], v2
    v_cvt_pk_bf16_f32 v66, v100, v101
    v_cvt_pk_bf16_f32 v67, v102, v103
    ds_write_b128 v192, v[64:67] offset:0
    s_nop 0
    v_cvt_pk_bf16_f32 v68, v104, v105
    v_cvt_pk_bf16_f32 v69, v106, v107
    s_nop 1
    v_cvt_pk_bf16_f32 v70, v108, v109
    v_cvt_pk_bf16_f32 v71, v110, v111
    s_nop 1
    v_mfma_f32_16x16x32_bf16 v[84:87], v[68:71], v[12:15], 0
    buffer_load_dwordx4 v[176:179], v1, s[36:39], s74 offen offset:0 sc1
    buffer_load_dwordx4 v[180:183], v1, s[36:39], s74 offen offset:1024 sc1
    s_waitcnt lgkmcnt(0)
    s_barrier
    ds_read_b128 v[52:55], v195 offset:0
    ds_read_b128 v[56:59], v196 offset:0
    ds_read_b128 v[60:63], v197 offset:0
    buffer_load_dwordx4 v[184:187], v1, s[36:39], s74 offen offset:2048 sc1
    buffer_load_dwordx4 v[188:191], v1, s[36:39], s74 offen offset:3072 sc1
    v_smfmac_f32_16x16x64_bf16 v[112:115], v[32:35], a[32:39], v2
    v_smfmac_f32_16x16x64_bf16 v[116:119], v[32:35], a[40:47], v2
    v_smfmac_f32_16x16x64_bf16 v[112:115], v[36:39], a[80:87], v2
    s_waitcnt lgkmcnt(2)
    v_mfma_f32_16x16x32_bf16 v[84:87], v[52:55], v[12:15], v[84:87]
    s_waitcnt lgkmcnt(1)
    v_mfma_f32_16x16x32_bf16 v[84:87], v[56:59], v[12:15], v[84:87]
    s_waitcnt lgkmcnt(0)
    v_mfma_f32_16x16x32_bf16 v[84:87], v[60:63], v[12:15], v[84:87]
    v_smfmac_f32_16x16x64_bf16 v[116:119], v[36:39], a[88:95], v2
    v_smfmac_f32_16x16x64_bf16 v[112:115], v[40:43], a[128:135], v2
    s_cmp_lg_u32 s55, 0
    s_nop 4
    v_cvt_pk_bf16_f32 v10, v84, v85
    v_cvt_pk_bf16_f32 v11, v86, v87
    v_and_or_b32 v10, v10, -2, 0
    s_cbranch_scc1 L_Bslow_01
    buffer_store_dwordx2 v[10:11], v4, s[36:39], s69 offen
L_Bback_01:
    v_smfmac_f32_16x16x64_bf16 v[116:119], v[40:43], a[136:143], v2
    v_smfmac_f32_16x16x64_bf16 v[112:115], v[44:47], a[176:183], v2
    v_smfmac_f32_16x16x64_bf16 v[116:119], v[44:47], a[184:191], v2
    v_mov_b32 v88, 0
    v_mov_b32 v89, 0
    v_mov_b32 v90, 0
    v_mov_b32_e64 v91, 0
    s_nop 2
    v_cvt_pk_bf16_f32 v72, v112, v113
    v_cvt_pk_bf16_f32 v73, v114, v115
    v_cvt_pk_bf16_f32 v74, v116, v117
    v_cvt_pk_bf16_f32 v75, v118, v119
    ds_write_b128 v7, v[72:75] offset:8192
    s_waitcnt lgkmcnt(0)
    s_barrier
    s_add_u32 s73, s73, 0x80000
    s_add_u32 s74, s74, 0x80000
    s_cmp_lg_u32 s3, 0
    s_cbranch_scc1 L_kv0_01
L_kv0b_01:
    buffer_load_dwordx4 v[32:35], v1, s[36:39], s68 offen offset:0 sc1
    buffer_load_dwordx4 v[36:39], v1, s[36:39], s68 offen offset:1024 sc1
    buffer_load_dwordx4 v[40:43], v1, s[36:39], s68 offen offset:2048 sc1
    buffer_load_dwordx4 v[44:47], v1, s[36:39], s68 offen offset:3072 sc1
    s_cmp_eq_u32 s58, 63
    s_cbranch_scc1 L_chain_fin
    s_load_dword s44, s[40:41], 0
    s_load_dword s45, s[40:41], 64
    s_load_dword s46, s[40:41], 128
    s_load_dword s47, s[40:41], 192
    s_load_dword s48, s[40:41], 256
    s_load_dword s49, s[40:41], 320
    s_load_dword s50, s[40:41], 384
    s_load_dword s51, s[40:41], 448
    s_add_u32 s40, s40, 0x80000
    s_addc_u32 s41, s41, 0
    s_and_b32 s96, s58, 3
    s_cmp_eq_u32 s96, 3
    s_cselect_b32 s18, s77, 0x40000000
    s_cmp_ge_u32 s58, 58
    s_cselect_b32 s18, s77, s18
    s_and_b32 s96, s58, 3
    s_lshl_b32 s96, s96, 18
    s_add_u32 s64, s62, s96
    s_add_u32 s63, s61, s96
    s_xor_b32 s96, s96, 0x80000
    s_add_u32 s65, s62, s96
    s_add_u32 s97, s58, 8
    s_min_u32 s97, s97, 64
    s_cmp_ge_u32 s75, s97
    s_cselect_b32 s98, 0x40000000, s76
    s_add_u32 s97, s68, 4096
    s_waitcnt vmcnt(3)
L_Cgo0_01:
    v_mfma_f32_16x16x32_bf16 v[64:67], v[128:131], v[32:35], 0
    v_bitop3_b32 v28, v32, v34, 1 bitop3:0xa8
    v_cmp_ne_u32 vcc, 0, v28
    v_mfma_f32_16x16x32_bf16 v[68:71], v[144:147], v[32:35], 0
    s_cbranch_vccnz L_Cfail0_01
    s_waitcnt vmcnt(2)
    v_bitop3_b32 v28, v36, v38, 1 bitop3:0xa8
    v_cmp_ne_u32_e64 vcc, 0, v28
    v_mfma_f32_16x16x32_bf16 v[72:75], v[32:35], v[32:35], v[24:27]
    s_cbranch_vccnz L_Cfail1_01
L_Cgo1_01:
    v_mfma_f32_16x16x32_bf16 v[64:67], v[132:135], v[36:39], v[64:67]
    v_mfma_f32_16x16x32_bf16 v[68:71], v[148:151], v[36:39], v[68:71]
    s_waitcnt vmcnt(1)
    v_bitop3_b32 v28, v40, v42, 1 bitop3:0xa8
    v_cmp_ne_u32 vcc, 0, v28
    v_mfma_f32_16x16x32_bf16 v[72:75], v[36:39], v[36:39], v[72:75]
    s_cbranch_vccnz L_Cfail2_01
L_Cgo2_01:
    v_mfma_f32_16x16x32_bf16 v[64:67], v[136:139], v[40:43], v[64:67]
    v_mfma_f32_16x16x32_bf16 v[68:71], v[152:155], v[40:43], v[68:71]
    s_waitcnt vmcnt(0)
    v_bitop3_b32 v28, v44, v46, 1 bitop3:0xa8
    v_cmp_ne_u32 vcc, 0, v28
    v_mfma_f32_16x16x32_bf16 v[72:75], v[40:43], v[40:43], v[72:75]
    s_cbranch_vccnz L_Cfail3_01
L_Cgo3_01:
    v_mfma_f32_16x16x32_bf16 v[64:67], v[140:143], v[44:47], v[64:67]
    v_mfma_f32_16x16x32_bf16 v[68:71], v[156:159], v[44:47], v[68:71]
    v_mfma_f32_16x16x32_bf16 v[72:75], v[44:47], v[44:47], v[72:75]
    s_add_u32 s96, s58, 2
    s_cmp_lt_u32 s75, s96
    s_cselect_b32 s3, 1, 0
    s_nop 2
    v_max3_f32 v92, v64, v65, v66
    v_max3_f32 v93, v68, v69, v70
    v_max3_f32 v92, v92, v67, v71
    v_max3_f32 v94, v72, v73, v74
    v_max3_f32 v93, v93, v92, v75
    v_max_f32 v92, v94, v93
    v_max_f32 v94, v94, v93
    buffer_load_dwordx4 v[48:51], v5, s[36:39], s97 offen offset:0 sc1
    buffer_load_dwordx4 v[52:55], v5, s[36:39], s97 offen offset:512 sc1
    v_permlane16_swap_b32 v92, v94
    v_max_f32 v93, v92, v94
    v_max_f32 v92, v92, v94
    buffer_load_dwordx4 v[56:59], v5, s[36:39], s97 offen offset:1024 sc1
    buffer_load_dwordx4 v[60:63], v5, s[36:39], s97 offen offset:1536 sc1
    v_permlane32_swap_b32 v92, v93
    v_max3_f32 v92, v92, v93, v203
    v_mul_f32 v92, s79, v92
    v_fma_f32 v64, v64, s79, -v92
    v_fma_f32 v65, v65, s79, -v92
    v_exp_f32 v64, v64
    v_fma_f32 v66, v66, s79, -v92
    v_exp_f32 v65, v65
    buffer_load_dwordx4 v[128:131], v1, s[36:39], s71 offen offset:0 sc1
    v_fma_f32 v67, v67, s79, -v92
    v_exp_f32 v66, v66
    v_cvt_pk_bf16_f32 v76, v64, v65
    v_fma_f32 v68, v68, s79, -v92
    v_exp_f32 v67, v67
    v_fma_f32 v69, v69, s79, -v92
    v_exp_f32 v68, v68
    v_cvt_pk_bf16_f32 v77, v66, v67
    v_fma_f32 v70, v70, s79, -v92
    v_exp_f32_e64 v69, v69
    buffer_load_dwordx4 v[132:135], v1, s[36:39], s71 offen offset:1024 sc1
    v_fma_f32 v71, v71, s79, -v92
    v_exp_f32 v70, v70
    v_cvt_pk_bf16_f32 v78, v68, v69
    v_exp_f32 v71, v71
    v_fma_f32 v72, v72, s79, -v92
    v_cvt_pk_bf16_f32 v79, v70, v71
    v_fma_f32 v73, v73, s79, -v92
    v_exp_f32 v72, v72
    v_mfma_f32_16x16x32_bf16 v[84:87], v[20:23], v[76:79], 0
    v_exp_f32 v73, v73
    v_fma_f32 v74, v74, s79, -v92
    v_mfma_f32_16x16x32_bf16 v[96:99], v[160:163], v[76:79], 0
    v_fma_f32 v75, v75, s79, -v92
    v_exp_f32_e64 v74, v74
    v_mfma_f32_16x16x32_bf16 v[100:103], v[164:167], v[76:79], 0
    v_exp_f32_e64 v75, v75
    v_cvt_pk_bf16_f32 v80, v72, v73
    v_mfma_f32_16x16x32_bf16 v[104:107], v[176:179], v[76:79], 0
    v_cvt_pk_bf16_f32 v81, v74, v75
    v_mov_b32_dpp v224, v76 row_shr:8 row_mask:0xf bank_mask:0xc
    v_mov_b32_dpp v225, v77 row_shr:8 row_mask:0xf bank_mask:0xc
    v_mfma_f32_16x16x16_bf16 v[84:87], v[20:21], v[80:81], v[84:87]
    v_mov_b32_dpp v226, v78 row_shr:8 row_mask:0xf bank_mask:0xc
    v_mov_b32_dpp v227, v79 row_shr:8 row_mask:0xf bank_mask:0xc
    v_mfma_f32_16x16x32_bf16 v[108:111], v[180:183], v[76:79], 0
    v_mov_b32_dpp v228, v80 row_shr:8 row_mask:0xf bank_mask:0xc
    v_mov_b32_dpp v229, v81 row_shr:8 row_mask:0xf bank_mask:0xc
    s_waitcnt vmcnt(2)
    v_bitop3_b32 v28, v48, v50, v52 bitop3:0xfe
    v_mfma_f32_16x16x32_bf16 v[96:99], v[168:171], v[224:227], v[96:99]
    v_bitop3_b32 v29, v54, v56, v58 bitop3:0xfe
    v_bitop3_b32 v28, v28, v60, v62 bitop3:0xfe
    v_mfma_f32_16x16x32_bf16 v[100:103], v[172:175], v[224:227], v[100:103]
    v_bitop3_b32 v28, v28, v29, 1 bitop3:0xa8
    v_cmp_ne_u32 vcc, 0, v28
    s_cbranch_vccnz L_CfailV_01
L_CgoV_01:
    v_mfma_f32_16x16x16_bf16 v[96:99], v[48:49], v[80:81], v[96:99]
    v_rcp_f32 v82, v84
    buffer_load_dwordx4 v[136:139], v1, s[36:39], s71 offen offset:2048 sc1
    v_mfma_f32_16x16x16_bf16 v[96:99], v[52:53], v[228:229], v[96:99]
    v_mov_b32_dpp v82, v82 row_shr:8 row_mask:0xf bank_mask:0xc
    buffer_load_dwordx4 v[140:143], v1, s[36:39], s71 offen offset:3072 sc1
    v_mfma_f32_16x16x32_bf16 v[104:107], v[184:187], v[224:227], v[104:107]
    buffer_load_dwordx4 v[144:147], v1, s[36:39], s72 offen offset:0 sc1
    v_mfma_f32_16x16x16_bf16 v[100:103], v[50:51], v[80:81], v[100:103]
    buffer_load_dwordx4 v[148:151], v1, s[36:39], s72 offen offset:1024 sc1
    v_mfma_f32_16x16x16_bf16 v[100:103], v[54:55], v[228:229], v[100:103]
    buffer_load_dwordx4 v[152:155], v1, s[36:39], s72 offen offset:2048 sc1
    v_mul_f32 v96, v96, v82
    v_mul_f32 v97, v97, v82
    v_mul_f32 v98, v98, v82
    v_mfma_f32_16x16x32_bf16 v[108:111], v[188:191], v[224:227], v[108:111]
    v_mul_f32 v99, v99, v82
    v_cvt_pk_bf16_f32 v64, v96, v97
    v_cvt_pk_bf16_f32 v65, v98, v99
    v_mfma_f32_16x16x16_bf16 v[104:107], v[56:57], v[80:81], v[104:107]
    buffer_load_dwordx4 v[156:159], v1, s[36:39], s72 offen offset:3072 sc1
    v_mfma_f32_16x16x16_bf16 v[104:107], v[60:61], v[228:229], v[104:107]
    v_mul_f32 v100, v100, v82
    v_mul_f32 v101, v101, v82
    v_mul_f32 v102, v102, v82
    v_mfma_f32_16x16x16_bf16 v[108:111], v[58:59], v[80:81], v[108:111]
    v_mul_f32 v103, v103, v82
    v_cvt_pk_bf16_f32 v66, v100, v101
    v_cvt_pk_bf16_f32 v67, v102, v103
    v_mfma_f32_16x16x16_bf16 v[108:111], v[62:63], v[228:229], v[108:111]
    ds_write_b128 v8, v[64:67] offset:12288
    v_mul_f32 v104, v104, v82
    v_mul_f32 v105, v105, v82
    v_mul_f32 v106, v106, v82
    v_mul_f32 v107, v107, v82
    v_cvt_pk_bf16_f32 v68, v104, v105
    v_cvt_pk_bf16_f32 v69, v106, v107
    s_nop 0
    v_mul_f32 v108, v108, v82
    v_mul_f32_e64 v109, v109, v82
    v_mul_f32_e64 v110, v110, v82
    v_mul_f32_e64 v111, v111, v82
    v_cvt_pk_bf16_f32 v70, v108, v109
    v_cvt_pk_bf16_f32 v71, v110, v111
    ds_write_b128 v8, v[68:71] offset:13312
    s_add_u32 s71, s71, 0x80000
    s_add_u32 s72, s72, 0x80000
    buffer_store_dword v198, v6, s[36:39], s65 offen sc1
    buffer_load_dword v222, v223, s[36:39], s98 offen sc1
    s_waitcnt lgkmcnt(0)
    s_barrier
    ds_read_b128 v[104:107], v200 offset:12288
    ds_read_b128 v[108:111], v200 offset:13312
    ds_read_b128 v[112:115], v201 offset:12288
    ds_read_b128 v[116:119], v201 offset:13312
    ds_read_b128 v[120:123], v202 offset:12288
    ds_read_b128 v[124:127], v202 offset:13312
    v_smfmac_f32_16x16x64_bf16 v[88:91], v[64:67], a[192:199], v2
    v_smfmac_f32_16x16x64_bf16 v[88:91], v[68:71], a[200:207], v2
    v_add_u32_e64 v194, 1, v194
    s_add_u32 s58, s58, 1
    s_waitcnt lgkmcnt(5)
    v_smfmac_f32_16x16x64_bf16 v[88:91], v[104:107], a[208:215], v2
    s_waitcnt lgkmcnt(4)
    v_smfmac_f32_16x16x64_bf16 v[88:91], v[108:111], a[216:223], v2
    s_waitcnt lgkmcnt(3)
    v_smfmac_f32_16x16x64_bf16 v[88:91], v[112:115], a[224:231], v2
    s_waitcnt lgkmcnt(2)
    v_smfmac_f32_16x16x64_bf16 v[88:91], v[116:119], a[232:239], v2
    s_waitcnt lgkmcnt(1)
    v_smfmac_f32_16x16x64_bf16 v[88:91], v[120:123], a[240:247], v2
    s_waitcnt lgkmcnt(0)
    v_smfmac_f32_16x16x64_bf16 v[88:91], v[124:127], a[248:255], v2
    s_nop 7
    v_permlane32_swap_b32 v88, v90
    v_permlane32_swap_b32 v89, v91
    v_add_f32 v28, v88, v90
    v_add_f32 v29, v89, v91
    v_cvt_pk_bf16_f32 v28, v28, v29
    v_or_b32 v28, 1, v28
    buffer_store_dword v28, v6, s[36:39], s64 offen sc1
    s_branch L_step_00
    s_nop 0
L_step_10:
    s_cmp_lg_u32 s3, 0
    s_cbranch_scc1 L_re_10
L_reb_10:
    s_barrier
    v_mov_b32 v96, 0
    v_mov_b32 v97, 0
    v_mov_b32 v98, 0
    v_mov_b32 v99, 0
    v_mov_b32 v100, 0
    v_mov_b32 v101, 0
    v_mov_b32 v102, 0
    v_mov_b32 v103, 0
    v_mov_b32 v104, 0
    v_mov_b32 v105, 0
    v_mov_b32 v106, 0
    v_mov_b32 v107, 0
    v_mov_b32 v108, 0
    v_mov_b32 v109, 0
    v_mov_b32 v110, 0
    v_mov_b32 v111, 0
    v_mov_b32 v112, 0
    v_mov_b32 v113, 0
    v_mov_b32 v114, 0
    v_mov_b32 v115, 0
    v_mov_b32 v116, 0
    v_mov_b32 v117, 0
    v_mov_b32 v118, 0
    v_mov_b32 v119, 0
    buffer_load_dwordx4 v[32:35], v1, s[36:39], s66 offen offset:0 sc1
    buffer_load_dwordx4 v[36:39], v1, s[36:39], s66 offen offset:1024 sc1
    buffer_load_dwordx4 v[40:43], v1, s[36:39], s66 offen offset:2048 sc1
    buffer_load_dwordx4 v[44:47], v1, s[36:39], s66 offen offset:3072 sc1
    s_load_dword s44, s[40:41], 8192
    s_load_dword s45, s[40:41], 8256
    s_load_dword s46, s[40:41], 8320
    s_load_dword s47, s[40:41], 8384
    s_load_dword s48, s[40:41], 8448
    s_load_dword s49, s[40:41], 8512
    s_load_dword s50, s[40:41], 8576
    s_load_dword s51, s[40:41], 8640
L_B_10:
    s_waitcnt vmcnt(3)
L_Bgo0_10:
    v_smfmac_f32_16x16x64_bf16 v[96:99], v[32:35], a[0:7], v2
    v_bitop3_b32 v28, v32, v34, 1 bitop3:0xa8
    v_cmp_ne_u32 vcc, 0, v28
    v_smfmac_f32_16x16x64_bf16 v[100:103], v[32:35], a[8:15], v2
    s_cbranch_vccnz L_Bfail0_10
    v_smfmac_f32_16x16x64_bf16 v[104:107], v[32:35], a[16:23], v2
    s_waitcnt vmcnt(2)
    v_bitop3_b32 v28, v36, v38, 1 bitop3:0xa8
    v_cmp_ne_u32 vcc, 0, v28
    v_smfmac_f32_16x16x64_bf16 v[108:111], v[32:35], a[24:31], v2
    s_cbranch_vccnz L_Bfail1_10
L_Bgo1_10:
    v_smfmac_f32_16x16x64_bf16 v[96:99], v[36:39], a[48:55], v2
    v_smfmac_f32_16x16x64_bf16 v[100:103], v[36:39], a[56:63], v2
    v_smfmac_f32_16x16x64_bf16 v[104:107], v[36:39], a[64:71], v2
    s_waitcnt vmcnt(0)
    v_bitop3_b32 v29, v40, v42, v44 bitop3:0xfe
    v_bitop3_b32 v28, v29, v46, 1 bitop3:0xa8
    v_cmp_ne_u32 vcc, 0, v28
    v_smfmac_f32_16x16x64_bf16 v[108:111], v[36:39], a[72:79], v2
    s_cbranch_vccnz L_Bfail2_10
L_Bgo2_10:
    v_smfmac_f32_16x16x64_bf16 v[96:99], v[40:43], a[96:103], v2
    buffer_load_dwordx4 v[160:163], v1, s[36:39], s73 offen offset:0 sc1
    v_min_u32_dpp v222, v222, v222 row_ror:4 row_mask:0xf bank_mask:0xf
    v_smfmac_f32_16x16x64_bf16 v[100:103], v[40:43], a[104:111], v2
    s_nop 0
    v_min_u32_dpp v222, v222, v222 row_ror:2 row_mask:0xf bank_mask:0xf
    v_smfmac_f32_16x16x64_bf16 v[96:99], v[44:47], a[144:151], v2
    buffer_load_dwordx4 v[164:167], v1, s[36:39], s73 offen offset:1024 sc1
    v_min_u32_dpp v222, v222, v222 row_ror:1 row_mask:0xf bank_mask:0xf
    v_smfmac_f32_16x16x64_bf16 v[100:103], v[44:47], a[152:159], v2
    v_readfirstlane_b32 s96, v222
    v_smfmac_f32_16x16x64_bf16 v[104:107], v[40:43], a[112:119], v2
    buffer_load_dwordx4 v[168:171], v1, s[36:39], s73 offen offset:2048 sc1
    s_max_u32 s75, s75, s96
    v_smfmac_f32_16x16x64_bf16 v[108:111], v[40:43], a[120:127], v2
    v_smfmac_f32_16x16x64_bf16 v[104:107], v[44:47], a[160:167], v2
    buffer_load_dwordx4 v[172:175], v1, s[36:39], s73 offen offset:3072 sc1
    v_cvt_pk_bf16_f32 v64, v96, v97
    v_cvt_pk_bf16_f32 v65, v98, v99
    v_smfmac_f32_16x16x64_bf16 v[108:111], v[44:47], a[168:175], v2
    v_cvt_pk_bf16_f32 v66, v100, v101
    v_cvt_pk_bf16_f32 v67, v102, v103
    ds_write_b128 v192, v[64:67] offset:0
    s_nop 0
    v_cvt_pk_bf16_f32 v68, v104, v105
    v_cvt_pk_bf16_f32 v69, v106, v107
    s_nop 1
    v_cvt_pk_bf16_f32 v70, v108, v109
    v_cvt_pk_bf16_f32 v71, v110, v111
    ds_write_b128 v193, v[68:71] offset:0
    buffer_load_dwordx4 v[176:179], v1, s[36:39], s74 offen offset:0 sc1
    buffer_load_dwordx4 v[180:183], v1, s[36:39], s74 offen offset:1024 sc1
    s_waitcnt lgkmcnt(0)
    s_barrier
    v_smfmac_f32_16x16x64_bf16 v[112:115], v[32:35], a[32:39], v2
    buffer_load_dwordx4 v[184:187], v1, s[36:39], s74 offen offset:2048 sc1
    v_smfmac_f32_16x16x64_bf16 v[116:119], v[32:35], a[40:47], v2
    buffer_load_dwordx4 v[188:191], v1, s[36:39], s74 offen offset:3072 sc1
    v_smfmac_f32_16x16x64_bf16 v[112:115], v[36:39], a[80:87], v2
    v_smfmac_f32_16x16x64_bf16 v[116:119], v[36:39], a[88:95], v2
    v_smfmac_f32_16x16x64_bf16 v[112:115], v[40:43], a[128:135], v2
    v_smfmac_f32_16x16x64_bf16 v[116:119], v[40:43], a[136:143], v2
    v_smfmac_f32_16x16x64_bf16 v[112:115], v[44:47], a[176:183], v2
    v_smfmac_f32_16x16x64_bf16 v[116:119], v[44:47], a[184:191], v2
    v_mov_b32 v88, 0
    v_mov_b32 v89, 0
    v_mov_b32_e64 v90, 0
    v_mov_b32 v91, 0
    s_nop 2
    v_cvt_pk_bf16_f32 v72, v112, v113
    v_cvt_pk_bf16_f32 v73, v114, v115
    v_cvt_pk_bf16_f32 v74, v116, v117
    v_cvt_pk_bf16_f32 v75, v118, v119
    ds_write_b128 v7, v[72:75] offset:8192
    s_waitcnt lgkmcnt(0)
    s_barrier
    s_add_u32 s73, s73, 0x80000
    s_add_u32 s74, s74, 0x80000
    s_cmp_lg_u32 s3, 0
    s_cbranch_scc1 L_kv0_10
L_kv0b_10:
    ds_read_b128 v[48:51], v9 offset:0
    ds_read_b128 v[52:55], v9 offset:1024
    ds_read_b128 v[56:59], v9 offset:2048
    ds_read_b128 v[60:63], v9 offset:3072
    s_waitcnt lgkmcnt(3)
    v_mfma_f32_16x16x32_bf16 v[84:87], v[12:15], v[48:51], 0
    s_waitcnt lgkmcnt(2)
    v_mfma_f32_16x16x32_bf16 v[84:87], v[12:15], v[52:55], v[84:87]
    s_waitcnt lgkmcnt(1)
    v_mfma_f32_16x16x32_bf16 v[84:87], v[12:15], v[56:59], v[84:87]
    s_waitcnt lgkmcnt(0)
    v_mfma_f32_16x16x32_bf16 v[84:87], v[12:15], v[60:63], v[84:87]
    buffer_load_dwordx4 v[32:35], v1, s[36:39], s68 offen offset:0 sc1
    buffer_load_dwordx4 v[36:39], v1, s[36:39], s68 offen offset:1024 sc1
    buffer_load_dwordx4 v[40:43], v1, s[36:39], s68 offen offset:2048 sc1
    buffer_load_dwordx4 v[44:47], v1, s[36:39], s68 offen offset:3072 sc1
    s_cmp_lg_u32 s55, 0
    s_nop 2
    v_cvt_pk_bf16_f32 v10, v84, v85
    v_cvt_pk_bf16_f32 v11, v86, v87
    v_and_or_b32 v10, v10, -2, 1
    s_cbranch_scc1 L_Bslow_10
    buffer_store_dwordx2 v[10:11], v4, s[36:39], s69 offen
L_Bback_10:
    s_load_dword s44, s[40:41], 0
    s_load_dword s45, s[40:41], 64
    s_load_dword s46, s[40:41], 128
    s_load_dword s47, s[40:41], 192
    s_load_dword s48, s[40:41], 256
    s_load_dword s49, s[40:41], 320
    s_load_dword s50, s[40:41], 384
    s_load_dword s51, s[40:41], 448
    s_add_u32 s40, s40, 0x80000
    s_addc_u32 s41, s41, 0
    s_and_b32 s96, s58, 3
    s_cmp_eq_u32 s96, 3
    s_cselect_b32 s18, s77, 0x40000000
    s_cmp_ge_u32 s58, 58
    s_cselect_b32 s18, s77, s18
    s_and_b32 s96, s58, 3
    s_lshl_b32 s96, s96, 18
    s_add_u32 s64, s62, s96
    s_add_u32 s63, s61, s96
    s_xor_b32 s96, s96, 0x80000
    s_add_u32 s65, s62, s96
    s_add_u32 s97, s58, 8
    s_min_u32 s97, s97, 64
    s_cmp_ge_u32 s75, s97
    s_cselect_b32 s98, 0x40000000, s76
    s_add_u32 s97, s68, 4096
    s_waitcnt vmcnt(4)
L_Cgo0_10:
    v_mfma_f32_16x16x32_bf16 v[64:67], v[128:131], v[32:35], 0
    v_bitop3_b32 v28, v32, v34, 1 bitop3:0x80
    v_cmp_ne_u32 vcc, 1, v28
    v_mfma_f32_16x16x32_bf16 v[68:71], v[144:147], v[32:35], 0
    s_cbranch_vccnz L_Cfail0_10
    s_waitcnt vmcnt(3)
    v_bitop3_b32 v28, v36, v38, 1 bitop3:0x80
    v_cmp_ne_u32 vcc, 1, v28
    v_mfma_f32_16x16x32_bf16 v[72:75], v[32:35], v[32:35], v[24:27]
    s_cbranch_vccnz L_Cfail1_10
L_Cgo1_10:
    v_mfma_f32_16x16x32_bf16 v[64:67], v[132:135], v[36:39], v[64:67]
    v_mfma_f32_16x16x32_bf16 v[68:71], v[148:151], v[36:39], v[68:71]
    s_waitcnt vmcnt(2)
    v_bitop3_b32 v28, v40, v42, 1 bitop3:0x80
    v_cmp_ne_u32 vcc, 1, v28
    v_mfma_f32_16x16x32_bf16 v[72:75], v[36:39], v[36:39], v[72:75]
    s_cbranch_vccnz L_Cfail2_10
L_Cgo2_10:
    v_mfma_f32_16x16x32_bf16 v[64:67], v[136:139], v[40:43], v[64:67]
    v_mfma_f32_16x16x32_bf16 v[68:71], v[152:155], v[40:43], v[68:71]
    s_waitcnt vmcnt(1)
    v_bitop3_b32 v28, v44, v46, 1 bitop3:0x80
    v_cmp_ne_u32 vcc, 1, v28
    v_mfma_f32_16x16x32_bf16 v[72:75], v[40:43], v[40:43], v[72:75]
    s_cbranch_vccnz L_Cfail3_10
L_Cgo3_10:
    v_mfma_f32_16x16x32_bf16 v[64:67], v[140:143], v[44:47], v[64:67]
    v_mfma_f32_16x16x32_bf16 v[68:71], v[156:159], v[44:47], v[68:71]
    v_mfma_f32_16x16x32_bf16 v[72:75], v[44:47], v[44:47], v[72:75]
    s_add_u32 s96, s58, 2
    s_cmp_lt_u32 s75, s96
    s_cselect_b32 s3, 1, 0
    s_nop 2
    v_max3_f32 v92, v64, v65, v66
    v_max3_f32 v93, v68, v69, v70
    v_max3_f32 v92, v92, v67, v71
    v_max3_f32 v94, v72, v73, v74
    v_max3_f32 v93, v93, v92, v75
    v_max_f32 v92, v94, v93
    v_max_f32 v94, v94, v93
    buffer_load_dwordx4 v[48:51], v5, s[36:39], s97 offen offset:0 sc1
    buffer_load_dwordx4 v[52:55], v5, s[36:39], s97 offen offset:512 sc1
    v_permlane16_swap_b32 v92, v94
    v_max_f32 v93, v92, v94
    v_max_f32 v92, v92, v94
    buffer_load_dwordx4 v[56:59], v5, s[36:39], s97 offen offset:1024 sc1
    buffer_load_dwordx4 v[60:63], v5, s[36:39], s97 offen offset:1536 sc1
    v_permlane32_swap_b32 v92, v93
    v_max3_f32 v92, v92, v93, v203
    v_mul_f32 v92, s79, v92
    v_fma_f32 v64, v64, s79, -v92
    v_fma_f32 v65, v65, s79, -v92
    v_exp_f32 v64, v64
    v_fma_f32 v66, v66, s79, -v92
    v_exp_f32 v65, v65
    buffer_load_dwordx4 v[128:131], v1, s[36:39], s71 offen offset:0 sc1
    v_fma_f32 v67, v67, s79, -v92
    v_exp_f32 v66, v66
    v_cvt_pk_bf16_f32 v76, v64, v65
    v_fma_f32 v68, v68, s79, -v92
    v_exp_f32 v67, v67
    v_fma_f32 v69, v69, s79, -v92
    v_exp_f32 v68, v68
    v_cvt_pk_bf16_f32 v77, v66, v67
    v_fma_f32 v70, v70, s79, -v92
    v_exp_f32_e64 v69, v69
    buffer_load_dwordx4 v[132:135], v1, s[36:39], s71 offen offset:1024 sc1
    v_fma_f32 v71, v71, s79, -v92
    v_exp_f32 v70, v70
    v_cvt_pk_bf16_f32 v78, v68, v69
    v_exp_f32 v71, v71
    v_fma_f32 v72, v72, s79, -v92
    v_cvt_pk_bf16_f32 v79, v70, v71
    v_fma_f32 v73, v73, s79, -v92
    v_exp_f32 v72, v72
    v_mfma_f32_16x16x32_bf16 v[84:87], v[20:23], v[76:79], 0
    v_exp_f32 v73, v73
    v_fma_f32 v74, v74, s79, -v92
    v_mfma_f32_16x16x32_bf16 v[96:99], v[160:163], v[76:79], 0
    v_fma_f32 v75, v75, s79, -v92
    v_exp_f32_e64 v74, v74
    v_mfma_f32_16x16x32_bf16 v[100:103], v[164:167], v[76:79], 0
    v_exp_f32_e64 v75, v75
    v_cvt_pk_bf16_f32 v80, v72, v73
    v_mfma_f32_16x16x32_bf16 v[104:107], v[176:179], v[76:79], 0
    v_cvt_pk_bf16_f32 v81, v74, v75
    v_mov_b32_dpp v224, v76 row_shr:8 row_mask:0xf bank_mask:0xc
    v_mov_b32_dpp v225, v77 row_shr:8 row_mask:0xf bank_mask:0xc
    v_mfma_f32_16x16x16_bf16 v[84:87], v[20:21], v[80:81], v[84:87]
    v_mov_b32_dpp v226, v78 row_shr:8 row_mask:0xf bank_mask:0xc
    v_mov_b32_dpp v227, v79 row_shr:8 row_mask:0xf bank_mask:0xc
    v_mfma_f32_16x16x32_bf16 v[108:111], v[180:183], v[76:79], 0
    v_mov_b32_dpp v228, v80 row_shr:8 row_mask:0xf bank_mask:0xc
    v_mov_b32_dpp v229, v81 row_shr:8 row_mask:0xf bank_mask:0xc
    s_waitcnt vmcnt(2)
    v_bitop3_b32 v28, v48, v50, v52 bitop3:0x80
    v_mfma_f32_16x16x32_bf16 v[96:99], v[168:171], v[224:227], v[96:99]
    v_bitop3_b32 v29, v54, v56, v58 bitop3:0x80
    v_bitop3_b32 v28, v28, v60, v62 bitop3:0x80
    v_mfma_f32_16x16x32_bf16 v[100:103], v[172:175], v[224:227], v[100:103]
    v_bitop3_b32 v28, v28, v29, 1 bitop3:0x80
    v_cmp_ne_u32 vcc, 1, v28
    s_cbranch_vccnz L_CfailV_10
L_CgoV_10:
    v_mfma_f32_16x16x16_bf16 v[96:99], v[48:49], v[80:81], v[96:99]
    v_rcp_f32 v82, v84
    buffer_load_dwordx4 v[136:139], v1, s[36:39], s71 offen offset:2048 sc1
    v_mfma_f32_16x16x16_bf16 v[96:99], v[52:53], v[228:229], v[96:99]
    v_mov_b32_dpp v82, v82 row_shr:8 row_mask:0xf bank_mask:0xc
    buffer_load_dwordx4 v[140:143], v1, s[36:39], s71 offen offset:3072 sc1
    v_mfma_f32_16x16x32_bf16 v[104:107], v[184:187], v[224:227], v[104:107]
    buffer_load_dwordx4 v[144:147], v1, s[36:39], s72 offen offset:0 sc1
    v_mfma_f32_16x16x16_bf16 v[100:103], v[50:51], v[80:81], v[100:103]
    buffer_load_dwordx4 v[148:151], v1, s[36:39], s72 offen offset:1024 sc1
    v_mfma_f32_16x16x16_bf16 v[100:103], v[54:55], v[228:229], v[100:103]
    buffer_load_dwordx4 v[152:155], v1, s[36:39], s72 offen offset:2048 sc1
    v_mul_f32 v96, v96, v82
    v_mul_f32 v97, v97, v82
    v_mul_f32 v98, v98, v82
    v_mfma_f32_16x16x32_bf16 v[108:111], v[188:191], v[224:227], v[108:111]
    v_mul_f32 v99, v99, v82
    v_cvt_pk_bf16_f32 v64, v96, v97
    v_cvt_pk_bf16_f32 v65, v98, v99
    v_mfma_f32_16x16x16_bf16 v[104:107], v[56:57], v[80:81], v[104:107]
    buffer_load_dwordx4 v[156:159], v1, s[36:39], s72 offen offset:3072 sc1
    v_mfma_f32_16x16x16_bf16 v[104:107], v[60:61], v[228:229], v[104:107]
    v_mul_f32 v100, v100, v82
    v_mul_f32 v101, v101, v82
    v_mul_f32 v102, v102, v82
    v_mfma_f32_16x16x16_bf16 v[108:111], v[58:59], v[80:81], v[108:111]
    v_mul_f32 v103, v103, v82
    v_cvt_pk_bf16_f32 v66, v100, v101
    v_cvt_pk_bf16_f32 v67, v102, v103
    v_mfma_f32_16x16x16_bf16 v[108:111], v[62:63], v[228:229], v[108:111]
    ds_write_b128 v8, v[64:67] offset:12288
    v_mul_f32 v104, v104, v82
    v_mul_f32 v105, v105, v82
    v_mul_f32 v106, v106, v82
    v_mul_f32 v107, v107, v82
    v_cvt_pk_bf16_f32 v68, v104, v105
    v_cvt_pk_bf16_f32 v69, v106, v107
    s_nop 0
    v_mul_f32 v108, v108, v82
    v_mul_f32_e64 v109, v109, v82
    v_mul_f32_e64 v110, v110, v82
    v_mul_f32_e64 v111, v111, v82
    v_cvt_pk_bf16_f32 v70, v108, v109
    v_cvt_pk_bf16_f32 v71, v110, v111
    ds_write_b128 v8, v[68:71] offset:13312
    s_add_u32 s71, s71, 0x80000
    s_add_u32 s72, s72, 0x80000
    v_add_u32_e64 v31, -1, v194
    buffer_store_dword v31, v209, s[36:39], s18 offen sc1
    buffer_store_dword v198, v6, s[36:39], s65 offen sc1
    buffer_load_dword v222, v223, s[36:39], s98 offen sc1
    s_waitcnt lgkmcnt(0)
    s_barrier
    ds_read_b128 v[104:107], v200 offset:12288
    ds_read_b128 v[108:111], v200 offset:13312
    ds_read_b128 v[112:115], v201 offset:12288
    ds_read_b128 v[116:119], v201 offset:13312
    ds_read_b128 v[120:123], v202 offset:12288
    ds_read_b128 v[124:127], v202 offset:13312
    v_smfmac_f32_16x16x64_bf16 v[88:91], v[64:67], a[192:199], v2
    v_smfmac_f32_16x16x64_bf16 v[88:91], v[68:71], a[200:207], v2
    v_add_u32 v194, 1, v194
    s_add_u32 s58, s58, 1
    s_waitcnt lgkmcnt(5)
    v_smfmac_f32_16x16x64_bf16 v[88:91], v[104:107], a[208:215], v2
    s_waitcnt lgkmcnt(4)
    v_smfmac_f32_16x16x64_bf16 v[88:91], v[108:111], a[216:223], v2
    s_waitcnt lgkmcnt(3)
    v_smfmac_f32_16x16x64_bf16 v[88:91], v[112:115], a[224:231], v2
    s_waitcnt lgkmcnt(2)
    v_smfmac_f32_16x16x64_bf16 v[88:91], v[116:119], a[232:239], v2
    s_waitcnt lgkmcnt(1)
    v_smfmac_f32_16x16x64_bf16 v[88:91], v[120:123], a[240:247], v2
    s_waitcnt lgkmcnt(0)
    v_smfmac_f32_16x16x64_bf16 v[88:91], v[124:127], a[248:255], v2
    s_set_gpr_idx_on s1, gpr_idx(SRC0)
    v_mov_b32 v204, v32
    v_mov_b32 v205, v33
    v_mov_b32 v206, v34
    v_mov_b32 v207, v35
    s_set_gpr_idx_off
    s_nop 1
    v_permlane32_swap_b32 v88, v90
    v_permlane32_swap_b32 v89, v91
    v_add_f32 v28, v88, v90
    v_add_f32 v29, v89, v91
    v_cvt_pk_bf16_f32 v28, v28, v29
    v_or_b32 v28, 1, v28
    buffer_store_dword v28, v6, s[36:39], s64 offen sc1
    buffer_store_dwordx4 v[204:207], v208, s[36:39], s70 offen sc1
    s_add_u32 s70, s70, 196608
L_step_11:
    s_cmp_lg_u32 s3, 0
    s_cbranch_scc1 L_re_11
L_reb_11:
    s_barrier
    v_mov_b32 v96, 0
    v_mov_b32 v97, 0
    v_mov_b32 v98, 0
    v_mov_b32 v99, 0
    v_mov_b32 v100, 0
    v_mov_b32 v101, 0
    v_mov_b32 v102, 0
    v_mov_b32 v103, 0
    v_mov_b32 v104, 0
    v_mov_b32 v105, 0
    v_mov_b32 v106, 0
    v_mov_b32 v107, 0
    v_mov_b32 v108, 0
    v_mov_b32 v109, 0
    v_mov_b32 v110, 0
    v_mov_b32 v111, 0
    v_mov_b32 v112, 0
    v_mov_b32 v113, 0
    v_mov_b32 v114, 0
    v_mov_b32_e64 v115, 0
    v_mov_b32_e64 v116, 0
    v_mov_b32_e64 v117, 0
    v_mov_b32_e64 v118, 0
    v_mov_b32_e64 v119, 0
    buffer_load_dwordx4 v[32:35], v1, s[36:39], s66 offen offset:0 sc1
    buffer_load_dwordx4 v[36:39], v1, s[36:39], s66 offen offset:1024 sc1
    buffer_load_dwordx4 v[40:43], v1, s[36:39], s66 offen offset:2048 sc1
    buffer_load_dwordx4 v[44:47], v1, s[36:39], s66 offen offset:3072 sc1
    s_load_dword s44, s[40:41], 8192
    s_load_dword s45, s[40:41], 8256
    s_load_dword s46, s[40:41], 8320
    s_load_dword s47, s[40:41], 8384
    s_load_dword s48, s[40:41], 8448
    s_load_dword s49, s[40:41], 8512
    s_load_dword s50, s[40:41], 8576
    s_load_dword s51, s[40:41], 8640
L_B_11:
    s_waitcnt vmcnt(3)
L_Bgo0_11:
    v_smfmac_f32_16x16x64_bf16 v[96:99], v[32:35], a[0:7], v2
    v_bitop3_b32 v28, v32, v34, 1 bitop3:0x80
    v_cmp_ne_u32 vcc, 1, v28
    v_smfmac_f32_16x16x64_bf16 v[100:103], v[32:35], a[8:15], v2
    s_cbranch_vccnz L_Bfail0_11
    v_smfmac_f32_16x16x64_bf16 v[104:107], v[32:35], a[16:23], v2
    s_waitcnt vmcnt(2)
    v_bitop3_b32 v28, v36, v38, 1 bitop3:0x80
    v_cmp_ne_u32 vcc, 1, v28
    v_smfmac_f32_16x16x64_bf16 v[108:111], v[32:35], a[24:31], v2
    s_cbranch_vccnz L_Bfail1_11
L_Bgo1_11:
    v_smfmac_f32_16x16x64_bf16 v[96:99], v[36:39], a[48:55], v2
    v_smfmac_f32_16x16x64_bf16 v[100:103], v[36:39], a[56:63], v2
    v_smfmac_f32_16x16x64_bf16 v[104:107], v[36:39], a[64:71], v2
    s_waitcnt vmcnt(0)
    v_bitop3_b32 v29, v40, v42, v44 bitop3:0x80
    v_bitop3_b32 v28, v29, v46, 1 bitop3:0x80
    v_cmp_ne_u32 vcc, 1, v28
    v_smfmac_f32_16x16x64_bf16 v[108:111], v[36:39], a[72:79], v2
    s_cbranch_vccnz L_Bfail2_11
L_Bgo2_11:
    s_cmp_eq_u32 s58, 63
    s_cbranch_scc1 L_f62
L_f62b:
    v_smfmac_f32_16x16x64_bf16 v[96:99], v[40:43], a[96:103], v2
    buffer_load_dwordx4 v[160:163], v1, s[36:39], s73 offen offset:0 sc1
    v_min_u32_dpp v222, v222, v222 row_ror:4 row_mask:0xf bank_mask:0xf
    v_smfmac_f32_16x16x64_bf16 v[100:103], v[40:43], a[104:111], v2
    s_nop 0
    v_min_u32_dpp v222, v222, v222 row_ror:2 row_mask:0xf bank_mask:0xf
    v_smfmac_f32_16x16x64_bf16 v[96:99], v[44:47], a[144:151], v2
    buffer_load_dwordx4 v[164:167], v1, s[36:39], s73 offen offset:1024 sc1
    v_min_u32_dpp v222, v222, v222 row_ror:1 row_mask:0xf bank_mask:0xf
    v_smfmac_f32_16x16x64_bf16 v[100:103], v[44:47], a[152:159], v2
    v_readfirstlane_b32 s96, v222
    v_smfmac_f32_16x16x64_bf16 v[104:107], v[40:43], a[112:119], v2
    buffer_load_dwordx4 v[168:171], v1, s[36:39], s73 offen offset:2048 sc1
    s_max_u32 s75, s75, s96
    v_smfmac_f32_16x16x64_bf16 v[108:111], v[40:43], a[120:127], v2
    v_smfmac_f32_16x16x64_bf16 v[104:107], v[44:47], a[160:167], v2
    buffer_load_dwordx4 v[172:175], v1, s[36:39], s73 offen offset:3072 sc1
    v_cvt_pk_bf16_f32 v64, v96, v97
    v_cvt_pk_bf16_f32 v65, v98, v99
    v_smfmac_f32_16x16x64_bf16 v[108:111], v[44:47], a[168:175], v2
    v_cvt_pk_bf16_f32 v66, v100, v101
    v_cvt_pk_bf16_f32 v67, v102, v103
    ds_write_b128 v192, v[64:67] offset:0
    s_nop 0
    v_cvt_pk_bf16_f32 v68, v104, v105
    v_cvt_pk_bf16_f32 v69, v106, v107
    s_nop 1
    v_cvt_pk_bf16_f32 v70, v108, v109
    v_cvt_pk_bf16_f32 v71, v110, v111
    ds_write_b128 v193, v[68:71] offset:0
    buffer_load_dwordx4 v[176:179], v1, s[36:39], s74 offen offset:0 sc1
    buffer_load_dwordx4 v[180:183], v1, s[36:39], s74 offen offset:1024 sc1
    s_waitcnt lgkmcnt(0)
    s_barrier
    v_smfmac_f32_16x16x64_bf16 v[112:115], v[32:35], a[32:39], v2
    buffer_load_dwordx4 v[184:187], v1, s[36:39], s74 offen offset:2048 sc1
    v_smfmac_f32_16x16x64_bf16 v[116:119], v[32:35], a[40:47], v2
    buffer_load_dwordx4 v[188:191], v1, s[36:39], s74 offen offset:3072 sc1
    v_smfmac_f32_16x16x64_bf16 v[112:115], v[36:39], a[80:87], v2
    v_smfmac_f32_16x16x64_bf16 v[116:119], v[36:39], a[88:95], v2
    v_smfmac_f32_16x16x64_bf16 v[112:115], v[40:43], a[128:135], v2
    v_smfmac_f32_16x16x64_bf16 v[116:119], v[40:43], a[136:143], v2
    v_smfmac_f32_16x16x64_bf16 v[112:115], v[44:47], a[176:183], v2
    v_smfmac_f32_16x16x64_bf16 v[116:119], v[44:47], a[184:191], v2
    v_mov_b32 v88, 0
    v_mov_b32 v89, 0
    v_mov_b32_e64 v90, 0
    v_mov_b32_e64 v91, 0
    s_nop 2
    v_cvt_pk_bf16_f32 v72, v112, v113
    v_cvt_pk_bf16_f32 v73, v114, v115
    v_cvt_pk_bf16_f32 v74, v116, v117
    v_cvt_pk_bf16_f32 v75, v118, v119
    ds_write_b128 v7, v[72:75] offset:8192
    s_waitcnt lgkmcnt(0)
    s_barrier
    s_add_u32 s73, s73, 0x80000
    s_add_u32 s74, s74, 0x80000
    s_cmp_lg_u32 s3, 0
    s_cbranch_scc1 L_kv0_11
L_kv0b_11:
    ds_read_b128 v[48:51], v9 offset:0
    ds_read_b128 v[52:55], v9 offset:1024
    ds_read_b128 v[56:59], v9 offset:2048
    ds_read_b128 v[60:63], v9 offset:3072
    s_waitcnt lgkmcnt(3)
    v_mfma_f32_16x16x32_bf16 v[84:87], v[12:15], v[48:51], 0
    s_waitcnt lgkmcnt(2)
    v_mfma_f32_16x16x32_bf16 v[84:87], v[12:15], v[52:55], v[84:87]
    s_waitcnt lgkmcnt(1)
    v_mfma_f32_16x16x32_bf16 v[84:87], v[12:15], v[56:59], v[84:87]
    s_waitcnt lgkmcnt(0)
    v_mfma_f32_16x16x32_bf16 v[84:87], v[12:15], v[60:63], v[84:87]
    buffer_load_dwordx4 v[32:35], v1, s[36:39], s68 offen offset:0 sc1
    buffer_load_dwordx4 v[36:39], v1, s[36:39], s68 offen offset:1024 sc1
    buffer_load_dwordx4 v[40:43], v1, s[36:39], s68 offen offset:2048 sc1
    buffer_load_dwordx4 v[44:47], v1, s[36:39], s68 offen offset:3072 sc1
    s_cmp_lg_u32 s55, 0
    s_nop 2
    v_cvt_pk_bf16_f32 v10, v84, v85
    v_cvt_pk_bf16_f32 v11, v86, v87
    v_and_or_b32 v10, v10, -2, 0
    s_cbranch_scc1 L_Bslow_11
    buffer_store_dwordx2 v[10:11], v4, s[36:39], s69 offen
L_Bback_11:
    s_cmp_eq_u32 s58, 63
    s_cbranch_scc1 L_chain_fin
    s_load_dword s44, s[40:41], 0
    s_load_dword s45, s[40:41], 64
    s_load_dword s46, s[40:41], 128
    s_load_dword s47, s[40:41], 192
    s_load_dword s48, s[40:41], 256
    s_load_dword s49, s[40:41], 320
    s_load_dword s50, s[40:41], 384
    s_load_dword s51, s[40:41], 448
    s_add_u32 s40, s40, 0x80000
    s_addc_u32 s41, s41, 0
    s_and_b32 s96, s58, 3
    s_cmp_eq_u32 s96, 3
    s_cselect_b32 s18, s77, 0x40000000
    s_cmp_ge_u32 s58, 58
    s_cselect_b32 s18, s77, s18
    s_and_b32 s96, s58, 3
    s_lshl_b32 s96, s96, 18
    s_add_u32 s64, s62, s96
    s_add_u32 s63, s61, s96
    s_xor_b32 s96, s96, 0x80000
    s_add_u32 s65, s62, s96
    s_add_u32 s97, s58, 8
    s_min_u32 s97, s97, 64
    s_cmp_ge_u32 s75, s97
    s_cselect_b32 s98, 0x40000000, s76
    s_add_u32 s97, s68, 4096
    s_waitcnt vmcnt(4)
L_Cgo0_11:
    v_mfma_f32_16x16x32_bf16 v[64:67], v[128:131], v[32:35], 0
    v_bitop3_b32 v28, v32, v34, 1 bitop3:0xa8
    v_cmp_ne_u32_e64 vcc, 0, v28
    v_mfma_f32_16x16x32_bf16 v[68:71], v[144:147], v[32:35], 0
    s_cbranch_vccnz L_Cfail0_11
    s_waitcnt vmcnt(3)
    v_bitop3_b32 v28, v36, v38, 1 bitop3:0xa8
    v_cmp_ne_u32 vcc, 0, v28
    v_mfma_f32_16x16x32_bf16 v[72:75], v[32:35], v[32:35], v[24:27]
    s_cbranch_vccnz L_Cfail1_11
L_Cgo1_11:
    v_mfma_f32_16x16x32_bf16 v[64:67], v[132:135], v[36:39], v[64:67]
    v_mfma_f32_16x16x32_bf16 v[68:71], v[148:151], v[36:39], v[68:71]
    s_waitcnt vmcnt(2)
    v_bitop3_b32 v28, v40, v42, 1 bitop3:0xa8
    v_cmp_ne_u32 vcc, 0, v28
    v_mfma_f32_16x16x32_bf16 v[72:75], v[36:39], v[36:39], v[72:75]
    s_cbranch_vccnz L_Cfail2_11
L_Cgo2_11:
    v_mfma_f32_16x16x32_bf16 v[64:67], v[136:139], v[40:43], v[64:67]
    v_mfma_f32_16x16x32_bf16 v[68:71], v[152:155], v[40:43], v[68:71]
    s_waitcnt vmcnt(1)
    v_bitop3_b32 v28, v44, v46, 1 bitop3:0xa8
    v_cmp_ne_u32 vcc, 0, v28
    v_mfma_f32_16x16x32_bf16 v[72:75], v[40:43], v[40:43], v[72:75]
    s_cbranch_vccnz L_Cfail3_11
L_Cgo3_11:
    v_mfma_f32_16x16x32_bf16 v[64:67], v[140:143], v[44:47], v[64:67]
    v_mfma_f32_16x16x32_bf16 v[68:71], v[156:159], v[44:47], v[68:71]
    v_mfma_f32_16x16x32_bf16 v[72:75], v[44:47], v[44:47], v[72:75]
    s_add_u32 s96, s58, 2
    s_cmp_lt_u32 s75, s96
    s_cselect_b32 s3, 1, 0
    s_nop 2
    v_max3_f32 v92, v64, v65, v66
    v_max3_f32 v93, v68, v69, v70
    v_max3_f32 v92, v92, v67, v71
    v_max3_f32 v94, v72, v73, v74
    v_max3_f32 v93, v93, v92, v75
    v_max_f32 v92, v94, v93
    v_max_f32 v94, v94, v93
    buffer_load_dwordx4 v[48:51], v5, s[36:39], s97 offen offset:0 sc1
    buffer_load_dwordx4 v[52:55], v5, s[36:39], s97 offen offset:512 sc1
    v_permlane16_swap_b32 v92, v94
    v_max_f32 v93, v92, v94
    v_max_f32 v92, v92, v94
    buffer_load_dwordx4 v[56:59], v5, s[36:39], s97 offen offset:1024 sc1
    buffer_load_dwordx4 v[60:63], v5, s[36:39], s97 offen offset:1536 sc1
    v_permlane32_swap_b32 v92, v93
    v_max3_f32 v92, v92, v93, v203
    v_mul_f32 v92, s79, v92
    v_fma_f32 v64, v64, s79, -v92
    v_fma_f32 v65, v65, s79, -v92
    v_exp_f32 v64, v64
    v_fma_f32 v66, v66, s79, -v92
    v_exp_f32 v65, v65
    buffer_load_dwordx4 v[128:131], v1, s[36:39], s71 offen offset:0 sc1
    v_fma_f32 v67, v67, s79, -v92
    v_exp_f32 v66, v66
    v_cvt_pk_bf16_f32 v76, v64, v65
    v_fma_f32 v68, v68, s79, -v92
    v_exp_f32 v67, v67
    v_fma_f32 v69, v69, s79, -v92
    v_exp_f32 v68, v68
    v_cvt_pk_bf16_f32 v77, v66, v67
    v_fma_f32 v70, v70, s79, -v92
    v_exp_f32 v69, v69
    buffer_load_dwordx4 v[132:135], v1, s[36:39], s71 offen offset:1024 sc1
    v_fma_f32 v71, v71, s79, -v92
    v_exp_f32 v70, v70
    v_cvt_pk_bf16_f32 v78, v68, v69
    v_exp_f32_e64 v71, v71
    v_fma_f32 v72, v72, s79, -v92
    v_cvt_pk_bf16_f32 v79, v70, v71
    v_fma_f32 v73, v73, s79, -v92
    v_exp_f32 v72, v72
    v_mfma_f32_16x16x32_bf16 v[84:87], v[20:23], v[76:79], 0
    v_exp_f32 v73, v73
    v_fma_f32 v74, v74, s79, -v92
    v_mfma_f32_16x16x32_bf16 v[96:99], v[160:163], v[76:79], 0
    v_fma_f32 v75, v75, s79, -v92
    v_exp_f32_e64 v74, v74
    v_mfma_f32_16x16x32_bf16 v[100:103], v[164:167], v[76:79], 0
    v_exp_f32_e64 v75, v75
    v_cvt_pk_bf16_f32 v80, v72, v73
    v_mfma_f32_16x16x32_bf16 v[104:107], v[176:179], v[76:79], 0
    v_cvt_pk_bf16_f32 v81, v74, v75
    v_mov_b32_dpp v224, v76 row_shr:8 row_mask:0xf bank_mask:0xc
    v_mov_b32_dpp v225, v77 row_shr:8 row_mask:0xf bank_mask:0xc
    v_mfma_f32_16x16x16_bf16 v[84:87], v[20:21], v[80:81], v[84:87]
    v_mov_b32_dpp v226, v78 row_shr:8 row_mask:0xf bank_mask:0xc
    v_mov_b32_dpp v227, v79 row_shr:8 row_mask:0xf bank_mask:0xc
    v_mfma_f32_16x16x32_bf16 v[108:111], v[180:183], v[76:79], 0
    v_mov_b32_dpp v228, v80 row_shr:8 row_mask:0xf bank_mask:0xc
    v_mov_b32_dpp v229, v81 row_shr:8 row_mask:0xf bank_mask:0xc
    s_waitcnt vmcnt(2)
    v_bitop3_b32 v28, v48, v50, v52 bitop3:0xfe
    v_mfma_f32_16x16x32_bf16 v[96:99], v[168:171], v[224:227], v[96:99]
    v_bitop3_b32 v29, v54, v56, v58 bitop3:0xfe
    v_bitop3_b32 v28, v28, v60, v62 bitop3:0xfe
    v_mfma_f32_16x16x32_bf16 v[100:103], v[172:175], v[224:227], v[100:103]
    v_bitop3_b32 v28, v28, v29, 1 bitop3:0xa8
    v_cmp_ne_u32_e64 vcc, 0, v28
    s_cbranch_vccnz L_CfailV_11
L_CgoV_11:
    v_mfma_f32_16x16x16_bf16 v[96:99], v[48:49], v[80:81], v[96:99]
    v_rcp_f32_e64 v82, v84
    buffer_load_dwordx4 v[136:139], v1, s[36:39], s71 offen offset:2048 sc1
    v_mfma_f32_16x16x16_bf16 v[96:99], v[52:53], v[228:229], v[96:99]
    v_mov_b32_dpp v82, v82 row_shr:8 row_mask:0xf bank_mask:0xc
    buffer_load_dwordx4 v[140:143], v1, s[36:39], s71 offen offset:3072 sc1
    v_mfma_f32_16x16x32_bf16 v[104:107], v[184:187], v[224:227], v[104:107]
    buffer_load_dwordx4 v[144:147], v1, s[36:39], s72 offen offset:0 sc1
    v_mfma_f32_16x16x16_bf16 v[100:103], v[50:51], v[80:81], v[100:103]
    buffer_load_dwordx4 v[148:151], v1, s[36:39], s72 offen offset:1024 sc1
    v_mfma_f32_16x16x16_bf16 v[100:103], v[54:55], v[228:229], v[100:103]
    buffer_load_dwordx4 v[152:155], v1, s[36:39], s72 offen offset:2048 sc1
    v_mul_f32 v96, v96, v82
    v_mul_f32 v97, v97, v82
    v_mul_f32 v98, v98, v82
    v_mfma_f32_16x16x32_bf16 v[108:111], v[188:191], v[224:227], v[108:111]
    v_mul_f32 v99, v99, v82
    v_cvt_pk_bf16_f32 v64, v96, v97
    v_cvt_pk_bf16_f32 v65, v98, v99
    v_mfma_f32_16x16x16_bf16 v[104:107], v[56:57], v[80:81], v[104:107]
    buffer_load_dwordx4 v[156:159], v1, s[36:39], s72 offen offset:3072 sc1
    v_mfma_f32_16x16x16_bf16 v[104:107], v[60:61], v[228:229], v[104:107]
    v_mul_f32 v100, v100, v82
    v_mul_f32 v101, v101, v82
    v_mul_f32 v102, v102, v82
    v_mfma_f32_16x16x16_bf16 v[108:111], v[58:59], v[80:81], v[108:111]
    v_mul_f32 v103, v103, v82
    v_cvt_pk_bf16_f32 v66, v100, v101
    v_cvt_pk_bf16_f32 v67, v102, v103
    v_mfma_f32_16x16x16_bf16 v[108:111], v[62:63], v[228:229], v[108:111]
    ds_write_b128 v8, v[64:67] offset:12288
    v_mul_f32 v104, v104, v82
    v_mul_f32 v105, v105, v82
    v_mul_f32 v106, v106, v82
    v_mul_f32 v107, v107, v82
    v_cvt_pk_bf16_f32 v68, v104, v105
    v_cvt_pk_bf16_f32 v69, v106, v107
    s_nop 0
    v_mul_f32 v108, v108, v82
    v_mul_f32_e64 v109, v109, v82
    v_mul_f32_e64 v110, v110, v82
    v_mul_f32_e64 v111, v111, v82
    v_cvt_pk_bf16_f32 v70, v108, v109
    v_cvt_pk_bf16_f32 v71, v110, v111
    ds_write_b128 v8, v[68:71] offset:13312
    s_add_u32 s71, s71, 0x80000
    s_add_u32 s72, s72, 0x80000
    v_add_u32_e64 v31, -1, v194
    buffer_store_dword v31, v209, s[36:39], s18 offen sc1
    buffer_store_dword v198, v6, s[36:39], s65 offen sc1
    buffer_load_dword v222, v223, s[36:39], s98 offen sc1
    s_waitcnt lgkmcnt(0)
    s_barrier
    ds_read_b128 v[104:107], v200 offset:12288
    ds_read_b128 v[108:111], v200 offset:13312
    ds_read_b128 v[112:115], v201 offset:12288
    ds_read_b128 v[116:119], v201 offset:13312
    ds_read_b128 v[120:123], v202 offset:12288
    ds_read_b128 v[124:127], v202 offset:13312
    v_smfmac_f32_16x16x64_bf16 v[88:91], v[64:67], a[192:199], v2
    v_smfmac_f32_16x16x64_bf16 v[88:91], v[68:71], a[200:207], v2
    v_add_u32 v194, 1, v194
    s_add_u32 s58, s58, 1
    s_waitcnt lgkmcnt(5)
    v_smfmac_f32_16x16x64_bf16 v[88:91], v[104:107], a[208:215], v2
    s_waitcnt lgkmcnt(4)
    v_smfmac_f32_16x16x64_bf16 v[88:91], v[108:111], a[216:223], v2
    s_waitcnt lgkmcnt(3)
    v_smfmac_f32_16x16x64_bf16 v[88:91], v[112:115], a[224:231], v2
    s_waitcnt lgkmcnt(2)
    v_smfmac_f32_16x16x64_bf16 v[88:91], v[116:119], a[232:239], v2
    s_waitcnt lgkmcnt(1)
    v_smfmac_f32_16x16x64_bf16 v[88:91], v[120:123], a[240:247], v2
    s_waitcnt lgkmcnt(0)
    v_smfmac_f32_16x16x64_bf16 v[88:91], v[124:127], a[248:255], v2
    s_set_gpr_idx_on s1, gpr_idx(SRC0)
    v_mov_b32 v204, v32
    v_mov_b32 v205, v33
    v_mov_b32 v206, v34
    v_mov_b32 v207, v35
    s_set_gpr_idx_off
    s_nop 1
    v_permlane32_swap_b32 v88, v90
    v_permlane32_swap_b32 v89, v91
    v_add_f32 v28, v88, v90
    v_add_f32 v29, v89, v91
    v_cvt_pk_bf16_f32 v28, v28, v29
    v_or_b32 v28, 1, v28
    buffer_store_dword v28, v6, s[36:39], s64 offen sc1
    buffer_store_dwordx4 v[204:207], v208, s[36:39], s70 offen sc1
    s_add_u32 s70, s70, 196608
    s_branch L_step_10
L_re_00:
    buffer_load_dword v28, v223, s[36:39], s76 offen sc1
    s_waitcnt vmcnt(0)
    v_min_u32_dpp v28, v28, v28 row_ror:4 row_mask:0xf bank_mask:0xf
    s_nop 1
    v_min_u32_dpp v28, v28, v28 row_ror:2 row_mask:0xf bank_mask:0xf
    s_nop 1
    v_min_u32_dpp v28, v28, v28 row_ror:1 row_mask:0xf bank_mask:0xf
    s_nop 0
    v_readfirstlane_b32 s75, v28
    s_cmp_gt_u32 s75, s58
    s_cbranch_scc0 L_reb_00
    s_mov_b32 s3, 0
    s_mov_b32 s3, 4
    s_branch L_reb_00
L_Afail_00:
    s_sub_u32 s57, s57, 1
    s_cbranch_scc1 L_exit
    s_branch L_A_00
L_Aslow_00:
    buffer_store_dwordx2 v[28:29], v3, s[36:39], s67 offen sc1
    s_branch L_Aback_00
    s_nop 0
L_Bfail0_00:
    s_sub_u32 s57, s57, 1
    s_cbranch_scc1 L_exit
    buffer_load_dwordx4 v[32:35], v1, s[36:39], s66 offen offset:0 sc1
    buffer_load_dwordx4 v[36:39], v1, s[36:39], s66 offen offset:1024 sc1
    buffer_load_dwordx4 v[40:43], v1, s[36:39], s66 offen offset:2048 sc1
    buffer_load_dwordx4 v[44:47], v1, s[36:39], s66 offen offset:3072 sc1
    v_mov_b32 v96, 0
    v_mov_b32 v97, 0
    v_mov_b32 v98, 0
    v_mov_b32 v99, 0
    v_mov_b32 v100, 0
    v_mov_b32 v101, 0
    v_mov_b32 v102, 0
    v_mov_b32 v103, 0
    s_branch L_B_00
L_Bfail1_00:
    s_sub_u32 s57, s57, 1
    s_cbranch_scc1 L_exit
    buffer_load_dwordx4 v[36:39], v1, s[36:39], s66 offen offset:1024 sc1
    buffer_load_dwordx4 v[40:43], v1, s[36:39], s66 offen offset:2048 sc1
    buffer_load_dwordx4 v[44:47], v1, s[36:39], s66 offen offset:3072 sc1
    s_waitcnt vmcnt(2)
    v_bitop3_b32 v28, v36, v38, 1 bitop3:0xa8
    v_cmp_ne_u32 vcc, 0, v28
    s_cbranch_vccnz L_Bfail1_00
    s_branch L_Bgo1_00
    s_nop 0
    s_nop 0
L_Bfail2_00:
    s_sub_u32 s57, s57, 1
    s_cbranch_scc1 L_exit
    buffer_load_dwordx4 v[40:43], v1, s[36:39], s66 offen offset:2048 sc1
    buffer_load_dwordx4 v[44:47], v1, s[36:39], s66 offen offset:3072 sc1
    s_waitcnt vmcnt(0)
    v_bitop3_b32 v29, v40, v42, v44 bitop3:0xfe
    v_bitop3_b32 v28, v29, v46, 1 bitop3:0xa8
    v_cmp_ne_u32 vcc, 0, v28
    s_cbranch_vccnz L_Bfail2_00
    s_branch L_Bgo2_00
L_Bslow_00:
    buffer_store_dwordx2 v[10:11], v4, s[36:39], s69 offen sc1
    s_branch L_Bback_00
L_kv0_00:
    s_cmp_lg_u32 s3, 4
    s_cbranch_scc1 L_kv0f_00
    s_sub_u32 s71, s71, 0x80000
    s_sub_u32 s72, s72, 0x80000
    buffer_load_dwordx4 v[128:131], v1, s[36:39], s71 offen offset:0 sc1
    buffer_load_dwordx4 v[132:135], v1, s[36:39], s71 offen offset:1024 sc1
    buffer_load_dwordx4 v[136:139], v1, s[36:39], s71 offen offset:2048 sc1
    buffer_load_dwordx4 v[140:143], v1, s[36:39], s71 offen offset:3072 sc1
    buffer_load_dwordx4 v[144:147], v1, s[36:39], s72 offen offset:0 sc1
    buffer_load_dwordx4 v[148:151], v1, s[36:39], s72 offen offset:1024 sc1
    buffer_load_dwordx4 v[152:155], v1, s[36:39], s72 offen offset:2048 sc1
    buffer_load_dwordx4 v[156:159], v1, s[36:39], s72 offen offset:3072 sc1
    s_add_u32 s71, s71, 0x80000
    s_add_u32 s72, s72, 0x80000
    s_branch L_kv0b_00
L_kv0f_00:
    s_cmp_eq_u32 s3, 2
    s_cbranch_scc1 L_kv0p_00
    s_add_u32 s96, s58, 1
    s_cmp_lt_u32 s75, s96
    s_cbranch_scc1 L_prog_33
L_progok_34:
    s_sub_u32 s71, s71, 0x80000
    s_sub_u32 s72, s72, 0x80000
    s_sub_u32 s73, s73, 0x80000
    s_sub_u32 s74, s74, 0x80000
    buffer_load_dwordx4 v[128:131], v1, s[36:39], s71 offen offset:0 sc1
    buffer_load_dwordx4 v[132:135], v1, s[36:39], s71 offen offset:1024 sc1
    buffer_load_dwordx4 v[136:139], v1, s[36:39], s71 offen offset:2048 sc1
    buffer_load_dwordx4 v[140:143], v1, s[36:39], s71 offen offset:3072 sc1
    buffer_load_dwordx4 v[144:147], v1, s[36:39], s72 offen offset:0 sc1
    buffer_load_dwordx4 v[148:151], v1, s[36:39], s72 offen offset:1024 sc1
    buffer_load_dwordx4 v[152:155], v1, s[36:39], s72 offen offset:2048 sc1
    buffer_load_dwordx4 v[156:159], v1, s[36:39], s72 offen offset:3072 sc1
    s_add_u32 s71, s71, 0x80000
    s_add_u32 s72, s72, 0x80000
    buffer_load_dwordx4 v[160:163], v1, s[36:39], s73 offen offset:0 sc1
    buffer_load_dwordx4 v[164:167], v1, s[36:39], s73 offen offset:1024 sc1
    buffer_load_dwordx4 v[168:171], v1, s[36:39], s73 offen offset:2048 sc1
    buffer_load_dwordx4 v[172:175], v1, s[36:39], s73 offen offset:3072 sc1
    buffer_load_dwordx4 v[176:179], v1, s[36:39], s74 offen offset:0 sc1
    buffer_load_dwordx4 v[180:183], v1, s[36:39], s74 offen offset:1024 sc1
    buffer_load_dwordx4 v[184:187], v1, s[36:39], s74 offen offset:2048 sc1
    buffer_load_dwordx4 v[188:191], v1, s[36:39], s74 offen offset:3072 sc1
    s_add_u32 s73, s73, 0x80000
    s_add_u32 s74, s74, 0x80000
    s_cmp_lg_u32 s58, 0
    s_cbranch_scc1 L_kv0b_00
L_kv0p_00:
    s_mov_b32 s96, 16896
L_par_35:
    buffer_load_dword v29, off, s[36:39], s96 sc1
    s_waitcnt vmcnt(0)
    v_readfirstlane_b32 s78, v29
    s_cmp_lg_u32 s78, 0
    s_cbranch_scc1 L_par_35_ok
    s_sub_u32 s57, s57, 1
    s_cbranch_scc1 L_exit
    s_branch L_par_35
L_par_35_ok:
    s_and_b32 s78, s78, 8192
    s_add_u32 s61, s61, s78
    s_add_u32 s62, s62, s78
    s_branch L_kv0b_00
L_prog_33:
    buffer_load_dword v28, v223, s[36:39], s76 offen sc1
    s_waitcnt vmcnt(0)
    v_min_u32_dpp v28, v28, v28 row_ror:4 row_mask:0xf bank_mask:0xf
    s_nop 1
    v_min_u32_dpp v28, v28, v28 row_ror:2 row_mask:0xf bank_mask:0xf
    s_nop 1
    v_min_u32_dpp v28, v28, v28 row_ror:1 row_mask:0xf bank_mask:0xf
    s_nop 0
    v_readfirstlane_b32 s75, v28
    s_cmp_ge_u32 s75, s96
    s_cbranch_scc1 L_progok_34
    s_sub_u32 s57, s57, 1
    s_cbranch_scc1 L_exit
    s_branch L_prog_33
    s_nop 0
    s_nop 0
L_Cfail0_00:
    s_sub_u32 s57, s57, 1
    s_cbranch_scc1 L_exit
    buffer_load_dwordx4 v[32:35], v1, s[36:39], s68 offen offset:0 sc1
    buffer_load_dwordx4 v[36:39], v1, s[36:39], s68 offen offset:1024 sc1
    buffer_load_dwordx4 v[40:43], v1, s[36:39], s68 offen offset:2048 sc1
    buffer_load_dwordx4 v[44:47], v1, s[36:39], s68 offen offset:3072 sc1
    s_waitcnt vmcnt(3)
    v_bitop3_b32 v28, v32, v34, 1 bitop3:0x80
    v_cmp_ne_u32 vcc, 1, v28
    s_cbranch_vccnz L_Cfail0_00
    s_branch L_Cgo0_00
    s_nop 0
L_Cfail1_00:
    s_sub_u32 s57, s57, 1
    s_cbranch_scc1 L_exit
    buffer_load_dwordx4 v[36:39], v1, s[36:39], s68 offen offset:1024 sc1
    buffer_load_dwordx4 v[40:43], v1, s[36:39], s68 offen offset:2048 sc1
    buffer_load_dwordx4 v[44:47], v1, s[36:39], s68 offen offset:3072 sc1
    s_waitcnt vmcnt(2)
    v_bitop3_b32 v28, v36, v38, 1 bitop3:0x80
    v_cmp_ne_u32 vcc, 1, v28
    s_cbranch_vccnz L_Cfail1_00
    s_branch L_Cgo1_00
    s_nop 0
L_Cfail2_00:
    s_sub_u32 s57, s57, 1
    s_cbranch_scc1 L_exit
    buffer_load_dwordx4 v[40:43], v1, s[36:39], s68 offen offset:2048 sc1
    buffer_load_dwordx4 v[44:47], v1, s[36:39], s68 offen offset:3072 sc1
    s_waitcnt vmcnt(1)
    v_bitop3_b32 v28, v40, v42, 1 bitop3:0x80
    v_cmp_ne_u32 vcc, 1, v28
    s_cbranch_vccnz L_Cfail2_00
    s_branch L_Cgo2_00
    s_nop 0
L_Cfail3_00:
    s_sub_u32 s57, s57, 1
    s_cbranch_scc1 L_exit
    buffer_load_dwordx4 v[44:47], v1, s[36:39], s68 offen offset:3072 sc1
    s_waitcnt vmcnt(0)
    v_bitop3_b32 v28, v44, v46, 1 bitop3:0x80
    v_cmp_ne_u32 vcc, 1, v28
    s_cbranch_vccnz L_Cfail3_00
    s_branch L_Cgo3_00
L_CfailV_00:
    s_sub_u32 s57, s57, 1
    s_cbranch_scc1 L_exit
    buffer_load_dwordx4 v[48:51], v5, s[36:39], s97 offen offset:0 sc1
    buffer_load_dwordx4 v[52:55], v5, s[36:39], s97 offen offset:512 sc1
    buffer_load_dwordx4 v[56:59], v5, s[36:39], s97 offen offset:1024 sc1
    buffer_load_dwordx4 v[60:63], v5, s[36:39], s97 offen offset:1536 sc1
    s_waitcnt vmcnt(0)
    v_bitop3_b32 v28, v48, v50, v52 bitop3:0x80
    v_bitop3_b32 v29, v54, v56, v58 bitop3:0x80
    v_bitop3_b32 v28, v28, v60, v62 bitop3:0x80
    v_bitop3_b32 v28, v28, v29, 1 bitop3:0x80
    v_cmp_ne_u32 vcc, 1, v28
    s_cbranch_vccnz L_CfailV_00
    s_branch L_CgoV_00
L_re_01:
    buffer_load_dword v28, v223, s[36:39], s76 offen sc1
    s_waitcnt vmcnt(0)
    v_min_u32_dpp v28, v28, v28 row_ror:4 row_mask:0xf bank_mask:0xf
    s_nop 1
    v_min_u32_dpp v28, v28, v28 row_ror:2 row_mask:0xf bank_mask:0xf
    s_nop 1
    v_min_u32_dpp v28, v28, v28 row_ror:1 row_mask:0xf bank_mask:0xf
    s_nop 0
    v_readfirstlane_b32 s75, v28
    s_cmp_gt_u32 s75, s58
    s_cbranch_scc0 L_reb_01
    s_mov_b32 s3, 0
    s_mov_b32 s3, 4
    s_branch L_reb_01
L_Afail_01:
    s_sub_u32 s57, s57, 1
    s_cbranch_scc1 L_exit
    s_branch L_A_01
L_Aslow_01:
    buffer_store_dwordx2 v[28:29], v3, s[36:39], s67 offen sc1
    s_branch L_Aback_01
    s_nop 0
L_Bfail0_01:
    s_sub_u32 s57, s57, 1
    s_cbranch_scc1 L_exit
    buffer_load_dwordx4 v[32:35], v1, s[36:39], s66 offen offset:0 sc1
    buffer_load_dwordx4 v[36:39], v1, s[36:39], s66 offen offset:1024 sc1
    buffer_load_dwordx4 v[40:43], v1, s[36:39], s66 offen offset:2048 sc1
    buffer_load_dwordx4 v[44:47], v1, s[36:39], s66 offen offset:3072 sc1
    v_mov_b32 v96, 0
    v_mov_b32 v97, 0
    v_mov_b32 v98, 0
    v_mov_b32 v99, 0
    v_mov_b32 v100, 0
    v_mov_b32 v101, 0
    v_mov_b32 v102, 0
    v_mov_b32 v103, 0
    s_branch L_B_01
L_Bfail1_01:
    s_sub_u32 s57, s57, 1
    s_cbranch_scc1 L_exit
    buffer_load_dwordx4 v[36:39], v1, s[36:39], s66 offen offset:1024 sc1
    buffer_load_dwordx4 v[40:43], v1, s[36:39], s66 offen offset:2048 sc1
    buffer_load_dwordx4 v[44:47], v1, s[36:39], s66 offen offset:3072 sc1
    s_waitcnt vmcnt(2)
    v_bitop3_b32 v28, v36, v38, 1 bitop3:0x80
    v_cmp_ne_u32 vcc, 1, v28
    s_cbranch_vccnz L_Bfail1_01
    s_branch L_Bgo1_01
    s_nop 0
    s_nop 0
L_Bfail2_01:
    s_sub_u32 s57, s57, 1
    s_cbranch_scc1 L_exit
    buffer_load_dwordx4 v[40:43], v1, s[36:39], s66 offen offset:2048 sc1
    buffer_load_dwordx4 v[44:47], v1, s[36:39], s66 offen offset:3072 sc1
    s_waitcnt vmcnt(0)
    v_bitop3_b32 v29, v40, v42, v44 bitop3:0x80
    v_bitop3_b32 v28, v29, v46, 1 bitop3:0x80
    v_cmp_ne_u32 vcc, 1, v28
    s_cbranch_vccnz L_Bfail2_01
    s_branch L_Bgo2_01
L_Bslow_01:
    buffer_store_dwordx2 v[10:11], v4, s[36:39], s69 offen sc1
    s_branch L_Bback_01
L_kv0_01:
    s_cmp_lg_u32 s3, 4
    s_cbranch_scc1 L_kv0f_01
    s_sub_u32 s71, s71, 0x80000
    s_sub_u32 s72, s72, 0x80000
    buffer_load_dwordx4 v[128:131], v1, s[36:39], s71 offen offset:0 sc1
    buffer_load_dwordx4 v[132:135], v1, s[36:39], s71 offen offset:1024 sc1
    buffer_load_dwordx4 v[136:139], v1, s[36:39], s71 offen offset:2048 sc1
    buffer_load_dwordx4 v[140:143], v1, s[36:39], s71 offen offset:3072 sc1
    buffer_load_dwordx4 v[144:147], v1, s[36:39], s72 offen offset:0 sc1
    buffer_load_dwordx4 v[148:151], v1, s[36:39], s72 offen offset:1024 sc1
    buffer_load_dwordx4 v[152:155], v1, s[36:39], s72 offen offset:2048 sc1
    buffer_load_dwordx4 v[156:159], v1, s[36:39], s72 offen offset:3072 sc1
    s_add_u32 s71, s71, 0x80000
    s_add_u32 s72, s72, 0x80000
    s_branch L_kv0b_01
L_kv0f_01:
    s_add_u32 s96, s58, 1
    s_cmp_lt_u32 s75, s96
    s_cbranch_scc1 L_prog_36
L_progok_37:
    s_sub_u32 s71, s71, 0x80000
    s_sub_u32 s72, s72, 0x80000
    s_sub_u32 s73, s73, 0x80000
    s_sub_u32 s74, s74, 0x80000
    buffer_load_dwordx4 v[128:131], v1, s[36:39], s71 offen offset:0 sc1
    buffer_load_dwordx4 v[132:135], v1, s[36:39], s71 offen offset:1024 sc1
    buffer_load_dwordx4 v[136:139], v1, s[36:39], s71 offen offset:2048 sc1
    buffer_load_dwordx4 v[140:143], v1, s[36:39], s71 offen offset:3072 sc1
    buffer_load_dwordx4 v[144:147], v1, s[36:39], s72 offen offset:0 sc1
    buffer_load_dwordx4 v[148:151], v1, s[36:39], s72 offen offset:1024 sc1
    buffer_load_dwordx4 v[152:155], v1, s[36:39], s72 offen offset:2048 sc1
    buffer_load_dwordx4 v[156:159], v1, s[36:39], s72 offen offset:3072 sc1
    s_add_u32 s71, s71, 0x80000
    s_add_u32 s72, s72, 0x80000
    buffer_load_dwordx4 v[160:163], v1, s[36:39], s73 offen offset:0 sc1
    buffer_load_dwordx4 v[164:167], v1, s[36:39], s73 offen offset:1024 sc1
    buffer_load_dwordx4 v[168:171], v1, s[36:39], s73 offen offset:2048 sc1
    buffer_load_dwordx4 v[172:175], v1, s[36:39], s73 offen offset:3072 sc1
    buffer_load_dwordx4 v[176:179], v1, s[36:39], s74 offen offset:0 sc1
    buffer_load_dwordx4 v[180:183], v1, s[36:39], s74 offen offset:1024 sc1
    buffer_load_dwordx4 v[184:187], v1, s[36:39], s74 offen offset:2048 sc1
    buffer_load_dwordx4 v[188:191], v1, s[36:39], s74 offen offset:3072 sc1
    s_add_u32 s73, s73, 0x80000
    s_add_u32 s74, s74, 0x80000
    s_branch L_kv0b_01
    s_nop 0
L_prog_36:
    buffer_load_dword v28, v223, s[36:39], s76 offen sc1
    s_waitcnt vmcnt(0)
    v_min_u32_dpp v28, v28, v28 row_ror:4 row_mask:0xf bank_mask:0xf
    s_nop 1
    v_min_u32_dpp v28, v28, v28 row_ror:2 row_mask:0xf bank_mask:0xf
    s_nop 1
    v_min_u32_dpp v28, v28, v28 row_ror:1 row_mask:0xf bank_mask:0xf
    s_nop 0
    v_readfirstlane_b32 s75, v28
    s_cmp_ge_u32 s75, s96
    s_cbranch_scc1 L_progok_37
    s_sub_u32 s57, s57, 1
    s_cbranch_scc1 L_exit
    s_branch L_prog_36
L_Cfail0_01:
    s_sub_u32 s57, s57, 1
    s_cbranch_scc1 L_exit
    buffer_load_dwordx4 v[32:35], v1, s[36:39], s68 offen offset:0 sc1
    buffer_load_dwordx4 v[36:39], v1, s[36:39], s68 offen offset:1024 sc1
    buffer_load_dwordx4 v[40:43], v1, s[36:39], s68 offen offset:2048 sc1
    buffer_load_dwordx4 v[44:47], v1, s[36:39], s68 offen offset:3072 sc1
    s_waitcnt vmcnt(3)
    v_bitop3_b32 v28, v32, v34, 1 bitop3:0xa8
    v_cmp_ne_u32 vcc, 0, v28
    s_cbranch_vccnz L_Cfail0_01
    s_branch L_Cgo0_01
L_Cfail1_01:
    s_sub_u32 s57, s57, 1
    s_cbranch_scc1 L_exit
    buffer_load_dwordx4 v[36:39], v1, s[36:39], s68 offen offset:1024 sc1
    buffer_load_dwordx4 v[40:43], v1, s[36:39], s68 offen offset:2048 sc1
    buffer_load_dwordx4 v[44:47], v1, s[36:39], s68 offen offset:3072 sc1
    s_waitcnt vmcnt(2)
    v_bitop3_b32 v28, v36, v38, 1 bitop3:0xa8
    v_cmp_ne_u32 vcc, 0, v28
    s_cbranch_vccnz L_Cfail1_01
    s_branch L_Cgo1_01
    s_nop 0
L_Cfail2_01:
    s_sub_u32 s57, s57, 1
    s_cbranch_scc1 L_exit
    buffer_load_dwordx4 v[40:43], v1, s[36:39], s68 offen offset:2048 sc1
    buffer_load_dwordx4 v[44:47], v1, s[36:39], s68 offen offset:3072 sc1
    s_waitcnt vmcnt(1)
    v_bitop3_b32 v28, v40, v42, 1 bitop3:0xa8
    v_cmp_ne_u32 vcc, 0, v28
    s_cbranch_vccnz L_Cfail2_01
    s_branch L_Cgo2_01
    s_nop 0
L_Cfail3_01:
    s_sub_u32 s57, s57, 1
    s_cbranch_scc1 L_exit
    buffer_load_dwordx4 v[44:47], v1, s[36:39], s68 offen offset:3072 sc1
    s_waitcnt vmcnt(0)
    v_bitop3_b32 v28, v44, v46, 1 bitop3:0xa8
    v_cmp_ne_u32 vcc, 0, v28
    s_cbranch_vccnz L_Cfail3_01
    s_branch L_Cgo3_01
L_CfailV_01:
    s_sub_u32 s57, s57, 1
    s_cbranch_scc1 L_exit
    buffer_load_dwordx4 v[48:51], v5, s[36:39], s97 offen offset:0 sc1
    buffer_load_dwordx4 v[52:55], v5, s[36:39], s97 offen offset:512 sc1
    buffer_load_dwordx4 v[56:59], v5, s[36:39], s97 offen offset:1024 sc1
    buffer_load_dwordx4 v[60:63], v5, s[36:39], s97 offen offset:1536 sc1
    s_waitcnt vmcnt(0)
    v_bitop3_b32 v28, v48, v50, v52 bitop3:0xfe
    v_bitop3_b32 v29, v54, v56, v58 bitop3:0xfe
    v_bitop3_b32 v28, v28, v60, v62 bitop3:0xfe
    v_bitop3_b32 v28, v28, v29, 1 bitop3:0xa8
    v_cmp_ne_u32 vcc, 0, v28
    s_cbranch_vccnz L_CfailV_01
    s_branch L_CgoV_01
    s_nop 0
    s_nop 0
L_re_10:
    buffer_load_dword v28, v223, s[36:39], s76 offen sc1
    s_waitcnt vmcnt(0)
    v_min_u32_dpp v28, v28, v28 row_ror:4 row_mask:0xf bank_mask:0xf
    s_nop 1
    v_min_u32_dpp v28, v28, v28 row_ror:2 row_mask:0xf bank_mask:0xf
    s_nop 1
    v_min_u32_dpp v28, v28, v28 row_ror:1 row_mask:0xf bank_mask:0xf
    s_nop 0
    v_readfirstlane_b32 s75, v28
    s_cmp_gt_u32 s75, s58
    s_cbranch_scc0 L_reb_10
    s_mov_b32 s3, 0
    s_sub_u32 s71, s71, 0x80000
    s_sub_u32 s72, s72, 0x80000
    buffer_load_dwordx4 v[128:131], v1, s[36:39], s71 offen offset:0 sc1
    buffer_load_dwordx4 v[132:135], v1, s[36:39], s71 offen offset:1024 sc1
    buffer_load_dwordx4 v[136:139], v1, s[36:39], s71 offen offset:2048 sc1
    buffer_load_dwordx4 v[140:143], v1, s[36:39], s71 offen offset:3072 sc1
    buffer_load_dwordx4 v[144:147], v1, s[36:39], s72 offen offset:0 sc1
    buffer_load_dwordx4 v[148:151], v1, s[36:39], s72 offen offset:1024 sc1
    buffer_load_dwordx4 v[152:155], v1, s[36:39], s72 offen offset:2048 sc1
    buffer_load_dwordx4 v[156:159], v1, s[36:39], s72 offen offset:3072 sc1
    s_add_u32 s71, s71, 0x80000
    s_add_u32 s72, s72, 0x80000
    s_branch L_reb_10
    s_nop 0
L_Bfail0_10:
    s_sub_u32 s57, s57, 1
    s_cbranch_scc1 L_exit
    buffer_load_dwordx4 v[32:35], v1, s[36:39], s66 offen offset:0 sc1
    buffer_load_dwordx4 v[36:39], v1, s[36:39], s66 offen offset:1024 sc1
    buffer_load_dwordx4 v[40:43], v1, s[36:39], s66 offen offset:2048 sc1
    buffer_load_dwordx4 v[44:47], v1, s[36:39], s66 offen offset:3072 sc1
    v_mov_b32 v96, 0
    v_mov_b32 v97, 0
    v_mov_b32 v98, 0
    v_mov_b32 v99, 0
    v_mov_b32 v100, 0
    v_mov_b32 v101, 0
    v_mov_b32 v102, 0
    v_mov_b32 v103, 0
    s_branch L_B_10
    s_nop 0
    s_nop 0
L_Bfail1_10:
    s_sub_u32 s57, s57, 1
    s_cbranch_scc1 L_exit
    buffer_load_dwordx4 v[36:39], v1, s[36:39], s66 offen offset:1024 sc1
    buffer_load_dwordx4 v[40:43], v1, s[36:39], s66 offen offset:2048 sc1
    buffer_load_dwordx4 v[44:47], v1, s[36:39], s66 offen offset:3072 sc1
    s_waitcnt vmcnt(2)
    v_bitop3_b32 v28, v36, v38, 1 bitop3:0xa8
    v_cmp_ne_u32 vcc, 0, v28
    s_cbranch_vccnz L_Bfail1_10
    s_branch L_Bgo1_10
    s_nop 0
    s_nop 0
L_Bfail2_10:
    s_sub_u32 s57, s57, 1
    s_cbranch_scc1 L_exit
    buffer_load_dwordx4 v[40:43], v1, s[36:39], s66 offen offset:2048 sc1
    buffer_load_dwordx4 v[44:47], v1, s[36:39], s66 offen offset:3072 sc1
    s_waitcnt vmcnt(0)
    v_bitop3_b32 v29, v40, v42, v44 bitop3:0xfe
    v_bitop3_b32 v28, v29, v46, 1 bitop3:0xa8
    v_cmp_ne_u32 vcc, 0, v28
    s_cbranch_vccnz L_Bfail2_10
    s_branch L_Bgo2_10
L_kv0_10:
    s_cmp_eq_u32 s3, 2
    s_cbranch_scc1 L_kv0p_10
    s_add_u32 s96, s58, 1
    s_cmp_lt_u32 s75, s96
    s_cbranch_scc1 L_prog_38
L_progok_39:
    s_sub_u32 s71, s71, 0x80000
    s_sub_u32 s72, s72, 0x80000
    s_sub_u32 s73, s73, 0x80000
    s_sub_u32 s74, s74, 0x80000
    buffer_load_dwordx4 v[128:131], v1, s[36:39], s71 offen offset:0 sc1
    buffer_load_dwordx4 v[132:135], v1, s[36:39], s71 offen offset:1024 sc1
    buffer_load_dwordx4 v[136:139], v1, s[36:39], s71 offen offset:2048 sc1
    buffer_load_dwordx4 v[140:143], v1, s[36:39], s71 offen offset:3072 sc1
    buffer_load_dwordx4 v[144:147], v1, s[36:39], s72 offen offset:0 sc1
    buffer_load_dwordx4 v[148:151], v1, s[36:39], s72 offen offset:1024 sc1
    buffer_load_dwordx4 v[152:155], v1, s[36:39], s72 offen offset:2048 sc1
    buffer_load_dwordx4 v[156:159], v1, s[36:39], s72 offen offset:3072 sc1
    s_add_u32 s71, s71, 0x80000
    s_add_u32 s72, s72, 0x80000
    buffer_load_dwordx4 v[160:163], v1, s[36:39], s73 offen offset:0 sc1
    buffer_load_dwordx4 v[164:167], v1, s[36:39], s73 offen offset:1024 sc1
    buffer_load_dwordx4 v[168:171], v1, s[36:39], s73 offen offset:2048 sc1
    buffer_load_dwordx4 v[172:175], v1, s[36:39], s73 offen offset:3072 sc1
    buffer_load_dwordx4 v[176:179], v1, s[36:39], s74 offen offset:0 sc1
    buffer_load_dwordx4 v[180:183], v1, s[36:39], s74 offen offset:1024 sc1
    buffer_load_dwordx4 v[184:187], v1, s[36:39], s74 offen offset:2048 sc1
    buffer_load_dwordx4 v[188:191], v1, s[36:39], s74 offen offset:3072 sc1
    s_add_u32 s73, s73, 0x80000
    s_add_u32 s74, s74, 0x80000
    s_cmp_lg_u32 s58, 0
    s_cbranch_scc1 L_kv0b_10
L_kv0p_10:
    s_mov_b32 s96, 16896
L_par_40:
    buffer_load_dword v29, off, s[36:39], s96 sc1
    s_waitcnt vmcnt(0)
    v_readfirstlane_b32 s78, v29
    s_cmp_lg_u32 s78, 0
    s_cbranch_scc1 L_par_40_ok
    s_sub_u32 s57, s57, 1
    s_cbranch_scc1 L_exit
    s_branch L_par_40
    s_nop 0
L_par_40_ok:
    s_and_b32 s78, s78, 8192
    s_add_u32 s61, s61, s78
    s_add_u32 s62, s62, s78
    s_branch L_kv0b_10
L_prog_38:
    buffer_load_dword v28, v223, s[36:39], s76 offen sc1
    s_waitcnt vmcnt(0)
    v_min_u32_dpp v28, v28, v28 row_ror:4 row_mask:0xf bank_mask:0xf
    s_nop 1
    v_min_u32_dpp v28, v28, v28 row_ror:2 row_mask:0xf bank_mask:0xf
    s_nop 1
    v_min_u32_dpp v28, v28, v28 row_ror:1 row_mask:0xf bank_mask:0xf
    s_nop 0
    v_readfirstlane_b32 s75, v28
    s_cmp_ge_u32 s75, s96
    s_cbranch_scc1 L_progok_39
    s_sub_u32 s57, s57, 1
    s_cbranch_scc1 L_exit
    s_branch L_prog_38
    s_nop 0
    s_nop 0
L_Bslow_10:
    buffer_store_dwordx2 v[10:11], v4, s[36:39], s69 offen sc1
    s_branch L_Bback_10
    s_nop 0
    s_nop 0
L_Cfail0_10:
    s_sub_u32 s57, s57, 1
    s_cbranch_scc1 L_exit
    buffer_load_dwordx4 v[32:35], v1, s[36:39], s68 offen offset:0 sc1
    buffer_load_dwordx4 v[36:39], v1, s[36:39], s68 offen offset:1024 sc1
    buffer_load_dwordx4 v[40:43], v1, s[36:39], s68 offen offset:2048 sc1
    buffer_load_dwordx4 v[44:47], v1, s[36:39], s68 offen offset:3072 sc1
    s_waitcnt vmcnt(0)
    v_bitop3_b32 v28, v32, v34, 1 bitop3:0x80
    v_cmp_ne_u32 vcc, 1, v28
    s_cbranch_vccnz L_Cfail0_10
    s_branch L_Cgo0_10
    s_nop 0
L_Cfail1_10:
    s_sub_u32 s57, s57, 1
    s_cbranch_scc1 L_exit
    buffer_load_dwordx4 v[36:39], v1, s[36:39], s68 offen offset:1024 sc1
    buffer_load_dwordx4 v[40:43], v1, s[36:39], s68 offen offset:2048 sc1
    buffer_load_dwordx4 v[44:47], v1, s[36:39], s68 offen offset:3072 sc1
    s_waitcnt vmcnt(0)
    v_bitop3_b32 v28, v36, v38, 1 bitop3:0x80
    v_cmp_ne_u32 vcc, 1, v28
    s_cbranch_vccnz L_Cfail1_10
    s_branch L_Cgo1_10
    s_nop 0
L_Cfail2_10:
    s_sub_u32 s57, s57, 1
    s_cbranch_scc1 L_exit
    buffer_load_dwordx4 v[40:43], v1, s[36:39], s68 offen offset:2048 sc1
    buffer_load_dwordx4 v[44:47], v1, s[36:39], s68 offen offset:3072 sc1
    s_waitcnt vmcnt(0)
    v_bitop3_b32 v28, v40, v42, 1 bitop3:0x80
    v_cmp_ne_u32 vcc, 1, v28
    s_cbranch_vccnz L_Cfail2_10
    s_branch L_Cgo2_10
    s_nop 0
    s_nop 0
L_Cfail3_10:
    s_sub_u32 s57, s57, 1
    s_cbranch_scc1 L_exit
    buffer_load_dwordx4 v[44:47], v1, s[36:39], s68 offen offset:3072 sc1
    s_waitcnt vmcnt(0)
    v_bitop3_b32 v28, v44, v46, 1 bitop3:0x80
    v_cmp_ne_u32 vcc, 1, v28
    s_cbranch_vccnz L_Cfail3_10
    s_branch L_Cgo3_10
    s_nop 0
    s_nop 0
L_CfailV_10:
    s_sub_u32 s57, s57, 1
    s_cbranch_scc1 L_exit
    buffer_load_dwordx4 v[48:51], v5, s[36:39], s97 offen offset:0 sc1
    buffer_load_dwordx4 v[52:55], v5, s[36:39], s97 offen offset:512 sc1
    buffer_load_dwordx4 v[56:59], v5, s[36:39], s97 offen offset:1024 sc1
    buffer_load_dwordx4 v[60:63], v5, s[36:39], s97 offen offset:1536 sc1
    s_waitcnt vmcnt(0)
    v_bitop3_b32 v28, v48, v50, v52 bitop3:0x80
    v_bitop3_b32 v29, v54, v56, v58 bitop3:0x80
    v_bitop3_b32 v28, v28, v60, v62 bitop3:0x80
    v_bitop3_b32 v28, v28, v29, 1 bitop3:0x80
    v_cmp_ne_u32 vcc, 1, v28
    s_cbranch_vccnz L_CfailV_10
    s_branch L_CgoV_10
    s_nop 0
    s_nop 0
L_re_11:
    buffer_load_dword v28, v223, s[36:39], s76 offen sc1
    s_waitcnt vmcnt(0)
    v_min_u32_dpp v28, v28, v28 row_ror:4 row_mask:0xf bank_mask:0xf
    s_nop 1
    v_min_u32_dpp v28, v28, v28 row_ror:2 row_mask:0xf bank_mask:0xf
    s_nop 1
    v_min_u32_dpp v28, v28, v28 row_ror:1 row_mask:0xf bank_mask:0xf
    s_nop 0
    v_readfirstlane_b32 s75, v28
    s_cmp_gt_u32 s75, s58
    s_cbranch_scc0 L_reb_11
    s_mov_b32 s3, 0
    s_sub_u32 s71, s71, 0x80000
    s_sub_u32 s72, s72, 0x80000
    buffer_load_dwordx4 v[128:131], v1, s[36:39], s71 offen offset:0 sc1
    buffer_load_dwordx4 v[132:135], v1, s[36:39], s71 offen offset:1024 sc1
    buffer_load_dwordx4 v[136:139], v1, s[36:39], s71 offen offset:2048 sc1
    buffer_load_dwordx4 v[140:143], v1, s[36:39], s71 offen offset:3072 sc1
    buffer_load_dwordx4 v[144:147], v1, s[36:39], s72 offen offset:0 sc1
    buffer_load_dwordx4 v[148:151], v1, s[36:39], s72 offen offset:1024 sc1
    buffer_load_dwordx4 v[152:155], v1, s[36:39], s72 offen offset:2048 sc1
    buffer_load_dwordx4 v[156:159], v1, s[36:39], s72 offen offset:3072 sc1
    s_add_u32 s71, s71, 0x80000
    s_add_u32 s72, s72, 0x80000
    s_branch L_reb_11
L_f62:
    v_mov_b32 v31, 63
    buffer_store_dword v31, v209, s[36:39], s77 offen sc1
    s_branch L_f62b
    s_nop 0
L_Bfail0_11:
    s_sub_u32 s57, s57, 1
    s_cbranch_scc1 L_exit
    buffer_load_dwordx4 v[32:35], v1, s[36:39], s66 offen offset:0 sc1
    buffer_load_dwordx4 v[36:39], v1, s[36:39], s66 offen offset:1024 sc1
    buffer_load_dwordx4 v[40:43], v1, s[36:39], s66 offen offset:2048 sc1
    buffer_load_dwordx4 v[44:47], v1, s[36:39], s66 offen offset:3072 sc1
    v_mov_b32 v96, 0
    v_mov_b32 v97, 0
    v_mov_b32 v98, 0
    v_mov_b32 v99, 0
    v_mov_b32 v100, 0
    v_mov_b32 v101, 0
    v_mov_b32 v102, 0
    v_mov_b32 v103, 0
    s_branch L_B_11
    s_nop 0
L_Bfail1_11:
    s_sub_u32 s57, s57, 1
    s_cbranch_scc1 L_exit
    buffer_load_dwordx4 v[36:39], v1, s[36:39], s66 offen offset:1024 sc1
    buffer_load_dwordx4 v[40:43], v1, s[36:39], s66 offen offset:2048 sc1
    buffer_load_dwordx4 v[44:47], v1, s[36:39], s66 offen offset:3072 sc1
    s_waitcnt vmcnt(2)
    v_bitop3_b32 v28, v36, v38, 1 bitop3:0x80
    v_cmp_ne_u32 vcc, 1, v28
    s_cbranch_vccnz L_Bfail1_11
    s_branch L_Bgo1_11
    s_nop 0
L_Bfail2_11:
    s_sub_u32 s57, s57, 1
    s_cbranch_scc1 L_exit
    buffer_load_dwordx4 v[40:43], v1, s[36:39], s66 offen offset:2048 sc1
    buffer_load_dwordx4 v[44:47], v1, s[36:39], s66 offen offset:3072 sc1
    s_waitcnt vmcnt(0)
    v_bitop3_b32 v29, v40, v42, v44 bitop3:0x80
    v_bitop3_b32 v28, v29, v46, 1 bitop3:0x80
    v_cmp_ne_u32 vcc, 1, v28
    s_cbranch_vccnz L_Bfail2_11
    s_branch L_Bgo2_11
L_kv0_11:
    s_add_u32 s96, s58, 1
    s_cmp_lt_u32 s75, s96
    s_cbranch_scc1 L_prog_41
L_progok_42:
    s_sub_u32 s71, s71, 0x80000
    s_sub_u32 s72, s72, 0x80000
    s_sub_u32 s73, s73, 0x80000
    s_sub_u32 s74, s74, 0x80000
    buffer_load_dwordx4 v[128:131], v1, s[36:39], s71 offen offset:0 sc1
    buffer_load_dwordx4 v[132:135], v1, s[36:39], s71 offen offset:1024 sc1
    buffer_load_dwordx4 v[136:139], v1, s[36:39], s71 offen offset:2048 sc1
    buffer_load_dwordx4 v[140:143], v1, s[36:39], s71 offen offset:3072 sc1
    buffer_load_dwordx4 v[144:147], v1, s[36:39], s72 offen offset:0 sc1
    buffer_load_dwordx4 v[148:151], v1, s[36:39], s72 offen offset:1024 sc1
    buffer_load_dwordx4 v[152:155], v1, s[36:39], s72 offen offset:2048 sc1
    buffer_load_dwordx4 v[156:159], v1, s[36:39], s72 offen offset:3072 sc1
    s_add_u32 s71, s71, 0x80000
    s_add_u32 s72, s72, 0x80000
    buffer_load_dwordx4 v[160:163], v1, s[36:39], s73 offen offset:0 sc1
    buffer_load_dwordx4 v[164:167], v1, s[36:39], s73 offen offset:1024 sc1
    buffer_load_dwordx4 v[168:171], v1, s[36:39], s73 offen offset:2048 sc1
    buffer_load_dwordx4 v[172:175], v1, s[36:39], s73 offen offset:3072 sc1
    buffer_load_dwordx4 v[176:179], v1, s[36:39], s74 offen offset:0 sc1
    buffer_load_dwordx4 v[180:183], v1, s[36:39], s74 offen offset:1024 sc1
    buffer_load_dwordx4 v[184:187], v1, s[36:39], s74 offen offset:2048 sc1
    buffer_load_dwordx4 v[188:191], v1, s[36:39], s74 offen offset:3072 sc1
    s_add_u32 s73, s73, 0x80000
    s_add_u32 s74, s74, 0x80000
    s_branch L_kv0b_11
L_prog_41:
    buffer_load_dword v28, v223, s[36:39], s76 offen sc1
    s_waitcnt vmcnt(0)
    v_min_u32_dpp v28, v28, v28 row_ror:4 row_mask:0xf bank_mask:0xf
    s_nop 1
    v_min_u32_dpp v28, v28, v28 row_ror:2 row_mask:0xf bank_mask:0xf
    s_nop 1
    v_min_u32_dpp v28, v28, v28 row_ror:1 row_mask:0xf bank_mask:0xf
    s_nop 0
    v_readfirstlane_b32 s75, v28
    s_cmp_ge_u32 s75, s96
    s_cbranch_scc1 L_progok_42
    s_sub_u32 s57, s57, 1
    s_cbranch_scc1 L_exit
    s_branch L_prog_41
L_Bslow_11:
    buffer_store_dwordx2 v[10:11], v4, s[36:39], s69 offen sc1
    s_branch L_Bback_11
L_Cfail0_11:
    s_sub_u32 s57, s57, 1
    s_cbranch_scc1 L_exit
    buffer_load_dwordx4 v[32:35], v1, s[36:39], s68 offen offset:0 sc1
    buffer_load_dwordx4 v[36:39], v1, s[36:39], s68 offen offset:1024 sc1
    buffer_load_dwordx4 v[40:43], v1, s[36:39], s68 offen offset:2048 sc1
    buffer_load_dwordx4 v[44:47], v1, s[36:39], s68 offen offset:3072 sc1
    s_waitcnt vmcnt(0)
    v_bitop3_b32 v28, v32, v34, 1 bitop3:0xa8
    v_cmp_ne_u32 vcc, 0, v28
    s_cbranch_vccnz L_Cfail0_11
    s_branch L_Cgo0_11
L_Cfail1_11:
    s_sub_u32 s57, s57, 1
    s_cbranch_scc1 L_exit
    buffer_load_dwordx4 v[36:39], v1, s[36:39], s68 offen offset:1024 sc1
    buffer_load_dwordx4 v[40:43], v1, s[36:39], s68 offen offset:2048 sc1
    buffer_load_dwordx4 v[44:47], v1, s[36:39], s68 offen offset:3072 sc1
    s_waitcnt vmcnt(0)
    v_bitop3_b32 v28, v36, v38, 1 bitop3:0xa8
    v_cmp_ne_u32 vcc, 0, v28
    s_cbranch_vccnz L_Cfail1_11
    s_branch L_Cgo1_11
L_Cfail2_11:
    s_sub_u32 s57, s57, 1
    s_cbranch_scc1 L_exit
    buffer_load_dwordx4 v[40:43], v1, s[36:39], s68 offen offset:2048 sc1
    buffer_load_dwordx4 v[44:47], v1, s[36:39], s68 offen offset:3072 sc1
    s_waitcnt vmcnt(0)
    v_bitop3_b32 v28, v40, v42, 1 bitop3:0xa8
    v_cmp_ne_u32 vcc, 0, v28
    s_cbranch_vccnz L_Cfail2_11
    s_branch L_Cgo2_11
    s_nop 0
L_Cfail3_11:
    s_sub_u32 s57, s57, 1
    s_cbranch_scc1 L_exit
    buffer_load_dwordx4 v[44:47], v1, s[36:39], s68 offen offset:3072 sc1
    s_waitcnt vmcnt(0)
    v_bitop3_b32 v28, v44, v46, 1 bitop3:0xa8
    v_cmp_ne_u32 vcc, 0, v28
    s_cbranch_vccnz L_Cfail3_11
    s_branch L_Cgo3_11
L_CfailV_11:
    s_sub_u32 s57, s57, 1
    s_cbranch_scc1 L_exit
    buffer_load_dwordx4 v[48:51], v5, s[36:39], s97 offen offset:0 sc1
    buffer_load_dwordx4 v[52:55], v5, s[36:39], s97 offen offset:512 sc1
    buffer_load_dwordx4 v[56:59], v5, s[36:39], s97 offen offset:1024 sc1
    buffer_load_dwordx4 v[60:63], v5, s[36:39], s97 offen offset:1536 sc1
    s_waitcnt vmcnt(0)
    v_bitop3_b32 v28, v48, v50, v52 bitop3:0xfe
    v_bitop3_b32 v29, v54, v56, v58 bitop3:0xfe
    v_bitop3_b32 v28, v28, v60, v62 bitop3:0xfe
    v_bitop3_b32 v28, v28, v29, 1 bitop3:0xa8
    v_cmp_ne_u32 vcc, 0, v28
    s_cbranch_vccnz L_CfailV_11
    s_branch L_CgoV_11
L_chain_fin:
    s_add_u32 s96, s69, 14548992
    buffer_store_dwordx2 v[10:11], v4, s[36:39], s96 offen sc1
    s_lshl_b32 s96, s59, 4
    s_add_u32 s96, s96, s60
    s_lshl_b32 s96, s96, 7
    s_lshl_b32 s97, s19, 2
    s_add_u32 s96, s96, s97
    s_add_u32 s96, s96, 49152
    s_cmp_lt_u32 s19, 3
    s_cselect_b32 s96, s96, 0x40000000
    v_mov_b32 v31, 63
    v_mov_b32 v30, 64
    s_waitcnt vmcnt(0)
    buffer_store_dword v30, v199, s[36:39], s96 offen sc1
    s_branch L_exit
L_exit:
    s_endpgm
.section .rodata,"a"
.p2align 6
.amdhsa_kernel gated_mix__memory_aug_recurrent_mem_tr__moe_arch_mod__prompt_kernel
  .amdhsa_next_free_vgpr 512
  .amdhsa_next_free_sgpr 102
  .amdhsa_accum_offset 256
  .amdhsa_group_segment_fixed_size 0
  .amdhsa_kernarg_size 128
  .amdhsa_user_sgpr_count 2
  .amdhsa_user_sgpr_kernarg_segment_ptr 1
  .amdhsa_system_sgpr_workgroup_id_x 1
  .amdhsa_float_denorm_mode_32 3
.end_amdhsa_kernel
```
